```python
import torch

def _softmax(x, axis=-1):
    return torch.softmax(x, dim=axis)
def _gelu(x):
    return torch.nn.functional.gelu(x, approximate="tanh")
def _silu(x):
    return torch.nn.functional.silu(x)
def _sigmoid(x):
    return torch.sigmoid(x)
def _layernorm(x, axis=-1, eps=1e-5):
    m = x.mean(dim=axis, keepdim=True)
    v = x.var(dim=axis, keepdim=True, unbiased=False)
    return (x - m) / torch.sqrt(v + eps)
def _scatter_add(tgt, idx, src, axis=0):
    return tgt.clone().index_add_(axis, idx, src)
def _segment_sum(src, seg, n):
    out = torch.zeros((n,) + src.shape[1:], dtype=src.dtype)
    return out.index_add_(0, seg, src)
def _pad(x, pw):
    flat = tuple(v for pair in reversed(pw) for v in pair)
    return torch.nn.functional.pad(x, flat)

kernel_name = 'standalone__gqa_softmax__near_ridge'

def setup_inputs():

    _w = (lambda a: (lambda t: t.to(torch.bfloat16) if t.is_floating_point() else t)(torch.as_tensor(a)))
    B, Hq, Hkv, Sq, Sk, D = 8, 32, 8, 128, 2048, 128
    return {
        "q": _w((lambda *s: torch.randn(*s, dtype=torch.bfloat16) * 0.8)(B, Hq, Sq, D)),
        "k": _w((lambda *s: torch.randn(*s, dtype=torch.bfloat16) * 0.8)(B, Hkv, Sk, D)),
        "v": _w((lambda *s: torch.randn(*s, dtype=torch.bfloat16) * 0.05)(B, Hkv, Sk, D)),
    }

def reference(q, k, v):
    B, Hq, Sq, D = q.shape
    Hkv = k.shape[1]
    rep = Hq // Hkv
    k = (lambda x, n, axis: torch.repeat_interleave(x, n, dim=axis))(k, rep, axis=1)
    v = (lambda x, n, axis: torch.repeat_interleave(x, n, dim=axis))(v, rep, axis=1)
    scale = D ** -0.5
    scores = torch.einsum("bhqd,bhkd->bhqk", q, k) * scale
    p = _softmax(scores, axis=-1)
    return torch.einsum("bhqk,bhkd->bhqd", p, v)
```

```asm
; @launch grid=(256,1,1) block=(256,1,1) lds=163840
.amdgcn_target "amdgcn-amd-amdhsa--gfx950"
.text
.globl standalone__gqa_softmax__near_ridge_kernel
.p2align 8
.type standalone__gqa_softmax__near_ridge_kernel,@function
standalone__gqa_softmax__near_ridge_kernel:
    s_cmp_ge_u32 s2, 256
    s_cbranch_scc1 L_exit
    s_load_dwordx4 s[4:7], s[0:1], 0
    s_load_dwordx4 s[8:11], s[0:1], 16
    v_lshrrev_b32 v1, 6, v0
    v_and_b32 v0, 63, v0
    s_getpc_b64 s[52:53]
L_pc:
    s_add_u32 s52, s52, L_main-L_pc
    s_addc_u32 s53, s53, 0
    s_lshr_b32 s54, s2, 3
    s_mul_i32 s54, s54, 12
    v_min_u32 v208, 2, v0
    v_mad_u32_u24 v208, v1, 3, v208
    v_add_u32 v208, s54, v208
    v_min_u32 v208, 299, v208
    v_lshlrev_b32 v208, 7, v208
    v_mov_b32 v209, s53
    v_add_co_u32 v208, vcc, s52, v208
    v_readfirstlane_b32 s28, v1
    s_nop 0
    v_addc_co_u32 v209, vcc, 0, v209, vcc
    global_load_dword v210, v[208:209], off
L_restart:
    s_and_b32 s44, s2, 7
    s_lshr_b32 s45, s2, 3
    s_lshl_b32 s44, s44, 3
    s_lshr_b32 s46, s45, 2
    s_add_u32 s44, s44, s46
    s_and_b32 s43, s45, 3
    s_lshl_b32 s46, s44, 2
    s_add_u32 s45, s43, s46
    s_and_b32 s68, s44, 1
    s_lshl_b32 s68, s68, 7
    s_and_b32 s46, s44, 15
    s_lshl_b32 s64, s46, 15
    s_xor_b32 s65, s64, 0x2000
    s_add_u32 s66, s64, s68
    s_xor_b32 s67, s66, 0x80
    s_lshl_b32 s44, s44, 19
    s_lshl_b32 s45, s45, 15
    s_and_b32 s29, s28, 1
    s_lshr_b32 s30, s28, 1
    s_lshl_b32 s31, s28, 12
    v_and_b32 v1, 15, v0
    v_lshrrev_b32 v2, 4, v0
    s_lshl_b32 s46, s30, 14
    s_lshl_b32 s47, s29, 12
    s_add_u32 s46, s46, s47
    v_lshlrev_b32 v246, 1, v2
    v_xor_b32 v246, v246, v1
    v_lshlrev_b32 v246, 4, v246
    v_lshl_add_u32 v246, v2, 8, v246
    v_add_u32 v228, s46, v246
    v_xor_b32 v229, 0x80, v228
    s_lshl_b32 s48, s29, 1
    s_add_u32 s48, s48, s30
    s_lshl_b32 s48, s48, 13
    s_add_u32 s49, s48, s45
    s_add_u32 s49, s49, 4096
    s_mul_i32 s55, s29, 49152
    s_add_u32 s55, s55, 0x18000
    s_lshl_b32 s46, s30, 13
    s_add_u32 s50, s55, s46
    v_lshlrev_b32 v247, 4, v0
    v_add_u32 v248, s50, v246
    v_xor_b32 v249, 0x80, v248
    s_lshl_b32 s51, s28, 13
    v_and_b32 v250, 7, v0
    v_xor_b32 v250, v250, v2
    v_lshlrev_b32 v250, 4, v250
    v_lshrrev_b32 v251, 3, v0
    v_lshl_add_u32 v250, v251, 8, v250
    v_add_u32 v224, s51, v250
    v_add_u32 v225, 0x400, v224
    v_add_u32 v226, 0x800, v224
    v_add_u32 v227, 0xc00, v224
    v_and_b32 v250, 7, v1
    v_lshlrev_b32 v250, 1, v250
    v_xor_b32 v250, v250, v2
    v_lshlrev_b32 v250, 4, v250
    v_lshl_add_u32 v250, v1, 8, v250
    v_add_u32 v212, s46, v250
    v_xor_b32 v213, 0x40, v212
    v_xor_b32 v214, 0x80, v212
    v_xor_b32 v215, 0xc0, v212
    v_add_u32 v180, s55, v212
    v_add_u32 v181, s55, v213
    v_add_u32 v182, s55, v214
    v_add_u32 v183, s55, v215
    v_xor_b32 v184, 0x2000, v180
    v_xor_b32 v185, 0x2000, v181
    v_xor_b32 v186, 0x2000, v182
    v_xor_b32 v187, 0x2000, v183
    s_mul_i32 s46, s30, 49152
    s_add_u32 s46, s46, 0x10000
    s_add_u32 s33, s46, s47
    v_lshrrev_b32 v252, 1, v0
    v_bfe_u32 v253, v0, 3, 2
    v_and_b32 v251, 1, v0
    v_lshlrev_b32 v250, 6, v252
    v_lshl_add_u32 v250, v253, 4, v250
    v_lshl_add_u32 v250, v251, 3, v250
    v_add_u32 v220, s46, v250
    v_xor_b32 v221, 0x10, v220
    v_xor_b32 v222, 0x20, v220
    v_xor_b32 v223, 0x30, v220
    v_and_b32 v251, 3, v0
    s_waitcnt lgkmcnt(0)
    s_add_u32 s12, s6, s44
    s_addc_u32 s13, s7, 0
    s_add_u32 m0, s31, 0x0
    s_add_u32 s32, s64, 0x0
    s_and_b32 s32, s32, 0x7ffff
    s_add_u32 s72, s12, s32
    s_addc_u32 s73, s13, 0
    global_load_lds_dwordx4 v228, s[72:73] nt
    global_load_lds_dwordx4 v229, s[72:73] offset:1024 nt
    global_load_lds_dwordx4 v228, s[72:73] offset:2048 nt
    global_load_lds_dwordx4 v229, s[72:73] offset:3072 nt
    s_add_u32 s16, s4, s49
    s_addc_u32 s17, s5, 0
    global_load_dwordx4 v[148:151], v247, s[16:17] offset:-4096 nt
    global_load_dwordx4 v[152:155], v247, s[16:17] offset:-3072 nt
    global_load_dwordx4 v[156:159], v247, s[16:17] offset:-2048 nt
    global_load_dwordx4 v[160:163], v247, s[16:17] offset:-1024 nt
    s_add_u32 m0, s31, 0x4000
    s_add_u32 s32, s65, 0x0
    s_and_b32 s32, s32, 0x7ffff
    s_add_u32 s74, s12, s32
    s_addc_u32 s75, s13, 0
    global_load_lds_dwordx4 v228, s[74:75] nt
    global_load_lds_dwordx4 v229, s[74:75] offset:1024 nt
    global_load_lds_dwordx4 v228, s[74:75] offset:2048 nt
    global_load_lds_dwordx4 v229, s[74:75] offset:3072 nt
    s_add_u32 s14, s8, s44
    s_addc_u32 s15, s9, 0
    s_waitcnt vmcnt(12)
    s_mov_b64 exec, 0
    s_cmp_eq_u32 s28, 0
    s_cbranch_scc1 L_stub0
    s_cmp_eq_u32 s28, 1
    s_cbranch_scc1 L_stub1
    s_cmp_eq_u32 s28, 2
    s_cbranch_scc1 L_stub2
    s_branch L_stub3
L_back:
    s_mov_b64 exec, -1
    v_cmp_gt_u32 vcc, 2, v251
    v_mov_b32 v250, 0x3f803f80
    s_mov_b32 s40, 0x3e0293ee
    v_cndmask_b32 v250, 0, v250, vcc
    v_cmp_eq_u32 vcc, 1, v251
    v_mov_b32 v251, 0x44444444
    v_mov_b32 v252, 0xeeeeeeee
    s_mov_b32 s41, 0x3e0293ee
    v_cndmask_b32 v236, v251, v252, vcc
    s_mov_b32 s42, 0xffff0000
    v_accvgpr_write_b32 a144, v250
    v_accvgpr_write_b32 a145, v250
    v_accvgpr_write_b32 a146, v250
    v_accvgpr_write_b32 a147, v250
    v_accvgpr_write_b32 a128, 0
    v_accvgpr_write_b32 a129, 0
    v_accvgpr_write_b32 a130, 0
    v_accvgpr_write_b32 a131, 0
    v_accvgpr_write_b32 a132, 0
    v_accvgpr_write_b32 a133, 0
    v_accvgpr_write_b32 a134, 0
    v_accvgpr_write_b32 a135, 0
    v_accvgpr_write_b32 a136, 0
    v_accvgpr_write_b32 a137, 0
    v_accvgpr_write_b32 a138, 0
    v_accvgpr_write_b32 a139, 0
    v_accvgpr_write_b32 a140, 0
    v_accvgpr_write_b32 a141, 0
    v_accvgpr_write_b32 a142, 0
    v_accvgpr_write_b32 a143, 0
    s_add_u32 s84, s33, 0x6000
    s_lshl_b32 s85, s28, 11
    s_lshl_b32 s86, s28, 10
    s_add_u32 s86, s86, 0x14000
    s_lshl_b32 s87, s28, 2
    s_add_u32 s87, s87, 0x15000
    s_lshl_b32 s47, s29, 14
    global_load_dwordx4 v[164:167], v247, s[16:17] nt
    global_load_dwordx4 v[168:171], v247, s[16:17] offset:1024 nt
    global_load_dwordx4 v[172:175], v247, s[16:17] offset:2048 nt
    global_load_dwordx4 v[176:179], v247, s[16:17] offset:3072 nt
    s_waitcnt vmcnt(11)
    v_lshlrev_b32 v188, 16, v148
    v_and_b32 v189, s42, v148
    v_lshlrev_b32 v190, 16, v149
    v_and_b32 v191, s42, v149
    v_pk_mul_f32 v[188:189], v[188:189], s[40:41]
    v_pk_mul_f32 v[190:191], v[190:191], s[40:41]
    v_cvt_pk_bf16_f32 v148, v188, v189
    v_cvt_pk_bf16_f32 v149, v190, v191
    v_lshlrev_b32 v188, 16, v150
    v_and_b32 v189, s42, v150
    v_lshlrev_b32 v190, 16, v151
    v_and_b32 v191, s42, v151
    v_pk_mul_f32 v[188:189], v[188:189], s[40:41]
    v_pk_mul_f32 v[190:191], v[190:191], s[40:41]
    v_cvt_pk_bf16_f32 v150, v188, v189
    v_cvt_pk_bf16_f32 v151, v190, v191
    ds_write_b128 v248, v[148:151]
    s_add_u32 m0, s31, 0x8000
    s_add_u32 s32, s64, 0x8000
    s_and_b32 s32, s32, 0x7ffff
    s_add_u32 s72, s12, s32
    s_addc_u32 s73, s13, 0
    global_load_lds_dwordx4 v228, s[72:73] nt
    s_waitcnt vmcnt(11)
    v_lshlrev_b32 v188, 16, v152
    v_and_b32 v189, s42, v152
    v_lshlrev_b32 v190, 16, v153
    v_and_b32 v191, s42, v153
    v_pk_mul_f32 v[188:189], v[188:189], s[40:41]
    v_pk_mul_f32 v[190:191], v[190:191], s[40:41]
    v_cvt_pk_bf16_f32 v152, v188, v189
    v_cvt_pk_bf16_f32 v153, v190, v191
    v_lshlrev_b32 v188, 16, v154
    v_and_b32 v189, s42, v154
    v_lshlrev_b32 v190, 16, v155
    v_and_b32 v191, s42, v155
    v_pk_mul_f32 v[188:189], v[188:189], s[40:41]
    v_pk_mul_f32 v[190:191], v[190:191], s[40:41]
    v_cvt_pk_bf16_f32 v154, v188, v189
    v_cvt_pk_bf16_f32 v155, v190, v191
    ds_write_b128 v249, v[152:155] offset:1024
    global_load_lds_dwordx4 v229, s[72:73] offset:1024 nt
    s_waitcnt vmcnt(11)
    v_lshlrev_b32 v188, 16, v156
    v_and_b32 v189, s42, v156
    v_lshlrev_b32 v190, 16, v157
    v_and_b32 v191, s42, v157
    v_pk_mul_f32 v[188:189], v[188:189], s[40:41]
    v_pk_mul_f32 v[190:191], v[190:191], s[40:41]
    v_cvt_pk_bf16_f32 v156, v188, v189
    v_cvt_pk_bf16_f32 v157, v190, v191
    v_lshlrev_b32 v188, 16, v158
    v_and_b32 v189, s42, v158
    v_lshlrev_b32 v190, 16, v159
    v_and_b32 v191, s42, v159
    v_pk_mul_f32 v[188:189], v[188:189], s[40:41]
    v_pk_mul_f32 v[190:191], v[190:191], s[40:41]
    v_cvt_pk_bf16_f32 v158, v188, v189
    v_cvt_pk_bf16_f32 v159, v190, v191
    ds_write_b128 v248, v[156:159] offset:2048
    global_load_lds_dwordx4 v228, s[72:73] offset:2048 nt
    s_waitcnt vmcnt(11)
    v_lshlrev_b32 v188, 16, v160
    v_and_b32 v189, s42, v160
    v_lshlrev_b32 v190, 16, v161
    v_and_b32 v191, s42, v161
    v_pk_mul_f32 v[188:189], v[188:189], s[40:41]
    v_pk_mul_f32 v[190:191], v[190:191], s[40:41]
    v_cvt_pk_bf16_f32 v160, v188, v189
    v_cvt_pk_bf16_f32 v161, v190, v191
    v_lshlrev_b32 v188, 16, v162
    v_and_b32 v189, s42, v162
    v_lshlrev_b32 v190, 16, v163
    v_and_b32 v191, s42, v163
    v_pk_mul_f32 v[188:189], v[188:189], s[40:41]
    v_pk_mul_f32 v[190:191], v[190:191], s[40:41]
    v_cvt_pk_bf16_f32 v162, v188, v189
    v_cvt_pk_bf16_f32 v163, v190, v191
    ds_write_b128 v249, v[160:163] offset:3072
    global_load_lds_dwordx4 v229, s[72:73] offset:3072 nt
    s_waitcnt vmcnt(8) lgkmcnt(0)
    s_barrier
    ds_read_b128 a[64:67], v212
    ds_read_b128 a[148:151], v180
    ds_read_b128 a[68:71], v213
    ds_read_b128 a[152:155], v181
    ds_read_b128 a[72:75], v214
    ds_read_b128 a[156:159], v182
    ds_read_b128 a[76:79], v215
    ds_read_b128 a[160:163], v183
    ds_read_b128 a[180:183], v184
    ds_read_b128 a[184:187], v185
    ds_read_b128 a[188:191], v186
    ds_read_b128 a[192:195], v187
    s_branch L_main
L_slow:
    s_waitcnt vmcnt(0) lgkmcnt(0)
    s_mov_b32 s44, 0
    v_lshlrev_b32 v148, 8, v1
    v_lshl_add_u32 v148, v2, 4, v148
    v_mov_b32 v232, 0xff800000
    v_mov_b32 v233, 0xff800000
    v_mov_b32 v234, 0xff800000
    v_mov_b32 v235, 0xff800000
L_slow_loop:
    global_load_dwordx4 v[152:155], v148, s[12:13]
    global_load_dwordx4 v[156:159], v148, s[12:13] offset:64
    global_load_dwordx4 v[160:163], v148, s[12:13] offset:128
    global_load_dwordx4 v[164:167], v148, s[12:13] offset:192
    s_waitcnt vmcnt(0)
    v_mfma_f32_16x16x32_bf16 v[180:183], v[152:155], a[148:151], 0
    v_mfma_f32_16x16x32_bf16 v[180:183], v[156:159], a[152:155], v[180:183]
    v_mfma_f32_16x16x32_bf16 v[180:183], v[160:163], a[156:159], v[180:183]
    v_mfma_f32_16x16x32_bf16 v[180:183], v[164:167], a[160:163], v[180:183]
    v_mfma_f32_16x16x32_bf16 v[184:187], v[152:155], a[164:167], 0
    v_mfma_f32_16x16x32_bf16 v[184:187], v[156:159], a[168:171], v[184:187]
    v_mfma_f32_16x16x32_bf16 v[184:187], v[160:163], a[172:175], v[184:187]
    v_mfma_f32_16x16x32_bf16 v[184:187], v[164:167], a[176:179], v[184:187]
    v_mfma_f32_16x16x32_bf16 v[188:191], v[152:155], a[180:183], 0
    v_mfma_f32_16x16x32_bf16 v[188:191], v[156:159], a[184:187], v[188:191]
    v_mfma_f32_16x16x32_bf16 v[188:191], v[160:163], a[188:191], v[188:191]
    v_mfma_f32_16x16x32_bf16 v[188:191], v[164:167], a[192:195], v[188:191]
    v_mfma_f32_16x16x32_bf16 v[192:195], v[152:155], a[196:199], 0
    v_mfma_f32_16x16x32_bf16 v[192:195], v[156:159], a[200:203], v[192:195]
    v_mfma_f32_16x16x32_bf16 v[192:195], v[160:163], a[204:207], v[192:195]
    v_mfma_f32_16x16x32_bf16 v[192:195], v[164:167], a[208:211], v[192:195]
    s_nop 7
    v_max3_f32 v232, v232, v180, v181
    v_max3_f32 v232, v232, v182, v183
    v_max3_f32 v233, v233, v184, v185
    v_max3_f32 v233, v233, v186, v187
    v_max3_f32 v234, v234, v188, v189
    v_max3_f32 v234, v234, v190, v191
    v_max3_f32 v235, v235, v192, v193
    v_max3_f32 v235, v235, v194, v195
    v_add_u32 v148, 4096, v148
    s_add_u32 s44, s44, 4096
    s_cmp_lt_u32 s44, 0x80000
    s_cbranch_scc1 L_slow_loop
    v_mov_b32 v148, v232
    v_mov_b32 v149, v233
    v_mov_b32 v150, v234
    v_mov_b32 v151, v235
    s_nop 1
    v_permlane16_swap_b32 v232, v148
    v_permlane16_swap_b32 v233, v149
    v_permlane16_swap_b32 v234, v150
    v_permlane16_swap_b32 v235, v151
    v_max_f32 v232, v232, v148
    v_max_f32 v233, v233, v149
    v_max_f32 v234, v234, v150
    v_max_f32 v235, v235, v151
    v_mov_b32 v148, v232
    v_mov_b32 v149, v233
    v_mov_b32 v150, v234
    v_mov_b32 v151, v235
    s_nop 1
    v_permlane32_swap_b32 v232, v148
    v_permlane32_swap_b32 v233, v149
    v_permlane32_swap_b32 v234, v150
    v_permlane32_swap_b32 v235, v151
    v_max_f32 v232, v232, v148
    v_max_f32 v233, v233, v149
    v_max_f32 v234, v234, v150
    v_max_f32 v235, v235, v151
    s_barrier
    s_branch M_restart
.p2align 12
L_main:
L_stub0:
    s_cbranch_execz L_stub4
    s_waitcnt lgkmcnt(4)
    v_mfma_f32_16x16x32_bf16 v[84:87], a[64:67], a[148:151], -4.0
    ds_read_b128 a[80:83], v212 offset:4096
    s_add_u32 m0, s31, 0xc000
    v_mfma_f32_16x16x32_bf16 v[84:87], a[68:71], a[152:155], v[84:87]
    ds_read_b128 a[84:87], v213 offset:4096
    s_add_u32 s32, s65, 0x8000
    v_mfma_f32_16x16x32_bf16 v[84:87], a[72:75], a[156:159], v[84:87]
    ds_read_b128 a[88:91], v214 offset:4096
    s_and_b32 s32, s32, 0x7ffff
    v_mfma_f32_16x16x32_bf16 v[84:87], a[76:79], a[160:163], v[84:87]
    ds_read_b128 a[92:95], v215 offset:4096
    s_add_u32 s74, s12, s32
    s_waitcnt lgkmcnt(4)
    v_mfma_f32_16x16x32_bf16 v[88:91], a[72:75], a[188:191], -4.0
    ds_read_b128 a[212:215], v212 offset:16384
    s_addc_u32 s75, s13, 0
    v_mfma_f32_16x16x32_bf16 v[88:91], a[76:79], a[192:195], v[88:91]
    ds_read_b128 a[216:219], v213 offset:16384
    global_load_lds_dwordx4 v228, s[74:75] nt
    v_mfma_f32_16x16x32_bf16 v[88:91], a[64:67], a[180:183], v[88:91]
    ds_read_b128 a[220:223], v214 offset:16384
    global_load_lds_dwordx4 v229, s[74:75] offset:1024 nt
    v_mfma_f32_16x16x32_bf16 v[88:91], a[68:71], a[184:187], v[88:91]
    ds_read_b128 a[224:227], v215 offset:16384
    s_waitcnt lgkmcnt(4)
    v_mfma_f32_16x16x32_bf16 v[92:95], a[80:83], a[148:151], -4.0
    ds_read_b128 a[228:231], v212 offset:20480
    global_load_lds_dwordx4 v228, s[74:75] offset:2048 nt
    v_exp_f32 v84, v84
    v_exp_f32 v85, v85
    v_mfma_f32_16x16x32_bf16 v[92:95], a[84:87], a[152:155], v[92:95]
    ds_read_b128 a[232:235], v213 offset:20480
    global_load_lds_dwordx4 v229, s[74:75] offset:3072 nt
    v_exp_f32 v86, v86
    v_cvt_pk_bf16_f32 v20, v84, v85
    v_mfma_f32_16x16x32_bf16 v[92:95], a[88:91], a[156:159], v[92:95]
    ds_read_b128 a[236:239], v214 offset:20480
    s_add_u32 m0, s33, 0x0
    v_exp_f32 v87, v87
    v_exp_f32 v88, v88
    v_mfma_f32_16x16x32_bf16 v[92:95], a[92:95], a[160:163], v[92:95]
    ds_read_b128 a[240:243], v215 offset:20480
    v_cvt_pk_bf16_f32 v21, v86, v87
    v_exp_f32 v89, v89
    v_exp_f32 v90, v90
    v_mfma_f32_16x16x32_bf16 v[96:99], a[88:91], a[188:191], -4.0
    s_add_u32 s32, s66, 0x0
    v_cvt_pk_bf16_f32 v36, v88, v89
    s_waitcnt vmcnt(11)
    v_lshlrev_b32 v188, 16, v164
    v_and_b32 v189, s42, v164
    v_lshlrev_b32 v190, 16, v165
    v_mfma_f32_16x16x32_bf16 v[96:99], a[92:95], a[192:195], v[96:99]
    s_and_b32 s32, s32, 0x7ffff
    v_and_b32 v191, s42, v165
    v_mul_f32 v188, s40, v188
    v_mul_f32 v189, s40, v189
    v_mul_f32 v190, s40, v190
    v_mul_f32 v191, s40, v191
    v_mfma_f32_16x16x32_bf16 v[96:99], a[80:83], a[180:183], v[96:99]
    s_add_u32 s72, s14, s32
    v_cvt_pk_bf16_f32 v164, v188, v189
    v_cvt_pk_bf16_f32 v165, v190, v191
    v_lshlrev_b32 v188, 16, v166
    v_and_b32 v189, s42, v166
    v_lshlrev_b32 v190, 16, v167
    v_mfma_f32_16x16x32_bf16 v[96:99], a[84:87], a[184:187], v[96:99]
    v_and_b32 v191, s42, v167
    v_mul_f32 v188, s40, v188
    v_mul_f32 v189, s40, v189
    v_mul_f32 v190, s40, v190
    v_mul_f32 v191, s40, v191
    s_waitcnt lgkmcnt(4)
    v_mfma_f32_16x16x32_bf16 v[100:103], a[212:215], a[148:151], -4.0
    s_addc_u32 s73, s15, 0
    v_cvt_pk_bf16_f32 v166, v188, v189
    v_cvt_pk_bf16_f32 v167, v190, v191
    v_mfma_f32_16x16x32_bf16 v[100:103], a[216:219], a[152:155], v[100:103]
    global_load_lds_dwordx4 v224, s[72:73] nt
    ds_write_b128 v248, v[164:167] offset:4096
    s_waitcnt vmcnt(11)
    v_lshlrev_b32 v188, 16, v168
    v_and_b32 v189, s42, v168
    v_lshlrev_b32 v190, 16, v169
    v_and_b32 v191, s42, v169
    v_mul_f32 v188, s40, v188
    v_mul_f32 v189, s40, v189
    v_mfma_f32_16x16x32_bf16 v[100:103], a[220:223], a[156:159], v[100:103]
    global_load_lds_dwordx4 v225, s[72:73] offset:1024 nt
    v_mul_f32 v190, s40, v190
    v_mul_f32 v191, s40, v191
    v_cvt_pk_bf16_f32 v168, v188, v189
    v_cvt_pk_bf16_f32 v169, v190, v191
    v_mfma_f32_16x16x32_bf16 v[100:103], a[224:227], a[160:163], v[100:103]
    v_lshlrev_b32 v188, 16, v170
    v_and_b32 v189, s42, v170
    v_lshlrev_b32 v190, 16, v171
    v_and_b32 v191, s42, v171
    v_mul_f32 v188, s40, v188
    v_mfma_f32_16x16x32_bf16 v[104:107], a[220:223], a[188:191], -4.0
    global_load_lds_dwordx4 v226, s[72:73] offset:2048 nt
    v_mul_f32 v189, s40, v189
    v_mul_f32 v190, s40, v190
    v_mul_f32 v191, s40, v191
    v_cvt_pk_bf16_f32 v170, v188, v189
    v_cvt_pk_bf16_f32 v171, v190, v191
    v_mfma_f32_16x16x32_bf16 v[104:107], a[224:227], a[192:195], v[104:107]
    global_load_lds_dwordx4 v227, s[72:73] offset:3072 nt
    ds_write_b128 v249, v[168:171] offset:5120
    s_waitcnt vmcnt(13)
    v_lshlrev_b32 v188, 16, v172
    v_and_b32 v189, s42, v172
    v_lshlrev_b32 v190, 16, v173
    v_mfma_f32_16x16x32_bf16 v[104:107], a[212:215], a[180:183], v[104:107]
    s_add_u32 m0, s33, 0x2000
    v_and_b32 v191, s42, v173
    v_mul_f32 v188, s40, v188
    v_mul_f32 v189, s40, v189
    v_mul_f32 v190, s40, v190
    v_mul_f32 v191, s40, v191
    v_mfma_f32_16x16x32_bf16 v[104:107], a[216:219], a[184:187], v[104:107]
    v_cvt_pk_bf16_f32 v172, v188, v189
    v_cvt_pk_bf16_f32 v173, v190, v191
    v_lshlrev_b32 v188, 16, v174
    v_and_b32 v189, s42, v174
    v_lshlrev_b32 v190, 16, v175
    s_waitcnt lgkmcnt(2)
    v_mfma_f32_16x16x32_bf16 v[108:111], a[228:231], a[148:151], -4.0
    s_add_u32 s32, s66, 0x8000
    v_and_b32 v191, s42, v175
    v_mul_f32 v188, s40, v188
    v_mul_f32 v189, s40, v189
    v_mul_f32 v190, s40, v190
    v_mul_f32 v191, s40, v191
    v_mfma_f32_16x16x32_bf16 v[108:111], a[232:235], a[152:155], v[108:111]
    s_and_b32 s32, s32, 0x7ffff
    v_cvt_pk_bf16_f32 v174, v188, v189
    v_cvt_pk_bf16_f32 v175, v190, v191
    v_mfma_f32_16x16x32_bf16 v[108:111], a[236:239], a[156:159], v[108:111]
    s_add_u32 s74, s14, s32
    ds_write_b128 v248, v[172:175] offset:6144
    s_waitcnt vmcnt(12)
    v_lshlrev_b32 v188, 16, v176
    v_and_b32 v189, s42, v176
    v_lshlrev_b32 v190, 16, v177
    v_and_b32 v191, s42, v177
    v_mul_f32 v188, s40, v188
    v_mul_f32 v189, s40, v189
    v_mul_f32 v190, s40, v190
    v_mfma_f32_16x16x32_bf16 v[108:111], a[240:243], a[160:163], v[108:111]
    v_mul_f32 v191, s40, v191
    v_cvt_pk_bf16_f32 v176, v188, v189
    v_cvt_pk_bf16_f32 v177, v190, v191
    v_lshlrev_b32 v188, 16, v178
    v_and_b32 v189, s42, v178
    v_mfma_f32_16x16x32_bf16 v[112:115], a[236:239], a[188:191], -4.0
    s_addc_u32 s75, s15, 0
    v_lshlrev_b32 v190, 16, v179
    v_and_b32 v191, s42, v179
    v_mul_f32 v188, s40, v188
    v_mul_f32 v189, s40, v189
    v_mul_f32 v190, s40, v190
    v_mfma_f32_16x16x32_bf16 v[112:115], a[240:243], a[192:195], v[112:115]
    global_load_lds_dwordx4 v224, s[74:75] nt
    v_mul_f32 v191, s40, v191
    v_cvt_pk_bf16_f32 v178, v188, v189
    v_cvt_pk_bf16_f32 v179, v190, v191
    v_mfma_f32_16x16x32_bf16 v[112:115], a[228:231], a[180:183], v[112:115]
    global_load_lds_dwordx4 v225, s[74:75] offset:1024 nt
    ds_write_b128 v249, v[176:179] offset:7168
    v_exp_f32 v91, v91
    v_exp_f32 v92, v92
    v_mfma_f32_16x16x32_bf16 v[112:115], a[232:235], a[184:187], v[112:115]
    s_waitcnt lgkmcnt(0)
    s_barrier
    ds_read_b128 a[164:167], v180 offset:4096
    ds_read_b128 a[168:171], v181 offset:4096
    ds_read_b128 a[172:175], v182 offset:4096
    ds_read_b128 a[176:179], v183 offset:4096
    ds_read_b128 a[196:199], v184 offset:4096
    ds_read_b128 a[200:203], v185 offset:4096
    ds_read_b128 a[204:207], v186 offset:4096
    ds_read_b128 a[208:211], v187 offset:4096
    v_cvt_pk_bf16_f32 v37, v90, v91
    v_exp_f32 v93, v93
    v_exp_f32 v94, v94
    v_cvt_pk_bf16_f32 v22, v92, v93
    v_exp_f32 v95, v95
    v_exp_f32 v96, v96
    v_cvt_pk_bf16_f32 v23, v94, v95
    v_exp_f32 v97, v97
    v_exp_f32 v98, v98
    v_cvt_pk_bf16_f32 v38, v96, v97
    v_exp_f32 v99, v99
    s_waitcnt lgkmcnt(4)
    v_mfma_f32_16x16x32_bf16 v[116:119], a[64:67], a[164:167], -4.0
    global_load_lds_dwordx4 v226, s[74:75] offset:2048 nt
    v_exp_f32 v100, v100
    v_cvt_pk_bf16_f32 v39, v98, v99
    v_mfma_f32_16x16x32_bf16 v[116:119], a[68:71], a[168:171], v[116:119]
    global_load_lds_dwordx4 v227, s[74:75] offset:3072 nt
    v_exp_f32 v101, v101
    v_mfma_f32_16x16x32_bf16 v[116:119], a[72:75], a[172:175], v[116:119]
    v_exp_f32 v102, v102
    v_cvt_pk_bf16_f32 v24, v100, v101
    v_mfma_f32_16x16x32_bf16 v[116:119], a[76:79], a[176:179], v[116:119]
    s_add_u32 m0, s31, 0x0
    v_exp_f32 v103, v103
    v_exp_f32 v104, v104
    s_waitcnt lgkmcnt(0)
    v_mfma_f32_16x16x32_bf16 v[120:123], a[72:75], a[204:207], -4.0
    v_cvt_pk_bf16_f32 v25, v102, v103
    v_exp_f32 v105, v105
    v_mfma_f32_16x16x32_bf16 v[120:123], a[76:79], a[208:211], v[120:123]
    s_add_u32 s32, s64, 0x10000
    v_exp_f32 v106, v106
    v_mfma_f32_16x16x32_bf16 v[120:123], a[64:67], a[196:199], v[120:123]
    v_cvt_pk_bf16_f32 v40, v104, v105
    v_exp_f32 v107, v107
    v_mfma_f32_16x16x32_bf16 v[120:123], a[68:71], a[200:203], v[120:123]
    s_and_b32 s32, s32, 0x7ffff
    v_exp_f32 v108, v108
    v_cvt_pk_bf16_f32 v41, v106, v107
    v_mfma_f32_16x16x32_bf16 v[124:127], a[80:83], a[164:167], -4.0
    s_add_u32 s72, s12, s32
    v_exp_f32 v109, v109
    v_exp_f32 v110, v110
    v_mfma_f32_16x16x32_bf16 v[124:127], a[84:87], a[168:171], v[124:127]
    v_cvt_pk_bf16_f32 v26, v108, v109
    v_exp_f32 v111, v111
    v_mfma_f32_16x16x32_bf16 v[124:127], a[88:91], a[172:175], v[124:127]
    s_addc_u32 s73, s13, 0
    v_exp_f32 v112, v112
    v_mfma_f32_16x16x32_bf16 v[124:127], a[92:95], a[176:179], v[124:127]
    v_cvt_pk_bf16_f32 v27, v110, v111
    v_exp_f32 v113, v113
    v_mfma_f32_16x16x32_bf16 v[128:131], a[88:91], a[204:207], -4.0
    global_load_lds_dwordx4 v228, s[72:73] nt
    v_exp_f32 v114, v114
    v_mfma_f32_16x16x32_bf16 v[128:131], a[92:95], a[208:211], v[128:131]
    v_cvt_pk_bf16_f32 v42, v112, v113
    v_exp_f32 v115, v115
    v_mfma_f32_16x16x32_bf16 v[128:131], a[80:83], a[196:199], v[128:131]
    global_load_lds_dwordx4 v229, s[72:73] offset:1024 nt
    v_exp_f32 v116, v116
    v_mfma_f32_16x16x32_bf16 v[128:131], a[84:87], a[200:203], v[128:131]
    s_waitcnt vmcnt(14) lgkmcnt(0)
    s_barrier
    v_cvt_pk_bf16_f32 v43, v114, v115
    v_exp_f32 v117, v117
    v_mfma_f32_16x16x32_bf16 v[132:135], a[212:215], a[164:167], -4.0
    ds_read_b128 a[64:67], v212 offset:32768
    global_load_lds_dwordx4 v228, s[72:73] offset:2048 nt
    v_exp_f32 v118, v118
    v_mfma_f32_16x16x32_bf16 v[132:135], a[216:219], a[168:171], v[132:135]
    ds_read_b128 a[68:71], v213 offset:32768
    global_load_lds_dwordx4 v229, s[72:73] offset:3072 nt
    v_cvt_pk_bf16_f32 v28, v116, v117
    v_mfma_f32_16x16x32_bf16 v[132:135], a[220:223], a[172:175], v[132:135]
    ds_read_b128 a[72:75], v214 offset:32768
    v_exp_f32 v119, v119
    v_mfma_f32_16x16x32_bf16 v[132:135], a[224:227], a[176:179], v[132:135]
    ds_read_b128 a[76:79], v215 offset:32768
    s_add_u32 m0, s31, 0x4000
    v_exp_f32 v120, v120
    v_cvt_pk_bf16_f32 v29, v118, v119
    v_mfma_f32_16x16x32_bf16 v[136:139], a[220:223], a[204:207], -4.0
    v_exp_f32 v121, v121
    v_exp_f32 v122, v122
    v_mfma_f32_16x16x32_bf16 v[136:139], a[224:227], a[208:211], v[136:139]
    s_add_u32 s32, s65, 0x10000
    v_cvt_pk_bf16_f32 v44, v120, v121
    v_exp_f32 v123, v123
    v_mfma_f32_16x16x32_bf16 v[136:139], a[212:215], a[196:199], v[136:139]
    v_exp_f32 v124, v124
    v_cvt_pk_bf16_f32 v45, v122, v123
    v_mfma_f32_16x16x32_bf16 v[136:139], a[216:219], a[200:203], v[136:139]
    s_and_b32 s32, s32, 0x7ffff
    v_exp_f32 v125, v125
    v_exp_f32 v126, v126
    v_mfma_f32_16x16x32_bf16 v[140:143], a[228:231], a[164:167], -4.0
    s_add_u32 s74, s12, s32
    v_cvt_pk_bf16_f32 v30, v124, v125
    v_exp_f32 v127, v127
    v_mfma_f32_16x16x32_bf16 v[140:143], a[232:235], a[168:171], v[140:143]
    v_exp_f32 v128, v128
    v_cvt_pk_bf16_f32 v31, v126, v127
    v_mfma_f32_16x16x32_bf16 v[140:143], a[236:239], a[172:175], v[140:143]
    s_addc_u32 s75, s13, 0
    v_exp_f32 v129, v129
    v_exp_f32 v130, v130
    v_mfma_f32_16x16x32_bf16 v[140:143], a[240:243], a[176:179], v[140:143]
    v_cvt_pk_bf16_f32 v46, v128, v129
    v_exp_f32 v131, v131
    v_mfma_f32_16x16x32_bf16 v[144:147], a[236:239], a[204:207], -4.0
    global_load_lds_dwordx4 v228, s[74:75] nt
    v_exp_f32 v132, v132
    v_mfma_f32_16x16x32_bf16 v[144:147], a[240:243], a[208:211], v[144:147]
    v_cvt_pk_bf16_f32 v47, v130, v131
    v_exp_f32 v133, v133
    v_mfma_f32_16x16x32_bf16 v[144:147], a[228:231], a[196:199], v[144:147]
    global_load_lds_dwordx4 v229, s[74:75] offset:1024 nt
    v_exp_f32 v134, v134
    v_mfma_f32_16x16x32_bf16 v[144:147], a[232:235], a[200:203], v[144:147]
    v_cvt_pk_bf16_f32 v32, v132, v133
    v_exp_f32 v135, v135
    s_waitcnt lgkmcnt(0)
    v_mfma_f32_16x16x32_bf16 v[84:87], a[64:67], a[148:151], -4.0
    ds_read_b128 a[80:83], v212 offset:36864
    global_load_lds_dwordx4 v228, s[74:75] offset:2048 nt
    v_exp_f32 v136, v136
    v_mfma_f32_16x16x32_bf16 v[84:87], a[68:71], a[152:155], v[84:87]
    ds_read_b128 a[84:87], v213 offset:36864
    v_cvt_pk_bf16_f32 v33, v134, v135
    v_exp_f32 v137, v137
    v_mfma_f32_16x16x32_bf16 v[84:87], a[72:75], a[156:159], v[84:87]
    ds_read_b128 a[88:91], v214 offset:36864
    global_load_lds_dwordx4 v229, s[74:75] offset:3072 nt
    v_mfma_f32_16x16x32_bf16 v[84:87], a[76:79], a[160:163], v[84:87]
    ds_read_b128 a[92:95], v215 offset:36864
    v_exp_f32 v138, v138
    v_mfma_f32_16x16x32_bf16 v[88:91], a[72:75], a[172:175], -4.0
    s_add_u32 m0, s33, 0x4000
    v_cvt_pk_bf16_f32 v48, v136, v137
    v_exp_f32 v139, v139
    v_exp_f32 v140, v140
    v_mfma_f32_16x16x32_bf16 v[88:91], a[76:79], a[176:179], v[88:91]
    v_cvt_pk_bf16_f32 v49, v138, v139
    v_exp_f32 v141, v141
    v_mfma_f32_16x16x32_bf16 v[88:91], a[64:67], a[164:167], v[88:91]
    s_add_u32 s32, s67, 0x0
    v_exp_f32 v142, v142
    v_mfma_f32_16x16x32_bf16 v[88:91], a[68:71], a[168:171], v[88:91]
    v_cvt_pk_bf16_f32 v34, v140, v141
    v_exp_f32 v143, v143
    v_mfma_f32_16x16x32_bf16 v[92:95], a[64:67], a[180:183], -4.0
    s_and_b32 s32, s32, 0x7ffff
    v_exp_f32 v144, v144
    v_cvt_pk_bf16_f32 v35, v142, v143
    v_exp_f32 v145, v145
    v_mfma_f32_16x16x32_bf16 v[92:95], a[68:71], a[184:187], v[92:95]
    v_exp_f32 v146, v146
    v_mfma_f32_16x16x32_bf16 v[92:95], a[72:75], a[188:191], v[92:95]
    s_add_u32 s72, s14, s32
    v_cvt_pk_bf16_f32 v50, v144, v145
    v_exp_f32 v147, v147
    v_mfma_f32_16x16x32_bf16 v[92:95], a[76:79], a[192:195], v[92:95]
    v_exp_f32 v84, v84
    v_cvt_pk_bf16_f32 v51, v146, v147
    v_mfma_f32_16x16x32_bf16 v[96:99], a[72:75], a[204:207], -4.0
    s_addc_u32 s73, s15, 0
    v_exp_f32 v85, v85
    v_exp_f32 v86, v86
    v_mfma_f32_16x16x32_bf16 v[96:99], a[76:79], a[208:211], v[96:99]
    v_cvt_pk_bf16_f32 v52, v84, v85
    v_exp_f32 v87, v87
    v_mfma_f32_16x16x32_bf16 v[96:99], a[64:67], a[196:199], v[96:99]
    global_load_lds_dwordx4 v224, s[72:73] nt
    v_exp_f32 v88, v88
    v_mfma_f32_16x16x32_bf16 v[96:99], a[68:71], a[200:203], v[96:99]
    s_waitcnt vmcnt(17) lgkmcnt(0)
    s_barrier
    v_cvt_pk_bf16_f32 v53, v86, v87
    v_exp_f32 v89, v89
    v_mfma_f32_16x16x32_bf16 v[100:103], a[80:83], a[148:151], -4.0
    ds_read_b128 a[64:67], v212 offset:49152
    global_load_lds_dwordx4 v225, s[72:73] offset:1024 nt
    v_exp_f32 v90, v90
    v_mfma_f32_16x16x32_bf16 v[100:103], a[84:87], a[152:155], v[100:103]
    ds_read_b128 a[68:71], v213 offset:49152
    v_cvt_pk_bf16_f32 v60, v88, v89
    v_exp_f32 v91, v91
    v_mfma_f32_16x16x32_bf16 v[100:103], a[88:91], a[156:159], v[100:103]
    ds_read_b128 a[72:75], v214 offset:49152
    v_exp_f32 v92, v92
    v_mfma_f32_16x16x32_bf16 v[100:103], a[92:95], a[160:163], v[100:103]
    ds_read_b128 a[76:79], v215 offset:49152
    v_cvt_pk_bf16_f32 v61, v90, v91
    v_mfma_f32_16x16x32_bf16 v[104:107], a[88:91], a[172:175], -4.0
    v_exp_f32 v93, v93
    v_exp_f32 v94, v94
    v_mfma_f32_16x16x32_bf16 v[104:107], a[92:95], a[176:179], v[104:107]
    global_load_lds_dwordx4 v226, s[72:73] offset:2048 nt
    v_cvt_pk_bf16_f32 v68, v92, v93
    v_mfma_f32_16x16x32_bf16 v[104:107], a[80:83], a[164:167], v[104:107]
    v_exp_f32 v95, v95
    v_exp_f32 v96, v96
    v_mfma_f32_16x16x32_bf16 v[104:107], a[84:87], a[168:171], v[104:107]
    v_cvt_pk_bf16_f32 v69, v94, v95
    v_exp_f32 v97, v97
    v_mfma_f32_16x16x32_bf16 v[108:111], a[80:83], a[180:183], -4.0
    v_exp_f32 v98, v98
    v_mfma_f32_16x16x32_bf16 v[108:111], a[84:87], a[184:187], v[108:111]
    v_cvt_pk_bf16_f32 v76, v96, v97
    v_exp_f32 v99, v99
    v_mfma_f32_16x16x32_bf16 v[108:111], a[88:91], a[188:191], v[108:111]
    global_load_lds_dwordx4 v227, s[72:73] offset:3072 nt
    v_exp_f32 v100, v100
    v_mfma_f32_16x16x32_bf16 v[108:111], a[92:95], a[192:195], v[108:111]
    v_cvt_pk_bf16_f32 v77, v98, v99
    v_exp_f32 v101, v101
    v_mfma_f32_16x16x32_bf16 v[112:115], a[88:91], a[204:207], -4.0
    v_exp_f32 v102, v102
    v_cvt_pk_bf16_f32 v54, v100, v101
    v_mfma_f32_16x16x32_bf16 v[112:115], a[92:95], a[208:211], v[112:115]
    v_exp_f32 v103, v103
    v_exp_f32 v104, v104
    v_mfma_f32_16x16x32_bf16 v[112:115], a[80:83], a[196:199], v[112:115]
    v_cvt_pk_bf16_f32 v55, v102, v103
    v_exp_f32 v105, v105
    v_mfma_f32_16x16x32_bf16 v[112:115], a[84:87], a[200:203], v[112:115]
    v_exp_f32 v106, v106
    v_smfmac_f32_16x16x64_bf16 a[128:131], a[144:147], v[20:27], v236
    v_cvt_pk_bf16_f32 v62, v104, v105
    v_exp_f32 v107, v107
    s_waitcnt lgkmcnt(0)
    v_mfma_f32_16x16x32_bf16 v[116:119], a[64:67], a[148:151], -4.0
    ds_read_b128 a[80:83], v212 offset:53248
    s_add_u32 m0, s31, 0x8000
    v_exp_f32 v108, v108
    v_cvt_pk_bf16_f32 v63, v106, v107
    v_mfma_f32_16x16x32_bf16 v[116:119], a[68:71], a[152:155], v[116:119]
    ds_read_b128 a[84:87], v213 offset:53248
    v_exp_f32 v109, v109
    v_mfma_f32_16x16x32_bf16 v[116:119], a[72:75], a[156:159], v[116:119]
    ds_read_b128 a[88:91], v214 offset:53248
    s_add_u32 s32, s64, 0x18000
    v_exp_f32 v110, v110
    v_mfma_f32_16x16x32_bf16 v[116:119], a[76:79], a[160:163], v[116:119]
    ds_read_b128 a[92:95], v215 offset:53248
    v_cvt_pk_bf16_f32 v70, v108, v109
    v_exp_f32 v111, v111
    v_mfma_f32_16x16x32_bf16 v[120:123], a[72:75], a[172:175], -4.0
    s_and_b32 s32, s32, 0x7ffff
    v_exp_f32 v112, v112
    v_mfma_f32_16x16x32_bf16 v[120:123], a[76:79], a[176:179], v[120:123]
    v_cvt_pk_bf16_f32 v71, v110, v111
    v_exp_f32 v113, v113
    v_mfma_f32_16x16x32_bf16 v[120:123], a[64:67], a[164:167], v[120:123]
    s_add_u32 s74, s12, s32
    v_exp_f32 v114, v114
    v_cvt_pk_bf16_f32 v78, v112, v113
    v_mfma_f32_16x16x32_bf16 v[120:123], a[68:71], a[168:171], v[120:123]
    v_exp_f32 v115, v115
    v_exp_f32 v116, v116
    v_mfma_f32_16x16x32_bf16 v[124:127], a[64:67], a[180:183], -4.0
    s_addc_u32 s75, s13, 0
    v_cvt_pk_bf16_f32 v79, v114, v115
    v_exp_f32 v117, v117
    v_mfma_f32_16x16x32_bf16 v[124:127], a[68:71], a[184:187], v[124:127]
    v_exp_f32 v118, v118
    v_mfma_f32_16x16x32_bf16 v[124:127], a[72:75], a[188:191], v[124:127]
    global_load_lds_dwordx4 v228, s[74:75] nt
    v_cvt_pk_bf16_f32 v56, v116, v117
    v_exp_f32 v119, v119
    v_mfma_f32_16x16x32_bf16 v[124:127], a[76:79], a[192:195], v[124:127]
    v_exp_f32 v120, v120
    v_mfma_f32_16x16x32_bf16 v[128:131], a[72:75], a[204:207], -4.0
    global_load_lds_dwordx4 v229, s[74:75] offset:1024 nt
    v_cvt_pk_bf16_f32 v57, v118, v119
    v_exp_f32 v121, v121
    v_mfma_f32_16x16x32_bf16 v[128:131], a[76:79], a[208:211], v[128:131]
    v_exp_f32 v122, v122
    v_mfma_f32_16x16x32_bf16 v[128:131], a[64:67], a[196:199], v[128:131]
    global_load_lds_dwordx4 v228, s[74:75] offset:2048 nt
    v_cvt_pk_bf16_f32 v64, v120, v121
    v_exp_f32 v123, v123
    v_mfma_f32_16x16x32_bf16 v[128:131], a[68:71], a[200:203], v[128:131]
    v_exp_f32 v124, v124
    v_smfmac_f32_16x16x64_bf16 a[136:139], a[144:147], v[36:43], v236
    s_waitcnt vmcnt(11) lgkmcnt(0)
    s_barrier
    v_cvt_pk_bf16_f32 v65, v122, v123
    v_exp_f32 v125, v125
    v_mfma_f32_16x16x32_bf16 v[132:135], a[80:83], a[148:151], -4.0
    ds_read_b128 a[64:67], v212
    global_load_lds_dwordx4 v229, s[74:75] offset:3072 nt
    v_exp_f32 v126, v126
    v_mfma_f32_16x16x32_bf16 v[132:135], a[84:87], a[152:155], v[132:135]
    ds_read_b64_tr_b16 a[96:97], v220
    v_cvt_pk_bf16_f32 v72, v124, v125
    v_exp_f32 v127, v127
    v_mfma_f32_16x16x32_bf16 v[132:135], a[88:91], a[156:159], v[132:135]
    ds_read_b64_tr_b16 a[98:99], v220 offset:2048
    s_add_u32 m0, s33, 0x6000
    v_exp_f32 v128, v128
    v_mfma_f32_16x16x32_bf16 v[132:135], a[92:95], a[160:163], v[132:135]
    ds_read_b128 a[68:71], v213
    v_cvt_pk_bf16_f32 v73, v126, v127
    v_mfma_f32_16x16x32_bf16 v[136:139], a[88:91], a[172:175], -4.0
    ds_read_b64_tr_b16 a[100:101], v220 offset:4096
    s_add_u32 s32, s67, 0x8000
    v_exp_f32 v129, v129
    v_mfma_f32_16x16x32_bf16 v[136:139], a[92:95], a[176:179], v[136:139]
    ds_read_b64_tr_b16 a[102:103], v220 offset:6144
    v_exp_f32 v130, v130
    v_mfma_f32_16x16x32_bf16 v[136:139], a[80:83], a[164:167], v[136:139]
    ds_read_b128 a[72:75], v214
    s_and_b32 s32, s32, 0x7ffff
    v_cvt_pk_bf16_f32 v80, v128, v129
    v_exp_f32 v131, v131
    v_mfma_f32_16x16x32_bf16 v[136:139], a[84:87], a[168:171], v[136:139]
    ds_read_b64_tr_b16 a[104:105], v220 offset:8192
    v_exp_f32 v132, v132
    v_mfma_f32_16x16x32_bf16 v[140:143], a[80:83], a[180:183], -4.0
    ds_read_b64_tr_b16 a[106:107], v220 offset:10240
    s_add_u32 s72, s14, s32
    v_cvt_pk_bf16_f32 v81, v130, v131
    v_mfma_f32_16x16x32_bf16 v[140:143], a[84:87], a[184:187], v[140:143]
    ds_read_b128 a[76:79], v215
    v_exp_f32 v133, v133
    v_mfma_f32_16x16x32_bf16 v[140:143], a[88:91], a[188:191], v[140:143]
    ds_read_b64_tr_b16 a[108:109], v220 offset:12288
    s_addc_u32 s73, s15, 0
    v_exp_f32 v134, v134
    v_mfma_f32_16x16x32_bf16 v[140:143], a[92:95], a[192:195], v[140:143]
    ds_read_b64_tr_b16 a[110:111], v220 offset:14336
    v_cvt_pk_bf16_f32 v58, v132, v133
    v_exp_f32 v135, v135
    v_mfma_f32_16x16x32_bf16 v[144:147], a[88:91], a[204:207], -4.0
    global_load_lds_dwordx4 v224, s[72:73] nt
    v_exp_f32 v136, v136
    v_mfma_f32_16x16x32_bf16 v[144:147], a[92:95], a[208:211], v[144:147]
    v_cvt_pk_bf16_f32 v59, v134, v135
    v_exp_f32 v137, v137
    v_mfma_f32_16x16x32_bf16 v[144:147], a[80:83], a[196:199], v[144:147]
    global_load_lds_dwordx4 v225, s[72:73] offset:1024 nt
    v_exp_f32 v138, v138
    v_mfma_f32_16x16x32_bf16 v[144:147], a[84:87], a[200:203], v[144:147]
    v_cvt_pk_bf16_f32 v66, v136, v137
    v_exp_f32 v139, v139
    v_smfmac_f32_16x16x64_bf16 a[132:135], a[144:147], v[28:35], v236
    v_exp_f32 v140, v140
    v_smfmac_f32_16x16x64_bf16 a[140:143], a[144:147], v[44:51], v236
    v_cvt_pk_bf16_f32 v67, v138, v139
    v_exp_f32 v141, v141
    v_exp_f32 v142, v142
    v_cvt_pk_bf16_f32 v74, v140, v141
    v_exp_f32 v143, v143
    s_waitcnt lgkmcnt(2)
    v_mfma_f32_16x16x32_bf16 v[4:7], a[64:67], a[148:151], -4.0
    v_exp_f32 v144, v144
    v_mfma_f32_16x16x32_bf16 v[4:7], a[68:71], a[152:155], v[4:7]
    ds_read_b128 a[80:83], v212 offset:4096
    v_cvt_pk_bf16_f32 v75, v142, v143
    v_mfma_f32_16x16x32_bf16 v[4:7], a[72:75], a[156:159], v[4:7]
    v_exp_f32 v145, v145
    v_mfma_f32_16x16x32_bf16 v[4:7], a[76:79], a[160:163], v[4:7]
    ds_read_b64_tr_b16 a[112:113], v221
    v_mfma_f32_16x16x32_bf16 v[8:11], a[72:75], a[172:175], -4.0
    v_exp_f32 v146, v146
    v_mfma_f32_16x16x32_bf16 v[8:11], a[76:79], a[176:179], v[8:11]
    ds_read_b64_tr_b16 a[114:115], v221 offset:2048
    v_cvt_pk_bf16_f32 v82, v144, v145
    v_mfma_f32_16x16x32_bf16 v[8:11], a[64:67], a[164:167], v[8:11]
    s_waitcnt lgkmcnt(3)
    v_exp_f32 v147, v147
    v_mfma_f32_16x16x32_bf16 v[8:11], a[68:71], a[168:171], v[8:11]
    global_load_lds_dwordx4 v226, s[72:73] offset:2048 nt
    v_mfma_f32_16x16x32_bf16 v[12:15], a[64:67], a[180:183], -4.0
    s_add_u32 s32, s65, 0x18000
    v_exp_f32 v4, v4
    v_mfma_f32_16x16x32_bf16 v[12:15], a[68:71], a[184:187], v[12:15]
    ds_read_b128 a[84:87], v213 offset:4096
    v_cvt_pk_bf16_f32 v83, v146, v147
    v_mfma_f32_16x16x32_bf16 v[12:15], a[72:75], a[188:191], v[12:15]
    s_and_b32 s32, s32, 0x7ffff
    v_exp_f32 v5, v5
    v_mfma_f32_16x16x32_bf16 v[12:15], a[76:79], a[192:195], v[12:15]
    ds_read_b64_tr_b16 a[116:117], v221 offset:4096
    v_mfma_f32_16x16x32_bf16 v[16:19], a[72:75], a[204:207], -4.0
    v_exp_f32 v6, v6
    v_mfma_f32_16x16x32_bf16 v[16:19], a[76:79], a[208:211], v[16:19]
    ds_read_b64_tr_b16 a[118:119], v221 offset:6144
    v_cvt_pk_bf16_f32 v84, v4, v5
    v_mfma_f32_16x16x32_bf16 v[16:19], a[64:67], a[196:199], v[16:19]
    v_exp_f32 v7, v7
    v_mfma_f32_16x16x32_bf16 v[16:19], a[68:71], a[200:203], v[16:19]
    global_load_lds_dwordx4 v227, s[72:73] offset:3072 nt
    v_mfma_f32_16x16x32_bf16 v[148:151], v[20:23], a[96:99], 0
    s_add_u32 s74, s12, s32
    v_exp_f32 v8, v8
    v_mfma_f32_16x16x32_bf16 v[148:151], v[24:27], a[100:103], v[148:151]
    ds_read_b128 a[88:91], v214 offset:4096
    v_cvt_pk_bf16_f32 v85, v6, v7
    v_mfma_f32_16x16x32_bf16 v[148:151], v[52:55], a[104:107], v[148:151]
    s_addc_u32 s75, s13, 0
    v_exp_f32 v9, v9
    v_mfma_f32_16x16x32_bf16 v[148:151], v[56:59], a[108:111], v[148:151]
    ds_read_b64_tr_b16 a[120:121], v221 offset:8192
    v_mfma_f32_16x16x32_bf16 v[152:155], v[60:63], a[104:107], 0
    s_add_u32 m0, s31, 0xc000
    v_exp_f32 v10, v10
    v_mfma_f32_16x16x32_bf16 v[152:155], v[64:67], a[108:111], v[152:155]
    ds_read_b64_tr_b16 a[122:123], v221 offset:10240
    v_cvt_pk_bf16_f32 v92, v8, v9
    v_mfma_f32_16x16x32_bf16 v[152:155], v[28:31], a[96:99], v[152:155]
    v_exp_f32 v11, v11
    v_mfma_f32_16x16x32_bf16 v[152:155], v[32:35], a[100:103], v[152:155]
    global_load_lds_dwordx4 v228, s[74:75] nt
    v_mfma_f32_16x16x32_bf16 a[0:3], v[36:39], a[96:99], 0
    ds_read_b128 a[92:95], v215 offset:4096
    v_cvt_pk_bf16_f32 v93, v10, v11
    v_mfma_f32_16x16x32_bf16 a[0:3], v[40:43], a[100:103], a[0:3]
    ds_read_b64_tr_b16 a[124:125], v221 offset:12288
    v_mfma_f32_16x16x32_bf16 a[0:3], v[68:71], a[104:107], a[0:3]
    ds_read_b64_tr_b16 a[126:127], v221 offset:14336
    v_mfma_f32_16x16x32_bf16 a[0:3], v[72:75], a[108:111], a[0:3]
    global_load_lds_dwordx4 v229, s[74:75] offset:1024 nt
    v_mfma_f32_16x16x32_bf16 a[4:7], v[76:79], a[104:107], 0
    s_add_u32 s32, s66, 0x10000
    v_exp_f32 v12, v12
    v_mfma_f32_16x16x32_bf16 a[4:7], v[80:83], a[108:111], a[4:7]
    s_and_b32 s32, s32, 0x7ffff
    v_exp_f32 v13, v13
    v_mfma_f32_16x16x32_bf16 a[4:7], v[44:47], a[96:99], a[4:7]
    v_exp_f32 v14, v14
    v_mfma_f32_16x16x32_bf16 a[4:7], v[48:51], a[100:103], a[4:7]
    s_waitcnt vmcnt(14) lgkmcnt(0)
    v_exp_f32 v15, v15
    v_smfmac_f32_16x16x64_bf16 a[128:131], a[144:147], v[52:59], v236
    s_barrier
    v_mfma_f32_16x16x32_bf16 v[4:7], a[80:83], a[148:151], -4.0
    s_add_u32 s72, s14, s32
    v_exp_f32 v16, v16
    v_mfma_f32_16x16x32_bf16 v[4:7], a[84:87], a[152:155], v[4:7]
    ds_read_b128 a[64:67], v212 offset:16384
    v_cvt_pk_bf16_f32 v101, v14, v15
    v_mfma_f32_16x16x32_bf16 v[4:7], a[88:91], a[156:159], v[4:7]
    s_addc_u32 s73, s15, 0
    v_exp_f32 v17, v17
    v_mfma_f32_16x16x32_bf16 v[4:7], a[92:95], a[160:163], v[4:7]
    ds_read_b64_tr_b16 a[96:97], v222
    v_cvt_pk_bf16_f32 v100, v12, v13
    v_mfma_f32_16x16x32_bf16 v[8:11], a[88:91], a[172:175], -4.0
    v_exp_f32 v18, v18
    v_mfma_f32_16x16x32_bf16 v[8:11], a[92:95], a[176:179], v[8:11]
    ds_read_b64_tr_b16 a[98:99], v222 offset:2048
    v_cvt_pk_bf16_f32 v108, v16, v17
    v_mfma_f32_16x16x32_bf16 v[8:11], a[80:83], a[164:167], v[8:11]
L_stub1:
    s_cbranch_execz L_stub5
    v_exp_f32 v19, v19
    v_mfma_f32_16x16x32_bf16 v[8:11], a[84:87], a[168:171], v[8:11]
    global_load_lds_dwordx4 v228, s[74:75] offset:2048 nt
    v_mfma_f32_16x16x32_bf16 v[12:15], a[80:83], a[180:183], -4.0
    v_exp_f32 v4, v4
    v_mfma_f32_16x16x32_bf16 v[12:15], a[84:87], a[184:187], v[12:15]
    ds_read_b128 a[68:71], v213 offset:16384
    v_cvt_pk_bf16_f32 v109, v18, v19
    v_mfma_f32_16x16x32_bf16 v[12:15], a[88:91], a[188:191], v[12:15]
    v_exp_f32 v5, v5
    v_mfma_f32_16x16x32_bf16 v[12:15], a[92:95], a[192:195], v[12:15]
    ds_read_b64_tr_b16 a[100:101], v222 offset:4096
    v_mfma_f32_16x16x32_bf16 v[16:19], a[88:91], a[204:207], -4.0
    v_exp_f32 v6, v6
    v_mfma_f32_16x16x32_bf16 v[16:19], a[92:95], a[208:211], v[16:19]
    ds_read_b64_tr_b16 a[102:103], v222 offset:6144
    v_cvt_pk_bf16_f32 v86, v4, v5
    v_mfma_f32_16x16x32_bf16 v[16:19], a[80:83], a[196:199], v[16:19]
    v_exp_f32 v7, v7
    v_mfma_f32_16x16x32_bf16 v[16:19], a[84:87], a[200:203], v[16:19]
    global_load_lds_dwordx4 v229, s[74:75] offset:3072 nt
    v_mfma_f32_16x16x32_bf16 v[156:159], v[20:23], a[112:115], 0
    v_exp_f32 v8, v8
    v_mfma_f32_16x16x32_bf16 v[156:159], v[24:27], a[116:119], v[156:159]
    ds_read_b128 a[72:75], v214 offset:16384
    v_cvt_pk_bf16_f32 v87, v6, v7
    v_mfma_f32_16x16x32_bf16 v[156:159], v[52:55], a[120:123], v[156:159]
    v_exp_f32 v9, v9
    v_mfma_f32_16x16x32_bf16 v[156:159], v[56:59], a[124:127], v[156:159]
    ds_read_b64_tr_b16 a[104:105], v222 offset:8192
    v_mfma_f32_16x16x32_bf16 v[160:163], v[60:63], a[120:123], 0
    s_add_u32 m0, s33, 0x8000
    v_exp_f32 v10, v10
    v_mfma_f32_16x16x32_bf16 v[160:163], v[64:67], a[124:127], v[160:163]
    ds_read_b64_tr_b16 a[106:107], v222 offset:10240
    v_cvt_pk_bf16_f32 v94, v8, v9
    v_mfma_f32_16x16x32_bf16 v[160:163], v[28:31], a[112:115], v[160:163]
    v_exp_f32 v11, v11
    v_mfma_f32_16x16x32_bf16 v[160:163], v[32:35], a[116:119], v[160:163]
    global_load_lds_dwordx4 v224, s[72:73] nt
    v_mfma_f32_16x16x32_bf16 a[8:11], v[36:39], a[112:115], 0
    s_add_u32 s32, s64, 0x20000
    v_exp_f32 v12, v12
    v_mfma_f32_16x16x32_bf16 a[8:11], v[40:43], a[116:119], a[8:11]
    ds_read_b128 a[76:79], v215 offset:16384
    v_cvt_pk_bf16_f32 v95, v10, v11
    v_mfma_f32_16x16x32_bf16 a[8:11], v[68:71], a[120:123], a[8:11]
    s_and_b32 s32, s32, 0x7ffff
    v_exp_f32 v13, v13
    v_mfma_f32_16x16x32_bf16 a[8:11], v[72:75], a[124:127], a[8:11]
    ds_read_b64_tr_b16 a[108:109], v222 offset:12288
    v_mfma_f32_16x16x32_bf16 a[12:15], v[76:79], a[120:123], 0
    v_exp_f32 v14, v14
    v_mfma_f32_16x16x32_bf16 a[12:15], v[80:83], a[124:127], a[12:15]
    ds_read_b64_tr_b16 a[110:111], v222 offset:14336
    v_cvt_pk_bf16_f32 v102, v12, v13
    v_mfma_f32_16x16x32_bf16 a[12:15], v[44:47], a[112:115], a[12:15]
    s_waitcnt lgkmcnt(2)
    v_exp_f32 v15, v15
    v_mfma_f32_16x16x32_bf16 a[12:15], v[48:51], a[116:119], a[12:15]
    global_load_lds_dwordx4 v225, s[72:73] offset:1024 nt
    v_smfmac_f32_16x16x64_bf16 a[132:135], a[144:147], v[60:67], v236
    v_mfma_f32_16x16x32_bf16 v[4:7], a[64:67], a[148:151], -4.0
    s_add_u32 s74, s12, s32
    v_exp_f32 v16, v16
    v_mfma_f32_16x16x32_bf16 v[4:7], a[68:71], a[152:155], v[4:7]
    ds_read_b128 a[80:83], v212 offset:20480
    v_cvt_pk_bf16_f32 v103, v14, v15
    v_mfma_f32_16x16x32_bf16 v[4:7], a[72:75], a[156:159], v[4:7]
    s_addc_u32 s75, s13, 0
    v_exp_f32 v17, v17
    v_mfma_f32_16x16x32_bf16 v[4:7], a[76:79], a[160:163], v[4:7]
    ds_read_b64_tr_b16 a[112:113], v223
    v_mfma_f32_16x16x32_bf16 v[8:11], a[72:75], a[172:175], -4.0
    v_exp_f32 v18, v18
    v_mfma_f32_16x16x32_bf16 v[8:11], a[76:79], a[176:179], v[8:11]
    ds_read_b64_tr_b16 a[114:115], v223 offset:2048
    v_cvt_pk_bf16_f32 v110, v16, v17
    v_mfma_f32_16x16x32_bf16 v[8:11], a[64:67], a[164:167], v[8:11]
    s_waitcnt lgkmcnt(3)
    v_exp_f32 v19, v19
    v_mfma_f32_16x16x32_bf16 v[8:11], a[68:71], a[168:171], v[8:11]
    global_load_lds_dwordx4 v226, s[72:73] offset:2048 nt
    v_mfma_f32_16x16x32_bf16 v[12:15], a[64:67], a[180:183], -4.0
    v_exp_f32 v4, v4
    v_mfma_f32_16x16x32_bf16 v[12:15], a[68:71], a[184:187], v[12:15]
    ds_read_b128 a[84:87], v213 offset:20480
    v_cvt_pk_bf16_f32 v111, v18, v19
    v_mfma_f32_16x16x32_bf16 v[12:15], a[72:75], a[188:191], v[12:15]
    v_exp_f32 v5, v5
    v_mfma_f32_16x16x32_bf16 v[12:15], a[76:79], a[192:195], v[12:15]
    ds_read_b64_tr_b16 a[116:117], v223 offset:4096
    v_mfma_f32_16x16x32_bf16 v[16:19], a[72:75], a[204:207], -4.0
    v_exp_f32 v6, v6
    v_mfma_f32_16x16x32_bf16 v[16:19], a[76:79], a[208:211], v[16:19]
    ds_read_b64_tr_b16 a[118:119], v223 offset:6144
    v_cvt_pk_bf16_f32 v88, v4, v5
    v_mfma_f32_16x16x32_bf16 v[16:19], a[64:67], a[196:199], v[16:19]
    v_exp_f32 v7, v7
    v_mfma_f32_16x16x32_bf16 v[16:19], a[68:71], a[200:203], v[16:19]
    global_load_lds_dwordx4 v227, s[72:73] offset:3072 nt
    v_mfma_f32_16x16x32_bf16 v[164:167], v[20:23], a[96:99], 0
    v_exp_f32 v8, v8
    v_mfma_f32_16x16x32_bf16 v[164:167], v[24:27], a[100:103], v[164:167]
    ds_read_b128 a[88:91], v214 offset:20480
    v_cvt_pk_bf16_f32 v89, v6, v7
    v_mfma_f32_16x16x32_bf16 v[164:167], v[52:55], a[104:107], v[164:167]
    v_exp_f32 v9, v9
    v_mfma_f32_16x16x32_bf16 v[164:167], v[56:59], a[108:111], v[164:167]
    ds_read_b64_tr_b16 a[120:121], v223 offset:8192
    v_mfma_f32_16x16x32_bf16 v[168:171], v[60:63], a[104:107], 0
    s_add_u32 m0, s31, 0x0
    v_exp_f32 v10, v10
    v_mfma_f32_16x16x32_bf16 v[168:171], v[64:67], a[108:111], v[168:171]
    ds_read_b64_tr_b16 a[122:123], v223 offset:10240
    v_cvt_pk_bf16_f32 v96, v8, v9
    v_mfma_f32_16x16x32_bf16 v[168:171], v[28:31], a[96:99], v[168:171]
    v_exp_f32 v11, v11
    v_mfma_f32_16x16x32_bf16 v[168:171], v[32:35], a[100:103], v[168:171]
    global_load_lds_dwordx4 v228, s[74:75] nt
    v_mfma_f32_16x16x32_bf16 a[16:19], v[36:39], a[96:99], 0
    ds_read_b128 a[92:95], v215 offset:20480
    v_cvt_pk_bf16_f32 v97, v10, v11
    v_mfma_f32_16x16x32_bf16 a[16:19], v[40:43], a[100:103], a[16:19]
    ds_read_b64_tr_b16 a[124:125], v223 offset:12288
    v_mfma_f32_16x16x32_bf16 a[16:19], v[68:71], a[104:107], a[16:19]
    ds_read_b64_tr_b16 a[126:127], v223 offset:14336
    v_mfma_f32_16x16x32_bf16 a[16:19], v[72:75], a[108:111], a[16:19]
    global_load_lds_dwordx4 v229, s[74:75] offset:1024 nt
    v_mfma_f32_16x16x32_bf16 a[20:23], v[76:79], a[104:107], 0
    s_add_u32 s32, s66, 0x18000
    v_exp_f32 v12, v12
    v_mfma_f32_16x16x32_bf16 a[20:23], v[80:83], a[108:111], a[20:23]
    s_and_b32 s32, s32, 0x7ffff
    v_exp_f32 v13, v13
    v_mfma_f32_16x16x32_bf16 a[20:23], v[44:47], a[96:99], a[20:23]
    v_exp_f32 v14, v14
    v_mfma_f32_16x16x32_bf16 a[20:23], v[48:51], a[100:103], a[20:23]
    s_waitcnt vmcnt(10) lgkmcnt(0)
    v_exp_f32 v15, v15
    v_smfmac_f32_16x16x64_bf16 a[136:139], a[144:147], v[68:75], v236
    s_barrier
    v_mfma_f32_16x16x32_bf16 v[4:7], a[80:83], a[148:151], -4.0
    s_add_u32 s72, s14, s32
    v_exp_f32 v16, v16
    v_mfma_f32_16x16x32_bf16 v[4:7], a[84:87], a[152:155], v[4:7]
    ds_read_b128 a[64:67], v212 offset:32768
    v_cvt_pk_bf16_f32 v105, v14, v15
    v_mfma_f32_16x16x32_bf16 v[4:7], a[88:91], a[156:159], v[4:7]
    s_addc_u32 s73, s15, 0
    v_exp_f32 v17, v17
    v_mfma_f32_16x16x32_bf16 v[4:7], a[92:95], a[160:163], v[4:7]
    ds_read_b64_tr_b16 a[96:97], v220 offset:16384
    v_cvt_pk_bf16_f32 v104, v12, v13
    v_mfma_f32_16x16x32_bf16 v[8:11], a[88:91], a[172:175], -4.0
    v_exp_f32 v18, v18
    v_mfma_f32_16x16x32_bf16 v[8:11], a[92:95], a[176:179], v[8:11]
    ds_read_b64_tr_b16 a[98:99], v220 offset:18432
    v_cvt_pk_bf16_f32 v112, v16, v17
    v_mfma_f32_16x16x32_bf16 v[8:11], a[80:83], a[164:167], v[8:11]
    v_exp_f32 v19, v19
    v_mfma_f32_16x16x32_bf16 v[8:11], a[84:87], a[168:171], v[8:11]
    global_load_lds_dwordx4 v228, s[74:75] offset:2048 nt
    v_mfma_f32_16x16x32_bf16 v[12:15], a[80:83], a[180:183], -4.0
    v_exp_f32 v4, v4
    v_mfma_f32_16x16x32_bf16 v[12:15], a[84:87], a[184:187], v[12:15]
    ds_read_b128 a[68:71], v213 offset:32768
    v_cvt_pk_bf16_f32 v113, v18, v19
    v_mfma_f32_16x16x32_bf16 v[12:15], a[88:91], a[188:191], v[12:15]
    v_exp_f32 v5, v5
    v_mfma_f32_16x16x32_bf16 v[12:15], a[92:95], a[192:195], v[12:15]
    ds_read_b64_tr_b16 a[100:101], v220 offset:20480
    v_mfma_f32_16x16x32_bf16 v[16:19], a[88:91], a[204:207], -4.0
    v_exp_f32 v6, v6
    v_mfma_f32_16x16x32_bf16 v[16:19], a[92:95], a[208:211], v[16:19]
    ds_read_b64_tr_b16 a[102:103], v220 offset:22528
    v_cvt_pk_bf16_f32 v90, v4, v5
    v_mfma_f32_16x16x32_bf16 v[16:19], a[80:83], a[196:199], v[16:19]
    v_exp_f32 v7, v7
    v_mfma_f32_16x16x32_bf16 v[16:19], a[84:87], a[200:203], v[16:19]
    global_load_lds_dwordx4 v229, s[74:75] offset:3072 nt
    v_mfma_f32_16x16x32_bf16 v[172:175], v[20:23], a[112:115], 0
    v_exp_f32 v8, v8
    v_mfma_f32_16x16x32_bf16 v[172:175], v[24:27], a[116:119], v[172:175]
    ds_read_b128 a[72:75], v214 offset:32768
    v_cvt_pk_bf16_f32 v91, v6, v7
    v_mfma_f32_16x16x32_bf16 v[172:175], v[52:55], a[120:123], v[172:175]
    v_exp_f32 v9, v9
    v_mfma_f32_16x16x32_bf16 v[172:175], v[56:59], a[124:127], v[172:175]
    ds_read_b64_tr_b16 a[104:105], v220 offset:24576
    v_mfma_f32_16x16x32_bf16 v[176:179], v[60:63], a[120:123], 0
    s_add_u32 m0, s33, 0xa000
    v_exp_f32 v10, v10
    v_mfma_f32_16x16x32_bf16 v[176:179], v[64:67], a[124:127], v[176:179]
    ds_read_b64_tr_b16 a[106:107], v220 offset:26624
    v_cvt_pk_bf16_f32 v98, v8, v9
    v_mfma_f32_16x16x32_bf16 v[176:179], v[28:31], a[112:115], v[176:179]
    v_exp_f32 v11, v11
    v_mfma_f32_16x16x32_bf16 v[176:179], v[32:35], a[116:119], v[176:179]
    global_load_lds_dwordx4 v224, s[72:73] nt
    v_mfma_f32_16x16x32_bf16 a[24:27], v[36:39], a[112:115], 0
    s_add_u32 s32, s65, 0x20000
    v_exp_f32 v12, v12
    v_mfma_f32_16x16x32_bf16 a[24:27], v[40:43], a[116:119], a[24:27]
    ds_read_b128 a[76:79], v215 offset:32768
    v_cvt_pk_bf16_f32 v99, v10, v11
    v_mfma_f32_16x16x32_bf16 a[24:27], v[68:71], a[120:123], a[24:27]
    s_and_b32 s32, s32, 0x7ffff
    v_exp_f32 v13, v13
    v_mfma_f32_16x16x32_bf16 a[24:27], v[72:75], a[124:127], a[24:27]
    ds_read_b64_tr_b16 a[108:109], v220 offset:28672
    v_mfma_f32_16x16x32_bf16 a[28:31], v[76:79], a[120:123], 0
    v_exp_f32 v14, v14
    v_mfma_f32_16x16x32_bf16 a[28:31], v[80:83], a[124:127], a[28:31]
    ds_read_b64_tr_b16 a[110:111], v220 offset:30720
    v_cvt_pk_bf16_f32 v106, v12, v13
    v_mfma_f32_16x16x32_bf16 a[28:31], v[44:47], a[112:115], a[28:31]
    s_waitcnt lgkmcnt(2)
    v_exp_f32 v15, v15
    v_mfma_f32_16x16x32_bf16 a[28:31], v[48:51], a[116:119], a[28:31]
    global_load_lds_dwordx4 v225, s[72:73] offset:1024 nt
    v_smfmac_f32_16x16x64_bf16 a[140:143], a[144:147], v[76:83], v236
    v_mfma_f32_16x16x32_bf16 v[4:7], a[64:67], a[148:151], -4.0
    s_add_u32 s74, s12, s32
    v_exp_f32 v16, v16
    v_mfma_f32_16x16x32_bf16 v[4:7], a[68:71], a[152:155], v[4:7]
    ds_read_b128 a[80:83], v212 offset:36864
    v_cvt_pk_bf16_f32 v107, v14, v15
    v_mfma_f32_16x16x32_bf16 v[4:7], a[72:75], a[156:159], v[4:7]
    s_addc_u32 s75, s13, 0
    v_exp_f32 v17, v17
    v_mfma_f32_16x16x32_bf16 v[4:7], a[76:79], a[160:163], v[4:7]
    ds_read_b64_tr_b16 a[112:113], v221 offset:16384
    v_mfma_f32_16x16x32_bf16 v[8:11], a[72:75], a[172:175], -4.0
    v_exp_f32 v18, v18
    v_mfma_f32_16x16x32_bf16 v[8:11], a[76:79], a[176:179], v[8:11]
    ds_read_b64_tr_b16 a[114:115], v221 offset:18432
    v_cvt_pk_bf16_f32 v114, v16, v17
    v_mfma_f32_16x16x32_bf16 v[8:11], a[64:67], a[164:167], v[8:11]
    s_waitcnt lgkmcnt(3)
    v_exp_f32 v19, v19
    v_mfma_f32_16x16x32_bf16 v[8:11], a[68:71], a[168:171], v[8:11]
    global_load_lds_dwordx4 v226, s[72:73] offset:2048 nt
    v_mfma_f32_16x16x32_bf16 v[12:15], a[64:67], a[180:183], -4.0
    v_exp_f32 v4, v4
    v_mfma_f32_16x16x32_bf16 v[12:15], a[68:71], a[184:187], v[12:15]
    ds_read_b128 a[84:87], v213 offset:36864
    v_cvt_pk_bf16_f32 v115, v18, v19
    v_mfma_f32_16x16x32_bf16 v[12:15], a[72:75], a[188:191], v[12:15]
    v_exp_f32 v5, v5
    v_mfma_f32_16x16x32_bf16 v[12:15], a[76:79], a[192:195], v[12:15]
    ds_read_b64_tr_b16 a[116:117], v221 offset:20480
    v_mfma_f32_16x16x32_bf16 v[16:19], a[72:75], a[204:207], -4.0
    v_exp_f32 v6, v6
    v_mfma_f32_16x16x32_bf16 v[16:19], a[76:79], a[208:211], v[16:19]
    ds_read_b64_tr_b16 a[118:119], v221 offset:22528
    v_cvt_pk_bf16_f32 v116, v4, v5
    v_mfma_f32_16x16x32_bf16 v[16:19], a[64:67], a[196:199], v[16:19]
    v_exp_f32 v7, v7
    v_mfma_f32_16x16x32_bf16 v[16:19], a[68:71], a[200:203], v[16:19]
    global_load_lds_dwordx4 v227, s[72:73] offset:3072 nt
    v_mfma_f32_16x16x32_bf16 v[180:183], v[20:23], a[96:99], 0
    v_exp_f32 v8, v8
    v_mfma_f32_16x16x32_bf16 v[180:183], v[24:27], a[100:103], v[180:183]
    ds_read_b128 a[88:91], v214 offset:36864
    v_cvt_pk_bf16_f32 v117, v6, v7
    v_mfma_f32_16x16x32_bf16 v[180:183], v[52:55], a[104:107], v[180:183]
    v_exp_f32 v9, v9
    v_mfma_f32_16x16x32_bf16 v[180:183], v[56:59], a[108:111], v[180:183]
    ds_read_b64_tr_b16 a[120:121], v221 offset:24576
    v_mfma_f32_16x16x32_bf16 v[184:187], v[60:63], a[104:107], 0
    s_add_u32 m0, s31, 0x4000
    v_exp_f32 v10, v10
    v_mfma_f32_16x16x32_bf16 v[184:187], v[64:67], a[108:111], v[184:187]
    ds_read_b64_tr_b16 a[122:123], v221 offset:26624
    v_cvt_pk_bf16_f32 v124, v8, v9
    v_mfma_f32_16x16x32_bf16 v[184:187], v[28:31], a[96:99], v[184:187]
    v_exp_f32 v11, v11
    v_mfma_f32_16x16x32_bf16 v[184:187], v[32:35], a[100:103], v[184:187]
    global_load_lds_dwordx4 v228, s[74:75] nt
    v_mfma_f32_16x16x32_bf16 a[32:35], v[36:39], a[96:99], 0
    ds_read_b128 a[92:95], v215 offset:36864
    v_cvt_pk_bf16_f32 v125, v10, v11
    v_mfma_f32_16x16x32_bf16 a[32:35], v[40:43], a[100:103], a[32:35]
    ds_read_b64_tr_b16 a[124:125], v221 offset:28672
    v_mfma_f32_16x16x32_bf16 a[32:35], v[68:71], a[104:107], a[32:35]
    ds_read_b64_tr_b16 a[126:127], v221 offset:30720
    v_mfma_f32_16x16x32_bf16 a[32:35], v[72:75], a[108:111], a[32:35]
    global_load_lds_dwordx4 v229, s[74:75] offset:1024 nt
    v_mfma_f32_16x16x32_bf16 a[36:39], v[76:79], a[104:107], 0
    s_add_u32 s32, s67, 0x10000
    v_exp_f32 v12, v12
    v_mfma_f32_16x16x32_bf16 a[36:39], v[80:83], a[108:111], a[36:39]
    s_and_b32 s32, s32, 0x7ffff
    v_exp_f32 v13, v13
    v_mfma_f32_16x16x32_bf16 a[36:39], v[44:47], a[96:99], a[36:39]
    v_exp_f32 v14, v14
    v_mfma_f32_16x16x32_bf16 a[36:39], v[48:51], a[100:103], a[36:39]
    s_waitcnt vmcnt(14) lgkmcnt(0)
    v_exp_f32 v15, v15
    v_smfmac_f32_16x16x64_bf16 a[128:131], a[144:147], v[84:91], v236
    s_barrier
    v_mfma_f32_16x16x32_bf16 v[4:7], a[80:83], a[148:151], -4.0
    s_add_u32 s72, s14, s32
    v_exp_f32 v16, v16
    v_mfma_f32_16x16x32_bf16 v[4:7], a[84:87], a[152:155], v[4:7]
    ds_read_b128 a[64:67], v212 offset:49152
    v_cvt_pk_bf16_f32 v133, v14, v15
    v_mfma_f32_16x16x32_bf16 v[4:7], a[88:91], a[156:159], v[4:7]
    s_addc_u32 s73, s15, 0
    v_exp_f32 v17, v17
    v_mfma_f32_16x16x32_bf16 v[4:7], a[92:95], a[160:163], v[4:7]
    ds_read_b64_tr_b16 a[96:97], v222 offset:16384
    v_cvt_pk_bf16_f32 v132, v12, v13
    v_mfma_f32_16x16x32_bf16 v[8:11], a[88:91], a[172:175], -4.0
    v_exp_f32 v18, v18
    v_mfma_f32_16x16x32_bf16 v[8:11], a[92:95], a[176:179], v[8:11]
    ds_read_b64_tr_b16 a[98:99], v222 offset:18432
    v_cvt_pk_bf16_f32 v140, v16, v17
    v_mfma_f32_16x16x32_bf16 v[8:11], a[80:83], a[164:167], v[8:11]
    v_exp_f32 v19, v19
    v_mfma_f32_16x16x32_bf16 v[8:11], a[84:87], a[168:171], v[8:11]
    global_load_lds_dwordx4 v228, s[74:75] offset:2048 nt
    v_mfma_f32_16x16x32_bf16 v[12:15], a[80:83], a[180:183], -4.0
    v_exp_f32 v4, v4
    v_mfma_f32_16x16x32_bf16 v[12:15], a[84:87], a[184:187], v[12:15]
    ds_read_b128 a[68:71], v213 offset:49152
    v_cvt_pk_bf16_f32 v141, v18, v19
    v_mfma_f32_16x16x32_bf16 v[12:15], a[88:91], a[188:191], v[12:15]
    v_exp_f32 v5, v5
    v_mfma_f32_16x16x32_bf16 v[12:15], a[92:95], a[192:195], v[12:15]
    ds_read_b64_tr_b16 a[100:101], v222 offset:20480
    v_mfma_f32_16x16x32_bf16 v[16:19], a[88:91], a[204:207], -4.0
    v_exp_f32 v6, v6
    v_mfma_f32_16x16x32_bf16 v[16:19], a[92:95], a[208:211], v[16:19]
    ds_read_b64_tr_b16 a[102:103], v222 offset:22528
    v_cvt_pk_bf16_f32 v118, v4, v5
    v_mfma_f32_16x16x32_bf16 v[16:19], a[80:83], a[196:199], v[16:19]
    v_exp_f32 v7, v7
    v_mfma_f32_16x16x32_bf16 v[16:19], a[84:87], a[200:203], v[16:19]
    global_load_lds_dwordx4 v229, s[74:75] offset:3072 nt
    v_mfma_f32_16x16x32_bf16 v[188:191], v[20:23], a[112:115], 0
    v_exp_f32 v8, v8
    v_mfma_f32_16x16x32_bf16 v[188:191], v[24:27], a[116:119], v[188:191]
    ds_read_b128 a[72:75], v214 offset:49152
    v_cvt_pk_bf16_f32 v119, v6, v7
    v_mfma_f32_16x16x32_bf16 v[188:191], v[52:55], a[120:123], v[188:191]
    v_exp_f32 v9, v9
    v_mfma_f32_16x16x32_bf16 v[188:191], v[56:59], a[124:127], v[188:191]
    ds_read_b64_tr_b16 a[104:105], v222 offset:24576
    v_mfma_f32_16x16x32_bf16 v[192:195], v[60:63], a[120:123], 0
    s_add_u32 m0, s33, 0x0
    v_exp_f32 v10, v10
    v_mfma_f32_16x16x32_bf16 v[192:195], v[64:67], a[124:127], v[192:195]
    ds_read_b64_tr_b16 a[106:107], v222 offset:26624
    v_cvt_pk_bf16_f32 v126, v8, v9
    v_mfma_f32_16x16x32_bf16 v[192:195], v[28:31], a[112:115], v[192:195]
    v_exp_f32 v11, v11
    v_mfma_f32_16x16x32_bf16 v[192:195], v[32:35], a[116:119], v[192:195]
    global_load_lds_dwordx4 v224, s[72:73] nt
    v_mfma_f32_16x16x32_bf16 a[40:43], v[36:39], a[112:115], 0
    s_add_u32 s32, s64, 0x28000
    v_exp_f32 v12, v12
    v_mfma_f32_16x16x32_bf16 a[40:43], v[40:43], a[116:119], a[40:43]
    ds_read_b128 a[76:79], v215 offset:49152
    v_cvt_pk_bf16_f32 v127, v10, v11
    v_mfma_f32_16x16x32_bf16 a[40:43], v[68:71], a[120:123], a[40:43]
    s_and_b32 s32, s32, 0x7ffff
    v_exp_f32 v13, v13
    v_mfma_f32_16x16x32_bf16 a[40:43], v[72:75], a[124:127], a[40:43]
    ds_read_b64_tr_b16 a[108:109], v222 offset:28672
    v_mfma_f32_16x16x32_bf16 a[44:47], v[76:79], a[120:123], 0
    v_exp_f32 v14, v14
    v_mfma_f32_16x16x32_bf16 a[44:47], v[80:83], a[124:127], a[44:47]
    ds_read_b64_tr_b16 a[110:111], v222 offset:30720
    v_cvt_pk_bf16_f32 v134, v12, v13
    v_mfma_f32_16x16x32_bf16 a[44:47], v[44:47], a[112:115], a[44:47]
    s_waitcnt lgkmcnt(2)
    v_exp_f32 v15, v15
    v_mfma_f32_16x16x32_bf16 a[44:47], v[48:51], a[116:119], a[44:47]
    global_load_lds_dwordx4 v225, s[72:73] offset:1024 nt
    v_smfmac_f32_16x16x64_bf16 a[132:135], a[144:147], v[92:99], v236
    v_mfma_f32_16x16x32_bf16 v[4:7], a[64:67], a[148:151], -4.0
    s_add_u32 s74, s12, s32
    v_exp_f32 v16, v16
    v_mfma_f32_16x16x32_bf16 v[4:7], a[68:71], a[152:155], v[4:7]
    ds_read_b128 a[80:83], v212 offset:53248
    v_cvt_pk_bf16_f32 v135, v14, v15
    v_mfma_f32_16x16x32_bf16 v[4:7], a[72:75], a[156:159], v[4:7]
    s_addc_u32 s75, s13, 0
    v_exp_f32 v17, v17
    v_mfma_f32_16x16x32_bf16 v[4:7], a[76:79], a[160:163], v[4:7]
    ds_read_b64_tr_b16 a[112:113], v223 offset:16384
    v_mfma_f32_16x16x32_bf16 v[8:11], a[72:75], a[172:175], -4.0
    v_exp_f32 v18, v18
    v_mfma_f32_16x16x32_bf16 v[8:11], a[76:79], a[176:179], v[8:11]
    ds_read_b64_tr_b16 a[114:115], v223 offset:18432
    v_cvt_pk_bf16_f32 v142, v16, v17
    v_mfma_f32_16x16x32_bf16 v[8:11], a[64:67], a[164:167], v[8:11]
    s_waitcnt lgkmcnt(3)
    v_exp_f32 v19, v19
    v_mfma_f32_16x16x32_bf16 v[8:11], a[68:71], a[168:171], v[8:11]
    global_load_lds_dwordx4 v226, s[72:73] offset:2048 nt
    v_mfma_f32_16x16x32_bf16 v[12:15], a[64:67], a[180:183], -4.0
    v_exp_f32 v4, v4
    v_mfma_f32_16x16x32_bf16 v[12:15], a[68:71], a[184:187], v[12:15]
    ds_read_b128 a[84:87], v213 offset:53248
    v_cvt_pk_bf16_f32 v143, v18, v19
    v_mfma_f32_16x16x32_bf16 v[12:15], a[72:75], a[188:191], v[12:15]
    v_exp_f32 v5, v5
    v_mfma_f32_16x16x32_bf16 v[12:15], a[76:79], a[192:195], v[12:15]
    ds_read_b64_tr_b16 a[116:117], v223 offset:20480
    v_mfma_f32_16x16x32_bf16 v[16:19], a[72:75], a[204:207], -4.0
    v_exp_f32 v6, v6
    v_mfma_f32_16x16x32_bf16 v[16:19], a[76:79], a[208:211], v[16:19]
    ds_read_b64_tr_b16 a[118:119], v223 offset:22528
    v_cvt_pk_bf16_f32 v120, v4, v5
    v_mfma_f32_16x16x32_bf16 v[16:19], a[64:67], a[196:199], v[16:19]
    v_exp_f32 v7, v7
    v_mfma_f32_16x16x32_bf16 v[16:19], a[68:71], a[200:203], v[16:19]
    global_load_lds_dwordx4 v227, s[72:73] offset:3072 nt
    v_mfma_f32_16x16x32_bf16 v[196:199], v[20:23], a[96:99], 0
    v_exp_f32 v8, v8
    v_mfma_f32_16x16x32_bf16 v[196:199], v[24:27], a[100:103], v[196:199]
    ds_read_b128 a[88:91], v214 offset:53248
    v_cvt_pk_bf16_f32 v121, v6, v7
    v_mfma_f32_16x16x32_bf16 v[196:199], v[52:55], a[104:107], v[196:199]
    v_exp_f32 v9, v9
    v_mfma_f32_16x16x32_bf16 v[196:199], v[56:59], a[108:111], v[196:199]
    ds_read_b64_tr_b16 a[120:121], v223 offset:24576
    v_mfma_f32_16x16x32_bf16 v[200:203], v[60:63], a[104:107], 0
    s_add_u32 m0, s31, 0x8000
    v_exp_f32 v10, v10
    v_mfma_f32_16x16x32_bf16 v[200:203], v[64:67], a[108:111], v[200:203]
    ds_read_b64_tr_b16 a[122:123], v223 offset:26624
    v_cvt_pk_bf16_f32 v128, v8, v9
    v_mfma_f32_16x16x32_bf16 v[200:203], v[28:31], a[96:99], v[200:203]
    v_exp_f32 v11, v11
    v_mfma_f32_16x16x32_bf16 v[200:203], v[32:35], a[100:103], v[200:203]
    global_load_lds_dwordx4 v228, s[74:75] nt
    v_mfma_f32_16x16x32_bf16 a[48:51], v[36:39], a[96:99], 0
    ds_read_b128 a[92:95], v215 offset:53248
    v_cvt_pk_bf16_f32 v129, v10, v11
    v_mfma_f32_16x16x32_bf16 a[48:51], v[40:43], a[100:103], a[48:51]
    ds_read_b64_tr_b16 a[124:125], v223 offset:28672
    v_mfma_f32_16x16x32_bf16 a[48:51], v[68:71], a[104:107], a[48:51]
    ds_read_b64_tr_b16 a[126:127], v223 offset:30720
    v_mfma_f32_16x16x32_bf16 a[48:51], v[72:75], a[108:111], a[48:51]
    global_load_lds_dwordx4 v229, s[74:75] offset:1024 nt
    v_mfma_f32_16x16x32_bf16 a[52:55], v[76:79], a[104:107], 0
    s_add_u32 s32, s67, 0x18000
    v_exp_f32 v12, v12
    v_mfma_f32_16x16x32_bf16 a[52:55], v[80:83], a[108:111], a[52:55]
    s_and_b32 s32, s32, 0x7ffff
    v_exp_f32 v13, v13
    v_mfma_f32_16x16x32_bf16 a[52:55], v[44:47], a[96:99], a[52:55]
    v_exp_f32 v14, v14
    v_mfma_f32_16x16x32_bf16 a[52:55], v[48:51], a[100:103], a[52:55]
    s_waitcnt vmcnt(10) lgkmcnt(0)
    v_exp_f32 v15, v15
    v_smfmac_f32_16x16x64_bf16 a[136:139], a[144:147], v[100:107], v236
    s_barrier
    v_mfma_f32_16x16x32_bf16 v[4:7], a[80:83], a[148:151], -4.0
    s_add_u32 s72, s14, s32
    v_exp_f32 v16, v16
    v_mfma_f32_16x16x32_bf16 v[4:7], a[84:87], a[152:155], v[4:7]
    ds_read_b128 a[64:67], v212
    v_cvt_pk_bf16_f32 v137, v14, v15
    v_mfma_f32_16x16x32_bf16 v[4:7], a[88:91], a[156:159], v[4:7]
    s_addc_u32 s73, s15, 0
    v_exp_f32 v17, v17
    v_mfma_f32_16x16x32_bf16 v[4:7], a[92:95], a[160:163], v[4:7]
    ds_read_b64_tr_b16 a[96:97], v220 offset:32768
    v_cvt_pk_bf16_f32 v136, v12, v13
    v_mfma_f32_16x16x32_bf16 v[8:11], a[88:91], a[172:175], -4.0
    v_exp_f32 v18, v18
    v_mfma_f32_16x16x32_bf16 v[8:11], a[92:95], a[176:179], v[8:11]
    ds_read_b64_tr_b16 a[98:99], v220 offset:34816
    v_cvt_pk_bf16_f32 v144, v16, v17
    v_mfma_f32_16x16x32_bf16 v[8:11], a[80:83], a[164:167], v[8:11]
    v_exp_f32 v19, v19
    v_mfma_f32_16x16x32_bf16 v[8:11], a[84:87], a[168:171], v[8:11]
    global_load_lds_dwordx4 v228, s[74:75] offset:2048 nt
    v_mfma_f32_16x16x32_bf16 v[12:15], a[80:83], a[180:183], -4.0
    v_exp_f32 v4, v4
    v_mfma_f32_16x16x32_bf16 v[12:15], a[84:87], a[184:187], v[12:15]
    ds_read_b128 a[68:71], v213
    v_cvt_pk_bf16_f32 v145, v18, v19
    v_mfma_f32_16x16x32_bf16 v[12:15], a[88:91], a[188:191], v[12:15]
    v_exp_f32 v5, v5
    v_mfma_f32_16x16x32_bf16 v[12:15], a[92:95], a[192:195], v[12:15]
    ds_read_b64_tr_b16 a[100:101], v220 offset:36864
    v_mfma_f32_16x16x32_bf16 v[16:19], a[88:91], a[204:207], -4.0
    v_exp_f32 v6, v6
    v_mfma_f32_16x16x32_bf16 v[16:19], a[92:95], a[208:211], v[16:19]
    ds_read_b64_tr_b16 a[102:103], v220 offset:38912
    v_cvt_pk_bf16_f32 v122, v4, v5
    v_mfma_f32_16x16x32_bf16 v[16:19], a[80:83], a[196:199], v[16:19]
    v_exp_f32 v7, v7
    v_mfma_f32_16x16x32_bf16 v[16:19], a[84:87], a[200:203], v[16:19]
    global_load_lds_dwordx4 v229, s[74:75] offset:3072 nt
    v_mfma_f32_16x16x32_bf16 v[204:207], v[20:23], a[112:115], 0
    v_exp_f32 v8, v8
    v_mfma_f32_16x16x32_bf16 v[204:207], v[24:27], a[116:119], v[204:207]
    ds_read_b128 a[72:75], v214
    v_cvt_pk_bf16_f32 v123, v6, v7
    v_mfma_f32_16x16x32_bf16 v[204:207], v[52:55], a[120:123], v[204:207]
    v_exp_f32 v9, v9
    v_mfma_f32_16x16x32_bf16 v[204:207], v[56:59], a[124:127], v[204:207]
    ds_read_b64_tr_b16 a[104:105], v220 offset:40960
    v_mfma_f32_16x16x32_bf16 v[208:211], v[60:63], a[120:123], 0
    s_add_u32 m0, s33, 0x2000
    v_exp_f32 v10, v10
    v_mfma_f32_16x16x32_bf16 v[208:211], v[64:67], a[124:127], v[208:211]
    ds_read_b64_tr_b16 a[106:107], v220 offset:43008
    v_cvt_pk_bf16_f32 v130, v8, v9
    v_mfma_f32_16x16x32_bf16 v[208:211], v[28:31], a[112:115], v[208:211]
    v_exp_f32 v11, v11
    v_mfma_f32_16x16x32_bf16 v[208:211], v[32:35], a[116:119], v[208:211]
    global_load_lds_dwordx4 v224, s[72:73] nt
    v_mfma_f32_16x16x32_bf16 a[56:59], v[36:39], a[112:115], 0
    s_add_u32 s32, s65, 0x28000
    v_exp_f32 v12, v12
    v_mfma_f32_16x16x32_bf16 a[56:59], v[40:43], a[116:119], a[56:59]
    ds_read_b128 a[76:79], v215
    v_cvt_pk_bf16_f32 v131, v10, v11
    v_mfma_f32_16x16x32_bf16 a[56:59], v[68:71], a[120:123], a[56:59]
    s_and_b32 s32, s32, 0x7ffff
    v_exp_f32 v13, v13
    v_mfma_f32_16x16x32_bf16 a[56:59], v[72:75], a[124:127], a[56:59]
    ds_read_b64_tr_b16 a[108:109], v220 offset:45056
    v_mfma_f32_16x16x32_bf16 a[60:63], v[76:79], a[120:123], 0
    v_exp_f32 v14, v14
    v_mfma_f32_16x16x32_bf16 a[60:63], v[80:83], a[124:127], a[60:63]
    ds_read_b64_tr_b16 a[110:111], v220 offset:47104
    v_cvt_pk_bf16_f32 v138, v12, v13
    v_mfma_f32_16x16x32_bf16 a[60:63], v[44:47], a[112:115], a[60:63]
    s_waitcnt lgkmcnt(2)
    v_exp_f32 v15, v15
    v_mfma_f32_16x16x32_bf16 a[60:63], v[48:51], a[116:119], a[60:63]
    global_load_lds_dwordx4 v225, s[72:73] offset:1024 nt
    v_smfmac_f32_16x16x64_bf16 a[140:143], a[144:147], v[108:115], v236
    v_mfma_f32_16x16x32_bf16 v[4:7], a[64:67], a[148:151], -4.0
    s_add_u32 s74, s12, s32
    v_exp_f32 v16, v16
    v_mfma_f32_16x16x32_bf16 v[4:7], a[68:71], a[152:155], v[4:7]
    ds_read_b128 a[80:83], v212 offset:4096
    v_cvt_pk_bf16_f32 v139, v14, v15
    v_mfma_f32_16x16x32_bf16 v[4:7], a[72:75], a[156:159], v[4:7]
    s_addc_u32 s75, s13, 0
    v_exp_f32 v17, v17
    v_mfma_f32_16x16x32_bf16 v[4:7], a[76:79], a[160:163], v[4:7]
    ds_read_b64_tr_b16 a[112:113], v221 offset:32768
    v_lshlrev_b32 v248, 4, v0
    v_mfma_f32_16x16x32_bf16 v[8:11], a[72:75], a[172:175], -4.0
    v_exp_f32 v18, v18
    v_mfma_f32_16x16x32_bf16 v[8:11], a[76:79], a[176:179], v[8:11]
    ds_read_b64_tr_b16 a[114:115], v221 offset:34816
    v_cvt_pk_bf16_f32 v146, v16, v17
    v_mfma_f32_16x16x32_bf16 v[8:11], a[64:67], a[164:167], v[8:11]
    s_waitcnt lgkmcnt(3)
    v_exp_f32 v19, v19
    v_mfma_f32_16x16x32_bf16 v[8:11], a[68:71], a[168:171], v[8:11]
    global_load_lds_dwordx4 v226, s[72:73] offset:2048 nt
    v_add_u32 v240, s86, v248
    v_mfma_f32_16x16x32_bf16 v[12:15], a[64:67], a[180:183], -4.0
    v_exp_f32 v4, v4
    v_mfma_f32_16x16x32_bf16 v[12:15], a[68:71], a[184:187], v[12:15]
    ds_read_b128 a[84:87], v213 offset:4096
    v_cvt_pk_bf16_f32 v147, v18, v19
    v_mfma_f32_16x16x32_bf16 v[12:15], a[72:75], a[188:191], v[12:15]
    v_exp_f32 v5, v5
    v_mfma_f32_16x16x32_bf16 v[12:15], a[76:79], a[192:195], v[12:15]
    ds_read_b64_tr_b16 a[116:117], v221 offset:36864
    v_xor_b32 v241, 0x800, v240
    v_mfma_f32_16x16x32_bf16 v[16:19], a[72:75], a[204:207], -4.0
    v_exp_f32 v6, v6
    v_mfma_f32_16x16x32_bf16 v[16:19], a[76:79], a[208:211], v[16:19]
    ds_read_b64_tr_b16 a[118:119], v221 offset:38912
    v_cvt_pk_bf16_f32 v20, v4, v5
    v_mfma_f32_16x16x32_bf16 v[16:19], a[64:67], a[196:199], v[16:19]
    v_exp_f32 v7, v7
    v_mfma_f32_16x16x32_bf16 v[16:19], a[68:71], a[200:203], v[16:19]
    global_load_lds_dwordx4 v227, s[72:73] offset:3072 nt
    v_add_u32 v239, s85, v248
    v_mfma_f32_16x16x32_bf16 v[148:151], v[84:87], a[96:99], v[148:151]
L_stub2:
    s_cbranch_execz L_stub6
    v_exp_f32 v8, v8
    v_mfma_f32_16x16x32_bf16 v[148:151], v[88:91], a[100:103], v[148:151]
    ds_read_b128 a[88:91], v214 offset:4096
    v_cvt_pk_bf16_f32 v21, v6, v7
    v_mfma_f32_16x16x32_bf16 v[148:151], v[116:119], a[104:107], v[148:151]
    v_exp_f32 v9, v9
    v_mfma_f32_16x16x32_bf16 v[148:151], v[120:123], a[108:111], v[148:151]
    ds_read_b64_tr_b16 a[120:121], v221 offset:40960
    v_xor_b32 v238, 0x1000, v239
    v_mfma_f32_16x16x32_bf16 v[152:155], v[124:127], a[104:107], v[152:155]
    s_add_u32 m0, s31, 0xc000
    v_exp_f32 v10, v10
    v_mfma_f32_16x16x32_bf16 v[152:155], v[128:131], a[108:111], v[152:155]
    ds_read_b64_tr_b16 a[122:123], v221 offset:43008
    v_cvt_pk_bf16_f32 v28, v8, v9
    v_mfma_f32_16x16x32_bf16 v[152:155], v[92:95], a[96:99], v[152:155]
    v_exp_f32 v11, v11
    v_mfma_f32_16x16x32_bf16 v[152:155], v[96:99], a[100:103], v[152:155]
    global_load_lds_dwordx4 v228, s[74:75] nt
    v_lshrrev_b32 v249, 2, v0
    v_mfma_f32_16x16x32_bf16 a[0:3], v[100:103], a[96:99], a[0:3]
    ds_read_b128 a[92:95], v215 offset:4096
    v_cvt_pk_bf16_f32 v29, v10, v11
    v_mfma_f32_16x16x32_bf16 a[0:3], v[104:107], a[100:103], a[0:3]
    ds_read_b64_tr_b16 a[124:125], v221 offset:45056
    v_lshrrev_b32 v250, 3, v0
    v_mfma_f32_16x16x32_bf16 a[0:3], v[132:135], a[104:107], a[0:3]
    ds_read_b64_tr_b16 a[126:127], v221 offset:47104
    v_lshlrev_b32 v242, 8, v250
    v_mfma_f32_16x16x32_bf16 a[0:3], v[136:139], a[108:111], a[0:3]
    global_load_lds_dwordx4 v229, s[74:75] offset:1024 nt
    v_mfma_f32_16x16x32_bf16 a[4:7], v[140:143], a[104:107], a[4:7]
    s_add_u32 s32, s66, 0x20000
    v_exp_f32 v12, v12
    v_mfma_f32_16x16x32_bf16 a[4:7], v[144:147], a[108:111], a[4:7]
    s_and_b32 s32, s32, 0x7ffff
    v_exp_f32 v13, v13
    v_mfma_f32_16x16x32_bf16 a[4:7], v[108:111], a[96:99], a[4:7]
    v_exp_f32 v14, v14
    v_mfma_f32_16x16x32_bf16 a[4:7], v[112:115], a[100:103], a[4:7]
    s_waitcnt vmcnt(14) lgkmcnt(0)
    v_exp_f32 v15, v15
    v_smfmac_f32_16x16x64_bf16 a[128:131], a[144:147], v[116:123], v236
    s_barrier
    v_mfma_f32_16x16x32_bf16 v[4:7], a[80:83], a[148:151], -4.0
    s_add_u32 s72, s14, s32
    v_exp_f32 v16, v16
    v_mfma_f32_16x16x32_bf16 v[4:7], a[84:87], a[152:155], v[4:7]
    ds_read_b128 a[64:67], v212 offset:16384
    v_cvt_pk_bf16_f32 v37, v14, v15
    v_mfma_f32_16x16x32_bf16 v[4:7], a[88:91], a[156:159], v[4:7]
    s_addc_u32 s73, s15, 0
    v_exp_f32 v17, v17
    v_mfma_f32_16x16x32_bf16 v[4:7], a[92:95], a[160:163], v[4:7]
    ds_read_b64_tr_b16 a[96:97], v222 offset:32768
    v_cvt_pk_bf16_f32 v36, v12, v13
    v_mfma_f32_16x16x32_bf16 v[8:11], a[88:91], a[172:175], -4.0
    v_exp_f32 v18, v18
    v_mfma_f32_16x16x32_bf16 v[8:11], a[92:95], a[176:179], v[8:11]
    ds_read_b64_tr_b16 a[98:99], v222 offset:34816
    v_cvt_pk_bf16_f32 v44, v16, v17
    v_mfma_f32_16x16x32_bf16 v[8:11], a[80:83], a[164:167], v[8:11]
    v_exp_f32 v19, v19
    v_mfma_f32_16x16x32_bf16 v[8:11], a[84:87], a[168:171], v[8:11]
    global_load_lds_dwordx4 v228, s[74:75] offset:2048 nt
    v_and_b32 v250, 7, v0
    v_mfma_f32_16x16x32_bf16 v[12:15], a[80:83], a[180:183], -4.0
    v_exp_f32 v4, v4
    v_mfma_f32_16x16x32_bf16 v[12:15], a[84:87], a[184:187], v[12:15]
    ds_read_b128 a[68:71], v213 offset:16384
    v_cvt_pk_bf16_f32 v45, v18, v19
    v_mfma_f32_16x16x32_bf16 v[12:15], a[88:91], a[188:191], v[12:15]
    v_exp_f32 v5, v5
    v_mfma_f32_16x16x32_bf16 v[12:15], a[92:95], a[192:195], v[12:15]
    ds_read_b64_tr_b16 a[100:101], v222 offset:36864
    v_lshl_add_u32 v242, v250, 4, v242
    v_mfma_f32_16x16x32_bf16 v[16:19], a[88:91], a[204:207], -4.0
    v_exp_f32 v6, v6
    v_mfma_f32_16x16x32_bf16 v[16:19], a[92:95], a[208:211], v[16:19]
    ds_read_b64_tr_b16 a[102:103], v222 offset:38912
    v_cvt_pk_bf16_f32 v22, v4, v5
    v_mfma_f32_16x16x32_bf16 v[16:19], a[80:83], a[196:199], v[16:19]
    v_exp_f32 v7, v7
    v_mfma_f32_16x16x32_bf16 v[16:19], a[84:87], a[200:203], v[16:19]
    global_load_lds_dwordx4 v229, s[74:75] offset:3072 nt
    v_add_u32 v242, s47, v242
    v_mfma_f32_16x16x32_bf16 v[156:159], v[84:87], a[112:115], v[156:159]
    v_exp_f32 v8, v8
    v_mfma_f32_16x16x32_bf16 v[156:159], v[88:91], a[116:119], v[156:159]
    ds_read_b128 a[72:75], v214 offset:16384
    v_cvt_pk_bf16_f32 v23, v6, v7
    v_mfma_f32_16x16x32_bf16 v[156:159], v[116:119], a[120:123], v[156:159]
    v_exp_f32 v9, v9
    v_mfma_f32_16x16x32_bf16 v[156:159], v[120:123], a[124:127], v[156:159]
    ds_read_b64_tr_b16 a[104:105], v222 offset:40960
    v_and_b32 v248, 1, v2
    v_mfma_f32_16x16x32_bf16 v[160:163], v[124:127], a[120:123], v[160:163]
    s_add_u32 m0, s33, 0x4000
    v_exp_f32 v10, v10
    v_mfma_f32_16x16x32_bf16 v[160:163], v[128:131], a[124:127], v[160:163]
    ds_read_b64_tr_b16 a[106:107], v222 offset:43008
    v_cvt_pk_bf16_f32 v30, v8, v9
    v_mfma_f32_16x16x32_bf16 v[160:163], v[92:95], a[112:115], v[160:163]
    v_exp_f32 v11, v11
    v_mfma_f32_16x16x32_bf16 v[160:163], v[96:99], a[116:119], v[160:163]
    global_load_lds_dwordx4 v224, s[72:73] nt
    v_lshlrev_b32 v248, 3, v248
    v_mfma_f32_16x16x32_bf16 a[8:11], v[100:103], a[112:115], a[8:11]
    s_add_u32 s32, s64, 0x30000
    v_exp_f32 v12, v12
    v_mfma_f32_16x16x32_bf16 a[8:11], v[104:107], a[116:119], a[8:11]
    ds_read_b128 a[76:79], v215 offset:16384
    v_cvt_pk_bf16_f32 v31, v10, v11
    v_mfma_f32_16x16x32_bf16 a[8:11], v[132:135], a[120:123], a[8:11]
    s_and_b32 s32, s32, 0x7ffff
    v_exp_f32 v13, v13
    v_mfma_f32_16x16x32_bf16 a[8:11], v[136:139], a[124:127], a[8:11]
    ds_read_b64_tr_b16 a[108:109], v222 offset:45056
    v_xor_b32 v248, v248, v1
    v_mfma_f32_16x16x32_bf16 a[12:15], v[140:143], a[120:123], a[12:15]
    v_exp_f32 v14, v14
    v_mfma_f32_16x16x32_bf16 a[12:15], v[144:147], a[124:127], a[12:15]
    ds_read_b64_tr_b16 a[110:111], v222 offset:47104
    v_cvt_pk_bf16_f32 v38, v12, v13
    v_mfma_f32_16x16x32_bf16 a[12:15], v[108:111], a[112:115], a[12:15]
    s_waitcnt lgkmcnt(2)
    v_exp_f32 v15, v15
    v_mfma_f32_16x16x32_bf16 a[12:15], v[112:115], a[116:119], a[12:15]
    global_load_lds_dwordx4 v225, s[72:73] offset:1024 nt
    v_lshlrev_b32 v248, 3, v248
    v_smfmac_f32_16x16x64_bf16 a[132:135], a[144:147], v[124:131], v236
    v_lshl_add_u32 v248, v2, 9, v248
    v_mfma_f32_16x16x32_bf16 v[4:7], a[64:67], a[148:151], -4.0
    s_add_u32 s74, s12, s32
    v_exp_f32 v16, v16
    v_mfma_f32_16x16x32_bf16 v[4:7], a[68:71], a[152:155], v[4:7]
    ds_read_b128 a[80:83], v212 offset:20480
    v_cvt_pk_bf16_f32 v39, v14, v15
    v_mfma_f32_16x16x32_bf16 v[4:7], a[72:75], a[156:159], v[4:7]
    s_addc_u32 s75, s13, 0
    v_exp_f32 v17, v17
    v_mfma_f32_16x16x32_bf16 v[4:7], a[76:79], a[160:163], v[4:7]
    ds_read_b64_tr_b16 a[112:113], v223 offset:32768
    v_add_u32 v243, s84, v248
    v_mfma_f32_16x16x32_bf16 v[8:11], a[72:75], a[172:175], -4.0
    v_exp_f32 v18, v18
    v_mfma_f32_16x16x32_bf16 v[8:11], a[76:79], a[176:179], v[8:11]
    ds_read_b64_tr_b16 a[114:115], v223 offset:34816
    v_cvt_pk_bf16_f32 v46, v16, v17
    v_mfma_f32_16x16x32_bf16 v[8:11], a[64:67], a[164:167], v[8:11]
    s_waitcnt lgkmcnt(3)
    v_exp_f32 v19, v19
    v_mfma_f32_16x16x32_bf16 v[8:11], a[68:71], a[168:171], v[8:11]
    global_load_lds_dwordx4 v226, s[72:73] offset:2048 nt
    v_xor_b32 v244, 32, v243
    v_mfma_f32_16x16x32_bf16 v[12:15], a[64:67], a[180:183], -4.0
    v_exp_f32 v4, v4
    v_mfma_f32_16x16x32_bf16 v[12:15], a[68:71], a[184:187], v[12:15]
    ds_read_b128 a[84:87], v213 offset:20480
    v_cvt_pk_bf16_f32 v47, v18, v19
    v_mfma_f32_16x16x32_bf16 v[12:15], a[72:75], a[188:191], v[12:15]
    v_exp_f32 v5, v5
    v_mfma_f32_16x16x32_bf16 v[12:15], a[76:79], a[192:195], v[12:15]
    ds_read_b64_tr_b16 a[116:117], v223 offset:36864
    v_bfe_u32 v248, v0, 1, 1
    v_mfma_f32_16x16x32_bf16 v[16:19], a[72:75], a[204:207], -4.0
    v_exp_f32 v6, v6
    v_mfma_f32_16x16x32_bf16 v[16:19], a[76:79], a[208:211], v[16:19]
    ds_read_b64_tr_b16 a[118:119], v223 offset:38912
    v_cvt_pk_bf16_f32 v24, v4, v5
    v_mfma_f32_16x16x32_bf16 v[16:19], a[64:67], a[196:199], v[16:19]
    v_exp_f32 v7, v7
    v_mfma_f32_16x16x32_bf16 v[16:19], a[68:71], a[200:203], v[16:19]
    global_load_lds_dwordx4 v227, s[72:73] offset:3072 nt
    v_lshl_add_u32 v248, v2, 1, v248
    v_mfma_f32_16x16x32_bf16 v[164:167], v[84:87], a[96:99], v[164:167]
    v_exp_f32 v8, v8
    v_mfma_f32_16x16x32_bf16 v[164:167], v[88:91], a[100:103], v[164:167]
    ds_read_b128 a[88:91], v214 offset:20480
    v_cvt_pk_bf16_f32 v25, v6, v7
    v_mfma_f32_16x16x32_bf16 v[164:167], v[116:119], a[104:107], v[164:167]
    v_exp_f32 v9, v9
    v_mfma_f32_16x16x32_bf16 v[164:167], v[120:123], a[108:111], v[164:167]
    ds_read_b64_tr_b16 a[120:121], v223 offset:40960
    v_lshlrev_b32 v248, 7, v248
    v_mfma_f32_16x16x32_bf16 v[168:171], v[124:127], a[104:107], v[168:171]
    s_add_u32 m0, s31, 0x0
    v_exp_f32 v10, v10
    v_mfma_f32_16x16x32_bf16 v[168:171], v[128:131], a[108:111], v[168:171]
    ds_read_b64_tr_b16 a[122:123], v223 offset:43008
    v_cvt_pk_bf16_f32 v32, v8, v9
    v_mfma_f32_16x16x32_bf16 v[168:171], v[92:95], a[96:99], v[168:171]
    v_exp_f32 v11, v11
    v_mfma_f32_16x16x32_bf16 v[168:171], v[96:99], a[100:103], v[168:171]
    global_load_lds_dwordx4 v228, s[74:75] nt
    v_and_b32 v250, 1, v0
    v_mfma_f32_16x16x32_bf16 a[16:19], v[100:103], a[96:99], a[16:19]
    ds_read_b128 a[92:95], v215 offset:20480
    v_cvt_pk_bf16_f32 v33, v10, v11
    v_mfma_f32_16x16x32_bf16 a[16:19], v[104:107], a[100:103], a[16:19]
    ds_read_b64_tr_b16 a[124:125], v223 offset:45056
    v_lshlrev_b32 v250, 1, v250
    v_mfma_f32_16x16x32_bf16 a[16:19], v[132:135], a[104:107], a[16:19]
    ds_read_b64_tr_b16 a[126:127], v223 offset:47104
    v_xor_b32 v250, v250, v2
    v_mfma_f32_16x16x32_bf16 a[16:19], v[136:139], a[108:111], a[16:19]
    global_load_lds_dwordx4 v229, s[74:75] offset:1024 nt
    v_mfma_f32_16x16x32_bf16 a[20:23], v[140:143], a[104:107], a[20:23]
    s_add_u32 s32, s66, 0x28000
    v_exp_f32 v12, v12
    v_mfma_f32_16x16x32_bf16 a[20:23], v[144:147], a[108:111], a[20:23]
    s_and_b32 s32, s32, 0x7ffff
    v_exp_f32 v13, v13
    v_mfma_f32_16x16x32_bf16 a[20:23], v[108:111], a[96:99], a[20:23]
    v_exp_f32 v14, v14
    v_mfma_f32_16x16x32_bf16 a[20:23], v[112:115], a[100:103], a[20:23]
    s_waitcnt vmcnt(10) lgkmcnt(0)
    v_exp_f32 v15, v15
    v_smfmac_f32_16x16x64_bf16 a[136:139], a[144:147], v[132:139], v236
    s_barrier
    v_mfma_f32_16x16x32_bf16 v[4:7], a[80:83], a[148:151], -4.0
    s_add_u32 s72, s14, s32
    v_exp_f32 v16, v16
    v_mfma_f32_16x16x32_bf16 v[4:7], a[84:87], a[152:155], v[4:7]
    ds_read_b128 a[64:67], v212 offset:32768
    v_cvt_pk_bf16_f32 v41, v14, v15
    v_mfma_f32_16x16x32_bf16 v[4:7], a[88:91], a[156:159], v[4:7]
    s_addc_u32 s73, s15, 0
    v_exp_f32 v17, v17
    v_mfma_f32_16x16x32_bf16 v[4:7], a[92:95], a[160:163], v[4:7]
    ds_read_b64_tr_b16 a[96:97], v220
    v_cvt_pk_bf16_f32 v40, v12, v13
    v_mfma_f32_16x16x32_bf16 v[8:11], a[88:91], a[172:175], -4.0
    v_exp_f32 v18, v18
    v_mfma_f32_16x16x32_bf16 v[8:11], a[92:95], a[176:179], v[8:11]
    ds_read_b64_tr_b16 a[98:99], v220 offset:2048
    v_cvt_pk_bf16_f32 v48, v16, v17
    v_mfma_f32_16x16x32_bf16 v[8:11], a[80:83], a[164:167], v[8:11]
    v_exp_f32 v19, v19
    v_mfma_f32_16x16x32_bf16 v[8:11], a[84:87], a[168:171], v[8:11]
    global_load_lds_dwordx4 v228, s[74:75] offset:2048 nt
    v_lshl_add_u32 v248, v250, 5, v248
    v_mfma_f32_16x16x32_bf16 v[12:15], a[80:83], a[180:183], -4.0
    v_exp_f32 v4, v4
    v_mfma_f32_16x16x32_bf16 v[12:15], a[84:87], a[184:187], v[12:15]
    ds_read_b128 a[68:71], v213 offset:32768
    v_cvt_pk_bf16_f32 v49, v18, v19
    v_mfma_f32_16x16x32_bf16 v[12:15], a[88:91], a[188:191], v[12:15]
    v_exp_f32 v5, v5
    v_mfma_f32_16x16x32_bf16 v[12:15], a[92:95], a[192:195], v[12:15]
    ds_read_b64_tr_b16 a[100:101], v220 offset:4096
    v_and_b32 v249, 3, v249
    v_mfma_f32_16x16x32_bf16 v[16:19], a[88:91], a[204:207], -4.0
    v_exp_f32 v6, v6
    v_mfma_f32_16x16x32_bf16 v[16:19], a[92:95], a[208:211], v[16:19]
    ds_read_b64_tr_b16 a[102:103], v220 offset:6144
    v_cvt_pk_bf16_f32 v26, v4, v5
    v_mfma_f32_16x16x32_bf16 v[16:19], a[80:83], a[196:199], v[16:19]
    v_exp_f32 v7, v7
    v_mfma_f32_16x16x32_bf16 v[16:19], a[84:87], a[200:203], v[16:19]
    global_load_lds_dwordx4 v229, s[74:75] offset:3072 nt
    v_lshl_add_u32 v248, v249, 3, v248
    v_mfma_f32_16x16x32_bf16 v[172:175], v[84:87], a[112:115], v[172:175]
    v_exp_f32 v8, v8
    v_mfma_f32_16x16x32_bf16 v[172:175], v[88:91], a[116:119], v[172:175]
    ds_read_b128 a[72:75], v214 offset:32768
    v_cvt_pk_bf16_f32 v27, v6, v7
    v_mfma_f32_16x16x32_bf16 v[172:175], v[116:119], a[120:123], v[172:175]
    v_exp_f32 v9, v9
    v_mfma_f32_16x16x32_bf16 v[172:175], v[120:123], a[124:127], v[172:175]
    ds_read_b64_tr_b16 a[104:105], v220 offset:8192
    v_add_u32 v245, s84, v248
    v_mfma_f32_16x16x32_bf16 v[176:179], v[124:127], a[120:123], v[176:179]
    s_add_u32 m0, s33, 0x6000
    v_exp_f32 v10, v10
    v_mfma_f32_16x16x32_bf16 v[176:179], v[128:131], a[124:127], v[176:179]
    ds_read_b64_tr_b16 a[106:107], v220 offset:10240
    v_cvt_pk_bf16_f32 v34, v8, v9
    v_mfma_f32_16x16x32_bf16 v[176:179], v[92:95], a[112:115], v[176:179]
    v_exp_f32 v11, v11
    v_mfma_f32_16x16x32_bf16 v[176:179], v[96:99], a[116:119], v[176:179]
    global_load_lds_dwordx4 v224, s[72:73] nt
    v_xor_b32 v246, 32, v245
    v_mfma_f32_16x16x32_bf16 a[24:27], v[100:103], a[112:115], a[24:27]
    s_add_u32 s32, s65, 0x30000
    v_exp_f32 v12, v12
    v_mfma_f32_16x16x32_bf16 a[24:27], v[104:107], a[116:119], a[24:27]
    ds_read_b128 a[76:79], v215 offset:32768
    v_cvt_pk_bf16_f32 v35, v10, v11
    v_mfma_f32_16x16x32_bf16 a[24:27], v[132:135], a[120:123], a[24:27]
    s_and_b32 s32, s32, 0x7ffff
    v_exp_f32 v13, v13
    v_mfma_f32_16x16x32_bf16 a[24:27], v[136:139], a[124:127], a[24:27]
    ds_read_b64_tr_b16 a[108:109], v220 offset:12288
    v_mov_b32 v237, 0x3e800000
    v_mfma_f32_16x16x32_bf16 a[28:31], v[140:143], a[120:123], a[28:31]
    v_exp_f32 v14, v14
    v_mfma_f32_16x16x32_bf16 a[28:31], v[144:147], a[124:127], a[28:31]
    ds_read_b64_tr_b16 a[110:111], v220 offset:14336
    v_cvt_pk_bf16_f32 v42, v12, v13
    v_mfma_f32_16x16x32_bf16 a[28:31], v[108:111], a[112:115], a[28:31]
    s_waitcnt lgkmcnt(2)
    v_exp_f32 v15, v15
    v_mfma_f32_16x16x32_bf16 a[28:31], v[112:115], a[116:119], a[28:31]
    global_load_lds_dwordx4 v225, s[72:73] offset:1024 nt
    v_smfmac_f32_16x16x64_bf16 a[140:143], a[144:147], v[140:147], v236
    v_mfma_f32_16x16x32_bf16 v[4:7], a[64:67], a[148:151], -4.0
    s_add_u32 s74, s12, s32
    v_exp_f32 v16, v16
    v_mfma_f32_16x16x32_bf16 v[4:7], a[68:71], a[152:155], v[4:7]
    ds_read_b128 a[80:83], v212 offset:36864
    v_cvt_pk_bf16_f32 v43, v14, v15
    v_mfma_f32_16x16x32_bf16 v[4:7], a[72:75], a[156:159], v[4:7]
    s_addc_u32 s75, s13, 0
    v_exp_f32 v17, v17
    v_mfma_f32_16x16x32_bf16 v[4:7], a[76:79], a[160:163], v[4:7]
    ds_read_b64_tr_b16 a[112:113], v221
    v_mfma_f32_16x16x32_bf16 v[8:11], a[72:75], a[172:175], -4.0
    v_exp_f32 v18, v18
    v_mfma_f32_16x16x32_bf16 v[8:11], a[76:79], a[176:179], v[8:11]
    ds_read_b64_tr_b16 a[114:115], v221 offset:2048
    v_cvt_pk_bf16_f32 v50, v16, v17
    v_mfma_f32_16x16x32_bf16 v[8:11], a[64:67], a[164:167], v[8:11]
    s_waitcnt lgkmcnt(3)
    v_exp_f32 v19, v19
    v_mfma_f32_16x16x32_bf16 v[8:11], a[68:71], a[168:171], v[8:11]
    global_load_lds_dwordx4 v226, s[72:73] offset:2048 nt
    v_mfma_f32_16x16x32_bf16 v[12:15], a[64:67], a[180:183], -4.0
    v_exp_f32 v4, v4
    v_mfma_f32_16x16x32_bf16 v[12:15], a[68:71], a[184:187], v[12:15]
    ds_read_b128 a[84:87], v213 offset:36864
    v_cvt_pk_bf16_f32 v51, v18, v19
    v_mfma_f32_16x16x32_bf16 v[12:15], a[72:75], a[188:191], v[12:15]
    v_exp_f32 v5, v5
    v_mfma_f32_16x16x32_bf16 v[12:15], a[76:79], a[192:195], v[12:15]
    ds_read_b64_tr_b16 a[116:117], v221 offset:4096
    v_mfma_f32_16x16x32_bf16 v[16:19], a[72:75], a[204:207], -4.0
    v_exp_f32 v6, v6
    v_mfma_f32_16x16x32_bf16 v[16:19], a[76:79], a[208:211], v[16:19]
    ds_read_b64_tr_b16 a[118:119], v221 offset:6144
    v_cvt_pk_bf16_f32 v52, v4, v5
    v_mfma_f32_16x16x32_bf16 v[16:19], a[64:67], a[196:199], v[16:19]
    v_exp_f32 v7, v7
    v_mfma_f32_16x16x32_bf16 v[16:19], a[68:71], a[200:203], v[16:19]
    global_load_lds_dwordx4 v227, s[72:73] offset:3072 nt
    v_mfma_f32_16x16x32_bf16 v[180:183], v[84:87], a[96:99], v[180:183]
    v_exp_f32 v8, v8
    v_mfma_f32_16x16x32_bf16 v[180:183], v[88:91], a[100:103], v[180:183]
    ds_read_b128 a[88:91], v214 offset:36864
    v_cvt_pk_bf16_f32 v53, v6, v7
    v_mfma_f32_16x16x32_bf16 v[180:183], v[116:119], a[104:107], v[180:183]
    v_exp_f32 v9, v9
    v_mfma_f32_16x16x32_bf16 v[180:183], v[120:123], a[108:111], v[180:183]
    ds_read_b64_tr_b16 a[120:121], v221 offset:8192
    v_mfma_f32_16x16x32_bf16 v[184:187], v[124:127], a[104:107], v[184:187]
    s_add_u32 m0, s31, 0x4000
    v_exp_f32 v10, v10
    v_mfma_f32_16x16x32_bf16 v[184:187], v[128:131], a[108:111], v[184:187]
    ds_read_b64_tr_b16 a[122:123], v221 offset:10240
    v_cvt_pk_bf16_f32 v60, v8, v9
    v_mfma_f32_16x16x32_bf16 v[184:187], v[92:95], a[96:99], v[184:187]
    v_exp_f32 v11, v11
    v_mfma_f32_16x16x32_bf16 v[184:187], v[96:99], a[100:103], v[184:187]
    global_load_lds_dwordx4 v228, s[74:75] nt
    v_mfma_f32_16x16x32_bf16 a[32:35], v[100:103], a[96:99], a[32:35]
    ds_read_b128 a[92:95], v215 offset:36864
    v_cvt_pk_bf16_f32 v61, v10, v11
    v_mfma_f32_16x16x32_bf16 a[32:35], v[104:107], a[100:103], a[32:35]
    ds_read_b64_tr_b16 a[124:125], v221 offset:12288
    v_mfma_f32_16x16x32_bf16 a[32:35], v[132:135], a[104:107], a[32:35]
    ds_read_b64_tr_b16 a[126:127], v221 offset:14336
    v_mfma_f32_16x16x32_bf16 a[32:35], v[136:139], a[108:111], a[32:35]
    global_load_lds_dwordx4 v229, s[74:75] offset:1024 nt
    v_mfma_f32_16x16x32_bf16 a[36:39], v[140:143], a[104:107], a[36:39]
    s_add_u32 s32, s67, 0x20000
    v_exp_f32 v12, v12
    v_mfma_f32_16x16x32_bf16 a[36:39], v[144:147], a[108:111], a[36:39]
    s_and_b32 s32, s32, 0x7ffff
    v_exp_f32 v13, v13
    v_mfma_f32_16x16x32_bf16 a[36:39], v[108:111], a[96:99], a[36:39]
    v_exp_f32 v14, v14
    v_mfma_f32_16x16x32_bf16 a[36:39], v[112:115], a[100:103], a[36:39]
    s_waitcnt vmcnt(14) lgkmcnt(0)
    v_exp_f32 v15, v15
    v_smfmac_f32_16x16x64_bf16 a[128:131], a[144:147], v[20:27], v236
    s_barrier
    v_mfma_f32_16x16x32_bf16 v[4:7], a[80:83], a[148:151], -4.0
    s_add_u32 s72, s14, s32
    v_exp_f32 v16, v16
    v_mfma_f32_16x16x32_bf16 v[4:7], a[84:87], a[152:155], v[4:7]
    ds_read_b128 a[64:67], v212 offset:49152
    v_cvt_pk_bf16_f32 v69, v14, v15
    v_mfma_f32_16x16x32_bf16 v[4:7], a[88:91], a[156:159], v[4:7]
    s_addc_u32 s73, s15, 0
    v_exp_f32 v17, v17
    v_mfma_f32_16x16x32_bf16 v[4:7], a[92:95], a[160:163], v[4:7]
    ds_read_b64_tr_b16 a[96:97], v222
    v_cvt_pk_bf16_f32 v68, v12, v13
    v_mfma_f32_16x16x32_bf16 v[8:11], a[88:91], a[172:175], -4.0
    v_exp_f32 v18, v18
    v_mfma_f32_16x16x32_bf16 v[8:11], a[92:95], a[176:179], v[8:11]
    ds_read_b64_tr_b16 a[98:99], v222 offset:2048
    v_cvt_pk_bf16_f32 v76, v16, v17
    v_mfma_f32_16x16x32_bf16 v[8:11], a[80:83], a[164:167], v[8:11]
    v_exp_f32 v19, v19
    v_mfma_f32_16x16x32_bf16 v[8:11], a[84:87], a[168:171], v[8:11]
    global_load_lds_dwordx4 v228, s[74:75] offset:2048 nt
    v_mfma_f32_16x16x32_bf16 v[12:15], a[80:83], a[180:183], -4.0
    v_exp_f32 v4, v4
    v_mfma_f32_16x16x32_bf16 v[12:15], a[84:87], a[184:187], v[12:15]
    ds_read_b128 a[68:71], v213 offset:49152
    v_cvt_pk_bf16_f32 v77, v18, v19
    v_mfma_f32_16x16x32_bf16 v[12:15], a[88:91], a[188:191], v[12:15]
    v_exp_f32 v5, v5
    v_mfma_f32_16x16x32_bf16 v[12:15], a[92:95], a[192:195], v[12:15]
    ds_read_b64_tr_b16 a[100:101], v222 offset:4096
    v_mfma_f32_16x16x32_bf16 v[16:19], a[88:91], a[204:207], -4.0
    v_exp_f32 v6, v6
    v_mfma_f32_16x16x32_bf16 v[16:19], a[92:95], a[208:211], v[16:19]
    ds_read_b64_tr_b16 a[102:103], v222 offset:6144
    v_cvt_pk_bf16_f32 v54, v4, v5
    v_mfma_f32_16x16x32_bf16 v[16:19], a[80:83], a[196:199], v[16:19]
    v_exp_f32 v7, v7
    v_mfma_f32_16x16x32_bf16 v[16:19], a[84:87], a[200:203], v[16:19]
    global_load_lds_dwordx4 v229, s[74:75] offset:3072 nt
    v_mfma_f32_16x16x32_bf16 v[188:191], v[84:87], a[112:115], v[188:191]
    v_exp_f32 v8, v8
    v_mfma_f32_16x16x32_bf16 v[188:191], v[88:91], a[116:119], v[188:191]
    ds_read_b128 a[72:75], v214 offset:49152
    v_cvt_pk_bf16_f32 v55, v6, v7
    v_mfma_f32_16x16x32_bf16 v[188:191], v[116:119], a[120:123], v[188:191]
    v_exp_f32 v9, v9
    v_mfma_f32_16x16x32_bf16 v[188:191], v[120:123], a[124:127], v[188:191]
    ds_read_b64_tr_b16 a[104:105], v222 offset:8192
    v_mfma_f32_16x16x32_bf16 v[192:195], v[124:127], a[120:123], v[192:195]
    s_add_u32 m0, s33, 0x8000
    v_exp_f32 v10, v10
    v_mfma_f32_16x16x32_bf16 v[192:195], v[128:131], a[124:127], v[192:195]
    ds_read_b64_tr_b16 a[106:107], v222 offset:10240
    v_cvt_pk_bf16_f32 v62, v8, v9
    v_mfma_f32_16x16x32_bf16 v[192:195], v[92:95], a[112:115], v[192:195]
    v_exp_f32 v11, v11
    v_mfma_f32_16x16x32_bf16 v[192:195], v[96:99], a[116:119], v[192:195]
    global_load_lds_dwordx4 v224, s[72:73] nt
    v_mfma_f32_16x16x32_bf16 a[40:43], v[100:103], a[112:115], a[40:43]
    s_add_u32 s32, s64, 0x38000
    v_exp_f32 v12, v12
    v_mfma_f32_16x16x32_bf16 a[40:43], v[104:107], a[116:119], a[40:43]
    ds_read_b128 a[76:79], v215 offset:49152
    v_cvt_pk_bf16_f32 v63, v10, v11
    v_mfma_f32_16x16x32_bf16 a[40:43], v[132:135], a[120:123], a[40:43]
    s_and_b32 s32, s32, 0x7ffff
    v_exp_f32 v13, v13
    v_mfma_f32_16x16x32_bf16 a[40:43], v[136:139], a[124:127], a[40:43]
    ds_read_b64_tr_b16 a[108:109], v222 offset:12288
    v_mfma_f32_16x16x32_bf16 a[44:47], v[140:143], a[120:123], a[44:47]
    v_exp_f32 v14, v14
    v_mfma_f32_16x16x32_bf16 a[44:47], v[144:147], a[124:127], a[44:47]
    ds_read_b64_tr_b16 a[110:111], v222 offset:14336
    v_cvt_pk_bf16_f32 v70, v12, v13
    v_mfma_f32_16x16x32_bf16 a[44:47], v[108:111], a[112:115], a[44:47]
    s_waitcnt lgkmcnt(2)
    v_exp_f32 v15, v15
    v_mfma_f32_16x16x32_bf16 a[44:47], v[112:115], a[116:119], a[44:47]
    global_load_lds_dwordx4 v225, s[72:73] offset:1024 nt
    v_smfmac_f32_16x16x64_bf16 a[132:135], a[144:147], v[28:35], v236
    v_mfma_f32_16x16x32_bf16 v[4:7], a[64:67], a[148:151], -4.0
    s_add_u32 s74, s12, s32
    v_exp_f32 v16, v16
    v_mfma_f32_16x16x32_bf16 v[4:7], a[68:71], a[152:155], v[4:7]
    ds_read_b128 a[80:83], v212 offset:53248
    v_cvt_pk_bf16_f32 v71, v14, v15
    v_mfma_f32_16x16x32_bf16 v[4:7], a[72:75], a[156:159], v[4:7]
    s_addc_u32 s75, s13, 0
    v_exp_f32 v17, v17
    v_mfma_f32_16x16x32_bf16 v[4:7], a[76:79], a[160:163], v[4:7]
    ds_read_b64_tr_b16 a[112:113], v223
    v_mfma_f32_16x16x32_bf16 v[8:11], a[72:75], a[172:175], -4.0
    v_exp_f32 v18, v18
    v_mfma_f32_16x16x32_bf16 v[8:11], a[76:79], a[176:179], v[8:11]
    ds_read_b64_tr_b16 a[114:115], v223 offset:2048
    v_cvt_pk_bf16_f32 v78, v16, v17
    v_mfma_f32_16x16x32_bf16 v[8:11], a[64:67], a[164:167], v[8:11]
    s_waitcnt lgkmcnt(3)
    v_exp_f32 v19, v19
    v_mfma_f32_16x16x32_bf16 v[8:11], a[68:71], a[168:171], v[8:11]
    global_load_lds_dwordx4 v226, s[72:73] offset:2048 nt
    v_mfma_f32_16x16x32_bf16 v[12:15], a[64:67], a[180:183], -4.0
    v_exp_f32 v4, v4
    v_mfma_f32_16x16x32_bf16 v[12:15], a[68:71], a[184:187], v[12:15]
    ds_read_b128 a[84:87], v213 offset:53248
    v_cvt_pk_bf16_f32 v79, v18, v19
    v_mfma_f32_16x16x32_bf16 v[12:15], a[72:75], a[188:191], v[12:15]
    v_exp_f32 v5, v5
    v_mfma_f32_16x16x32_bf16 v[12:15], a[76:79], a[192:195], v[12:15]
    ds_read_b64_tr_b16 a[116:117], v223 offset:4096
    v_mfma_f32_16x16x32_bf16 v[16:19], a[72:75], a[204:207], -4.0
    v_exp_f32 v6, v6
    v_mfma_f32_16x16x32_bf16 v[16:19], a[76:79], a[208:211], v[16:19]
    ds_read_b64_tr_b16 a[118:119], v223 offset:6144
    v_cvt_pk_bf16_f32 v56, v4, v5
    v_mfma_f32_16x16x32_bf16 v[16:19], a[64:67], a[196:199], v[16:19]
    v_exp_f32 v7, v7
    v_mfma_f32_16x16x32_bf16 v[16:19], a[68:71], a[200:203], v[16:19]
    global_load_lds_dwordx4 v227, s[72:73] offset:3072 nt
    v_mfma_f32_16x16x32_bf16 v[196:199], v[84:87], a[96:99], v[196:199]
    v_exp_f32 v8, v8
    v_mfma_f32_16x16x32_bf16 v[196:199], v[88:91], a[100:103], v[196:199]
    ds_read_b128 a[88:91], v214 offset:53248
    v_cvt_pk_bf16_f32 v57, v6, v7
    v_mfma_f32_16x16x32_bf16 v[196:199], v[116:119], a[104:107], v[196:199]
    v_exp_f32 v9, v9
    v_mfma_f32_16x16x32_bf16 v[196:199], v[120:123], a[108:111], v[196:199]
    ds_read_b64_tr_b16 a[120:121], v223 offset:8192
    v_mfma_f32_16x16x32_bf16 v[200:203], v[124:127], a[104:107], v[200:203]
    s_add_u32 m0, s31, 0x8000
    v_exp_f32 v10, v10
    v_mfma_f32_16x16x32_bf16 v[200:203], v[128:131], a[108:111], v[200:203]
    ds_read_b64_tr_b16 a[122:123], v223 offset:10240
    v_cvt_pk_bf16_f32 v64, v8, v9
    v_mfma_f32_16x16x32_bf16 v[200:203], v[92:95], a[96:99], v[200:203]
    v_exp_f32 v11, v11
    v_mfma_f32_16x16x32_bf16 v[200:203], v[96:99], a[100:103], v[200:203]
    global_load_lds_dwordx4 v228, s[74:75] nt
    v_mfma_f32_16x16x32_bf16 a[48:51], v[100:103], a[96:99], a[48:51]
    ds_read_b128 a[92:95], v215 offset:53248
    v_cvt_pk_bf16_f32 v65, v10, v11
    v_mfma_f32_16x16x32_bf16 a[48:51], v[104:107], a[100:103], a[48:51]
    ds_read_b64_tr_b16 a[124:125], v223 offset:12288
    v_mfma_f32_16x16x32_bf16 a[48:51], v[132:135], a[104:107], a[48:51]
    ds_read_b64_tr_b16 a[126:127], v223 offset:14336
    v_mfma_f32_16x16x32_bf16 a[48:51], v[136:139], a[108:111], a[48:51]
    global_load_lds_dwordx4 v229, s[74:75] offset:1024 nt
    v_mfma_f32_16x16x32_bf16 a[52:55], v[140:143], a[104:107], a[52:55]
    s_add_u32 s32, s67, 0x28000
    v_exp_f32 v12, v12
    v_mfma_f32_16x16x32_bf16 a[52:55], v[144:147], a[108:111], a[52:55]
    s_and_b32 s32, s32, 0x7ffff
    v_exp_f32 v13, v13
    v_mfma_f32_16x16x32_bf16 a[52:55], v[108:111], a[96:99], a[52:55]
    v_exp_f32 v14, v14
    v_mfma_f32_16x16x32_bf16 a[52:55], v[112:115], a[100:103], a[52:55]
    s_waitcnt vmcnt(10) lgkmcnt(0)
    v_exp_f32 v15, v15
    v_smfmac_f32_16x16x64_bf16 a[136:139], a[144:147], v[36:43], v236
    s_barrier
    v_mfma_f32_16x16x32_bf16 v[4:7], a[80:83], a[148:151], -4.0
    s_add_u32 s72, s14, s32
    v_exp_f32 v16, v16
    v_mfma_f32_16x16x32_bf16 v[4:7], a[84:87], a[152:155], v[4:7]
    ds_read_b128 a[64:67], v212
    v_cvt_pk_bf16_f32 v73, v14, v15
    v_mfma_f32_16x16x32_bf16 v[4:7], a[88:91], a[156:159], v[4:7]
    s_addc_u32 s73, s15, 0
    v_exp_f32 v17, v17
    v_mfma_f32_16x16x32_bf16 v[4:7], a[92:95], a[160:163], v[4:7]
    ds_read_b64_tr_b16 a[96:97], v220 offset:16384
    v_cvt_pk_bf16_f32 v72, v12, v13
    v_mfma_f32_16x16x32_bf16 v[8:11], a[88:91], a[172:175], -4.0
    v_exp_f32 v18, v18
    v_mfma_f32_16x16x32_bf16 v[8:11], a[92:95], a[176:179], v[8:11]
    ds_read_b64_tr_b16 a[98:99], v220 offset:18432
    v_cvt_pk_bf16_f32 v80, v16, v17
    v_mfma_f32_16x16x32_bf16 v[8:11], a[80:83], a[164:167], v[8:11]
    v_exp_f32 v19, v19
    v_mfma_f32_16x16x32_bf16 v[8:11], a[84:87], a[168:171], v[8:11]
    global_load_lds_dwordx4 v228, s[74:75] offset:2048 nt
    v_mfma_f32_16x16x32_bf16 v[12:15], a[80:83], a[180:183], -4.0
    v_exp_f32 v4, v4
    v_mfma_f32_16x16x32_bf16 v[12:15], a[84:87], a[184:187], v[12:15]
    ds_read_b128 a[68:71], v213
    v_cvt_pk_bf16_f32 v81, v18, v19
    v_mfma_f32_16x16x32_bf16 v[12:15], a[88:91], a[188:191], v[12:15]
    v_exp_f32 v5, v5
    v_mfma_f32_16x16x32_bf16 v[12:15], a[92:95], a[192:195], v[12:15]
    ds_read_b64_tr_b16 a[100:101], v220 offset:20480
    v_mfma_f32_16x16x32_bf16 v[16:19], a[88:91], a[204:207], -4.0
    v_exp_f32 v6, v6
    v_mfma_f32_16x16x32_bf16 v[16:19], a[92:95], a[208:211], v[16:19]
    ds_read_b64_tr_b16 a[102:103], v220 offset:22528
    v_cvt_pk_bf16_f32 v58, v4, v5
    v_mfma_f32_16x16x32_bf16 v[16:19], a[80:83], a[196:199], v[16:19]
    v_exp_f32 v7, v7
    v_mfma_f32_16x16x32_bf16 v[16:19], a[84:87], a[200:203], v[16:19]
    global_load_lds_dwordx4 v229, s[74:75] offset:3072 nt
    v_mfma_f32_16x16x32_bf16 v[204:207], v[84:87], a[112:115], v[204:207]
    v_exp_f32 v8, v8
    v_mfma_f32_16x16x32_bf16 v[204:207], v[88:91], a[116:119], v[204:207]
    ds_read_b128 a[72:75], v214
    v_cvt_pk_bf16_f32 v59, v6, v7
    v_mfma_f32_16x16x32_bf16 v[204:207], v[116:119], a[120:123], v[204:207]
L_stub3:
    s_cbranch_execz L_stub7
    v_exp_f32 v9, v9
    v_mfma_f32_16x16x32_bf16 v[204:207], v[120:123], a[124:127], v[204:207]
    ds_read_b64_tr_b16 a[104:105], v220 offset:24576
    v_mfma_f32_16x16x32_bf16 v[208:211], v[124:127], a[120:123], v[208:211]
    s_add_u32 m0, s33, 0xa000
    v_exp_f32 v10, v10
    v_mfma_f32_16x16x32_bf16 v[208:211], v[128:131], a[124:127], v[208:211]
    ds_read_b64_tr_b16 a[106:107], v220 offset:26624
    v_cvt_pk_bf16_f32 v66, v8, v9
    v_mfma_f32_16x16x32_bf16 v[208:211], v[92:95], a[112:115], v[208:211]
    v_exp_f32 v11, v11
    v_mfma_f32_16x16x32_bf16 v[208:211], v[96:99], a[116:119], v[208:211]
    global_load_lds_dwordx4 v224, s[72:73] nt
    v_mfma_f32_16x16x32_bf16 a[56:59], v[100:103], a[112:115], a[56:59]
    s_add_u32 s32, s65, 0x38000
    v_exp_f32 v12, v12
    v_mfma_f32_16x16x32_bf16 a[56:59], v[104:107], a[116:119], a[56:59]
    ds_read_b128 a[76:79], v215
    v_cvt_pk_bf16_f32 v67, v10, v11
    v_mfma_f32_16x16x32_bf16 a[56:59], v[132:135], a[120:123], a[56:59]
    s_and_b32 s32, s32, 0x7ffff
    v_exp_f32 v13, v13
    v_mfma_f32_16x16x32_bf16 a[56:59], v[136:139], a[124:127], a[56:59]
    ds_read_b64_tr_b16 a[108:109], v220 offset:28672
    v_mfma_f32_16x16x32_bf16 a[60:63], v[140:143], a[120:123], a[60:63]
    v_exp_f32 v14, v14
    v_mfma_f32_16x16x32_bf16 a[60:63], v[144:147], a[124:127], a[60:63]
    ds_read_b64_tr_b16 a[110:111], v220 offset:30720
    v_cvt_pk_bf16_f32 v74, v12, v13
    v_mfma_f32_16x16x32_bf16 a[60:63], v[108:111], a[112:115], a[60:63]
    s_waitcnt lgkmcnt(2)
    v_exp_f32 v15, v15
    v_mfma_f32_16x16x32_bf16 a[60:63], v[112:115], a[116:119], a[60:63]
    global_load_lds_dwordx4 v225, s[72:73] offset:1024 nt
    v_smfmac_f32_16x16x64_bf16 a[140:143], a[144:147], v[44:51], v236
    v_mfma_f32_16x16x32_bf16 v[4:7], a[64:67], a[148:151], -4.0
    s_add_u32 s74, s12, s32
    v_exp_f32 v16, v16
    v_mfma_f32_16x16x32_bf16 v[4:7], a[68:71], a[152:155], v[4:7]
    ds_read_b128 a[80:83], v212 offset:4096
    v_cvt_pk_bf16_f32 v75, v14, v15
    v_mfma_f32_16x16x32_bf16 v[4:7], a[72:75], a[156:159], v[4:7]
    s_addc_u32 s75, s13, 0
    v_exp_f32 v17, v17
    v_mfma_f32_16x16x32_bf16 v[4:7], a[76:79], a[160:163], v[4:7]
    ds_read_b64_tr_b16 a[112:113], v221 offset:16384
    v_mfma_f32_16x16x32_bf16 v[8:11], a[72:75], a[172:175], -4.0
    v_exp_f32 v18, v18
    v_mfma_f32_16x16x32_bf16 v[8:11], a[76:79], a[176:179], v[8:11]
    ds_read_b64_tr_b16 a[114:115], v221 offset:18432
    v_cvt_pk_bf16_f32 v82, v16, v17
    v_mfma_f32_16x16x32_bf16 v[8:11], a[64:67], a[164:167], v[8:11]
    s_waitcnt lgkmcnt(3)
    v_exp_f32 v19, v19
    v_mfma_f32_16x16x32_bf16 v[8:11], a[68:71], a[168:171], v[8:11]
    global_load_lds_dwordx4 v226, s[72:73] offset:2048 nt
    v_mfma_f32_16x16x32_bf16 v[12:15], a[64:67], a[180:183], -4.0
    v_exp_f32 v4, v4
    v_mfma_f32_16x16x32_bf16 v[12:15], a[68:71], a[184:187], v[12:15]
    ds_read_b128 a[84:87], v213 offset:4096
    v_cvt_pk_bf16_f32 v83, v18, v19
    v_mfma_f32_16x16x32_bf16 v[12:15], a[72:75], a[188:191], v[12:15]
    v_exp_f32 v5, v5
    v_mfma_f32_16x16x32_bf16 v[12:15], a[76:79], a[192:195], v[12:15]
    ds_read_b64_tr_b16 a[116:117], v221 offset:20480
    v_mfma_f32_16x16x32_bf16 v[16:19], a[72:75], a[204:207], -4.0
    v_exp_f32 v6, v6
    v_mfma_f32_16x16x32_bf16 v[16:19], a[76:79], a[208:211], v[16:19]
    ds_read_b64_tr_b16 a[118:119], v221 offset:22528
    v_cvt_pk_bf16_f32 v84, v4, v5
    v_mfma_f32_16x16x32_bf16 v[16:19], a[64:67], a[196:199], v[16:19]
    v_exp_f32 v7, v7
    v_mfma_f32_16x16x32_bf16 v[16:19], a[68:71], a[200:203], v[16:19]
    global_load_lds_dwordx4 v227, s[72:73] offset:3072 nt
    v_mfma_f32_16x16x32_bf16 v[148:151], v[20:23], a[96:99], v[148:151]
    v_exp_f32 v8, v8
    v_mfma_f32_16x16x32_bf16 v[148:151], v[24:27], a[100:103], v[148:151]
    ds_read_b128 a[88:91], v214 offset:4096
    v_cvt_pk_bf16_f32 v85, v6, v7
    v_mfma_f32_16x16x32_bf16 v[148:151], v[52:55], a[104:107], v[148:151]
    v_exp_f32 v9, v9
    v_mfma_f32_16x16x32_bf16 v[148:151], v[56:59], a[108:111], v[148:151]
    ds_read_b64_tr_b16 a[120:121], v221 offset:24576
    v_mfma_f32_16x16x32_bf16 v[152:155], v[60:63], a[104:107], v[152:155]
    s_add_u32 m0, s31, 0xc000
    v_exp_f32 v10, v10
    v_mfma_f32_16x16x32_bf16 v[152:155], v[64:67], a[108:111], v[152:155]
    ds_read_b64_tr_b16 a[122:123], v221 offset:26624
    v_cvt_pk_bf16_f32 v92, v8, v9
    v_mfma_f32_16x16x32_bf16 v[152:155], v[28:31], a[96:99], v[152:155]
    v_exp_f32 v11, v11
    v_mfma_f32_16x16x32_bf16 v[152:155], v[32:35], a[100:103], v[152:155]
    global_load_lds_dwordx4 v228, s[74:75] nt
    v_mfma_f32_16x16x32_bf16 a[0:3], v[36:39], a[96:99], a[0:3]
    ds_read_b128 a[92:95], v215 offset:4096
    v_cvt_pk_bf16_f32 v93, v10, v11
    v_mfma_f32_16x16x32_bf16 a[0:3], v[40:43], a[100:103], a[0:3]
    ds_read_b64_tr_b16 a[124:125], v221 offset:28672
    v_mfma_f32_16x16x32_bf16 a[0:3], v[68:71], a[104:107], a[0:3]
    ds_read_b64_tr_b16 a[126:127], v221 offset:30720
    v_mfma_f32_16x16x32_bf16 a[0:3], v[72:75], a[108:111], a[0:3]
    global_load_lds_dwordx4 v229, s[74:75] offset:1024 nt
    v_mfma_f32_16x16x32_bf16 a[4:7], v[76:79], a[104:107], a[4:7]
    s_add_u32 s32, s66, 0x30000
    v_exp_f32 v12, v12
    v_mfma_f32_16x16x32_bf16 a[4:7], v[80:83], a[108:111], a[4:7]
    s_and_b32 s32, s32, 0x7ffff
    v_exp_f32 v13, v13
    v_mfma_f32_16x16x32_bf16 a[4:7], v[44:47], a[96:99], a[4:7]
    v_exp_f32 v14, v14
    v_mfma_f32_16x16x32_bf16 a[4:7], v[48:51], a[100:103], a[4:7]
    s_waitcnt vmcnt(14) lgkmcnt(0)
    v_exp_f32 v15, v15
    v_smfmac_f32_16x16x64_bf16 a[128:131], a[144:147], v[52:59], v236
    s_barrier
    v_mfma_f32_16x16x32_bf16 v[4:7], a[80:83], a[148:151], -4.0
    s_add_u32 s72, s14, s32
    v_exp_f32 v16, v16
    v_mfma_f32_16x16x32_bf16 v[4:7], a[84:87], a[152:155], v[4:7]
    ds_read_b128 a[64:67], v212 offset:16384
    v_cvt_pk_bf16_f32 v101, v14, v15
    v_mfma_f32_16x16x32_bf16 v[4:7], a[88:91], a[156:159], v[4:7]
    s_addc_u32 s73, s15, 0
    v_exp_f32 v17, v17
    v_mfma_f32_16x16x32_bf16 v[4:7], a[92:95], a[160:163], v[4:7]
    ds_read_b64_tr_b16 a[96:97], v222 offset:16384
    v_cvt_pk_bf16_f32 v100, v12, v13
    v_mfma_f32_16x16x32_bf16 v[8:11], a[88:91], a[172:175], -4.0
    v_exp_f32 v18, v18
    v_mfma_f32_16x16x32_bf16 v[8:11], a[92:95], a[176:179], v[8:11]
    ds_read_b64_tr_b16 a[98:99], v222 offset:18432
    v_cvt_pk_bf16_f32 v108, v16, v17
    v_mfma_f32_16x16x32_bf16 v[8:11], a[80:83], a[164:167], v[8:11]
    v_exp_f32 v19, v19
    v_mfma_f32_16x16x32_bf16 v[8:11], a[84:87], a[168:171], v[8:11]
    global_load_lds_dwordx4 v228, s[74:75] offset:2048 nt
    v_mfma_f32_16x16x32_bf16 v[12:15], a[80:83], a[180:183], -4.0
    v_exp_f32 v4, v4
    v_mfma_f32_16x16x32_bf16 v[12:15], a[84:87], a[184:187], v[12:15]
    ds_read_b128 a[68:71], v213 offset:16384
    v_cvt_pk_bf16_f32 v109, v18, v19
    v_mfma_f32_16x16x32_bf16 v[12:15], a[88:91], a[188:191], v[12:15]
    v_exp_f32 v5, v5
    v_mfma_f32_16x16x32_bf16 v[12:15], a[92:95], a[192:195], v[12:15]
    ds_read_b64_tr_b16 a[100:101], v222 offset:20480
    v_mfma_f32_16x16x32_bf16 v[16:19], a[88:91], a[204:207], -4.0
    v_exp_f32 v6, v6
    v_mfma_f32_16x16x32_bf16 v[16:19], a[92:95], a[208:211], v[16:19]
    ds_read_b64_tr_b16 a[102:103], v222 offset:22528
    v_cvt_pk_bf16_f32 v86, v4, v5
    v_mfma_f32_16x16x32_bf16 v[16:19], a[80:83], a[196:199], v[16:19]
    v_exp_f32 v7, v7
    v_mfma_f32_16x16x32_bf16 v[16:19], a[84:87], a[200:203], v[16:19]
    global_load_lds_dwordx4 v229, s[74:75] offset:3072 nt
    v_mfma_f32_16x16x32_bf16 v[156:159], v[20:23], a[112:115], v[156:159]
    v_exp_f32 v8, v8
    v_mfma_f32_16x16x32_bf16 v[156:159], v[24:27], a[116:119], v[156:159]
    ds_read_b128 a[72:75], v214 offset:16384
    v_cvt_pk_bf16_f32 v87, v6, v7
    v_mfma_f32_16x16x32_bf16 v[156:159], v[52:55], a[120:123], v[156:159]
    v_exp_f32 v9, v9
    v_mfma_f32_16x16x32_bf16 v[156:159], v[56:59], a[124:127], v[156:159]
    ds_read_b64_tr_b16 a[104:105], v222 offset:24576
    v_mfma_f32_16x16x32_bf16 v[160:163], v[60:63], a[120:123], v[160:163]
    s_add_u32 m0, s33, 0x0
    v_exp_f32 v10, v10
    v_mfma_f32_16x16x32_bf16 v[160:163], v[64:67], a[124:127], v[160:163]
    ds_read_b64_tr_b16 a[106:107], v222 offset:26624
    v_cvt_pk_bf16_f32 v94, v8, v9
    v_mfma_f32_16x16x32_bf16 v[160:163], v[28:31], a[112:115], v[160:163]
    v_exp_f32 v11, v11
    v_mfma_f32_16x16x32_bf16 v[160:163], v[32:35], a[116:119], v[160:163]
    global_load_lds_dwordx4 v224, s[72:73] nt
    v_mfma_f32_16x16x32_bf16 a[8:11], v[36:39], a[112:115], a[8:11]
    s_add_u32 s32, s64, 0x40000
    v_exp_f32 v12, v12
    v_mfma_f32_16x16x32_bf16 a[8:11], v[40:43], a[116:119], a[8:11]
    ds_read_b128 a[76:79], v215 offset:16384
    v_cvt_pk_bf16_f32 v95, v10, v11
    v_mfma_f32_16x16x32_bf16 a[8:11], v[68:71], a[120:123], a[8:11]
    s_and_b32 s32, s32, 0x7ffff
    v_exp_f32 v13, v13
    v_mfma_f32_16x16x32_bf16 a[8:11], v[72:75], a[124:127], a[8:11]
    ds_read_b64_tr_b16 a[108:109], v222 offset:28672
    v_mfma_f32_16x16x32_bf16 a[12:15], v[76:79], a[120:123], a[12:15]
    v_exp_f32 v14, v14
    v_mfma_f32_16x16x32_bf16 a[12:15], v[80:83], a[124:127], a[12:15]
    ds_read_b64_tr_b16 a[110:111], v222 offset:30720
    v_cvt_pk_bf16_f32 v102, v12, v13
    v_mfma_f32_16x16x32_bf16 a[12:15], v[44:47], a[112:115], a[12:15]
    s_waitcnt lgkmcnt(2)
    v_exp_f32 v15, v15
    v_mfma_f32_16x16x32_bf16 a[12:15], v[48:51], a[116:119], a[12:15]
    global_load_lds_dwordx4 v225, s[72:73] offset:1024 nt
    v_smfmac_f32_16x16x64_bf16 a[132:135], a[144:147], v[60:67], v236
    v_mfma_f32_16x16x32_bf16 v[4:7], a[64:67], a[148:151], -4.0
    s_add_u32 s74, s12, s32
    v_exp_f32 v16, v16
    v_mfma_f32_16x16x32_bf16 v[4:7], a[68:71], a[152:155], v[4:7]
    ds_read_b128 a[80:83], v212 offset:20480
    v_cvt_pk_bf16_f32 v103, v14, v15
    v_mfma_f32_16x16x32_bf16 v[4:7], a[72:75], a[156:159], v[4:7]
    s_addc_u32 s75, s13, 0
    v_exp_f32 v17, v17
    v_mfma_f32_16x16x32_bf16 v[4:7], a[76:79], a[160:163], v[4:7]
    ds_read_b64_tr_b16 a[112:113], v223 offset:16384
    v_mfma_f32_16x16x32_bf16 v[8:11], a[72:75], a[172:175], -4.0
    v_exp_f32 v18, v18
    v_mfma_f32_16x16x32_bf16 v[8:11], a[76:79], a[176:179], v[8:11]
    ds_read_b64_tr_b16 a[114:115], v223 offset:18432
    v_cvt_pk_bf16_f32 v110, v16, v17
    v_mfma_f32_16x16x32_bf16 v[8:11], a[64:67], a[164:167], v[8:11]
    s_waitcnt lgkmcnt(3)
    v_exp_f32 v19, v19
    v_mfma_f32_16x16x32_bf16 v[8:11], a[68:71], a[168:171], v[8:11]
    global_load_lds_dwordx4 v226, s[72:73] offset:2048 nt
    v_mfma_f32_16x16x32_bf16 v[12:15], a[64:67], a[180:183], -4.0
    v_exp_f32 v4, v4
    v_mfma_f32_16x16x32_bf16 v[12:15], a[68:71], a[184:187], v[12:15]
    ds_read_b128 a[84:87], v213 offset:20480
    v_cvt_pk_bf16_f32 v111, v18, v19
    v_mfma_f32_16x16x32_bf16 v[12:15], a[72:75], a[188:191], v[12:15]
    v_exp_f32 v5, v5
    v_mfma_f32_16x16x32_bf16 v[12:15], a[76:79], a[192:195], v[12:15]
    ds_read_b64_tr_b16 a[116:117], v223 offset:20480
    v_mfma_f32_16x16x32_bf16 v[16:19], a[72:75], a[204:207], -4.0
    v_exp_f32 v6, v6
    v_mfma_f32_16x16x32_bf16 v[16:19], a[76:79], a[208:211], v[16:19]
    ds_read_b64_tr_b16 a[118:119], v223 offset:22528
    v_cvt_pk_bf16_f32 v88, v4, v5
    v_mfma_f32_16x16x32_bf16 v[16:19], a[64:67], a[196:199], v[16:19]
    v_exp_f32 v7, v7
    v_mfma_f32_16x16x32_bf16 v[16:19], a[68:71], a[200:203], v[16:19]
    global_load_lds_dwordx4 v227, s[72:73] offset:3072 nt
    v_mfma_f32_16x16x32_bf16 v[164:167], v[20:23], a[96:99], v[164:167]
    v_exp_f32 v8, v8
    v_mfma_f32_16x16x32_bf16 v[164:167], v[24:27], a[100:103], v[164:167]
    ds_read_b128 a[88:91], v214 offset:20480
    v_cvt_pk_bf16_f32 v89, v6, v7
    v_mfma_f32_16x16x32_bf16 v[164:167], v[52:55], a[104:107], v[164:167]
    v_exp_f32 v9, v9
    v_mfma_f32_16x16x32_bf16 v[164:167], v[56:59], a[108:111], v[164:167]
    ds_read_b64_tr_b16 a[120:121], v223 offset:24576
    v_mfma_f32_16x16x32_bf16 v[168:171], v[60:63], a[104:107], v[168:171]
    s_add_u32 m0, s31, 0x0
    v_exp_f32 v10, v10
    v_mfma_f32_16x16x32_bf16 v[168:171], v[64:67], a[108:111], v[168:171]
    ds_read_b64_tr_b16 a[122:123], v223 offset:26624
    v_cvt_pk_bf16_f32 v96, v8, v9
    v_mfma_f32_16x16x32_bf16 v[168:171], v[28:31], a[96:99], v[168:171]
    v_exp_f32 v11, v11
    v_mfma_f32_16x16x32_bf16 v[168:171], v[32:35], a[100:103], v[168:171]
    global_load_lds_dwordx4 v228, s[74:75] nt
    v_mfma_f32_16x16x32_bf16 a[16:19], v[36:39], a[96:99], a[16:19]
    ds_read_b128 a[92:95], v215 offset:20480
    v_cvt_pk_bf16_f32 v97, v10, v11
    v_mfma_f32_16x16x32_bf16 a[16:19], v[40:43], a[100:103], a[16:19]
    ds_read_b64_tr_b16 a[124:125], v223 offset:28672
    v_mfma_f32_16x16x32_bf16 a[16:19], v[68:71], a[104:107], a[16:19]
    ds_read_b64_tr_b16 a[126:127], v223 offset:30720
    v_mfma_f32_16x16x32_bf16 a[16:19], v[72:75], a[108:111], a[16:19]
    global_load_lds_dwordx4 v229, s[74:75] offset:1024 nt
    v_mfma_f32_16x16x32_bf16 a[20:23], v[76:79], a[104:107], a[20:23]
    s_add_u32 s32, s66, 0x38000
    v_exp_f32 v12, v12
    v_mfma_f32_16x16x32_bf16 a[20:23], v[80:83], a[108:111], a[20:23]
    s_and_b32 s32, s32, 0x7ffff
    v_exp_f32 v13, v13
    v_mfma_f32_16x16x32_bf16 a[20:23], v[44:47], a[96:99], a[20:23]
    v_exp_f32 v14, v14
    v_mfma_f32_16x16x32_bf16 a[20:23], v[48:51], a[100:103], a[20:23]
    s_waitcnt vmcnt(10) lgkmcnt(0)
    v_exp_f32 v15, v15
    v_smfmac_f32_16x16x64_bf16 a[136:139], a[144:147], v[68:75], v236
    s_barrier
    v_mfma_f32_16x16x32_bf16 v[4:7], a[80:83], a[148:151], -4.0
    s_add_u32 s72, s14, s32
    v_exp_f32 v16, v16
    v_mfma_f32_16x16x32_bf16 v[4:7], a[84:87], a[152:155], v[4:7]
    ds_read_b128 a[64:67], v212 offset:32768
    v_cvt_pk_bf16_f32 v105, v14, v15
    v_mfma_f32_16x16x32_bf16 v[4:7], a[88:91], a[156:159], v[4:7]
    s_addc_u32 s73, s15, 0
    v_exp_f32 v17, v17
    v_mfma_f32_16x16x32_bf16 v[4:7], a[92:95], a[160:163], v[4:7]
    ds_read_b64_tr_b16 a[96:97], v220 offset:32768
    v_cvt_pk_bf16_f32 v104, v12, v13
    v_mfma_f32_16x16x32_bf16 v[8:11], a[88:91], a[172:175], -4.0
    v_exp_f32 v18, v18
    v_mfma_f32_16x16x32_bf16 v[8:11], a[92:95], a[176:179], v[8:11]
    ds_read_b64_tr_b16 a[98:99], v220 offset:34816
    v_cvt_pk_bf16_f32 v112, v16, v17
    v_mfma_f32_16x16x32_bf16 v[8:11], a[80:83], a[164:167], v[8:11]
    v_exp_f32 v19, v19
    v_mfma_f32_16x16x32_bf16 v[8:11], a[84:87], a[168:171], v[8:11]
    global_load_lds_dwordx4 v228, s[74:75] offset:2048 nt
    v_mfma_f32_16x16x32_bf16 v[12:15], a[80:83], a[180:183], -4.0
    v_exp_f32 v4, v4
    v_mfma_f32_16x16x32_bf16 v[12:15], a[84:87], a[184:187], v[12:15]
    ds_read_b128 a[68:71], v213 offset:32768
    v_cvt_pk_bf16_f32 v113, v18, v19
    v_mfma_f32_16x16x32_bf16 v[12:15], a[88:91], a[188:191], v[12:15]
    v_exp_f32 v5, v5
    v_mfma_f32_16x16x32_bf16 v[12:15], a[92:95], a[192:195], v[12:15]
    ds_read_b64_tr_b16 a[100:101], v220 offset:36864
    v_mfma_f32_16x16x32_bf16 v[16:19], a[88:91], a[204:207], -4.0
    v_exp_f32 v6, v6
    v_mfma_f32_16x16x32_bf16 v[16:19], a[92:95], a[208:211], v[16:19]
    ds_read_b64_tr_b16 a[102:103], v220 offset:38912
    v_cvt_pk_bf16_f32 v90, v4, v5
    v_mfma_f32_16x16x32_bf16 v[16:19], a[80:83], a[196:199], v[16:19]
    v_exp_f32 v7, v7
    v_mfma_f32_16x16x32_bf16 v[16:19], a[84:87], a[200:203], v[16:19]
    global_load_lds_dwordx4 v229, s[74:75] offset:3072 nt
    v_mfma_f32_16x16x32_bf16 v[172:175], v[20:23], a[112:115], v[172:175]
    v_exp_f32 v8, v8
    v_mfma_f32_16x16x32_bf16 v[172:175], v[24:27], a[116:119], v[172:175]
    ds_read_b128 a[72:75], v214 offset:32768
    v_cvt_pk_bf16_f32 v91, v6, v7
    v_mfma_f32_16x16x32_bf16 v[172:175], v[52:55], a[120:123], v[172:175]
    v_exp_f32 v9, v9
    v_mfma_f32_16x16x32_bf16 v[172:175], v[56:59], a[124:127], v[172:175]
    ds_read_b64_tr_b16 a[104:105], v220 offset:40960
    v_mfma_f32_16x16x32_bf16 v[176:179], v[60:63], a[120:123], v[176:179]
    s_add_u32 m0, s33, 0x2000
    v_exp_f32 v10, v10
    v_mfma_f32_16x16x32_bf16 v[176:179], v[64:67], a[124:127], v[176:179]
    ds_read_b64_tr_b16 a[106:107], v220 offset:43008
    v_cvt_pk_bf16_f32 v98, v8, v9
    v_mfma_f32_16x16x32_bf16 v[176:179], v[28:31], a[112:115], v[176:179]
    v_exp_f32 v11, v11
    v_mfma_f32_16x16x32_bf16 v[176:179], v[32:35], a[116:119], v[176:179]
    global_load_lds_dwordx4 v224, s[72:73] nt
    v_mfma_f32_16x16x32_bf16 a[24:27], v[36:39], a[112:115], a[24:27]
    s_add_u32 s32, s65, 0x40000
    v_exp_f32 v12, v12
    v_mfma_f32_16x16x32_bf16 a[24:27], v[40:43], a[116:119], a[24:27]
    ds_read_b128 a[76:79], v215 offset:32768
    v_cvt_pk_bf16_f32 v99, v10, v11
    v_mfma_f32_16x16x32_bf16 a[24:27], v[68:71], a[120:123], a[24:27]
    s_and_b32 s32, s32, 0x7ffff
    v_exp_f32 v13, v13
    v_mfma_f32_16x16x32_bf16 a[24:27], v[72:75], a[124:127], a[24:27]
    ds_read_b64_tr_b16 a[108:109], v220 offset:45056
    v_mfma_f32_16x16x32_bf16 a[28:31], v[76:79], a[120:123], a[28:31]
    v_exp_f32 v14, v14
    v_mfma_f32_16x16x32_bf16 a[28:31], v[80:83], a[124:127], a[28:31]
    ds_read_b64_tr_b16 a[110:111], v220 offset:47104
    v_cvt_pk_bf16_f32 v106, v12, v13
    v_mfma_f32_16x16x32_bf16 a[28:31], v[44:47], a[112:115], a[28:31]
    s_waitcnt lgkmcnt(2)
    v_exp_f32 v15, v15
    v_mfma_f32_16x16x32_bf16 a[28:31], v[48:51], a[116:119], a[28:31]
    global_load_lds_dwordx4 v225, s[72:73] offset:1024 nt
    v_smfmac_f32_16x16x64_bf16 a[140:143], a[144:147], v[76:83], v236
    v_mfma_f32_16x16x32_bf16 v[4:7], a[64:67], a[148:151], -4.0
    s_add_u32 s74, s12, s32
    v_exp_f32 v16, v16
    v_mfma_f32_16x16x32_bf16 v[4:7], a[68:71], a[152:155], v[4:7]
    ds_read_b128 a[80:83], v212 offset:36864
    v_cvt_pk_bf16_f32 v107, v14, v15
    v_mfma_f32_16x16x32_bf16 v[4:7], a[72:75], a[156:159], v[4:7]
    s_addc_u32 s75, s13, 0
    v_exp_f32 v17, v17
    v_mfma_f32_16x16x32_bf16 v[4:7], a[76:79], a[160:163], v[4:7]
    ds_read_b64_tr_b16 a[112:113], v221 offset:32768
    v_mfma_f32_16x16x32_bf16 v[8:11], a[72:75], a[172:175], -4.0
    v_exp_f32 v18, v18
    v_mfma_f32_16x16x32_bf16 v[8:11], a[76:79], a[176:179], v[8:11]
    ds_read_b64_tr_b16 a[114:115], v221 offset:34816
    v_cvt_pk_bf16_f32 v114, v16, v17
    v_mfma_f32_16x16x32_bf16 v[8:11], a[64:67], a[164:167], v[8:11]
    s_waitcnt lgkmcnt(3)
    v_exp_f32 v19, v19
    v_mfma_f32_16x16x32_bf16 v[8:11], a[68:71], a[168:171], v[8:11]
    global_load_lds_dwordx4 v226, s[72:73] offset:2048 nt
    v_mfma_f32_16x16x32_bf16 v[12:15], a[64:67], a[180:183], -4.0
    v_exp_f32 v4, v4
    v_mfma_f32_16x16x32_bf16 v[12:15], a[68:71], a[184:187], v[12:15]
    ds_read_b128 a[84:87], v213 offset:36864
    v_cvt_pk_bf16_f32 v115, v18, v19
    v_mfma_f32_16x16x32_bf16 v[12:15], a[72:75], a[188:191], v[12:15]
    v_exp_f32 v5, v5
    v_mfma_f32_16x16x32_bf16 v[12:15], a[76:79], a[192:195], v[12:15]
    ds_read_b64_tr_b16 a[116:117], v221 offset:36864
    v_mfma_f32_16x16x32_bf16 v[16:19], a[72:75], a[204:207], -4.0
    v_exp_f32 v6, v6
    v_mfma_f32_16x16x32_bf16 v[16:19], a[76:79], a[208:211], v[16:19]
    ds_read_b64_tr_b16 a[118:119], v221 offset:38912
    v_cvt_pk_bf16_f32 v116, v4, v5
    v_mfma_f32_16x16x32_bf16 v[16:19], a[64:67], a[196:199], v[16:19]
    v_exp_f32 v7, v7
    v_mfma_f32_16x16x32_bf16 v[16:19], a[68:71], a[200:203], v[16:19]
    global_load_lds_dwordx4 v227, s[72:73] offset:3072 nt
    v_mfma_f32_16x16x32_bf16 v[180:183], v[20:23], a[96:99], v[180:183]
    v_exp_f32 v8, v8
    v_mfma_f32_16x16x32_bf16 v[180:183], v[24:27], a[100:103], v[180:183]
    ds_read_b128 a[88:91], v214 offset:36864
    v_cvt_pk_bf16_f32 v117, v6, v7
    v_mfma_f32_16x16x32_bf16 v[180:183], v[52:55], a[104:107], v[180:183]
    v_exp_f32 v9, v9
    v_mfma_f32_16x16x32_bf16 v[180:183], v[56:59], a[108:111], v[180:183]
    ds_read_b64_tr_b16 a[120:121], v221 offset:40960
    v_mfma_f32_16x16x32_bf16 v[184:187], v[60:63], a[104:107], v[184:187]
    s_add_u32 m0, s31, 0x4000
    v_exp_f32 v10, v10
    v_mfma_f32_16x16x32_bf16 v[184:187], v[64:67], a[108:111], v[184:187]
    ds_read_b64_tr_b16 a[122:123], v221 offset:43008
    v_cvt_pk_bf16_f32 v124, v8, v9
    v_mfma_f32_16x16x32_bf16 v[184:187], v[28:31], a[96:99], v[184:187]
    v_exp_f32 v11, v11
    v_mfma_f32_16x16x32_bf16 v[184:187], v[32:35], a[100:103], v[184:187]
    global_load_lds_dwordx4 v228, s[74:75] nt
    v_mfma_f32_16x16x32_bf16 a[32:35], v[36:39], a[96:99], a[32:35]
    ds_read_b128 a[92:95], v215 offset:36864
    v_cvt_pk_bf16_f32 v125, v10, v11
    v_mfma_f32_16x16x32_bf16 a[32:35], v[40:43], a[100:103], a[32:35]
    ds_read_b64_tr_b16 a[124:125], v221 offset:45056
    v_mfma_f32_16x16x32_bf16 a[32:35], v[68:71], a[104:107], a[32:35]
    ds_read_b64_tr_b16 a[126:127], v221 offset:47104
    v_mfma_f32_16x16x32_bf16 a[32:35], v[72:75], a[108:111], a[32:35]
    global_load_lds_dwordx4 v229, s[74:75] offset:1024 nt
    v_mfma_f32_16x16x32_bf16 a[36:39], v[76:79], a[104:107], a[36:39]
    s_add_u32 s32, s67, 0x30000
    v_exp_f32 v12, v12
    v_mfma_f32_16x16x32_bf16 a[36:39], v[80:83], a[108:111], a[36:39]
    s_and_b32 s32, s32, 0x7ffff
    v_exp_f32 v13, v13
    v_mfma_f32_16x16x32_bf16 a[36:39], v[44:47], a[96:99], a[36:39]
    v_exp_f32 v14, v14
    v_mfma_f32_16x16x32_bf16 a[36:39], v[48:51], a[100:103], a[36:39]
    s_waitcnt vmcnt(14) lgkmcnt(0)
    v_exp_f32 v15, v15
    v_smfmac_f32_16x16x64_bf16 a[128:131], a[144:147], v[84:91], v236
    s_barrier
    v_mfma_f32_16x16x32_bf16 v[4:7], a[80:83], a[148:151], -4.0
    s_add_u32 s72, s14, s32
    v_exp_f32 v16, v16
    v_mfma_f32_16x16x32_bf16 v[4:7], a[84:87], a[152:155], v[4:7]
    ds_read_b128 a[64:67], v212 offset:49152
    v_cvt_pk_bf16_f32 v133, v14, v15
    v_mfma_f32_16x16x32_bf16 v[4:7], a[88:91], a[156:159], v[4:7]
    s_addc_u32 s73, s15, 0
    v_exp_f32 v17, v17
    v_mfma_f32_16x16x32_bf16 v[4:7], a[92:95], a[160:163], v[4:7]
    ds_read_b64_tr_b16 a[96:97], v222 offset:32768
    v_cvt_pk_bf16_f32 v132, v12, v13
    v_mfma_f32_16x16x32_bf16 v[8:11], a[88:91], a[172:175], -4.0
    v_exp_f32 v18, v18
    v_mfma_f32_16x16x32_bf16 v[8:11], a[92:95], a[176:179], v[8:11]
    ds_read_b64_tr_b16 a[98:99], v222 offset:34816
    v_cvt_pk_bf16_f32 v140, v16, v17
    v_mfma_f32_16x16x32_bf16 v[8:11], a[80:83], a[164:167], v[8:11]
    v_exp_f32 v19, v19
    v_mfma_f32_16x16x32_bf16 v[8:11], a[84:87], a[168:171], v[8:11]
    global_load_lds_dwordx4 v228, s[74:75] offset:2048 nt
    v_mfma_f32_16x16x32_bf16 v[12:15], a[80:83], a[180:183], -4.0
    v_exp_f32 v4, v4
    v_mfma_f32_16x16x32_bf16 v[12:15], a[84:87], a[184:187], v[12:15]
    ds_read_b128 a[68:71], v213 offset:49152
    v_cvt_pk_bf16_f32 v141, v18, v19
    v_mfma_f32_16x16x32_bf16 v[12:15], a[88:91], a[188:191], v[12:15]
    v_exp_f32 v5, v5
    v_mfma_f32_16x16x32_bf16 v[12:15], a[92:95], a[192:195], v[12:15]
    ds_read_b64_tr_b16 a[100:101], v222 offset:36864
    v_mfma_f32_16x16x32_bf16 v[16:19], a[88:91], a[204:207], -4.0
    v_exp_f32 v6, v6
    v_mfma_f32_16x16x32_bf16 v[16:19], a[92:95], a[208:211], v[16:19]
    ds_read_b64_tr_b16 a[102:103], v222 offset:38912
    v_cvt_pk_bf16_f32 v118, v4, v5
    v_mfma_f32_16x16x32_bf16 v[16:19], a[80:83], a[196:199], v[16:19]
    v_exp_f32 v7, v7
    v_mfma_f32_16x16x32_bf16 v[16:19], a[84:87], a[200:203], v[16:19]
    global_load_lds_dwordx4 v229, s[74:75] offset:3072 nt
    v_mfma_f32_16x16x32_bf16 v[188:191], v[20:23], a[112:115], v[188:191]
    v_exp_f32 v8, v8
    v_mfma_f32_16x16x32_bf16 v[188:191], v[24:27], a[116:119], v[188:191]
    ds_read_b128 a[72:75], v214 offset:49152
    v_cvt_pk_bf16_f32 v119, v6, v7
    v_mfma_f32_16x16x32_bf16 v[188:191], v[52:55], a[120:123], v[188:191]
    v_exp_f32 v9, v9
    v_mfma_f32_16x16x32_bf16 v[188:191], v[56:59], a[124:127], v[188:191]
    ds_read_b64_tr_b16 a[104:105], v222 offset:40960
    v_mfma_f32_16x16x32_bf16 v[192:195], v[60:63], a[120:123], v[192:195]
    s_add_u32 m0, s33, 0x4000
    v_exp_f32 v10, v10
    v_mfma_f32_16x16x32_bf16 v[192:195], v[64:67], a[124:127], v[192:195]
    ds_read_b64_tr_b16 a[106:107], v222 offset:43008
    v_cvt_pk_bf16_f32 v126, v8, v9
    v_mfma_f32_16x16x32_bf16 v[192:195], v[28:31], a[112:115], v[192:195]
    v_exp_f32 v11, v11
    v_mfma_f32_16x16x32_bf16 v[192:195], v[32:35], a[116:119], v[192:195]
    global_load_lds_dwordx4 v224, s[72:73] nt
    v_mfma_f32_16x16x32_bf16 a[40:43], v[36:39], a[112:115], a[40:43]
    s_add_u32 s32, s64, 0x48000
    v_exp_f32 v12, v12
    v_mfma_f32_16x16x32_bf16 a[40:43], v[40:43], a[116:119], a[40:43]
    ds_read_b128 a[76:79], v215 offset:49152
    v_cvt_pk_bf16_f32 v127, v10, v11
    v_mfma_f32_16x16x32_bf16 a[40:43], v[68:71], a[120:123], a[40:43]
    s_and_b32 s32, s32, 0x7ffff
    v_exp_f32 v13, v13
    v_mfma_f32_16x16x32_bf16 a[40:43], v[72:75], a[124:127], a[40:43]
    ds_read_b64_tr_b16 a[108:109], v222 offset:45056
    v_mfma_f32_16x16x32_bf16 a[44:47], v[76:79], a[120:123], a[44:47]
    v_exp_f32 v14, v14
    v_mfma_f32_16x16x32_bf16 a[44:47], v[80:83], a[124:127], a[44:47]
    ds_read_b64_tr_b16 a[110:111], v222 offset:47104
    v_cvt_pk_bf16_f32 v134, v12, v13
    v_mfma_f32_16x16x32_bf16 a[44:47], v[44:47], a[112:115], a[44:47]
    s_waitcnt lgkmcnt(2)
    v_exp_f32 v15, v15
    v_mfma_f32_16x16x32_bf16 a[44:47], v[48:51], a[116:119], a[44:47]
    global_load_lds_dwordx4 v225, s[72:73] offset:1024 nt
    v_smfmac_f32_16x16x64_bf16 a[132:135], a[144:147], v[92:99], v236
    v_mfma_f32_16x16x32_bf16 v[4:7], a[64:67], a[148:151], -4.0
    s_add_u32 s74, s12, s32
    v_exp_f32 v16, v16
    v_mfma_f32_16x16x32_bf16 v[4:7], a[68:71], a[152:155], v[4:7]
    ds_read_b128 a[80:83], v212 offset:53248
    v_cvt_pk_bf16_f32 v135, v14, v15
    v_mfma_f32_16x16x32_bf16 v[4:7], a[72:75], a[156:159], v[4:7]
    s_addc_u32 s75, s13, 0
    v_exp_f32 v17, v17
    v_mfma_f32_16x16x32_bf16 v[4:7], a[76:79], a[160:163], v[4:7]
    ds_read_b64_tr_b16 a[112:113], v223 offset:32768
    v_mfma_f32_16x16x32_bf16 v[8:11], a[72:75], a[172:175], -4.0
    v_exp_f32 v18, v18
    v_mfma_f32_16x16x32_bf16 v[8:11], a[76:79], a[176:179], v[8:11]
    ds_read_b64_tr_b16 a[114:115], v223 offset:34816
    v_cvt_pk_bf16_f32 v142, v16, v17
    v_mfma_f32_16x16x32_bf16 v[8:11], a[64:67], a[164:167], v[8:11]
    s_waitcnt lgkmcnt(3)
    v_exp_f32 v19, v19
    v_mfma_f32_16x16x32_bf16 v[8:11], a[68:71], a[168:171], v[8:11]
    global_load_lds_dwordx4 v226, s[72:73] offset:2048 nt
    v_mfma_f32_16x16x32_bf16 v[12:15], a[64:67], a[180:183], -4.0
    v_exp_f32 v4, v4
    v_mfma_f32_16x16x32_bf16 v[12:15], a[68:71], a[184:187], v[12:15]
    ds_read_b128 a[84:87], v213 offset:53248
    v_cvt_pk_bf16_f32 v143, v18, v19
    v_mfma_f32_16x16x32_bf16 v[12:15], a[72:75], a[188:191], v[12:15]
    v_exp_f32 v5, v5
    v_mfma_f32_16x16x32_bf16 v[12:15], a[76:79], a[192:195], v[12:15]
    ds_read_b64_tr_b16 a[116:117], v223 offset:36864
    v_mfma_f32_16x16x32_bf16 v[16:19], a[72:75], a[204:207], -4.0
    v_exp_f32 v6, v6
    v_mfma_f32_16x16x32_bf16 v[16:19], a[76:79], a[208:211], v[16:19]
    ds_read_b64_tr_b16 a[118:119], v223 offset:38912
    v_cvt_pk_bf16_f32 v120, v4, v5
    v_mfma_f32_16x16x32_bf16 v[16:19], a[64:67], a[196:199], v[16:19]
    v_exp_f32 v7, v7
    v_mfma_f32_16x16x32_bf16 v[16:19], a[68:71], a[200:203], v[16:19]
    global_load_lds_dwordx4 v227, s[72:73] offset:3072 nt
    v_mfma_f32_16x16x32_bf16 v[196:199], v[20:23], a[96:99], v[196:199]
    v_exp_f32 v8, v8
    v_mfma_f32_16x16x32_bf16 v[196:199], v[24:27], a[100:103], v[196:199]
    ds_read_b128 a[88:91], v214 offset:53248
    v_cvt_pk_bf16_f32 v121, v6, v7
    v_mfma_f32_16x16x32_bf16 v[196:199], v[52:55], a[104:107], v[196:199]
    v_exp_f32 v9, v9
    v_mfma_f32_16x16x32_bf16 v[196:199], v[56:59], a[108:111], v[196:199]
    ds_read_b64_tr_b16 a[120:121], v223 offset:40960
    v_mfma_f32_16x16x32_bf16 v[200:203], v[60:63], a[104:107], v[200:203]
    s_add_u32 m0, s31, 0x8000
    v_exp_f32 v10, v10
    v_mfma_f32_16x16x32_bf16 v[200:203], v[64:67], a[108:111], v[200:203]
    ds_read_b64_tr_b16 a[122:123], v223 offset:43008
    v_cvt_pk_bf16_f32 v128, v8, v9
    v_mfma_f32_16x16x32_bf16 v[200:203], v[28:31], a[96:99], v[200:203]
    v_exp_f32 v11, v11
    v_mfma_f32_16x16x32_bf16 v[200:203], v[32:35], a[100:103], v[200:203]
    global_load_lds_dwordx4 v228, s[74:75] nt
    v_mfma_f32_16x16x32_bf16 a[48:51], v[36:39], a[96:99], a[48:51]
    ds_read_b128 a[92:95], v215 offset:53248
    v_cvt_pk_bf16_f32 v129, v10, v11
    v_mfma_f32_16x16x32_bf16 a[48:51], v[40:43], a[100:103], a[48:51]
    ds_read_b64_tr_b16 a[124:125], v223 offset:45056
    v_mfma_f32_16x16x32_bf16 a[48:51], v[68:71], a[104:107], a[48:51]
    ds_read_b64_tr_b16 a[126:127], v223 offset:47104
    v_mfma_f32_16x16x32_bf16 a[48:51], v[72:75], a[108:111], a[48:51]
    global_load_lds_dwordx4 v229, s[74:75] offset:1024 nt
    v_mfma_f32_16x16x32_bf16 a[52:55], v[76:79], a[104:107], a[52:55]
    s_add_u32 s32, s67, 0x38000
    v_exp_f32 v12, v12
    v_mfma_f32_16x16x32_bf16 a[52:55], v[80:83], a[108:111], a[52:55]
    s_and_b32 s32, s32, 0x7ffff
    v_exp_f32 v13, v13
    v_mfma_f32_16x16x32_bf16 a[52:55], v[44:47], a[96:99], a[52:55]
L_stub4:
    s_cbranch_execz L_stub8
    v_exp_f32 v14, v14
    v_mfma_f32_16x16x32_bf16 a[52:55], v[48:51], a[100:103], a[52:55]
    s_waitcnt vmcnt(10) lgkmcnt(0)
    v_exp_f32 v15, v15
    v_smfmac_f32_16x16x64_bf16 a[136:139], a[144:147], v[100:107], v236
    s_barrier
    v_mfma_f32_16x16x32_bf16 v[4:7], a[80:83], a[148:151], -4.0
    s_add_u32 s72, s14, s32
    v_exp_f32 v16, v16
    v_mfma_f32_16x16x32_bf16 v[4:7], a[84:87], a[152:155], v[4:7]
    ds_read_b128 a[64:67], v212
    v_cvt_pk_bf16_f32 v137, v14, v15
    v_mfma_f32_16x16x32_bf16 v[4:7], a[88:91], a[156:159], v[4:7]
    s_addc_u32 s73, s15, 0
    v_exp_f32 v17, v17
    v_mfma_f32_16x16x32_bf16 v[4:7], a[92:95], a[160:163], v[4:7]
    ds_read_b64_tr_b16 a[96:97], v220
    v_cvt_pk_bf16_f32 v136, v12, v13
    v_mfma_f32_16x16x32_bf16 v[8:11], a[88:91], a[172:175], -4.0
    v_exp_f32 v18, v18
    v_mfma_f32_16x16x32_bf16 v[8:11], a[92:95], a[176:179], v[8:11]
    ds_read_b64_tr_b16 a[98:99], v220 offset:2048
    v_cvt_pk_bf16_f32 v144, v16, v17
    v_mfma_f32_16x16x32_bf16 v[8:11], a[80:83], a[164:167], v[8:11]
    v_exp_f32 v19, v19
    v_mfma_f32_16x16x32_bf16 v[8:11], a[84:87], a[168:171], v[8:11]
    global_load_lds_dwordx4 v228, s[74:75] offset:2048 nt
    v_mfma_f32_16x16x32_bf16 v[12:15], a[80:83], a[180:183], -4.0
    v_exp_f32 v4, v4
    v_mfma_f32_16x16x32_bf16 v[12:15], a[84:87], a[184:187], v[12:15]
    ds_read_b128 a[68:71], v213
    v_cvt_pk_bf16_f32 v145, v18, v19
    v_mfma_f32_16x16x32_bf16 v[12:15], a[88:91], a[188:191], v[12:15]
    v_exp_f32 v5, v5
    v_mfma_f32_16x16x32_bf16 v[12:15], a[92:95], a[192:195], v[12:15]
    ds_read_b64_tr_b16 a[100:101], v220 offset:4096
    v_mfma_f32_16x16x32_bf16 v[16:19], a[88:91], a[204:207], -4.0
    v_exp_f32 v6, v6
    v_mfma_f32_16x16x32_bf16 v[16:19], a[92:95], a[208:211], v[16:19]
    ds_read_b64_tr_b16 a[102:103], v220 offset:6144
    v_cvt_pk_bf16_f32 v122, v4, v5
    v_mfma_f32_16x16x32_bf16 v[16:19], a[80:83], a[196:199], v[16:19]
    v_exp_f32 v7, v7
    v_mfma_f32_16x16x32_bf16 v[16:19], a[84:87], a[200:203], v[16:19]
    global_load_lds_dwordx4 v229, s[74:75] offset:3072 nt
    v_mfma_f32_16x16x32_bf16 v[204:207], v[20:23], a[112:115], v[204:207]
    v_exp_f32 v8, v8
    v_mfma_f32_16x16x32_bf16 v[204:207], v[24:27], a[116:119], v[204:207]
    ds_read_b128 a[72:75], v214
    v_cvt_pk_bf16_f32 v123, v6, v7
    v_mfma_f32_16x16x32_bf16 v[204:207], v[52:55], a[120:123], v[204:207]
    v_exp_f32 v9, v9
    v_mfma_f32_16x16x32_bf16 v[204:207], v[56:59], a[124:127], v[204:207]
    ds_read_b64_tr_b16 a[104:105], v220 offset:8192
    v_mfma_f32_16x16x32_bf16 v[208:211], v[60:63], a[120:123], v[208:211]
    s_add_u32 m0, s33, 0x6000
    v_exp_f32 v10, v10
    v_mfma_f32_16x16x32_bf16 v[208:211], v[64:67], a[124:127], v[208:211]
    ds_read_b64_tr_b16 a[106:107], v220 offset:10240
    v_cvt_pk_bf16_f32 v130, v8, v9
    v_mfma_f32_16x16x32_bf16 v[208:211], v[28:31], a[112:115], v[208:211]
    v_exp_f32 v11, v11
    v_mfma_f32_16x16x32_bf16 v[208:211], v[32:35], a[116:119], v[208:211]
    global_load_lds_dwordx4 v224, s[72:73] nt
    v_mfma_f32_16x16x32_bf16 a[56:59], v[36:39], a[112:115], a[56:59]
    s_add_u32 s32, s65, 0x48000
    v_exp_f32 v12, v12
    v_mfma_f32_16x16x32_bf16 a[56:59], v[40:43], a[116:119], a[56:59]
    ds_read_b128 a[76:79], v215
    v_cvt_pk_bf16_f32 v131, v10, v11
    v_mfma_f32_16x16x32_bf16 a[56:59], v[68:71], a[120:123], a[56:59]
    s_and_b32 s32, s32, 0x7ffff
    v_exp_f32 v13, v13
    v_mfma_f32_16x16x32_bf16 a[56:59], v[72:75], a[124:127], a[56:59]
    ds_read_b64_tr_b16 a[108:109], v220 offset:12288
    v_mfma_f32_16x16x32_bf16 a[60:63], v[76:79], a[120:123], a[60:63]
    v_exp_f32 v14, v14
    v_mfma_f32_16x16x32_bf16 a[60:63], v[80:83], a[124:127], a[60:63]
    ds_read_b64_tr_b16 a[110:111], v220 offset:14336
    v_cvt_pk_bf16_f32 v138, v12, v13
    v_mfma_f32_16x16x32_bf16 a[60:63], v[44:47], a[112:115], a[60:63]
    s_waitcnt lgkmcnt(2)
    v_exp_f32 v15, v15
    v_mfma_f32_16x16x32_bf16 a[60:63], v[48:51], a[116:119], a[60:63]
    global_load_lds_dwordx4 v225, s[72:73] offset:1024 nt
    v_smfmac_f32_16x16x64_bf16 a[140:143], a[144:147], v[108:115], v236
    v_mfma_f32_16x16x32_bf16 v[4:7], a[64:67], a[148:151], -4.0
    s_add_u32 s74, s12, s32
    v_exp_f32 v16, v16
    v_mfma_f32_16x16x32_bf16 v[4:7], a[68:71], a[152:155], v[4:7]
    ds_read_b128 a[80:83], v212 offset:4096
    v_cvt_pk_bf16_f32 v139, v14, v15
    v_mfma_f32_16x16x32_bf16 v[4:7], a[72:75], a[156:159], v[4:7]
    s_addc_u32 s75, s13, 0
    v_exp_f32 v17, v17
    v_mfma_f32_16x16x32_bf16 v[4:7], a[76:79], a[160:163], v[4:7]
    ds_read_b64_tr_b16 a[112:113], v221
    v_mfma_f32_16x16x32_bf16 v[8:11], a[72:75], a[172:175], -4.0
    v_exp_f32 v18, v18
    v_mfma_f32_16x16x32_bf16 v[8:11], a[76:79], a[176:179], v[8:11]
    ds_read_b64_tr_b16 a[114:115], v221 offset:2048
    v_cvt_pk_bf16_f32 v146, v16, v17
    v_mfma_f32_16x16x32_bf16 v[8:11], a[64:67], a[164:167], v[8:11]
    s_waitcnt lgkmcnt(3)
    v_exp_f32 v19, v19
    v_mfma_f32_16x16x32_bf16 v[8:11], a[68:71], a[168:171], v[8:11]
    global_load_lds_dwordx4 v226, s[72:73] offset:2048 nt
    v_mfma_f32_16x16x32_bf16 v[12:15], a[64:67], a[180:183], -4.0
    v_exp_f32 v4, v4
    v_mfma_f32_16x16x32_bf16 v[12:15], a[68:71], a[184:187], v[12:15]
    ds_read_b128 a[84:87], v213 offset:4096
    v_cvt_pk_bf16_f32 v147, v18, v19
    v_mfma_f32_16x16x32_bf16 v[12:15], a[72:75], a[188:191], v[12:15]
    v_exp_f32 v5, v5
    v_mfma_f32_16x16x32_bf16 v[12:15], a[76:79], a[192:195], v[12:15]
    ds_read_b64_tr_b16 a[116:117], v221 offset:4096
    v_mfma_f32_16x16x32_bf16 v[16:19], a[72:75], a[204:207], -4.0
    v_exp_f32 v6, v6
    v_mfma_f32_16x16x32_bf16 v[16:19], a[76:79], a[208:211], v[16:19]
    ds_read_b64_tr_b16 a[118:119], v221 offset:6144
    v_cvt_pk_bf16_f32 v20, v4, v5
    v_mfma_f32_16x16x32_bf16 v[16:19], a[64:67], a[196:199], v[16:19]
    v_exp_f32 v7, v7
    v_mfma_f32_16x16x32_bf16 v[16:19], a[68:71], a[200:203], v[16:19]
    global_load_lds_dwordx4 v227, s[72:73] offset:3072 nt
    v_mfma_f32_16x16x32_bf16 v[148:151], v[84:87], a[96:99], v[148:151]
    v_exp_f32 v8, v8
    v_mfma_f32_16x16x32_bf16 v[148:151], v[88:91], a[100:103], v[148:151]
    ds_read_b128 a[88:91], v214 offset:4096
    v_cvt_pk_bf16_f32 v21, v6, v7
    v_mfma_f32_16x16x32_bf16 v[148:151], v[116:119], a[104:107], v[148:151]
    v_exp_f32 v9, v9
    v_mfma_f32_16x16x32_bf16 v[148:151], v[120:123], a[108:111], v[148:151]
    ds_read_b64_tr_b16 a[120:121], v221 offset:8192
    v_mfma_f32_16x16x32_bf16 v[152:155], v[124:127], a[104:107], v[152:155]
    s_add_u32 m0, s31, 0xc000
    v_exp_f32 v10, v10
    v_mfma_f32_16x16x32_bf16 v[152:155], v[128:131], a[108:111], v[152:155]
    ds_read_b64_tr_b16 a[122:123], v221 offset:10240
    v_cvt_pk_bf16_f32 v28, v8, v9
    v_mfma_f32_16x16x32_bf16 v[152:155], v[92:95], a[96:99], v[152:155]
    v_exp_f32 v11, v11
    v_mfma_f32_16x16x32_bf16 v[152:155], v[96:99], a[100:103], v[152:155]
    global_load_lds_dwordx4 v228, s[74:75] nt
    v_mfma_f32_16x16x32_bf16 a[0:3], v[100:103], a[96:99], a[0:3]
    ds_read_b128 a[92:95], v215 offset:4096
    v_cvt_pk_bf16_f32 v29, v10, v11
    v_mfma_f32_16x16x32_bf16 a[0:3], v[104:107], a[100:103], a[0:3]
    ds_read_b64_tr_b16 a[124:125], v221 offset:12288
    v_mfma_f32_16x16x32_bf16 a[0:3], v[132:135], a[104:107], a[0:3]
    ds_read_b64_tr_b16 a[126:127], v221 offset:14336
    v_mfma_f32_16x16x32_bf16 a[0:3], v[136:139], a[108:111], a[0:3]
    global_load_lds_dwordx4 v229, s[74:75] offset:1024 nt
    v_mfma_f32_16x16x32_bf16 a[4:7], v[140:143], a[104:107], a[4:7]
    s_add_u32 s32, s66, 0x40000
    v_exp_f32 v12, v12
    v_mfma_f32_16x16x32_bf16 a[4:7], v[144:147], a[108:111], a[4:7]
    s_and_b32 s32, s32, 0x7ffff
    v_exp_f32 v13, v13
    v_mfma_f32_16x16x32_bf16 a[4:7], v[108:111], a[96:99], a[4:7]
    v_exp_f32 v14, v14
    v_mfma_f32_16x16x32_bf16 a[4:7], v[112:115], a[100:103], a[4:7]
    s_waitcnt vmcnt(14) lgkmcnt(0)
    v_exp_f32 v15, v15
    v_smfmac_f32_16x16x64_bf16 a[128:131], a[144:147], v[116:123], v236
    s_barrier
    v_mfma_f32_16x16x32_bf16 v[4:7], a[80:83], a[148:151], -4.0
    s_add_u32 s72, s14, s32
    v_exp_f32 v16, v16
    v_mfma_f32_16x16x32_bf16 v[4:7], a[84:87], a[152:155], v[4:7]
    ds_read_b128 a[64:67], v212 offset:16384
    v_cvt_pk_bf16_f32 v37, v14, v15
    v_mfma_f32_16x16x32_bf16 v[4:7], a[88:91], a[156:159], v[4:7]
    s_addc_u32 s73, s15, 0
    v_exp_f32 v17, v17
    v_mfma_f32_16x16x32_bf16 v[4:7], a[92:95], a[160:163], v[4:7]
    ds_read_b64_tr_b16 a[96:97], v222
    v_cvt_pk_bf16_f32 v36, v12, v13
    v_mfma_f32_16x16x32_bf16 v[8:11], a[88:91], a[172:175], -4.0
    v_exp_f32 v18, v18
    v_mfma_f32_16x16x32_bf16 v[8:11], a[92:95], a[176:179], v[8:11]
    ds_read_b64_tr_b16 a[98:99], v222 offset:2048
    v_cvt_pk_bf16_f32 v44, v16, v17
    v_mfma_f32_16x16x32_bf16 v[8:11], a[80:83], a[164:167], v[8:11]
    v_exp_f32 v19, v19
    v_mfma_f32_16x16x32_bf16 v[8:11], a[84:87], a[168:171], v[8:11]
    global_load_lds_dwordx4 v228, s[74:75] offset:2048 nt
    v_mfma_f32_16x16x32_bf16 v[12:15], a[80:83], a[180:183], -4.0
    v_exp_f32 v4, v4
    v_mfma_f32_16x16x32_bf16 v[12:15], a[84:87], a[184:187], v[12:15]
    ds_read_b128 a[68:71], v213 offset:16384
    v_cvt_pk_bf16_f32 v45, v18, v19
    v_mfma_f32_16x16x32_bf16 v[12:15], a[88:91], a[188:191], v[12:15]
    v_exp_f32 v5, v5
    v_mfma_f32_16x16x32_bf16 v[12:15], a[92:95], a[192:195], v[12:15]
    ds_read_b64_tr_b16 a[100:101], v222 offset:4096
    v_mfma_f32_16x16x32_bf16 v[16:19], a[88:91], a[204:207], -4.0
    v_exp_f32 v6, v6
    v_mfma_f32_16x16x32_bf16 v[16:19], a[92:95], a[208:211], v[16:19]
    ds_read_b64_tr_b16 a[102:103], v222 offset:6144
    v_cvt_pk_bf16_f32 v22, v4, v5
    v_mfma_f32_16x16x32_bf16 v[16:19], a[80:83], a[196:199], v[16:19]
    v_exp_f32 v7, v7
    v_mfma_f32_16x16x32_bf16 v[16:19], a[84:87], a[200:203], v[16:19]
    global_load_lds_dwordx4 v229, s[74:75] offset:3072 nt
    v_mfma_f32_16x16x32_bf16 v[156:159], v[84:87], a[112:115], v[156:159]
    v_exp_f32 v8, v8
    v_mfma_f32_16x16x32_bf16 v[156:159], v[88:91], a[116:119], v[156:159]
    ds_read_b128 a[72:75], v214 offset:16384
    v_cvt_pk_bf16_f32 v23, v6, v7
    v_mfma_f32_16x16x32_bf16 v[156:159], v[116:119], a[120:123], v[156:159]
    v_exp_f32 v9, v9
    v_mfma_f32_16x16x32_bf16 v[156:159], v[120:123], a[124:127], v[156:159]
    ds_read_b64_tr_b16 a[104:105], v222 offset:8192
    v_mfma_f32_16x16x32_bf16 v[160:163], v[124:127], a[120:123], v[160:163]
    s_add_u32 m0, s33, 0x8000
    v_exp_f32 v10, v10
    v_mfma_f32_16x16x32_bf16 v[160:163], v[128:131], a[124:127], v[160:163]
    ds_read_b64_tr_b16 a[106:107], v222 offset:10240
    v_cvt_pk_bf16_f32 v30, v8, v9
    v_mfma_f32_16x16x32_bf16 v[160:163], v[92:95], a[112:115], v[160:163]
    v_exp_f32 v11, v11
    v_mfma_f32_16x16x32_bf16 v[160:163], v[96:99], a[116:119], v[160:163]
    global_load_lds_dwordx4 v224, s[72:73] nt
    v_mfma_f32_16x16x32_bf16 a[8:11], v[100:103], a[112:115], a[8:11]
    s_add_u32 s32, s64, 0x50000
    v_exp_f32 v12, v12
    v_mfma_f32_16x16x32_bf16 a[8:11], v[104:107], a[116:119], a[8:11]
    ds_read_b128 a[76:79], v215 offset:16384
    v_cvt_pk_bf16_f32 v31, v10, v11
    v_mfma_f32_16x16x32_bf16 a[8:11], v[132:135], a[120:123], a[8:11]
    s_and_b32 s32, s32, 0x7ffff
    v_exp_f32 v13, v13
    v_mfma_f32_16x16x32_bf16 a[8:11], v[136:139], a[124:127], a[8:11]
    ds_read_b64_tr_b16 a[108:109], v222 offset:12288
    v_mfma_f32_16x16x32_bf16 a[12:15], v[140:143], a[120:123], a[12:15]
    v_exp_f32 v14, v14
    v_mfma_f32_16x16x32_bf16 a[12:15], v[144:147], a[124:127], a[12:15]
    ds_read_b64_tr_b16 a[110:111], v222 offset:14336
    v_cvt_pk_bf16_f32 v38, v12, v13
    v_mfma_f32_16x16x32_bf16 a[12:15], v[108:111], a[112:115], a[12:15]
    s_waitcnt lgkmcnt(2)
    v_exp_f32 v15, v15
    v_mfma_f32_16x16x32_bf16 a[12:15], v[112:115], a[116:119], a[12:15]
    global_load_lds_dwordx4 v225, s[72:73] offset:1024 nt
    v_smfmac_f32_16x16x64_bf16 a[132:135], a[144:147], v[124:131], v236
    v_mfma_f32_16x16x32_bf16 v[4:7], a[64:67], a[148:151], -4.0
    s_add_u32 s74, s12, s32
    v_exp_f32 v16, v16
    v_mfma_f32_16x16x32_bf16 v[4:7], a[68:71], a[152:155], v[4:7]
    ds_read_b128 a[80:83], v212 offset:20480
    v_cvt_pk_bf16_f32 v39, v14, v15
    v_mfma_f32_16x16x32_bf16 v[4:7], a[72:75], a[156:159], v[4:7]
    s_addc_u32 s75, s13, 0
    v_exp_f32 v17, v17
    v_mfma_f32_16x16x32_bf16 v[4:7], a[76:79], a[160:163], v[4:7]
    ds_read_b64_tr_b16 a[112:113], v223
    v_mfma_f32_16x16x32_bf16 v[8:11], a[72:75], a[172:175], -4.0
    v_exp_f32 v18, v18
    v_mfma_f32_16x16x32_bf16 v[8:11], a[76:79], a[176:179], v[8:11]
    ds_read_b64_tr_b16 a[114:115], v223 offset:2048
    v_cvt_pk_bf16_f32 v46, v16, v17
    v_mfma_f32_16x16x32_bf16 v[8:11], a[64:67], a[164:167], v[8:11]
    s_waitcnt lgkmcnt(3)
    v_exp_f32 v19, v19
    v_mfma_f32_16x16x32_bf16 v[8:11], a[68:71], a[168:171], v[8:11]
    global_load_lds_dwordx4 v226, s[72:73] offset:2048 nt
    v_mfma_f32_16x16x32_bf16 v[12:15], a[64:67], a[180:183], -4.0
    v_exp_f32 v4, v4
    v_mfma_f32_16x16x32_bf16 v[12:15], a[68:71], a[184:187], v[12:15]
    ds_read_b128 a[84:87], v213 offset:20480
    v_cvt_pk_bf16_f32 v47, v18, v19
    v_mfma_f32_16x16x32_bf16 v[12:15], a[72:75], a[188:191], v[12:15]
    v_exp_f32 v5, v5
    v_mfma_f32_16x16x32_bf16 v[12:15], a[76:79], a[192:195], v[12:15]
    ds_read_b64_tr_b16 a[116:117], v223 offset:4096
    v_mfma_f32_16x16x32_bf16 v[16:19], a[72:75], a[204:207], -4.0
    v_exp_f32 v6, v6
    v_mfma_f32_16x16x32_bf16 v[16:19], a[76:79], a[208:211], v[16:19]
    ds_read_b64_tr_b16 a[118:119], v223 offset:6144
    v_cvt_pk_bf16_f32 v24, v4, v5
    v_mfma_f32_16x16x32_bf16 v[16:19], a[64:67], a[196:199], v[16:19]
    v_exp_f32 v7, v7
    v_mfma_f32_16x16x32_bf16 v[16:19], a[68:71], a[200:203], v[16:19]
    global_load_lds_dwordx4 v227, s[72:73] offset:3072 nt
    v_mfma_f32_16x16x32_bf16 v[164:167], v[84:87], a[96:99], v[164:167]
    v_exp_f32 v8, v8
    v_mfma_f32_16x16x32_bf16 v[164:167], v[88:91], a[100:103], v[164:167]
    ds_read_b128 a[88:91], v214 offset:20480
    v_cvt_pk_bf16_f32 v25, v6, v7
    v_mfma_f32_16x16x32_bf16 v[164:167], v[116:119], a[104:107], v[164:167]
    v_exp_f32 v9, v9
    v_mfma_f32_16x16x32_bf16 v[164:167], v[120:123], a[108:111], v[164:167]
    ds_read_b64_tr_b16 a[120:121], v223 offset:8192
    v_mfma_f32_16x16x32_bf16 v[168:171], v[124:127], a[104:107], v[168:171]
    s_add_u32 m0, s31, 0x0
    v_exp_f32 v10, v10
    v_mfma_f32_16x16x32_bf16 v[168:171], v[128:131], a[108:111], v[168:171]
    ds_read_b64_tr_b16 a[122:123], v223 offset:10240
    v_cvt_pk_bf16_f32 v32, v8, v9
    v_mfma_f32_16x16x32_bf16 v[168:171], v[92:95], a[96:99], v[168:171]
    v_exp_f32 v11, v11
    v_mfma_f32_16x16x32_bf16 v[168:171], v[96:99], a[100:103], v[168:171]
    global_load_lds_dwordx4 v228, s[74:75] nt
    v_mfma_f32_16x16x32_bf16 a[16:19], v[100:103], a[96:99], a[16:19]
    ds_read_b128 a[92:95], v215 offset:20480
    v_cvt_pk_bf16_f32 v33, v10, v11
    v_mfma_f32_16x16x32_bf16 a[16:19], v[104:107], a[100:103], a[16:19]
    ds_read_b64_tr_b16 a[124:125], v223 offset:12288
    v_mfma_f32_16x16x32_bf16 a[16:19], v[132:135], a[104:107], a[16:19]
    ds_read_b64_tr_b16 a[126:127], v223 offset:14336
    v_mfma_f32_16x16x32_bf16 a[16:19], v[136:139], a[108:111], a[16:19]
    global_load_lds_dwordx4 v229, s[74:75] offset:1024 nt
    v_mfma_f32_16x16x32_bf16 a[20:23], v[140:143], a[104:107], a[20:23]
    s_add_u32 s32, s66, 0x48000
    v_exp_f32 v12, v12
    v_mfma_f32_16x16x32_bf16 a[20:23], v[144:147], a[108:111], a[20:23]
    s_and_b32 s32, s32, 0x7ffff
    v_exp_f32 v13, v13
    v_mfma_f32_16x16x32_bf16 a[20:23], v[108:111], a[96:99], a[20:23]
    v_exp_f32 v14, v14
    v_mfma_f32_16x16x32_bf16 a[20:23], v[112:115], a[100:103], a[20:23]
    s_waitcnt vmcnt(10) lgkmcnt(0)
    v_exp_f32 v15, v15
    v_smfmac_f32_16x16x64_bf16 a[136:139], a[144:147], v[132:139], v236
    s_barrier
    v_mfma_f32_16x16x32_bf16 v[4:7], a[80:83], a[148:151], -4.0
    s_add_u32 s72, s14, s32
    v_exp_f32 v16, v16
    v_mfma_f32_16x16x32_bf16 v[4:7], a[84:87], a[152:155], v[4:7]
    ds_read_b128 a[64:67], v212 offset:32768
    v_cvt_pk_bf16_f32 v41, v14, v15
    v_mfma_f32_16x16x32_bf16 v[4:7], a[88:91], a[156:159], v[4:7]
    s_addc_u32 s73, s15, 0
    v_exp_f32 v17, v17
    v_mfma_f32_16x16x32_bf16 v[4:7], a[92:95], a[160:163], v[4:7]
    ds_read_b64_tr_b16 a[96:97], v220 offset:16384
    v_cvt_pk_bf16_f32 v40, v12, v13
    v_mfma_f32_16x16x32_bf16 v[8:11], a[88:91], a[172:175], -4.0
    v_exp_f32 v18, v18
    v_mfma_f32_16x16x32_bf16 v[8:11], a[92:95], a[176:179], v[8:11]
    ds_read_b64_tr_b16 a[98:99], v220 offset:18432
    v_cvt_pk_bf16_f32 v48, v16, v17
    v_mfma_f32_16x16x32_bf16 v[8:11], a[80:83], a[164:167], v[8:11]
    v_exp_f32 v19, v19
    v_mfma_f32_16x16x32_bf16 v[8:11], a[84:87], a[168:171], v[8:11]
    global_load_lds_dwordx4 v228, s[74:75] offset:2048 nt
    v_mfma_f32_16x16x32_bf16 v[12:15], a[80:83], a[180:183], -4.0
    v_exp_f32 v4, v4
    v_mfma_f32_16x16x32_bf16 v[12:15], a[84:87], a[184:187], v[12:15]
    ds_read_b128 a[68:71], v213 offset:32768
    v_cvt_pk_bf16_f32 v49, v18, v19
    v_mfma_f32_16x16x32_bf16 v[12:15], a[88:91], a[188:191], v[12:15]
    v_exp_f32 v5, v5
    v_mfma_f32_16x16x32_bf16 v[12:15], a[92:95], a[192:195], v[12:15]
    ds_read_b64_tr_b16 a[100:101], v220 offset:20480
    v_mfma_f32_16x16x32_bf16 v[16:19], a[88:91], a[204:207], -4.0
    v_exp_f32 v6, v6
    v_mfma_f32_16x16x32_bf16 v[16:19], a[92:95], a[208:211], v[16:19]
    ds_read_b64_tr_b16 a[102:103], v220 offset:22528
    v_cvt_pk_bf16_f32 v26, v4, v5
    v_mfma_f32_16x16x32_bf16 v[16:19], a[80:83], a[196:199], v[16:19]
    v_exp_f32 v7, v7
    v_mfma_f32_16x16x32_bf16 v[16:19], a[84:87], a[200:203], v[16:19]
    global_load_lds_dwordx4 v229, s[74:75] offset:3072 nt
    v_mfma_f32_16x16x32_bf16 v[172:175], v[84:87], a[112:115], v[172:175]
    v_exp_f32 v8, v8
    v_mfma_f32_16x16x32_bf16 v[172:175], v[88:91], a[116:119], v[172:175]
    ds_read_b128 a[72:75], v214 offset:32768
    v_cvt_pk_bf16_f32 v27, v6, v7
    v_mfma_f32_16x16x32_bf16 v[172:175], v[116:119], a[120:123], v[172:175]
    v_exp_f32 v9, v9
    v_mfma_f32_16x16x32_bf16 v[172:175], v[120:123], a[124:127], v[172:175]
    ds_read_b64_tr_b16 a[104:105], v220 offset:24576
    v_mfma_f32_16x16x32_bf16 v[176:179], v[124:127], a[120:123], v[176:179]
    s_add_u32 m0, s33, 0xa000
    v_exp_f32 v10, v10
    v_mfma_f32_16x16x32_bf16 v[176:179], v[128:131], a[124:127], v[176:179]
    ds_read_b64_tr_b16 a[106:107], v220 offset:26624
    v_cvt_pk_bf16_f32 v34, v8, v9
    v_mfma_f32_16x16x32_bf16 v[176:179], v[92:95], a[112:115], v[176:179]
    v_exp_f32 v11, v11
    v_mfma_f32_16x16x32_bf16 v[176:179], v[96:99], a[116:119], v[176:179]
    global_load_lds_dwordx4 v224, s[72:73] nt
    v_mfma_f32_16x16x32_bf16 a[24:27], v[100:103], a[112:115], a[24:27]
    s_add_u32 s32, s65, 0x50000
    v_exp_f32 v12, v12
    v_mfma_f32_16x16x32_bf16 a[24:27], v[104:107], a[116:119], a[24:27]
    ds_read_b128 a[76:79], v215 offset:32768
    v_cvt_pk_bf16_f32 v35, v10, v11
    v_mfma_f32_16x16x32_bf16 a[24:27], v[132:135], a[120:123], a[24:27]
    s_and_b32 s32, s32, 0x7ffff
    v_exp_f32 v13, v13
    v_mfma_f32_16x16x32_bf16 a[24:27], v[136:139], a[124:127], a[24:27]
    ds_read_b64_tr_b16 a[108:109], v220 offset:28672
    v_mfma_f32_16x16x32_bf16 a[28:31], v[140:143], a[120:123], a[28:31]
    v_exp_f32 v14, v14
    v_mfma_f32_16x16x32_bf16 a[28:31], v[144:147], a[124:127], a[28:31]
    ds_read_b64_tr_b16 a[110:111], v220 offset:30720
    v_cvt_pk_bf16_f32 v42, v12, v13
    v_mfma_f32_16x16x32_bf16 a[28:31], v[108:111], a[112:115], a[28:31]
    s_waitcnt lgkmcnt(2)
    v_exp_f32 v15, v15
    v_mfma_f32_16x16x32_bf16 a[28:31], v[112:115], a[116:119], a[28:31]
    global_load_lds_dwordx4 v225, s[72:73] offset:1024 nt
    v_smfmac_f32_16x16x64_bf16 a[140:143], a[144:147], v[140:147], v236
    v_mfma_f32_16x16x32_bf16 v[4:7], a[64:67], a[148:151], -4.0
    s_add_u32 s74, s12, s32
    v_exp_f32 v16, v16
    v_mfma_f32_16x16x32_bf16 v[4:7], a[68:71], a[152:155], v[4:7]
    ds_read_b128 a[80:83], v212 offset:36864
    v_cvt_pk_bf16_f32 v43, v14, v15
    v_mfma_f32_16x16x32_bf16 v[4:7], a[72:75], a[156:159], v[4:7]
    s_addc_u32 s75, s13, 0
    v_exp_f32 v17, v17
    v_mfma_f32_16x16x32_bf16 v[4:7], a[76:79], a[160:163], v[4:7]
    ds_read_b64_tr_b16 a[112:113], v221 offset:16384
    v_mfma_f32_16x16x32_bf16 v[8:11], a[72:75], a[172:175], -4.0
    v_exp_f32 v18, v18
    v_mfma_f32_16x16x32_bf16 v[8:11], a[76:79], a[176:179], v[8:11]
    ds_read_b64_tr_b16 a[114:115], v221 offset:18432
    v_cvt_pk_bf16_f32 v50, v16, v17
    v_mfma_f32_16x16x32_bf16 v[8:11], a[64:67], a[164:167], v[8:11]
    s_waitcnt lgkmcnt(3)
    v_exp_f32 v19, v19
    v_mfma_f32_16x16x32_bf16 v[8:11], a[68:71], a[168:171], v[8:11]
    global_load_lds_dwordx4 v226, s[72:73] offset:2048 nt
    v_mfma_f32_16x16x32_bf16 v[12:15], a[64:67], a[180:183], -4.0
    v_exp_f32 v4, v4
    v_mfma_f32_16x16x32_bf16 v[12:15], a[68:71], a[184:187], v[12:15]
    ds_read_b128 a[84:87], v213 offset:36864
    v_cvt_pk_bf16_f32 v51, v18, v19
    v_mfma_f32_16x16x32_bf16 v[12:15], a[72:75], a[188:191], v[12:15]
    v_exp_f32 v5, v5
    v_mfma_f32_16x16x32_bf16 v[12:15], a[76:79], a[192:195], v[12:15]
    ds_read_b64_tr_b16 a[116:117], v221 offset:20480
    v_mfma_f32_16x16x32_bf16 v[16:19], a[72:75], a[204:207], -4.0
    v_exp_f32 v6, v6
    v_mfma_f32_16x16x32_bf16 v[16:19], a[76:79], a[208:211], v[16:19]
    ds_read_b64_tr_b16 a[118:119], v221 offset:22528
    v_cvt_pk_bf16_f32 v52, v4, v5
    v_mfma_f32_16x16x32_bf16 v[16:19], a[64:67], a[196:199], v[16:19]
    v_exp_f32 v7, v7
    v_mfma_f32_16x16x32_bf16 v[16:19], a[68:71], a[200:203], v[16:19]
    global_load_lds_dwordx4 v227, s[72:73] offset:3072 nt
    v_mfma_f32_16x16x32_bf16 v[180:183], v[84:87], a[96:99], v[180:183]
    v_exp_f32 v8, v8
    v_mfma_f32_16x16x32_bf16 v[180:183], v[88:91], a[100:103], v[180:183]
    ds_read_b128 a[88:91], v214 offset:36864
    v_cvt_pk_bf16_f32 v53, v6, v7
    v_mfma_f32_16x16x32_bf16 v[180:183], v[116:119], a[104:107], v[180:183]
    v_exp_f32 v9, v9
    v_mfma_f32_16x16x32_bf16 v[180:183], v[120:123], a[108:111], v[180:183]
    ds_read_b64_tr_b16 a[120:121], v221 offset:24576
    v_mfma_f32_16x16x32_bf16 v[184:187], v[124:127], a[104:107], v[184:187]
    s_add_u32 m0, s31, 0x4000
    v_exp_f32 v10, v10
    v_mfma_f32_16x16x32_bf16 v[184:187], v[128:131], a[108:111], v[184:187]
    ds_read_b64_tr_b16 a[122:123], v221 offset:26624
    v_cvt_pk_bf16_f32 v60, v8, v9
    v_mfma_f32_16x16x32_bf16 v[184:187], v[92:95], a[96:99], v[184:187]
    v_exp_f32 v11, v11
    v_mfma_f32_16x16x32_bf16 v[184:187], v[96:99], a[100:103], v[184:187]
    global_load_lds_dwordx4 v228, s[74:75] nt
    v_mfma_f32_16x16x32_bf16 a[32:35], v[100:103], a[96:99], a[32:35]
    ds_read_b128 a[92:95], v215 offset:36864
    v_cvt_pk_bf16_f32 v61, v10, v11
    v_mfma_f32_16x16x32_bf16 a[32:35], v[104:107], a[100:103], a[32:35]
    ds_read_b64_tr_b16 a[124:125], v221 offset:28672
    v_mfma_f32_16x16x32_bf16 a[32:35], v[132:135], a[104:107], a[32:35]
    ds_read_b64_tr_b16 a[126:127], v221 offset:30720
    v_mfma_f32_16x16x32_bf16 a[32:35], v[136:139], a[108:111], a[32:35]
    global_load_lds_dwordx4 v229, s[74:75] offset:1024 nt
    v_mfma_f32_16x16x32_bf16 a[36:39], v[140:143], a[104:107], a[36:39]
    s_add_u32 s32, s67, 0x40000
    v_exp_f32 v12, v12
    v_mfma_f32_16x16x32_bf16 a[36:39], v[144:147], a[108:111], a[36:39]
    s_and_b32 s32, s32, 0x7ffff
    v_exp_f32 v13, v13
    v_mfma_f32_16x16x32_bf16 a[36:39], v[108:111], a[96:99], a[36:39]
    v_exp_f32 v14, v14
    v_mfma_f32_16x16x32_bf16 a[36:39], v[112:115], a[100:103], a[36:39]
    s_waitcnt vmcnt(14) lgkmcnt(0)
    v_exp_f32 v15, v15
    v_smfmac_f32_16x16x64_bf16 a[128:131], a[144:147], v[20:27], v236
    s_barrier
    v_mfma_f32_16x16x32_bf16 v[4:7], a[80:83], a[148:151], -4.0
    s_add_u32 s72, s14, s32
    v_exp_f32 v16, v16
    v_mfma_f32_16x16x32_bf16 v[4:7], a[84:87], a[152:155], v[4:7]
    ds_read_b128 a[64:67], v212 offset:49152
    v_cvt_pk_bf16_f32 v69, v14, v15
    v_mfma_f32_16x16x32_bf16 v[4:7], a[88:91], a[156:159], v[4:7]
    s_addc_u32 s73, s15, 0
    v_exp_f32 v17, v17
    v_mfma_f32_16x16x32_bf16 v[4:7], a[92:95], a[160:163], v[4:7]
    ds_read_b64_tr_b16 a[96:97], v222 offset:16384
    v_cvt_pk_bf16_f32 v68, v12, v13
    v_mfma_f32_16x16x32_bf16 v[8:11], a[88:91], a[172:175], -4.0
    v_exp_f32 v18, v18
    v_mfma_f32_16x16x32_bf16 v[8:11], a[92:95], a[176:179], v[8:11]
    ds_read_b64_tr_b16 a[98:99], v222 offset:18432
    v_cvt_pk_bf16_f32 v76, v16, v17
    v_mfma_f32_16x16x32_bf16 v[8:11], a[80:83], a[164:167], v[8:11]
    v_exp_f32 v19, v19
    v_mfma_f32_16x16x32_bf16 v[8:11], a[84:87], a[168:171], v[8:11]
    global_load_lds_dwordx4 v228, s[74:75] offset:2048 nt
    v_mfma_f32_16x16x32_bf16 v[12:15], a[80:83], a[180:183], -4.0
    v_exp_f32 v4, v4
    v_mfma_f32_16x16x32_bf16 v[12:15], a[84:87], a[184:187], v[12:15]
    ds_read_b128 a[68:71], v213 offset:49152
    v_cvt_pk_bf16_f32 v77, v18, v19
    v_mfma_f32_16x16x32_bf16 v[12:15], a[88:91], a[188:191], v[12:15]
    v_exp_f32 v5, v5
    v_mfma_f32_16x16x32_bf16 v[12:15], a[92:95], a[192:195], v[12:15]
    ds_read_b64_tr_b16 a[100:101], v222 offset:20480
    v_mfma_f32_16x16x32_bf16 v[16:19], a[88:91], a[204:207], -4.0
    v_exp_f32 v6, v6
    v_mfma_f32_16x16x32_bf16 v[16:19], a[92:95], a[208:211], v[16:19]
    ds_read_b64_tr_b16 a[102:103], v222 offset:22528
    v_cvt_pk_bf16_f32 v54, v4, v5
    v_mfma_f32_16x16x32_bf16 v[16:19], a[80:83], a[196:199], v[16:19]
    v_exp_f32 v7, v7
    v_mfma_f32_16x16x32_bf16 v[16:19], a[84:87], a[200:203], v[16:19]
    global_load_lds_dwordx4 v229, s[74:75] offset:3072 nt
    v_mfma_f32_16x16x32_bf16 v[188:191], v[84:87], a[112:115], v[188:191]
    v_exp_f32 v8, v8
    v_mfma_f32_16x16x32_bf16 v[188:191], v[88:91], a[116:119], v[188:191]
    ds_read_b128 a[72:75], v214 offset:49152
    v_cvt_pk_bf16_f32 v55, v6, v7
    v_mfma_f32_16x16x32_bf16 v[188:191], v[116:119], a[120:123], v[188:191]
    v_exp_f32 v9, v9
    v_mfma_f32_16x16x32_bf16 v[188:191], v[120:123], a[124:127], v[188:191]
    ds_read_b64_tr_b16 a[104:105], v222 offset:24576
    v_mfma_f32_16x16x32_bf16 v[192:195], v[124:127], a[120:123], v[192:195]
    s_add_u32 m0, s33, 0x0
    v_exp_f32 v10, v10
    v_mfma_f32_16x16x32_bf16 v[192:195], v[128:131], a[124:127], v[192:195]
    ds_read_b64_tr_b16 a[106:107], v222 offset:26624
    v_cvt_pk_bf16_f32 v62, v8, v9
    v_mfma_f32_16x16x32_bf16 v[192:195], v[92:95], a[112:115], v[192:195]
    v_exp_f32 v11, v11
    v_mfma_f32_16x16x32_bf16 v[192:195], v[96:99], a[116:119], v[192:195]
    global_load_lds_dwordx4 v224, s[72:73] nt
    v_mfma_f32_16x16x32_bf16 a[40:43], v[100:103], a[112:115], a[40:43]
    s_add_u32 s32, s64, 0x58000
    v_exp_f32 v12, v12
    v_mfma_f32_16x16x32_bf16 a[40:43], v[104:107], a[116:119], a[40:43]
    ds_read_b128 a[76:79], v215 offset:49152
    v_cvt_pk_bf16_f32 v63, v10, v11
    v_mfma_f32_16x16x32_bf16 a[40:43], v[132:135], a[120:123], a[40:43]
    s_and_b32 s32, s32, 0x7ffff
    v_exp_f32 v13, v13
    v_mfma_f32_16x16x32_bf16 a[40:43], v[136:139], a[124:127], a[40:43]
    ds_read_b64_tr_b16 a[108:109], v222 offset:28672
    v_mfma_f32_16x16x32_bf16 a[44:47], v[140:143], a[120:123], a[44:47]
    v_exp_f32 v14, v14
    v_mfma_f32_16x16x32_bf16 a[44:47], v[144:147], a[124:127], a[44:47]
    ds_read_b64_tr_b16 a[110:111], v222 offset:30720
    v_cvt_pk_bf16_f32 v70, v12, v13
    v_mfma_f32_16x16x32_bf16 a[44:47], v[108:111], a[112:115], a[44:47]
    s_waitcnt lgkmcnt(2)
    v_exp_f32 v15, v15
    v_mfma_f32_16x16x32_bf16 a[44:47], v[112:115], a[116:119], a[44:47]
    global_load_lds_dwordx4 v225, s[72:73] offset:1024 nt
    v_smfmac_f32_16x16x64_bf16 a[132:135], a[144:147], v[28:35], v236
    v_mfma_f32_16x16x32_bf16 v[4:7], a[64:67], a[148:151], -4.0
    s_add_u32 s74, s12, s32
    v_exp_f32 v16, v16
    v_mfma_f32_16x16x32_bf16 v[4:7], a[68:71], a[152:155], v[4:7]
    ds_read_b128 a[80:83], v212 offset:53248
    v_cvt_pk_bf16_f32 v71, v14, v15
    v_mfma_f32_16x16x32_bf16 v[4:7], a[72:75], a[156:159], v[4:7]
    s_addc_u32 s75, s13, 0
    v_exp_f32 v17, v17
    v_mfma_f32_16x16x32_bf16 v[4:7], a[76:79], a[160:163], v[4:7]
    ds_read_b64_tr_b16 a[112:113], v223 offset:16384
    v_mfma_f32_16x16x32_bf16 v[8:11], a[72:75], a[172:175], -4.0
    v_exp_f32 v18, v18
    v_mfma_f32_16x16x32_bf16 v[8:11], a[76:79], a[176:179], v[8:11]
    ds_read_b64_tr_b16 a[114:115], v223 offset:18432
    v_cvt_pk_bf16_f32 v78, v16, v17
    v_mfma_f32_16x16x32_bf16 v[8:11], a[64:67], a[164:167], v[8:11]
    s_waitcnt lgkmcnt(3)
    v_exp_f32 v19, v19
    v_mfma_f32_16x16x32_bf16 v[8:11], a[68:71], a[168:171], v[8:11]
    global_load_lds_dwordx4 v226, s[72:73] offset:2048 nt
    v_mfma_f32_16x16x32_bf16 v[12:15], a[64:67], a[180:183], -4.0
L_stub5:
    s_cbranch_execz L_stub9
    v_exp_f32 v4, v4
    v_mfma_f32_16x16x32_bf16 v[12:15], a[68:71], a[184:187], v[12:15]
    ds_read_b128 a[84:87], v213 offset:53248
    v_cvt_pk_bf16_f32 v79, v18, v19
    v_mfma_f32_16x16x32_bf16 v[12:15], a[72:75], a[188:191], v[12:15]
    v_exp_f32 v5, v5
    v_mfma_f32_16x16x32_bf16 v[12:15], a[76:79], a[192:195], v[12:15]
    ds_read_b64_tr_b16 a[116:117], v223 offset:20480
    v_mfma_f32_16x16x32_bf16 v[16:19], a[72:75], a[204:207], -4.0
    v_exp_f32 v6, v6
    v_mfma_f32_16x16x32_bf16 v[16:19], a[76:79], a[208:211], v[16:19]
    ds_read_b64_tr_b16 a[118:119], v223 offset:22528
    v_cvt_pk_bf16_f32 v56, v4, v5
    v_mfma_f32_16x16x32_bf16 v[16:19], a[64:67], a[196:199], v[16:19]
    v_exp_f32 v7, v7
    v_mfma_f32_16x16x32_bf16 v[16:19], a[68:71], a[200:203], v[16:19]
    global_load_lds_dwordx4 v227, s[72:73] offset:3072 nt
    v_mfma_f32_16x16x32_bf16 v[196:199], v[84:87], a[96:99], v[196:199]
    v_exp_f32 v8, v8
    v_mfma_f32_16x16x32_bf16 v[196:199], v[88:91], a[100:103], v[196:199]
    ds_read_b128 a[88:91], v214 offset:53248
    v_cvt_pk_bf16_f32 v57, v6, v7
    v_mfma_f32_16x16x32_bf16 v[196:199], v[116:119], a[104:107], v[196:199]
    v_exp_f32 v9, v9
    v_mfma_f32_16x16x32_bf16 v[196:199], v[120:123], a[108:111], v[196:199]
    ds_read_b64_tr_b16 a[120:121], v223 offset:24576
    v_mfma_f32_16x16x32_bf16 v[200:203], v[124:127], a[104:107], v[200:203]
    s_add_u32 m0, s31, 0x8000
    v_exp_f32 v10, v10
    v_mfma_f32_16x16x32_bf16 v[200:203], v[128:131], a[108:111], v[200:203]
    ds_read_b64_tr_b16 a[122:123], v223 offset:26624
    v_cvt_pk_bf16_f32 v64, v8, v9
    v_mfma_f32_16x16x32_bf16 v[200:203], v[92:95], a[96:99], v[200:203]
    v_exp_f32 v11, v11
    v_mfma_f32_16x16x32_bf16 v[200:203], v[96:99], a[100:103], v[200:203]
    global_load_lds_dwordx4 v228, s[74:75] nt
    v_mfma_f32_16x16x32_bf16 a[48:51], v[100:103], a[96:99], a[48:51]
    ds_read_b128 a[92:95], v215 offset:53248
    v_cvt_pk_bf16_f32 v65, v10, v11
    v_mfma_f32_16x16x32_bf16 a[48:51], v[104:107], a[100:103], a[48:51]
    ds_read_b64_tr_b16 a[124:125], v223 offset:28672
    v_mfma_f32_16x16x32_bf16 a[48:51], v[132:135], a[104:107], a[48:51]
    ds_read_b64_tr_b16 a[126:127], v223 offset:30720
    v_mfma_f32_16x16x32_bf16 a[48:51], v[136:139], a[108:111], a[48:51]
    global_load_lds_dwordx4 v229, s[74:75] offset:1024 nt
    v_mfma_f32_16x16x32_bf16 a[52:55], v[140:143], a[104:107], a[52:55]
    s_add_u32 s32, s67, 0x48000
    v_exp_f32 v12, v12
    v_mfma_f32_16x16x32_bf16 a[52:55], v[144:147], a[108:111], a[52:55]
    s_and_b32 s32, s32, 0x7ffff
    v_exp_f32 v13, v13
    v_mfma_f32_16x16x32_bf16 a[52:55], v[108:111], a[96:99], a[52:55]
    v_exp_f32 v14, v14
    v_mfma_f32_16x16x32_bf16 a[52:55], v[112:115], a[100:103], a[52:55]
    s_waitcnt vmcnt(10) lgkmcnt(0)
    v_exp_f32 v15, v15
    v_smfmac_f32_16x16x64_bf16 a[136:139], a[144:147], v[36:43], v236
    s_barrier
    v_mfma_f32_16x16x32_bf16 v[4:7], a[80:83], a[148:151], -4.0
    s_add_u32 s72, s14, s32
    v_exp_f32 v16, v16
    v_mfma_f32_16x16x32_bf16 v[4:7], a[84:87], a[152:155], v[4:7]
    ds_read_b128 a[64:67], v212
    v_cvt_pk_bf16_f32 v73, v14, v15
    v_mfma_f32_16x16x32_bf16 v[4:7], a[88:91], a[156:159], v[4:7]
    s_addc_u32 s73, s15, 0
    v_exp_f32 v17, v17
    v_mfma_f32_16x16x32_bf16 v[4:7], a[92:95], a[160:163], v[4:7]
    ds_read_b64_tr_b16 a[96:97], v220 offset:32768
    v_cvt_pk_bf16_f32 v72, v12, v13
    v_mfma_f32_16x16x32_bf16 v[8:11], a[88:91], a[172:175], -4.0
    v_exp_f32 v18, v18
    v_mfma_f32_16x16x32_bf16 v[8:11], a[92:95], a[176:179], v[8:11]
    ds_read_b64_tr_b16 a[98:99], v220 offset:34816
    v_cvt_pk_bf16_f32 v80, v16, v17
    v_mfma_f32_16x16x32_bf16 v[8:11], a[80:83], a[164:167], v[8:11]
    v_exp_f32 v19, v19
    v_mfma_f32_16x16x32_bf16 v[8:11], a[84:87], a[168:171], v[8:11]
    global_load_lds_dwordx4 v228, s[74:75] offset:2048 nt
    v_mfma_f32_16x16x32_bf16 v[12:15], a[80:83], a[180:183], -4.0
    v_exp_f32 v4, v4
    v_mfma_f32_16x16x32_bf16 v[12:15], a[84:87], a[184:187], v[12:15]
    ds_read_b128 a[68:71], v213
    v_cvt_pk_bf16_f32 v81, v18, v19
    v_mfma_f32_16x16x32_bf16 v[12:15], a[88:91], a[188:191], v[12:15]
    v_exp_f32 v5, v5
    v_mfma_f32_16x16x32_bf16 v[12:15], a[92:95], a[192:195], v[12:15]
    ds_read_b64_tr_b16 a[100:101], v220 offset:36864
    v_mfma_f32_16x16x32_bf16 v[16:19], a[88:91], a[204:207], -4.0
    v_exp_f32 v6, v6
    v_mfma_f32_16x16x32_bf16 v[16:19], a[92:95], a[208:211], v[16:19]
    ds_read_b64_tr_b16 a[102:103], v220 offset:38912
    v_cvt_pk_bf16_f32 v58, v4, v5
    v_mfma_f32_16x16x32_bf16 v[16:19], a[80:83], a[196:199], v[16:19]
    v_exp_f32 v7, v7
    v_mfma_f32_16x16x32_bf16 v[16:19], a[84:87], a[200:203], v[16:19]
    global_load_lds_dwordx4 v229, s[74:75] offset:3072 nt
    v_mfma_f32_16x16x32_bf16 v[204:207], v[84:87], a[112:115], v[204:207]
    v_exp_f32 v8, v8
    v_mfma_f32_16x16x32_bf16 v[204:207], v[88:91], a[116:119], v[204:207]
    ds_read_b128 a[72:75], v214
    v_cvt_pk_bf16_f32 v59, v6, v7
    v_mfma_f32_16x16x32_bf16 v[204:207], v[116:119], a[120:123], v[204:207]
    v_exp_f32 v9, v9
    v_mfma_f32_16x16x32_bf16 v[204:207], v[120:123], a[124:127], v[204:207]
    ds_read_b64_tr_b16 a[104:105], v220 offset:40960
    v_mfma_f32_16x16x32_bf16 v[208:211], v[124:127], a[120:123], v[208:211]
    s_add_u32 m0, s33, 0x2000
    v_exp_f32 v10, v10
    v_mfma_f32_16x16x32_bf16 v[208:211], v[128:131], a[124:127], v[208:211]
    ds_read_b64_tr_b16 a[106:107], v220 offset:43008
    v_cvt_pk_bf16_f32 v66, v8, v9
    v_mfma_f32_16x16x32_bf16 v[208:211], v[92:95], a[112:115], v[208:211]
    v_exp_f32 v11, v11
    v_mfma_f32_16x16x32_bf16 v[208:211], v[96:99], a[116:119], v[208:211]
    global_load_lds_dwordx4 v224, s[72:73] nt
    v_mfma_f32_16x16x32_bf16 a[56:59], v[100:103], a[112:115], a[56:59]
    s_add_u32 s32, s65, 0x58000
    v_exp_f32 v12, v12
    v_mfma_f32_16x16x32_bf16 a[56:59], v[104:107], a[116:119], a[56:59]
    ds_read_b128 a[76:79], v215
    v_cvt_pk_bf16_f32 v67, v10, v11
    v_mfma_f32_16x16x32_bf16 a[56:59], v[132:135], a[120:123], a[56:59]
    s_and_b32 s32, s32, 0x7ffff
    v_exp_f32 v13, v13
    v_mfma_f32_16x16x32_bf16 a[56:59], v[136:139], a[124:127], a[56:59]
    ds_read_b64_tr_b16 a[108:109], v220 offset:45056
    v_mfma_f32_16x16x32_bf16 a[60:63], v[140:143], a[120:123], a[60:63]
    v_exp_f32 v14, v14
    v_mfma_f32_16x16x32_bf16 a[60:63], v[144:147], a[124:127], a[60:63]
    ds_read_b64_tr_b16 a[110:111], v220 offset:47104
    v_cvt_pk_bf16_f32 v74, v12, v13
    v_mfma_f32_16x16x32_bf16 a[60:63], v[108:111], a[112:115], a[60:63]
    s_waitcnt lgkmcnt(2)
    v_exp_f32 v15, v15
    v_mfma_f32_16x16x32_bf16 a[60:63], v[112:115], a[116:119], a[60:63]
    global_load_lds_dwordx4 v225, s[72:73] offset:1024 nt
    v_smfmac_f32_16x16x64_bf16 a[140:143], a[144:147], v[44:51], v236
    v_mfma_f32_16x16x32_bf16 v[4:7], a[64:67], a[148:151], -4.0
    s_add_u32 s74, s12, s32
    v_exp_f32 v16, v16
    v_mfma_f32_16x16x32_bf16 v[4:7], a[68:71], a[152:155], v[4:7]
    ds_read_b128 a[80:83], v212 offset:4096
    v_cvt_pk_bf16_f32 v75, v14, v15
    v_mfma_f32_16x16x32_bf16 v[4:7], a[72:75], a[156:159], v[4:7]
    s_addc_u32 s75, s13, 0
    v_exp_f32 v17, v17
    v_mfma_f32_16x16x32_bf16 v[4:7], a[76:79], a[160:163], v[4:7]
    ds_read_b64_tr_b16 a[112:113], v221 offset:32768
    v_mfma_f32_16x16x32_bf16 v[8:11], a[72:75], a[172:175], -4.0
    v_exp_f32 v18, v18
    v_mfma_f32_16x16x32_bf16 v[8:11], a[76:79], a[176:179], v[8:11]
    ds_read_b64_tr_b16 a[114:115], v221 offset:34816
    v_cvt_pk_bf16_f32 v82, v16, v17
    v_mfma_f32_16x16x32_bf16 v[8:11], a[64:67], a[164:167], v[8:11]
    s_waitcnt lgkmcnt(3)
    v_exp_f32 v19, v19
    v_mfma_f32_16x16x32_bf16 v[8:11], a[68:71], a[168:171], v[8:11]
    global_load_lds_dwordx4 v226, s[72:73] offset:2048 nt
    v_mfma_f32_16x16x32_bf16 v[12:15], a[64:67], a[180:183], -4.0
    v_exp_f32 v4, v4
    v_mfma_f32_16x16x32_bf16 v[12:15], a[68:71], a[184:187], v[12:15]
    ds_read_b128 a[84:87], v213 offset:4096
    v_cvt_pk_bf16_f32 v83, v18, v19
    v_mfma_f32_16x16x32_bf16 v[12:15], a[72:75], a[188:191], v[12:15]
    v_exp_f32 v5, v5
    v_mfma_f32_16x16x32_bf16 v[12:15], a[76:79], a[192:195], v[12:15]
    ds_read_b64_tr_b16 a[116:117], v221 offset:36864
    v_mfma_f32_16x16x32_bf16 v[16:19], a[72:75], a[204:207], -4.0
    v_exp_f32 v6, v6
    v_mfma_f32_16x16x32_bf16 v[16:19], a[76:79], a[208:211], v[16:19]
    ds_read_b64_tr_b16 a[118:119], v221 offset:38912
    v_cvt_pk_bf16_f32 v84, v4, v5
    v_mfma_f32_16x16x32_bf16 v[16:19], a[64:67], a[196:199], v[16:19]
    v_exp_f32 v7, v7
    v_mfma_f32_16x16x32_bf16 v[16:19], a[68:71], a[200:203], v[16:19]
    global_load_lds_dwordx4 v227, s[72:73] offset:3072 nt
    v_mfma_f32_16x16x32_bf16 v[148:151], v[20:23], a[96:99], v[148:151]
    v_exp_f32 v8, v8
    v_mfma_f32_16x16x32_bf16 v[148:151], v[24:27], a[100:103], v[148:151]
    ds_read_b128 a[88:91], v214 offset:4096
    v_cvt_pk_bf16_f32 v85, v6, v7
    v_mfma_f32_16x16x32_bf16 v[148:151], v[52:55], a[104:107], v[148:151]
    v_exp_f32 v9, v9
    v_mfma_f32_16x16x32_bf16 v[148:151], v[56:59], a[108:111], v[148:151]
    ds_read_b64_tr_b16 a[120:121], v221 offset:40960
    v_mfma_f32_16x16x32_bf16 v[152:155], v[60:63], a[104:107], v[152:155]
    s_add_u32 m0, s31, 0xc000
    v_exp_f32 v10, v10
    v_mfma_f32_16x16x32_bf16 v[152:155], v[64:67], a[108:111], v[152:155]
    ds_read_b64_tr_b16 a[122:123], v221 offset:43008
    v_cvt_pk_bf16_f32 v92, v8, v9
    v_mfma_f32_16x16x32_bf16 v[152:155], v[28:31], a[96:99], v[152:155]
    v_exp_f32 v11, v11
    v_mfma_f32_16x16x32_bf16 v[152:155], v[32:35], a[100:103], v[152:155]
    global_load_lds_dwordx4 v228, s[74:75] nt
    v_mfma_f32_16x16x32_bf16 a[0:3], v[36:39], a[96:99], a[0:3]
    ds_read_b128 a[92:95], v215 offset:4096
    v_cvt_pk_bf16_f32 v93, v10, v11
    v_mfma_f32_16x16x32_bf16 a[0:3], v[40:43], a[100:103], a[0:3]
    ds_read_b64_tr_b16 a[124:125], v221 offset:45056
    v_mfma_f32_16x16x32_bf16 a[0:3], v[68:71], a[104:107], a[0:3]
    ds_read_b64_tr_b16 a[126:127], v221 offset:47104
    v_mfma_f32_16x16x32_bf16 a[0:3], v[72:75], a[108:111], a[0:3]
    global_load_lds_dwordx4 v229, s[74:75] offset:1024 nt
    v_mfma_f32_16x16x32_bf16 a[4:7], v[76:79], a[104:107], a[4:7]
    s_add_u32 s32, s66, 0x50000
    v_exp_f32 v12, v12
    v_mfma_f32_16x16x32_bf16 a[4:7], v[80:83], a[108:111], a[4:7]
    s_and_b32 s32, s32, 0x7ffff
    v_exp_f32 v13, v13
    v_mfma_f32_16x16x32_bf16 a[4:7], v[44:47], a[96:99], a[4:7]
    v_exp_f32 v14, v14
    v_mfma_f32_16x16x32_bf16 a[4:7], v[48:51], a[100:103], a[4:7]
    s_waitcnt vmcnt(14) lgkmcnt(0)
    v_exp_f32 v15, v15
    v_smfmac_f32_16x16x64_bf16 a[128:131], a[144:147], v[52:59], v236
    s_barrier
    v_mfma_f32_16x16x32_bf16 v[4:7], a[80:83], a[148:151], -4.0
    s_add_u32 s72, s14, s32
    v_exp_f32 v16, v16
    v_mfma_f32_16x16x32_bf16 v[4:7], a[84:87], a[152:155], v[4:7]
    ds_read_b128 a[64:67], v212 offset:16384
    v_cvt_pk_bf16_f32 v101, v14, v15
    v_mfma_f32_16x16x32_bf16 v[4:7], a[88:91], a[156:159], v[4:7]
    s_addc_u32 s73, s15, 0
    v_exp_f32 v17, v17
    v_mfma_f32_16x16x32_bf16 v[4:7], a[92:95], a[160:163], v[4:7]
    ds_read_b64_tr_b16 a[96:97], v222 offset:32768
    v_cvt_pk_bf16_f32 v100, v12, v13
    v_mfma_f32_16x16x32_bf16 v[8:11], a[88:91], a[172:175], -4.0
    v_exp_f32 v18, v18
    v_mfma_f32_16x16x32_bf16 v[8:11], a[92:95], a[176:179], v[8:11]
    ds_read_b64_tr_b16 a[98:99], v222 offset:34816
    v_cvt_pk_bf16_f32 v108, v16, v17
    v_mfma_f32_16x16x32_bf16 v[8:11], a[80:83], a[164:167], v[8:11]
    v_exp_f32 v19, v19
    v_mfma_f32_16x16x32_bf16 v[8:11], a[84:87], a[168:171], v[8:11]
    global_load_lds_dwordx4 v228, s[74:75] offset:2048 nt
    v_mfma_f32_16x16x32_bf16 v[12:15], a[80:83], a[180:183], -4.0
    v_exp_f32 v4, v4
    v_mfma_f32_16x16x32_bf16 v[12:15], a[84:87], a[184:187], v[12:15]
    ds_read_b128 a[68:71], v213 offset:16384
    v_cvt_pk_bf16_f32 v109, v18, v19
    v_mfma_f32_16x16x32_bf16 v[12:15], a[88:91], a[188:191], v[12:15]
    v_exp_f32 v5, v5
    v_mfma_f32_16x16x32_bf16 v[12:15], a[92:95], a[192:195], v[12:15]
    ds_read_b64_tr_b16 a[100:101], v222 offset:36864
    v_mfma_f32_16x16x32_bf16 v[16:19], a[88:91], a[204:207], -4.0
    v_exp_f32 v6, v6
    v_mfma_f32_16x16x32_bf16 v[16:19], a[92:95], a[208:211], v[16:19]
    ds_read_b64_tr_b16 a[102:103], v222 offset:38912
    v_cvt_pk_bf16_f32 v86, v4, v5
    v_mfma_f32_16x16x32_bf16 v[16:19], a[80:83], a[196:199], v[16:19]
    v_exp_f32 v7, v7
    v_mfma_f32_16x16x32_bf16 v[16:19], a[84:87], a[200:203], v[16:19]
    global_load_lds_dwordx4 v229, s[74:75] offset:3072 nt
    v_mfma_f32_16x16x32_bf16 v[156:159], v[20:23], a[112:115], v[156:159]
    v_exp_f32 v8, v8
    v_mfma_f32_16x16x32_bf16 v[156:159], v[24:27], a[116:119], v[156:159]
    ds_read_b128 a[72:75], v214 offset:16384
    v_cvt_pk_bf16_f32 v87, v6, v7
    v_mfma_f32_16x16x32_bf16 v[156:159], v[52:55], a[120:123], v[156:159]
    v_exp_f32 v9, v9
    v_mfma_f32_16x16x32_bf16 v[156:159], v[56:59], a[124:127], v[156:159]
    ds_read_b64_tr_b16 a[104:105], v222 offset:40960
    v_mfma_f32_16x16x32_bf16 v[160:163], v[60:63], a[120:123], v[160:163]
    s_add_u32 m0, s33, 0x4000
    v_exp_f32 v10, v10
    v_mfma_f32_16x16x32_bf16 v[160:163], v[64:67], a[124:127], v[160:163]
    ds_read_b64_tr_b16 a[106:107], v222 offset:43008
    v_cvt_pk_bf16_f32 v94, v8, v9
    v_mfma_f32_16x16x32_bf16 v[160:163], v[28:31], a[112:115], v[160:163]
    v_exp_f32 v11, v11
    v_mfma_f32_16x16x32_bf16 v[160:163], v[32:35], a[116:119], v[160:163]
    global_load_lds_dwordx4 v224, s[72:73] nt
    v_mfma_f32_16x16x32_bf16 a[8:11], v[36:39], a[112:115], a[8:11]
    s_add_u32 s32, s64, 0x60000
    v_exp_f32 v12, v12
    v_mfma_f32_16x16x32_bf16 a[8:11], v[40:43], a[116:119], a[8:11]
    ds_read_b128 a[76:79], v215 offset:16384
    v_cvt_pk_bf16_f32 v95, v10, v11
    v_mfma_f32_16x16x32_bf16 a[8:11], v[68:71], a[120:123], a[8:11]
    s_and_b32 s32, s32, 0x7ffff
    v_exp_f32 v13, v13
    v_mfma_f32_16x16x32_bf16 a[8:11], v[72:75], a[124:127], a[8:11]
    ds_read_b64_tr_b16 a[108:109], v222 offset:45056
    v_mfma_f32_16x16x32_bf16 a[12:15], v[76:79], a[120:123], a[12:15]
    v_exp_f32 v14, v14
    v_mfma_f32_16x16x32_bf16 a[12:15], v[80:83], a[124:127], a[12:15]
    ds_read_b64_tr_b16 a[110:111], v222 offset:47104
    v_cvt_pk_bf16_f32 v102, v12, v13
    v_mfma_f32_16x16x32_bf16 a[12:15], v[44:47], a[112:115], a[12:15]
    s_waitcnt lgkmcnt(2)
    v_exp_f32 v15, v15
    v_mfma_f32_16x16x32_bf16 a[12:15], v[48:51], a[116:119], a[12:15]
    global_load_lds_dwordx4 v225, s[72:73] offset:1024 nt
    v_smfmac_f32_16x16x64_bf16 a[132:135], a[144:147], v[60:67], v236
    v_mfma_f32_16x16x32_bf16 v[4:7], a[64:67], a[148:151], -4.0
    s_add_u32 s74, s12, s32
    v_exp_f32 v16, v16
    v_mfma_f32_16x16x32_bf16 v[4:7], a[68:71], a[152:155], v[4:7]
    ds_read_b128 a[80:83], v212 offset:20480
    v_cvt_pk_bf16_f32 v103, v14, v15
    v_mfma_f32_16x16x32_bf16 v[4:7], a[72:75], a[156:159], v[4:7]
    s_addc_u32 s75, s13, 0
    v_exp_f32 v17, v17
    v_mfma_f32_16x16x32_bf16 v[4:7], a[76:79], a[160:163], v[4:7]
    ds_read_b64_tr_b16 a[112:113], v223 offset:32768
    v_mfma_f32_16x16x32_bf16 v[8:11], a[72:75], a[172:175], -4.0
    v_exp_f32 v18, v18
    v_mfma_f32_16x16x32_bf16 v[8:11], a[76:79], a[176:179], v[8:11]
    ds_read_b64_tr_b16 a[114:115], v223 offset:34816
    v_cvt_pk_bf16_f32 v110, v16, v17
    v_mfma_f32_16x16x32_bf16 v[8:11], a[64:67], a[164:167], v[8:11]
    s_waitcnt lgkmcnt(3)
    v_exp_f32 v19, v19
    v_mfma_f32_16x16x32_bf16 v[8:11], a[68:71], a[168:171], v[8:11]
    global_load_lds_dwordx4 v226, s[72:73] offset:2048 nt
    v_mfma_f32_16x16x32_bf16 v[12:15], a[64:67], a[180:183], -4.0
    v_exp_f32 v4, v4
    v_mfma_f32_16x16x32_bf16 v[12:15], a[68:71], a[184:187], v[12:15]
    ds_read_b128 a[84:87], v213 offset:20480
    v_cvt_pk_bf16_f32 v111, v18, v19
    v_mfma_f32_16x16x32_bf16 v[12:15], a[72:75], a[188:191], v[12:15]
    v_exp_f32 v5, v5
    v_mfma_f32_16x16x32_bf16 v[12:15], a[76:79], a[192:195], v[12:15]
    ds_read_b64_tr_b16 a[116:117], v223 offset:36864
    v_mfma_f32_16x16x32_bf16 v[16:19], a[72:75], a[204:207], -4.0
    v_exp_f32 v6, v6
    v_mfma_f32_16x16x32_bf16 v[16:19], a[76:79], a[208:211], v[16:19]
    ds_read_b64_tr_b16 a[118:119], v223 offset:38912
    v_cvt_pk_bf16_f32 v88, v4, v5
    v_mfma_f32_16x16x32_bf16 v[16:19], a[64:67], a[196:199], v[16:19]
    v_exp_f32 v7, v7
    v_mfma_f32_16x16x32_bf16 v[16:19], a[68:71], a[200:203], v[16:19]
    global_load_lds_dwordx4 v227, s[72:73] offset:3072 nt
    v_mfma_f32_16x16x32_bf16 v[164:167], v[20:23], a[96:99], v[164:167]
    v_exp_f32 v8, v8
    v_mfma_f32_16x16x32_bf16 v[164:167], v[24:27], a[100:103], v[164:167]
    ds_read_b128 a[88:91], v214 offset:20480
    v_cvt_pk_bf16_f32 v89, v6, v7
    v_mfma_f32_16x16x32_bf16 v[164:167], v[52:55], a[104:107], v[164:167]
    v_exp_f32 v9, v9
    v_mfma_f32_16x16x32_bf16 v[164:167], v[56:59], a[108:111], v[164:167]
    ds_read_b64_tr_b16 a[120:121], v223 offset:40960
    v_mfma_f32_16x16x32_bf16 v[168:171], v[60:63], a[104:107], v[168:171]
    s_add_u32 m0, s31, 0x0
    v_exp_f32 v10, v10
    v_mfma_f32_16x16x32_bf16 v[168:171], v[64:67], a[108:111], v[168:171]
    ds_read_b64_tr_b16 a[122:123], v223 offset:43008
    v_cvt_pk_bf16_f32 v96, v8, v9
    v_mfma_f32_16x16x32_bf16 v[168:171], v[28:31], a[96:99], v[168:171]
    v_exp_f32 v11, v11
    v_mfma_f32_16x16x32_bf16 v[168:171], v[32:35], a[100:103], v[168:171]
    global_load_lds_dwordx4 v228, s[74:75] nt
    v_mfma_f32_16x16x32_bf16 a[16:19], v[36:39], a[96:99], a[16:19]
    ds_read_b128 a[92:95], v215 offset:20480
    v_cvt_pk_bf16_f32 v97, v10, v11
    v_mfma_f32_16x16x32_bf16 a[16:19], v[40:43], a[100:103], a[16:19]
    ds_read_b64_tr_b16 a[124:125], v223 offset:45056
    v_mfma_f32_16x16x32_bf16 a[16:19], v[68:71], a[104:107], a[16:19]
    ds_read_b64_tr_b16 a[126:127], v223 offset:47104
    v_mfma_f32_16x16x32_bf16 a[16:19], v[72:75], a[108:111], a[16:19]
    global_load_lds_dwordx4 v229, s[74:75] offset:1024 nt
    v_mfma_f32_16x16x32_bf16 a[20:23], v[76:79], a[104:107], a[20:23]
    s_add_u32 s32, s66, 0x58000
    v_exp_f32 v12, v12
    v_mfma_f32_16x16x32_bf16 a[20:23], v[80:83], a[108:111], a[20:23]
    s_and_b32 s32, s32, 0x7ffff
    v_exp_f32 v13, v13
    v_mfma_f32_16x16x32_bf16 a[20:23], v[44:47], a[96:99], a[20:23]
    v_exp_f32 v14, v14
    v_mfma_f32_16x16x32_bf16 a[20:23], v[48:51], a[100:103], a[20:23]
    s_waitcnt vmcnt(10) lgkmcnt(0)
    v_exp_f32 v15, v15
    v_smfmac_f32_16x16x64_bf16 a[136:139], a[144:147], v[68:75], v236
    s_barrier
    v_mfma_f32_16x16x32_bf16 v[4:7], a[80:83], a[148:151], -4.0
    s_add_u32 s72, s14, s32
    v_exp_f32 v16, v16
    v_mfma_f32_16x16x32_bf16 v[4:7], a[84:87], a[152:155], v[4:7]
    ds_read_b128 a[64:67], v212 offset:32768
    v_cvt_pk_bf16_f32 v105, v14, v15
    v_mfma_f32_16x16x32_bf16 v[4:7], a[88:91], a[156:159], v[4:7]
    s_addc_u32 s73, s15, 0
    v_exp_f32 v17, v17
    v_mfma_f32_16x16x32_bf16 v[4:7], a[92:95], a[160:163], v[4:7]
    ds_read_b64_tr_b16 a[96:97], v220
    v_cvt_pk_bf16_f32 v104, v12, v13
    v_mfma_f32_16x16x32_bf16 v[8:11], a[88:91], a[172:175], -4.0
    v_exp_f32 v18, v18
    v_mfma_f32_16x16x32_bf16 v[8:11], a[92:95], a[176:179], v[8:11]
    ds_read_b64_tr_b16 a[98:99], v220 offset:2048
    v_cvt_pk_bf16_f32 v112, v16, v17
    v_mfma_f32_16x16x32_bf16 v[8:11], a[80:83], a[164:167], v[8:11]
    v_exp_f32 v19, v19
    v_mfma_f32_16x16x32_bf16 v[8:11], a[84:87], a[168:171], v[8:11]
    global_load_lds_dwordx4 v228, s[74:75] offset:2048 nt
    v_mfma_f32_16x16x32_bf16 v[12:15], a[80:83], a[180:183], -4.0
    v_exp_f32 v4, v4
    v_mfma_f32_16x16x32_bf16 v[12:15], a[84:87], a[184:187], v[12:15]
    ds_read_b128 a[68:71], v213 offset:32768
    v_cvt_pk_bf16_f32 v113, v18, v19
    v_mfma_f32_16x16x32_bf16 v[12:15], a[88:91], a[188:191], v[12:15]
    v_exp_f32 v5, v5
    v_mfma_f32_16x16x32_bf16 v[12:15], a[92:95], a[192:195], v[12:15]
    ds_read_b64_tr_b16 a[100:101], v220 offset:4096
    v_mfma_f32_16x16x32_bf16 v[16:19], a[88:91], a[204:207], -4.0
    v_exp_f32 v6, v6
    v_mfma_f32_16x16x32_bf16 v[16:19], a[92:95], a[208:211], v[16:19]
    ds_read_b64_tr_b16 a[102:103], v220 offset:6144
    v_cvt_pk_bf16_f32 v90, v4, v5
    v_mfma_f32_16x16x32_bf16 v[16:19], a[80:83], a[196:199], v[16:19]
    v_exp_f32 v7, v7
    v_mfma_f32_16x16x32_bf16 v[16:19], a[84:87], a[200:203], v[16:19]
    global_load_lds_dwordx4 v229, s[74:75] offset:3072 nt
    v_mfma_f32_16x16x32_bf16 v[172:175], v[20:23], a[112:115], v[172:175]
    v_exp_f32 v8, v8
    v_mfma_f32_16x16x32_bf16 v[172:175], v[24:27], a[116:119], v[172:175]
    ds_read_b128 a[72:75], v214 offset:32768
    v_cvt_pk_bf16_f32 v91, v6, v7
    v_mfma_f32_16x16x32_bf16 v[172:175], v[52:55], a[120:123], v[172:175]
    v_exp_f32 v9, v9
    v_mfma_f32_16x16x32_bf16 v[172:175], v[56:59], a[124:127], v[172:175]
    ds_read_b64_tr_b16 a[104:105], v220 offset:8192
    v_mfma_f32_16x16x32_bf16 v[176:179], v[60:63], a[120:123], v[176:179]
    s_add_u32 m0, s33, 0x6000
    v_exp_f32 v10, v10
    v_mfma_f32_16x16x32_bf16 v[176:179], v[64:67], a[124:127], v[176:179]
    ds_read_b64_tr_b16 a[106:107], v220 offset:10240
    v_cvt_pk_bf16_f32 v98, v8, v9
    v_mfma_f32_16x16x32_bf16 v[176:179], v[28:31], a[112:115], v[176:179]
    v_exp_f32 v11, v11
    v_mfma_f32_16x16x32_bf16 v[176:179], v[32:35], a[116:119], v[176:179]
    global_load_lds_dwordx4 v224, s[72:73] nt
    v_mfma_f32_16x16x32_bf16 a[24:27], v[36:39], a[112:115], a[24:27]
    s_add_u32 s32, s65, 0x60000
    v_exp_f32 v12, v12
    v_mfma_f32_16x16x32_bf16 a[24:27], v[40:43], a[116:119], a[24:27]
    ds_read_b128 a[76:79], v215 offset:32768
    v_cvt_pk_bf16_f32 v99, v10, v11
    v_mfma_f32_16x16x32_bf16 a[24:27], v[68:71], a[120:123], a[24:27]
    s_and_b32 s32, s32, 0x7ffff
    v_exp_f32 v13, v13
    v_mfma_f32_16x16x32_bf16 a[24:27], v[72:75], a[124:127], a[24:27]
    ds_read_b64_tr_b16 a[108:109], v220 offset:12288
    v_mfma_f32_16x16x32_bf16 a[28:31], v[76:79], a[120:123], a[28:31]
    v_exp_f32 v14, v14
    v_mfma_f32_16x16x32_bf16 a[28:31], v[80:83], a[124:127], a[28:31]
    ds_read_b64_tr_b16 a[110:111], v220 offset:14336
    v_cvt_pk_bf16_f32 v106, v12, v13
    v_mfma_f32_16x16x32_bf16 a[28:31], v[44:47], a[112:115], a[28:31]
    s_waitcnt lgkmcnt(2)
    v_exp_f32 v15, v15
    v_mfma_f32_16x16x32_bf16 a[28:31], v[48:51], a[116:119], a[28:31]
    global_load_lds_dwordx4 v225, s[72:73] offset:1024 nt
    v_smfmac_f32_16x16x64_bf16 a[140:143], a[144:147], v[76:83], v236
    v_mfma_f32_16x16x32_bf16 v[4:7], a[64:67], a[148:151], -4.0
    s_add_u32 s74, s12, s32
    v_exp_f32 v16, v16
    v_mfma_f32_16x16x32_bf16 v[4:7], a[68:71], a[152:155], v[4:7]
    ds_read_b128 a[80:83], v212 offset:36864
    v_cvt_pk_bf16_f32 v107, v14, v15
    v_mfma_f32_16x16x32_bf16 v[4:7], a[72:75], a[156:159], v[4:7]
    s_addc_u32 s75, s13, 0
    v_exp_f32 v17, v17
    v_mfma_f32_16x16x32_bf16 v[4:7], a[76:79], a[160:163], v[4:7]
    ds_read_b64_tr_b16 a[112:113], v221
    v_mfma_f32_16x16x32_bf16 v[8:11], a[72:75], a[172:175], -4.0
    v_exp_f32 v18, v18
    v_mfma_f32_16x16x32_bf16 v[8:11], a[76:79], a[176:179], v[8:11]
    ds_read_b64_tr_b16 a[114:115], v221 offset:2048
    v_cvt_pk_bf16_f32 v114, v16, v17
    v_mfma_f32_16x16x32_bf16 v[8:11], a[64:67], a[164:167], v[8:11]
    s_waitcnt lgkmcnt(3)
    v_exp_f32 v19, v19
    v_mfma_f32_16x16x32_bf16 v[8:11], a[68:71], a[168:171], v[8:11]
    global_load_lds_dwordx4 v226, s[72:73] offset:2048 nt
    v_mfma_f32_16x16x32_bf16 v[12:15], a[64:67], a[180:183], -4.0
    v_exp_f32 v4, v4
    v_mfma_f32_16x16x32_bf16 v[12:15], a[68:71], a[184:187], v[12:15]
    ds_read_b128 a[84:87], v213 offset:36864
    v_cvt_pk_bf16_f32 v115, v18, v19
    v_mfma_f32_16x16x32_bf16 v[12:15], a[72:75], a[188:191], v[12:15]
    v_exp_f32 v5, v5
    v_mfma_f32_16x16x32_bf16 v[12:15], a[76:79], a[192:195], v[12:15]
    ds_read_b64_tr_b16 a[116:117], v221 offset:4096
    v_mfma_f32_16x16x32_bf16 v[16:19], a[72:75], a[204:207], -4.0
    v_exp_f32 v6, v6
    v_mfma_f32_16x16x32_bf16 v[16:19], a[76:79], a[208:211], v[16:19]
    ds_read_b64_tr_b16 a[118:119], v221 offset:6144
    v_cvt_pk_bf16_f32 v116, v4, v5
    v_mfma_f32_16x16x32_bf16 v[16:19], a[64:67], a[196:199], v[16:19]
    v_exp_f32 v7, v7
    v_mfma_f32_16x16x32_bf16 v[16:19], a[68:71], a[200:203], v[16:19]
    global_load_lds_dwordx4 v227, s[72:73] offset:3072 nt
    v_mfma_f32_16x16x32_bf16 v[180:183], v[20:23], a[96:99], v[180:183]
    v_exp_f32 v8, v8
    v_mfma_f32_16x16x32_bf16 v[180:183], v[24:27], a[100:103], v[180:183]
    ds_read_b128 a[88:91], v214 offset:36864
    v_cvt_pk_bf16_f32 v117, v6, v7
    v_mfma_f32_16x16x32_bf16 v[180:183], v[52:55], a[104:107], v[180:183]
    v_exp_f32 v9, v9
    v_mfma_f32_16x16x32_bf16 v[180:183], v[56:59], a[108:111], v[180:183]
    ds_read_b64_tr_b16 a[120:121], v221 offset:8192
    v_mfma_f32_16x16x32_bf16 v[184:187], v[60:63], a[104:107], v[184:187]
    s_add_u32 m0, s31, 0x4000
    v_exp_f32 v10, v10
    v_mfma_f32_16x16x32_bf16 v[184:187], v[64:67], a[108:111], v[184:187]
    ds_read_b64_tr_b16 a[122:123], v221 offset:10240
    v_cvt_pk_bf16_f32 v124, v8, v9
    v_mfma_f32_16x16x32_bf16 v[184:187], v[28:31], a[96:99], v[184:187]
    v_exp_f32 v11, v11
    v_mfma_f32_16x16x32_bf16 v[184:187], v[32:35], a[100:103], v[184:187]
    global_load_lds_dwordx4 v228, s[74:75] nt
    v_mfma_f32_16x16x32_bf16 a[32:35], v[36:39], a[96:99], a[32:35]
    ds_read_b128 a[92:95], v215 offset:36864
    v_cvt_pk_bf16_f32 v125, v10, v11
    v_mfma_f32_16x16x32_bf16 a[32:35], v[40:43], a[100:103], a[32:35]
    ds_read_b64_tr_b16 a[124:125], v221 offset:12288
    v_mfma_f32_16x16x32_bf16 a[32:35], v[68:71], a[104:107], a[32:35]
    ds_read_b64_tr_b16 a[126:127], v221 offset:14336
    v_mfma_f32_16x16x32_bf16 a[32:35], v[72:75], a[108:111], a[32:35]
    global_load_lds_dwordx4 v229, s[74:75] offset:1024 nt
    v_mfma_f32_16x16x32_bf16 a[36:39], v[76:79], a[104:107], a[36:39]
    s_add_u32 s32, s67, 0x50000
    v_exp_f32 v12, v12
    v_mfma_f32_16x16x32_bf16 a[36:39], v[80:83], a[108:111], a[36:39]
    s_and_b32 s32, s32, 0x7ffff
    v_exp_f32 v13, v13
    v_mfma_f32_16x16x32_bf16 a[36:39], v[44:47], a[96:99], a[36:39]
    v_exp_f32 v14, v14
    v_mfma_f32_16x16x32_bf16 a[36:39], v[48:51], a[100:103], a[36:39]
    s_waitcnt vmcnt(14) lgkmcnt(0)
    v_exp_f32 v15, v15
    v_smfmac_f32_16x16x64_bf16 a[128:131], a[144:147], v[84:91], v236
    s_barrier
    v_mfma_f32_16x16x32_bf16 v[4:7], a[80:83], a[148:151], -4.0
    s_add_u32 s72, s14, s32
    v_exp_f32 v16, v16
    v_mfma_f32_16x16x32_bf16 v[4:7], a[84:87], a[152:155], v[4:7]
    ds_read_b128 a[64:67], v212 offset:49152
    v_cvt_pk_bf16_f32 v133, v14, v15
    v_mfma_f32_16x16x32_bf16 v[4:7], a[88:91], a[156:159], v[4:7]
    s_addc_u32 s73, s15, 0
    v_exp_f32 v17, v17
    v_mfma_f32_16x16x32_bf16 v[4:7], a[92:95], a[160:163], v[4:7]
    ds_read_b64_tr_b16 a[96:97], v222
    v_cvt_pk_bf16_f32 v132, v12, v13
    v_mfma_f32_16x16x32_bf16 v[8:11], a[88:91], a[172:175], -4.0
    v_exp_f32 v18, v18
    v_mfma_f32_16x16x32_bf16 v[8:11], a[92:95], a[176:179], v[8:11]
    ds_read_b64_tr_b16 a[98:99], v222 offset:2048
    v_cvt_pk_bf16_f32 v140, v16, v17
    v_mfma_f32_16x16x32_bf16 v[8:11], a[80:83], a[164:167], v[8:11]
    v_exp_f32 v19, v19
    v_mfma_f32_16x16x32_bf16 v[8:11], a[84:87], a[168:171], v[8:11]
    global_load_lds_dwordx4 v228, s[74:75] offset:2048 nt
    v_mfma_f32_16x16x32_bf16 v[12:15], a[80:83], a[180:183], -4.0
    v_exp_f32 v4, v4
    v_mfma_f32_16x16x32_bf16 v[12:15], a[84:87], a[184:187], v[12:15]
    ds_read_b128 a[68:71], v213 offset:49152
    v_cvt_pk_bf16_f32 v141, v18, v19
    v_mfma_f32_16x16x32_bf16 v[12:15], a[88:91], a[188:191], v[12:15]
    v_exp_f32 v5, v5
    v_mfma_f32_16x16x32_bf16 v[12:15], a[92:95], a[192:195], v[12:15]
    ds_read_b64_tr_b16 a[100:101], v222 offset:4096
    v_mfma_f32_16x16x32_bf16 v[16:19], a[88:91], a[204:207], -4.0
    v_exp_f32 v6, v6
    v_mfma_f32_16x16x32_bf16 v[16:19], a[92:95], a[208:211], v[16:19]
    ds_read_b64_tr_b16 a[102:103], v222 offset:6144
    v_cvt_pk_bf16_f32 v118, v4, v5
    v_mfma_f32_16x16x32_bf16 v[16:19], a[80:83], a[196:199], v[16:19]
    v_exp_f32 v7, v7
    v_mfma_f32_16x16x32_bf16 v[16:19], a[84:87], a[200:203], v[16:19]
    global_load_lds_dwordx4 v229, s[74:75] offset:3072 nt
    v_mfma_f32_16x16x32_bf16 v[188:191], v[20:23], a[112:115], v[188:191]
    v_exp_f32 v8, v8
    v_mfma_f32_16x16x32_bf16 v[188:191], v[24:27], a[116:119], v[188:191]
    ds_read_b128 a[72:75], v214 offset:49152
    v_cvt_pk_bf16_f32 v119, v6, v7
    v_mfma_f32_16x16x32_bf16 v[188:191], v[52:55], a[120:123], v[188:191]
L_stub6:
    s_cbranch_execz L_back
    v_exp_f32 v9, v9
    v_mfma_f32_16x16x32_bf16 v[188:191], v[56:59], a[124:127], v[188:191]
    ds_read_b64_tr_b16 a[104:105], v222 offset:8192
    v_mfma_f32_16x16x32_bf16 v[192:195], v[60:63], a[120:123], v[192:195]
    s_add_u32 m0, s33, 0x8000
    v_exp_f32 v10, v10
    v_mfma_f32_16x16x32_bf16 v[192:195], v[64:67], a[124:127], v[192:195]
    ds_read_b64_tr_b16 a[106:107], v222 offset:10240
    v_cvt_pk_bf16_f32 v126, v8, v9
    v_mfma_f32_16x16x32_bf16 v[192:195], v[28:31], a[112:115], v[192:195]
    v_exp_f32 v11, v11
    v_mfma_f32_16x16x32_bf16 v[192:195], v[32:35], a[116:119], v[192:195]
    global_load_lds_dwordx4 v224, s[72:73] nt
    v_mfma_f32_16x16x32_bf16 a[40:43], v[36:39], a[112:115], a[40:43]
    s_add_u32 s32, s64, 0x68000
    v_exp_f32 v12, v12
    v_mfma_f32_16x16x32_bf16 a[40:43], v[40:43], a[116:119], a[40:43]
    ds_read_b128 a[76:79], v215 offset:49152
    v_cvt_pk_bf16_f32 v127, v10, v11
    v_mfma_f32_16x16x32_bf16 a[40:43], v[68:71], a[120:123], a[40:43]
    s_and_b32 s32, s32, 0x7ffff
    v_exp_f32 v13, v13
    v_mfma_f32_16x16x32_bf16 a[40:43], v[72:75], a[124:127], a[40:43]
    ds_read_b64_tr_b16 a[108:109], v222 offset:12288
    v_mfma_f32_16x16x32_bf16 a[44:47], v[76:79], a[120:123], a[44:47]
    v_exp_f32 v14, v14
    v_mfma_f32_16x16x32_bf16 a[44:47], v[80:83], a[124:127], a[44:47]
    ds_read_b64_tr_b16 a[110:111], v222 offset:14336
    v_cvt_pk_bf16_f32 v134, v12, v13
    v_mfma_f32_16x16x32_bf16 a[44:47], v[44:47], a[112:115], a[44:47]
    s_waitcnt lgkmcnt(2)
    v_exp_f32 v15, v15
    v_mfma_f32_16x16x32_bf16 a[44:47], v[48:51], a[116:119], a[44:47]
    global_load_lds_dwordx4 v225, s[72:73] offset:1024 nt
    v_smfmac_f32_16x16x64_bf16 a[132:135], a[144:147], v[92:99], v236
    v_mfma_f32_16x16x32_bf16 v[4:7], a[64:67], a[148:151], -4.0
    s_add_u32 s74, s12, s32
    v_exp_f32 v16, v16
    v_mfma_f32_16x16x32_bf16 v[4:7], a[68:71], a[152:155], v[4:7]
    ds_read_b128 a[80:83], v212 offset:53248
    v_cvt_pk_bf16_f32 v135, v14, v15
    v_mfma_f32_16x16x32_bf16 v[4:7], a[72:75], a[156:159], v[4:7]
    s_addc_u32 s75, s13, 0
    v_exp_f32 v17, v17
    v_mfma_f32_16x16x32_bf16 v[4:7], a[76:79], a[160:163], v[4:7]
    ds_read_b64_tr_b16 a[112:113], v223
    v_mfma_f32_16x16x32_bf16 v[8:11], a[72:75], a[172:175], -4.0
    v_exp_f32 v18, v18
    v_mfma_f32_16x16x32_bf16 v[8:11], a[76:79], a[176:179], v[8:11]
    ds_read_b64_tr_b16 a[114:115], v223 offset:2048
    v_cvt_pk_bf16_f32 v142, v16, v17
    v_mfma_f32_16x16x32_bf16 v[8:11], a[64:67], a[164:167], v[8:11]
    s_waitcnt lgkmcnt(3)
    v_exp_f32 v19, v19
    v_mfma_f32_16x16x32_bf16 v[8:11], a[68:71], a[168:171], v[8:11]
    global_load_lds_dwordx4 v226, s[72:73] offset:2048 nt
    v_mfma_f32_16x16x32_bf16 v[12:15], a[64:67], a[180:183], -4.0
    v_exp_f32 v4, v4
    v_mfma_f32_16x16x32_bf16 v[12:15], a[68:71], a[184:187], v[12:15]
    ds_read_b128 a[84:87], v213 offset:53248
    v_cvt_pk_bf16_f32 v143, v18, v19
    v_mfma_f32_16x16x32_bf16 v[12:15], a[72:75], a[188:191], v[12:15]
    v_exp_f32 v5, v5
    v_mfma_f32_16x16x32_bf16 v[12:15], a[76:79], a[192:195], v[12:15]
    ds_read_b64_tr_b16 a[116:117], v223 offset:4096
    v_mfma_f32_16x16x32_bf16 v[16:19], a[72:75], a[204:207], -4.0
    v_exp_f32 v6, v6
    v_mfma_f32_16x16x32_bf16 v[16:19], a[76:79], a[208:211], v[16:19]
    ds_read_b64_tr_b16 a[118:119], v223 offset:6144
    v_cvt_pk_bf16_f32 v120, v4, v5
    v_mfma_f32_16x16x32_bf16 v[16:19], a[64:67], a[196:199], v[16:19]
    v_exp_f32 v7, v7
    v_mfma_f32_16x16x32_bf16 v[16:19], a[68:71], a[200:203], v[16:19]
    global_load_lds_dwordx4 v227, s[72:73] offset:3072 nt
    v_mfma_f32_16x16x32_bf16 v[196:199], v[20:23], a[96:99], v[196:199]
    v_exp_f32 v8, v8
    v_mfma_f32_16x16x32_bf16 v[196:199], v[24:27], a[100:103], v[196:199]
    ds_read_b128 a[88:91], v214 offset:53248
    v_cvt_pk_bf16_f32 v121, v6, v7
    v_mfma_f32_16x16x32_bf16 v[196:199], v[52:55], a[104:107], v[196:199]
    v_exp_f32 v9, v9
    v_mfma_f32_16x16x32_bf16 v[196:199], v[56:59], a[108:111], v[196:199]
    ds_read_b64_tr_b16 a[120:121], v223 offset:8192
    v_mfma_f32_16x16x32_bf16 v[200:203], v[60:63], a[104:107], v[200:203]
    s_add_u32 m0, s31, 0x8000
    v_exp_f32 v10, v10
    v_mfma_f32_16x16x32_bf16 v[200:203], v[64:67], a[108:111], v[200:203]
    ds_read_b64_tr_b16 a[122:123], v223 offset:10240
    v_cvt_pk_bf16_f32 v128, v8, v9
    v_mfma_f32_16x16x32_bf16 v[200:203], v[28:31], a[96:99], v[200:203]
    v_exp_f32 v11, v11
    v_mfma_f32_16x16x32_bf16 v[200:203], v[32:35], a[100:103], v[200:203]
    global_load_lds_dwordx4 v228, s[74:75] nt
    v_mfma_f32_16x16x32_bf16 a[48:51], v[36:39], a[96:99], a[48:51]
    ds_read_b128 a[92:95], v215 offset:53248
    v_cvt_pk_bf16_f32 v129, v10, v11
    v_mfma_f32_16x16x32_bf16 a[48:51], v[40:43], a[100:103], a[48:51]
    ds_read_b64_tr_b16 a[124:125], v223 offset:12288
    v_mfma_f32_16x16x32_bf16 a[48:51], v[68:71], a[104:107], a[48:51]
    ds_read_b64_tr_b16 a[126:127], v223 offset:14336
    v_mfma_f32_16x16x32_bf16 a[48:51], v[72:75], a[108:111], a[48:51]
    global_load_lds_dwordx4 v229, s[74:75] offset:1024 nt
    v_mfma_f32_16x16x32_bf16 a[52:55], v[76:79], a[104:107], a[52:55]
    s_add_u32 s32, s67, 0x58000
    v_exp_f32 v12, v12
    v_mfma_f32_16x16x32_bf16 a[52:55], v[80:83], a[108:111], a[52:55]
    s_and_b32 s32, s32, 0x7ffff
    v_exp_f32 v13, v13
    v_mfma_f32_16x16x32_bf16 a[52:55], v[44:47], a[96:99], a[52:55]
    v_exp_f32 v14, v14
    v_mfma_f32_16x16x32_bf16 a[52:55], v[48:51], a[100:103], a[52:55]
    s_waitcnt vmcnt(10) lgkmcnt(0)
    v_exp_f32 v15, v15
    v_smfmac_f32_16x16x64_bf16 a[136:139], a[144:147], v[100:107], v236
    s_barrier
    v_mfma_f32_16x16x32_bf16 v[4:7], a[80:83], a[148:151], -4.0
    s_add_u32 s72, s14, s32
    v_exp_f32 v16, v16
    v_mfma_f32_16x16x32_bf16 v[4:7], a[84:87], a[152:155], v[4:7]
    ds_read_b128 a[64:67], v212
    v_cvt_pk_bf16_f32 v137, v14, v15
    v_mfma_f32_16x16x32_bf16 v[4:7], a[88:91], a[156:159], v[4:7]
    s_addc_u32 s73, s15, 0
    v_exp_f32 v17, v17
    v_mfma_f32_16x16x32_bf16 v[4:7], a[92:95], a[160:163], v[4:7]
    ds_read_b64_tr_b16 a[96:97], v220 offset:16384
    v_cvt_pk_bf16_f32 v136, v12, v13
    v_mfma_f32_16x16x32_bf16 v[8:11], a[88:91], a[172:175], -4.0
    v_exp_f32 v18, v18
    v_mfma_f32_16x16x32_bf16 v[8:11], a[92:95], a[176:179], v[8:11]
    ds_read_b64_tr_b16 a[98:99], v220 offset:18432
    v_cvt_pk_bf16_f32 v144, v16, v17
    v_mfma_f32_16x16x32_bf16 v[8:11], a[80:83], a[164:167], v[8:11]
    v_exp_f32 v19, v19
    v_mfma_f32_16x16x32_bf16 v[8:11], a[84:87], a[168:171], v[8:11]
    global_load_lds_dwordx4 v228, s[74:75] offset:2048 nt
    v_mfma_f32_16x16x32_bf16 v[12:15], a[80:83], a[180:183], -4.0
    v_exp_f32 v4, v4
    v_mfma_f32_16x16x32_bf16 v[12:15], a[84:87], a[184:187], v[12:15]
    ds_read_b128 a[68:71], v213
    v_cvt_pk_bf16_f32 v145, v18, v19
    v_mfma_f32_16x16x32_bf16 v[12:15], a[88:91], a[188:191], v[12:15]
    v_exp_f32 v5, v5
    v_mfma_f32_16x16x32_bf16 v[12:15], a[92:95], a[192:195], v[12:15]
    ds_read_b64_tr_b16 a[100:101], v220 offset:20480
    v_mfma_f32_16x16x32_bf16 v[16:19], a[88:91], a[204:207], -4.0
    v_exp_f32 v6, v6
    v_mfma_f32_16x16x32_bf16 v[16:19], a[92:95], a[208:211], v[16:19]
    ds_read_b64_tr_b16 a[102:103], v220 offset:22528
    v_cvt_pk_bf16_f32 v122, v4, v5
    v_mfma_f32_16x16x32_bf16 v[16:19], a[80:83], a[196:199], v[16:19]
    v_exp_f32 v7, v7
    v_mfma_f32_16x16x32_bf16 v[16:19], a[84:87], a[200:203], v[16:19]
    global_load_lds_dwordx4 v229, s[74:75] offset:3072 nt
    v_mfma_f32_16x16x32_bf16 v[204:207], v[20:23], a[112:115], v[204:207]
    v_exp_f32 v8, v8
    v_mfma_f32_16x16x32_bf16 v[204:207], v[24:27], a[116:119], v[204:207]
    ds_read_b128 a[72:75], v214
    v_cvt_pk_bf16_f32 v123, v6, v7
    v_mfma_f32_16x16x32_bf16 v[204:207], v[52:55], a[120:123], v[204:207]
    v_exp_f32 v9, v9
    v_mfma_f32_16x16x32_bf16 v[204:207], v[56:59], a[124:127], v[204:207]
    ds_read_b64_tr_b16 a[104:105], v220 offset:24576
    v_mfma_f32_16x16x32_bf16 v[208:211], v[60:63], a[120:123], v[208:211]
    s_add_u32 m0, s33, 0xa000
    v_exp_f32 v10, v10
    v_mfma_f32_16x16x32_bf16 v[208:211], v[64:67], a[124:127], v[208:211]
    ds_read_b64_tr_b16 a[106:107], v220 offset:26624
    v_cvt_pk_bf16_f32 v130, v8, v9
    v_mfma_f32_16x16x32_bf16 v[208:211], v[28:31], a[112:115], v[208:211]
    v_exp_f32 v11, v11
    v_mfma_f32_16x16x32_bf16 v[208:211], v[32:35], a[116:119], v[208:211]
    global_load_lds_dwordx4 v224, s[72:73] nt
    v_mfma_f32_16x16x32_bf16 a[56:59], v[36:39], a[112:115], a[56:59]
    s_add_u32 s32, s65, 0x68000
    v_exp_f32 v12, v12
    v_mfma_f32_16x16x32_bf16 a[56:59], v[40:43], a[116:119], a[56:59]
    ds_read_b128 a[76:79], v215
    v_cvt_pk_bf16_f32 v131, v10, v11
    v_mfma_f32_16x16x32_bf16 a[56:59], v[68:71], a[120:123], a[56:59]
    s_and_b32 s32, s32, 0x7ffff
    v_exp_f32 v13, v13
    v_mfma_f32_16x16x32_bf16 a[56:59], v[72:75], a[124:127], a[56:59]
    ds_read_b64_tr_b16 a[108:109], v220 offset:28672
    v_mfma_f32_16x16x32_bf16 a[60:63], v[76:79], a[120:123], a[60:63]
    v_exp_f32 v14, v14
    v_mfma_f32_16x16x32_bf16 a[60:63], v[80:83], a[124:127], a[60:63]
    ds_read_b64_tr_b16 a[110:111], v220 offset:30720
    v_cvt_pk_bf16_f32 v138, v12, v13
    v_mfma_f32_16x16x32_bf16 a[60:63], v[44:47], a[112:115], a[60:63]
    s_waitcnt lgkmcnt(2)
    v_exp_f32 v15, v15
    v_mfma_f32_16x16x32_bf16 a[60:63], v[48:51], a[116:119], a[60:63]
    global_load_lds_dwordx4 v225, s[72:73] offset:1024 nt
    v_smfmac_f32_16x16x64_bf16 a[140:143], a[144:147], v[108:115], v236
    v_mfma_f32_16x16x32_bf16 v[4:7], a[64:67], a[148:151], -4.0
    s_add_u32 s74, s12, s32
    v_exp_f32 v16, v16
    v_mfma_f32_16x16x32_bf16 v[4:7], a[68:71], a[152:155], v[4:7]
    ds_read_b128 a[80:83], v212 offset:4096
    v_cvt_pk_bf16_f32 v139, v14, v15
    v_mfma_f32_16x16x32_bf16 v[4:7], a[72:75], a[156:159], v[4:7]
    s_addc_u32 s75, s13, 0
    v_exp_f32 v17, v17
    v_mfma_f32_16x16x32_bf16 v[4:7], a[76:79], a[160:163], v[4:7]
    ds_read_b64_tr_b16 a[112:113], v221 offset:16384
    v_mfma_f32_16x16x32_bf16 v[8:11], a[72:75], a[172:175], -4.0
    v_exp_f32 v18, v18
    v_mfma_f32_16x16x32_bf16 v[8:11], a[76:79], a[176:179], v[8:11]
    ds_read_b64_tr_b16 a[114:115], v221 offset:18432
    v_cvt_pk_bf16_f32 v146, v16, v17
    v_mfma_f32_16x16x32_bf16 v[8:11], a[64:67], a[164:167], v[8:11]
    s_waitcnt lgkmcnt(3)
    v_exp_f32 v19, v19
    v_mfma_f32_16x16x32_bf16 v[8:11], a[68:71], a[168:171], v[8:11]
    global_load_lds_dwordx4 v226, s[72:73] offset:2048 nt
    v_mfma_f32_16x16x32_bf16 v[12:15], a[64:67], a[180:183], -4.0
    v_exp_f32 v4, v4
    v_mfma_f32_16x16x32_bf16 v[12:15], a[68:71], a[184:187], v[12:15]
    ds_read_b128 a[84:87], v213 offset:4096
    v_cvt_pk_bf16_f32 v147, v18, v19
    v_mfma_f32_16x16x32_bf16 v[12:15], a[72:75], a[188:191], v[12:15]
    v_exp_f32 v5, v5
    v_mfma_f32_16x16x32_bf16 v[12:15], a[76:79], a[192:195], v[12:15]
    ds_read_b64_tr_b16 a[116:117], v221 offset:20480
    v_mfma_f32_16x16x32_bf16 v[16:19], a[72:75], a[204:207], -4.0
    v_exp_f32 v6, v6
    v_mfma_f32_16x16x32_bf16 v[16:19], a[76:79], a[208:211], v[16:19]
    ds_read_b64_tr_b16 a[118:119], v221 offset:22528
    v_cvt_pk_bf16_f32 v20, v4, v5
    v_mfma_f32_16x16x32_bf16 v[16:19], a[64:67], a[196:199], v[16:19]
    v_exp_f32 v7, v7
    v_mfma_f32_16x16x32_bf16 v[16:19], a[68:71], a[200:203], v[16:19]
    global_load_lds_dwordx4 v227, s[72:73] offset:3072 nt
    v_mfma_f32_16x16x32_bf16 v[148:151], v[84:87], a[96:99], v[148:151]
    v_exp_f32 v8, v8
    v_mfma_f32_16x16x32_bf16 v[148:151], v[88:91], a[100:103], v[148:151]
    ds_read_b128 a[88:91], v214 offset:4096
    v_cvt_pk_bf16_f32 v21, v6, v7
    v_mfma_f32_16x16x32_bf16 v[148:151], v[116:119], a[104:107], v[148:151]
    v_exp_f32 v9, v9
    v_mfma_f32_16x16x32_bf16 v[148:151], v[120:123], a[108:111], v[148:151]
    ds_read_b64_tr_b16 a[120:121], v221 offset:24576
    v_mfma_f32_16x16x32_bf16 v[152:155], v[124:127], a[104:107], v[152:155]
    s_add_u32 m0, s31, 0xc000
    v_exp_f32 v10, v10
    v_mfma_f32_16x16x32_bf16 v[152:155], v[128:131], a[108:111], v[152:155]
    ds_read_b64_tr_b16 a[122:123], v221 offset:26624
    v_cvt_pk_bf16_f32 v28, v8, v9
    v_mfma_f32_16x16x32_bf16 v[152:155], v[92:95], a[96:99], v[152:155]
    v_exp_f32 v11, v11
    v_mfma_f32_16x16x32_bf16 v[152:155], v[96:99], a[100:103], v[152:155]
    global_load_lds_dwordx4 v228, s[74:75] nt
    v_mfma_f32_16x16x32_bf16 a[0:3], v[100:103], a[96:99], a[0:3]
    ds_read_b128 a[92:95], v215 offset:4096
    v_cvt_pk_bf16_f32 v29, v10, v11
    v_mfma_f32_16x16x32_bf16 a[0:3], v[104:107], a[100:103], a[0:3]
    ds_read_b64_tr_b16 a[124:125], v221 offset:28672
    v_mfma_f32_16x16x32_bf16 a[0:3], v[132:135], a[104:107], a[0:3]
    ds_read_b64_tr_b16 a[126:127], v221 offset:30720
    v_mfma_f32_16x16x32_bf16 a[0:3], v[136:139], a[108:111], a[0:3]
    global_load_lds_dwordx4 v229, s[74:75] offset:1024 nt
    v_mfma_f32_16x16x32_bf16 a[4:7], v[140:143], a[104:107], a[4:7]
    s_add_u32 s32, s66, 0x60000
    v_exp_f32 v12, v12
    v_mfma_f32_16x16x32_bf16 a[4:7], v[144:147], a[108:111], a[4:7]
    s_and_b32 s32, s32, 0x7ffff
    v_exp_f32 v13, v13
    v_mfma_f32_16x16x32_bf16 a[4:7], v[108:111], a[96:99], a[4:7]
    v_exp_f32 v14, v14
    v_mfma_f32_16x16x32_bf16 a[4:7], v[112:115], a[100:103], a[4:7]
    s_waitcnt vmcnt(14) lgkmcnt(0)
    v_exp_f32 v15, v15
    v_smfmac_f32_16x16x64_bf16 a[128:131], a[144:147], v[116:123], v236
    s_barrier
    v_mfma_f32_16x16x32_bf16 v[4:7], a[80:83], a[148:151], -4.0
    s_add_u32 s72, s14, s32
    v_exp_f32 v16, v16
    v_mfma_f32_16x16x32_bf16 v[4:7], a[84:87], a[152:155], v[4:7]
    ds_read_b128 a[64:67], v212 offset:16384
    v_cvt_pk_bf16_f32 v37, v14, v15
    v_mfma_f32_16x16x32_bf16 v[4:7], a[88:91], a[156:159], v[4:7]
    s_addc_u32 s73, s15, 0
    v_exp_f32 v17, v17
    v_mfma_f32_16x16x32_bf16 v[4:7], a[92:95], a[160:163], v[4:7]
    ds_read_b64_tr_b16 a[96:97], v222 offset:16384
    v_cvt_pk_bf16_f32 v36, v12, v13
    v_mfma_f32_16x16x32_bf16 v[8:11], a[88:91], a[172:175], -4.0
    v_exp_f32 v18, v18
    v_mfma_f32_16x16x32_bf16 v[8:11], a[92:95], a[176:179], v[8:11]
    ds_read_b64_tr_b16 a[98:99], v222 offset:18432
    v_cvt_pk_bf16_f32 v44, v16, v17
    v_mfma_f32_16x16x32_bf16 v[8:11], a[80:83], a[164:167], v[8:11]
    v_exp_f32 v19, v19
    v_mfma_f32_16x16x32_bf16 v[8:11], a[84:87], a[168:171], v[8:11]
    global_load_lds_dwordx4 v228, s[74:75] offset:2048 nt
    v_mfma_f32_16x16x32_bf16 v[12:15], a[80:83], a[180:183], -4.0
    v_exp_f32 v4, v4
    v_mfma_f32_16x16x32_bf16 v[12:15], a[84:87], a[184:187], v[12:15]
    ds_read_b128 a[68:71], v213 offset:16384
    v_cvt_pk_bf16_f32 v45, v18, v19
    v_mfma_f32_16x16x32_bf16 v[12:15], a[88:91], a[188:191], v[12:15]
    v_exp_f32 v5, v5
    v_mfma_f32_16x16x32_bf16 v[12:15], a[92:95], a[192:195], v[12:15]
    ds_read_b64_tr_b16 a[100:101], v222 offset:20480
    v_mfma_f32_16x16x32_bf16 v[16:19], a[88:91], a[204:207], -4.0
    v_exp_f32 v6, v6
    v_mfma_f32_16x16x32_bf16 v[16:19], a[92:95], a[208:211], v[16:19]
    ds_read_b64_tr_b16 a[102:103], v222 offset:22528
    v_cvt_pk_bf16_f32 v22, v4, v5
    v_mfma_f32_16x16x32_bf16 v[16:19], a[80:83], a[196:199], v[16:19]
    v_exp_f32 v7, v7
    v_mfma_f32_16x16x32_bf16 v[16:19], a[84:87], a[200:203], v[16:19]
    global_load_lds_dwordx4 v229, s[74:75] offset:3072 nt
    v_mfma_f32_16x16x32_bf16 v[156:159], v[84:87], a[112:115], v[156:159]
    v_exp_f32 v8, v8
    v_mfma_f32_16x16x32_bf16 v[156:159], v[88:91], a[116:119], v[156:159]
    ds_read_b128 a[72:75], v214 offset:16384
    v_cvt_pk_bf16_f32 v23, v6, v7
    v_mfma_f32_16x16x32_bf16 v[156:159], v[116:119], a[120:123], v[156:159]
    v_exp_f32 v9, v9
    v_mfma_f32_16x16x32_bf16 v[156:159], v[120:123], a[124:127], v[156:159]
    ds_read_b64_tr_b16 a[104:105], v222 offset:24576
    v_mfma_f32_16x16x32_bf16 v[160:163], v[124:127], a[120:123], v[160:163]
    s_add_u32 m0, s33, 0x0
    v_exp_f32 v10, v10
    v_mfma_f32_16x16x32_bf16 v[160:163], v[128:131], a[124:127], v[160:163]
    ds_read_b64_tr_b16 a[106:107], v222 offset:26624
    v_cvt_pk_bf16_f32 v30, v8, v9
    v_mfma_f32_16x16x32_bf16 v[160:163], v[92:95], a[112:115], v[160:163]
    v_exp_f32 v11, v11
    v_mfma_f32_16x16x32_bf16 v[160:163], v[96:99], a[116:119], v[160:163]
    global_load_lds_dwordx4 v224, s[72:73] nt
    v_mfma_f32_16x16x32_bf16 a[8:11], v[100:103], a[112:115], a[8:11]
    s_add_u32 s32, s64, 0x70000
    v_exp_f32 v12, v12
    v_mfma_f32_16x16x32_bf16 a[8:11], v[104:107], a[116:119], a[8:11]
    ds_read_b128 a[76:79], v215 offset:16384
    v_cvt_pk_bf16_f32 v31, v10, v11
    v_mfma_f32_16x16x32_bf16 a[8:11], v[132:135], a[120:123], a[8:11]
    s_and_b32 s32, s32, 0x7ffff
    v_exp_f32 v13, v13
    v_mfma_f32_16x16x32_bf16 a[8:11], v[136:139], a[124:127], a[8:11]
    ds_read_b64_tr_b16 a[108:109], v222 offset:28672
    v_mfma_f32_16x16x32_bf16 a[12:15], v[140:143], a[120:123], a[12:15]
    v_exp_f32 v14, v14
    v_mfma_f32_16x16x32_bf16 a[12:15], v[144:147], a[124:127], a[12:15]
    ds_read_b64_tr_b16 a[110:111], v222 offset:30720
    v_cvt_pk_bf16_f32 v38, v12, v13
    v_mfma_f32_16x16x32_bf16 a[12:15], v[108:111], a[112:115], a[12:15]
    s_waitcnt lgkmcnt(2)
    v_exp_f32 v15, v15
    v_mfma_f32_16x16x32_bf16 a[12:15], v[112:115], a[116:119], a[12:15]
    global_load_lds_dwordx4 v225, s[72:73] offset:1024 nt
    v_smfmac_f32_16x16x64_bf16 a[132:135], a[144:147], v[124:131], v236
    v_mfma_f32_16x16x32_bf16 v[4:7], a[64:67], a[148:151], -4.0
    s_add_u32 s74, s12, s32
    v_exp_f32 v16, v16
    v_mfma_f32_16x16x32_bf16 v[4:7], a[68:71], a[152:155], v[4:7]
    ds_read_b128 a[80:83], v212 offset:20480
    v_cvt_pk_bf16_f32 v39, v14, v15
    v_mfma_f32_16x16x32_bf16 v[4:7], a[72:75], a[156:159], v[4:7]
    s_addc_u32 s75, s13, 0
    v_exp_f32 v17, v17
    v_mfma_f32_16x16x32_bf16 v[4:7], a[76:79], a[160:163], v[4:7]
    ds_read_b64_tr_b16 a[112:113], v223 offset:16384
    v_mfma_f32_16x16x32_bf16 v[8:11], a[72:75], a[172:175], -4.0
    v_exp_f32 v18, v18
    v_mfma_f32_16x16x32_bf16 v[8:11], a[76:79], a[176:179], v[8:11]
    ds_read_b64_tr_b16 a[114:115], v223 offset:18432
    v_cvt_pk_bf16_f32 v46, v16, v17
    v_mfma_f32_16x16x32_bf16 v[8:11], a[64:67], a[164:167], v[8:11]
    s_waitcnt lgkmcnt(3)
    v_exp_f32 v19, v19
    v_mfma_f32_16x16x32_bf16 v[8:11], a[68:71], a[168:171], v[8:11]
    global_load_lds_dwordx4 v226, s[72:73] offset:2048 nt
    v_mfma_f32_16x16x32_bf16 v[12:15], a[64:67], a[180:183], -4.0
    v_exp_f32 v4, v4
    v_mfma_f32_16x16x32_bf16 v[12:15], a[68:71], a[184:187], v[12:15]
    ds_read_b128 a[84:87], v213 offset:20480
    v_cvt_pk_bf16_f32 v47, v18, v19
    v_mfma_f32_16x16x32_bf16 v[12:15], a[72:75], a[188:191], v[12:15]
    v_exp_f32 v5, v5
    v_mfma_f32_16x16x32_bf16 v[12:15], a[76:79], a[192:195], v[12:15]
    ds_read_b64_tr_b16 a[116:117], v223 offset:20480
    v_mfma_f32_16x16x32_bf16 v[16:19], a[72:75], a[204:207], -4.0
    v_exp_f32 v6, v6
    v_mfma_f32_16x16x32_bf16 v[16:19], a[76:79], a[208:211], v[16:19]
    ds_read_b64_tr_b16 a[118:119], v223 offset:22528
    v_cvt_pk_bf16_f32 v24, v4, v5
    v_mfma_f32_16x16x32_bf16 v[16:19], a[64:67], a[196:199], v[16:19]
    v_exp_f32 v7, v7
    v_mfma_f32_16x16x32_bf16 v[16:19], a[68:71], a[200:203], v[16:19]
    global_load_lds_dwordx4 v227, s[72:73] offset:3072 nt
    v_mfma_f32_16x16x32_bf16 v[164:167], v[84:87], a[96:99], v[164:167]
    v_exp_f32 v8, v8
    v_mfma_f32_16x16x32_bf16 v[164:167], v[88:91], a[100:103], v[164:167]
    ds_read_b128 a[88:91], v214 offset:20480
    v_cvt_pk_bf16_f32 v25, v6, v7
    v_mfma_f32_16x16x32_bf16 v[164:167], v[116:119], a[104:107], v[164:167]
    v_exp_f32 v9, v9
    v_mfma_f32_16x16x32_bf16 v[164:167], v[120:123], a[108:111], v[164:167]
    ds_read_b64_tr_b16 a[120:121], v223 offset:24576
    v_mfma_f32_16x16x32_bf16 v[168:171], v[124:127], a[104:107], v[168:171]
    s_add_u32 m0, s31, 0x0
    v_exp_f32 v10, v10
    v_mfma_f32_16x16x32_bf16 v[168:171], v[128:131], a[108:111], v[168:171]
    ds_read_b64_tr_b16 a[122:123], v223 offset:26624
    v_cvt_pk_bf16_f32 v32, v8, v9
    v_mfma_f32_16x16x32_bf16 v[168:171], v[92:95], a[96:99], v[168:171]
    v_exp_f32 v11, v11
    v_mfma_f32_16x16x32_bf16 v[168:171], v[96:99], a[100:103], v[168:171]
    global_load_lds_dwordx4 v228, s[74:75] nt
    v_mfma_f32_16x16x32_bf16 a[16:19], v[100:103], a[96:99], a[16:19]
    ds_read_b128 a[92:95], v215 offset:20480
    v_cvt_pk_bf16_f32 v33, v10, v11
    v_mfma_f32_16x16x32_bf16 a[16:19], v[104:107], a[100:103], a[16:19]
    ds_read_b64_tr_b16 a[124:125], v223 offset:28672
    v_mfma_f32_16x16x32_bf16 a[16:19], v[132:135], a[104:107], a[16:19]
    ds_read_b64_tr_b16 a[126:127], v223 offset:30720
    v_mfma_f32_16x16x32_bf16 a[16:19], v[136:139], a[108:111], a[16:19]
    global_load_lds_dwordx4 v229, s[74:75] offset:1024 nt
    v_mfma_f32_16x16x32_bf16 a[20:23], v[140:143], a[104:107], a[20:23]
    s_add_u32 s32, s66, 0x68000
    v_exp_f32 v12, v12
    v_mfma_f32_16x16x32_bf16 a[20:23], v[144:147], a[108:111], a[20:23]
    s_and_b32 s32, s32, 0x7ffff
    v_exp_f32 v13, v13
    v_mfma_f32_16x16x32_bf16 a[20:23], v[108:111], a[96:99], a[20:23]
    v_exp_f32 v14, v14
    v_mfma_f32_16x16x32_bf16 a[20:23], v[112:115], a[100:103], a[20:23]
    s_waitcnt vmcnt(10) lgkmcnt(0)
    v_exp_f32 v15, v15
    v_smfmac_f32_16x16x64_bf16 a[136:139], a[144:147], v[132:139], v236
    s_barrier
    v_mfma_f32_16x16x32_bf16 v[4:7], a[80:83], a[148:151], -4.0
    s_add_u32 s72, s14, s32
    v_exp_f32 v16, v16
    v_mfma_f32_16x16x32_bf16 v[4:7], a[84:87], a[152:155], v[4:7]
    ds_read_b128 a[64:67], v212 offset:32768
    v_cvt_pk_bf16_f32 v41, v14, v15
    v_mfma_f32_16x16x32_bf16 v[4:7], a[88:91], a[156:159], v[4:7]
    s_addc_u32 s73, s15, 0
    v_exp_f32 v17, v17
    v_mfma_f32_16x16x32_bf16 v[4:7], a[92:95], a[160:163], v[4:7]
    ds_read_b64_tr_b16 a[96:97], v220 offset:32768
    v_cvt_pk_bf16_f32 v40, v12, v13
    v_mfma_f32_16x16x32_bf16 v[8:11], a[88:91], a[172:175], -4.0
    v_exp_f32 v18, v18
    v_mfma_f32_16x16x32_bf16 v[8:11], a[92:95], a[176:179], v[8:11]
    ds_read_b64_tr_b16 a[98:99], v220 offset:34816
    v_cvt_pk_bf16_f32 v48, v16, v17
    v_mfma_f32_16x16x32_bf16 v[8:11], a[80:83], a[164:167], v[8:11]
    v_exp_f32 v19, v19
    v_mfma_f32_16x16x32_bf16 v[8:11], a[84:87], a[168:171], v[8:11]
    global_load_lds_dwordx4 v228, s[74:75] offset:2048 nt
    v_mfma_f32_16x16x32_bf16 v[12:15], a[80:83], a[180:183], -4.0
    v_exp_f32 v4, v4
    v_mfma_f32_16x16x32_bf16 v[12:15], a[84:87], a[184:187], v[12:15]
    ds_read_b128 a[68:71], v213 offset:32768
    v_cvt_pk_bf16_f32 v49, v18, v19
    v_mfma_f32_16x16x32_bf16 v[12:15], a[88:91], a[188:191], v[12:15]
    v_exp_f32 v5, v5
    v_mfma_f32_16x16x32_bf16 v[12:15], a[92:95], a[192:195], v[12:15]
    ds_read_b64_tr_b16 a[100:101], v220 offset:36864
    v_mfma_f32_16x16x32_bf16 v[16:19], a[88:91], a[204:207], -4.0
    v_exp_f32 v6, v6
    v_mfma_f32_16x16x32_bf16 v[16:19], a[92:95], a[208:211], v[16:19]
    ds_read_b64_tr_b16 a[102:103], v220 offset:38912
    v_cvt_pk_bf16_f32 v26, v4, v5
    v_mfma_f32_16x16x32_bf16 v[16:19], a[80:83], a[196:199], v[16:19]
    v_exp_f32 v7, v7
    v_mfma_f32_16x16x32_bf16 v[16:19], a[84:87], a[200:203], v[16:19]
    global_load_lds_dwordx4 v229, s[74:75] offset:3072 nt
    v_mfma_f32_16x16x32_bf16 v[172:175], v[84:87], a[112:115], v[172:175]
    v_exp_f32 v8, v8
    v_mfma_f32_16x16x32_bf16 v[172:175], v[88:91], a[116:119], v[172:175]
    ds_read_b128 a[72:75], v214 offset:32768
    v_cvt_pk_bf16_f32 v27, v6, v7
    v_mfma_f32_16x16x32_bf16 v[172:175], v[116:119], a[120:123], v[172:175]
    v_exp_f32 v9, v9
    v_mfma_f32_16x16x32_bf16 v[172:175], v[120:123], a[124:127], v[172:175]
    ds_read_b64_tr_b16 a[104:105], v220 offset:40960
    v_mfma_f32_16x16x32_bf16 v[176:179], v[124:127], a[120:123], v[176:179]
    s_add_u32 m0, s33, 0x2000
    v_exp_f32 v10, v10
    v_mfma_f32_16x16x32_bf16 v[176:179], v[128:131], a[124:127], v[176:179]
    ds_read_b64_tr_b16 a[106:107], v220 offset:43008
    v_cvt_pk_bf16_f32 v34, v8, v9
    v_mfma_f32_16x16x32_bf16 v[176:179], v[92:95], a[112:115], v[176:179]
    v_exp_f32 v11, v11
    v_mfma_f32_16x16x32_bf16 v[176:179], v[96:99], a[116:119], v[176:179]
    global_load_lds_dwordx4 v224, s[72:73] nt
    v_mfma_f32_16x16x32_bf16 a[24:27], v[100:103], a[112:115], a[24:27]
    s_add_u32 s32, s65, 0x70000
    v_exp_f32 v12, v12
    v_mfma_f32_16x16x32_bf16 a[24:27], v[104:107], a[116:119], a[24:27]
    ds_read_b128 a[76:79], v215 offset:32768
    v_cvt_pk_bf16_f32 v35, v10, v11
    v_mfma_f32_16x16x32_bf16 a[24:27], v[132:135], a[120:123], a[24:27]
    s_and_b32 s32, s32, 0x7ffff
    v_exp_f32 v13, v13
    v_mfma_f32_16x16x32_bf16 a[24:27], v[136:139], a[124:127], a[24:27]
    ds_read_b64_tr_b16 a[108:109], v220 offset:45056
    v_mfma_f32_16x16x32_bf16 a[28:31], v[140:143], a[120:123], a[28:31]
    v_exp_f32 v14, v14
    v_mfma_f32_16x16x32_bf16 a[28:31], v[144:147], a[124:127], a[28:31]
    ds_read_b64_tr_b16 a[110:111], v220 offset:47104
    v_cvt_pk_bf16_f32 v42, v12, v13
    v_mfma_f32_16x16x32_bf16 a[28:31], v[108:111], a[112:115], a[28:31]
    s_waitcnt lgkmcnt(2)
    v_exp_f32 v15, v15
    v_mfma_f32_16x16x32_bf16 a[28:31], v[112:115], a[116:119], a[28:31]
    global_load_lds_dwordx4 v225, s[72:73] offset:1024 nt
    v_smfmac_f32_16x16x64_bf16 a[140:143], a[144:147], v[140:147], v236
    v_mfma_f32_16x16x32_bf16 v[4:7], a[64:67], a[148:151], -4.0
    s_add_u32 s74, s12, s32
    v_exp_f32 v16, v16
    v_mfma_f32_16x16x32_bf16 v[4:7], a[68:71], a[152:155], v[4:7]
    ds_read_b128 a[80:83], v212 offset:36864
    v_cvt_pk_bf16_f32 v43, v14, v15
    v_mfma_f32_16x16x32_bf16 v[4:7], a[72:75], a[156:159], v[4:7]
    s_addc_u32 s75, s13, 0
    v_exp_f32 v17, v17
    v_mfma_f32_16x16x32_bf16 v[4:7], a[76:79], a[160:163], v[4:7]
    ds_read_b64_tr_b16 a[112:113], v221 offset:32768
    v_mfma_f32_16x16x32_bf16 v[8:11], a[72:75], a[172:175], -4.0
    v_exp_f32 v18, v18
    v_mfma_f32_16x16x32_bf16 v[8:11], a[76:79], a[176:179], v[8:11]
    ds_read_b64_tr_b16 a[114:115], v221 offset:34816
    v_cvt_pk_bf16_f32 v50, v16, v17
    v_mfma_f32_16x16x32_bf16 v[8:11], a[64:67], a[164:167], v[8:11]
    s_waitcnt lgkmcnt(3)
    v_exp_f32 v19, v19
    v_mfma_f32_16x16x32_bf16 v[8:11], a[68:71], a[168:171], v[8:11]
    global_load_lds_dwordx4 v226, s[72:73] offset:2048 nt
    v_mfma_f32_16x16x32_bf16 v[12:15], a[64:67], a[180:183], -4.0
    v_exp_f32 v4, v4
    v_mfma_f32_16x16x32_bf16 v[12:15], a[68:71], a[184:187], v[12:15]
    ds_read_b128 a[84:87], v213 offset:36864
    v_cvt_pk_bf16_f32 v51, v18, v19
    v_mfma_f32_16x16x32_bf16 v[12:15], a[72:75], a[188:191], v[12:15]
    v_exp_f32 v5, v5
    v_mfma_f32_16x16x32_bf16 v[12:15], a[76:79], a[192:195], v[12:15]
    ds_read_b64_tr_b16 a[116:117], v221 offset:36864
    v_mfma_f32_16x16x32_bf16 v[16:19], a[72:75], a[204:207], -4.0
    v_exp_f32 v6, v6
    v_mfma_f32_16x16x32_bf16 v[16:19], a[76:79], a[208:211], v[16:19]
    ds_read_b64_tr_b16 a[118:119], v221 offset:38912
    v_cvt_pk_bf16_f32 v52, v4, v5
    v_mfma_f32_16x16x32_bf16 v[16:19], a[64:67], a[196:199], v[16:19]
    v_exp_f32 v7, v7
    v_mfma_f32_16x16x32_bf16 v[16:19], a[68:71], a[200:203], v[16:19]
    global_load_lds_dwordx4 v227, s[72:73] offset:3072 nt
    v_mfma_f32_16x16x32_bf16 v[180:183], v[84:87], a[96:99], v[180:183]
    v_exp_f32 v8, v8
    v_mfma_f32_16x16x32_bf16 v[180:183], v[88:91], a[100:103], v[180:183]
    ds_read_b128 a[88:91], v214 offset:36864
    v_cvt_pk_bf16_f32 v53, v6, v7
    v_mfma_f32_16x16x32_bf16 v[180:183], v[116:119], a[104:107], v[180:183]
    v_exp_f32 v9, v9
    v_mfma_f32_16x16x32_bf16 v[180:183], v[120:123], a[108:111], v[180:183]
    ds_read_b64_tr_b16 a[120:121], v221 offset:40960
    v_mfma_f32_16x16x32_bf16 v[184:187], v[124:127], a[104:107], v[184:187]
    s_add_u32 m0, s31, 0x4000
    v_exp_f32 v10, v10
    v_mfma_f32_16x16x32_bf16 v[184:187], v[128:131], a[108:111], v[184:187]
    ds_read_b64_tr_b16 a[122:123], v221 offset:43008
    v_cvt_pk_bf16_f32 v60, v8, v9
    v_mfma_f32_16x16x32_bf16 v[184:187], v[92:95], a[96:99], v[184:187]
    v_exp_f32 v11, v11
    v_mfma_f32_16x16x32_bf16 v[184:187], v[96:99], a[100:103], v[184:187]
    global_load_lds_dwordx4 v228, s[74:75] nt
    v_mfma_f32_16x16x32_bf16 a[32:35], v[100:103], a[96:99], a[32:35]
    ds_read_b128 a[92:95], v215 offset:36864
    v_cvt_pk_bf16_f32 v61, v10, v11
    v_mfma_f32_16x16x32_bf16 a[32:35], v[104:107], a[100:103], a[32:35]
    ds_read_b64_tr_b16 a[124:125], v221 offset:45056
    v_mfma_f32_16x16x32_bf16 a[32:35], v[132:135], a[104:107], a[32:35]
    ds_read_b64_tr_b16 a[126:127], v221 offset:47104
    v_mfma_f32_16x16x32_bf16 a[32:35], v[136:139], a[108:111], a[32:35]
    global_load_lds_dwordx4 v229, s[74:75] offset:1024 nt
    v_mfma_f32_16x16x32_bf16 a[36:39], v[140:143], a[104:107], a[36:39]
    s_add_u32 s32, s67, 0x60000
    v_exp_f32 v12, v12
    v_mfma_f32_16x16x32_bf16 a[36:39], v[144:147], a[108:111], a[36:39]
    s_and_b32 s32, s32, 0x7ffff
    v_exp_f32 v13, v13
    v_mfma_f32_16x16x32_bf16 a[36:39], v[108:111], a[96:99], a[36:39]
L_stub7:
    s_cbranch_execz L_back
    v_exp_f32 v14, v14
    v_mfma_f32_16x16x32_bf16 a[36:39], v[112:115], a[100:103], a[36:39]
    s_waitcnt vmcnt(14) lgkmcnt(0)
    v_exp_f32 v15, v15
    v_smfmac_f32_16x16x64_bf16 a[128:131], a[144:147], v[20:27], v236
    s_barrier
    v_mfma_f32_16x16x32_bf16 v[4:7], a[80:83], a[148:151], -4.0
    s_add_u32 s72, s14, s32
    v_exp_f32 v16, v16
    v_mfma_f32_16x16x32_bf16 v[4:7], a[84:87], a[152:155], v[4:7]
    ds_read_b128 a[64:67], v212 offset:49152
    v_cvt_pk_bf16_f32 v69, v14, v15
    v_mfma_f32_16x16x32_bf16 v[4:7], a[88:91], a[156:159], v[4:7]
    s_addc_u32 s73, s15, 0
    v_exp_f32 v17, v17
    v_mfma_f32_16x16x32_bf16 v[4:7], a[92:95], a[160:163], v[4:7]
    ds_read_b64_tr_b16 a[96:97], v222 offset:32768
    v_cvt_pk_bf16_f32 v68, v12, v13
    v_mfma_f32_16x16x32_bf16 v[8:11], a[88:91], a[172:175], -4.0
    v_exp_f32 v18, v18
    v_mfma_f32_16x16x32_bf16 v[8:11], a[92:95], a[176:179], v[8:11]
    ds_read_b64_tr_b16 a[98:99], v222 offset:34816
    v_cvt_pk_bf16_f32 v76, v16, v17
    v_mfma_f32_16x16x32_bf16 v[8:11], a[80:83], a[164:167], v[8:11]
    v_exp_f32 v19, v19
    v_mfma_f32_16x16x32_bf16 v[8:11], a[84:87], a[168:171], v[8:11]
    global_load_lds_dwordx4 v228, s[74:75] offset:2048 nt
    v_mfma_f32_16x16x32_bf16 v[12:15], a[80:83], a[180:183], -4.0
    v_exp_f32 v4, v4
    v_mfma_f32_16x16x32_bf16 v[12:15], a[84:87], a[184:187], v[12:15]
    ds_read_b128 a[68:71], v213 offset:49152
    v_cvt_pk_bf16_f32 v77, v18, v19
    v_mfma_f32_16x16x32_bf16 v[12:15], a[88:91], a[188:191], v[12:15]
    v_exp_f32 v5, v5
    v_mfma_f32_16x16x32_bf16 v[12:15], a[92:95], a[192:195], v[12:15]
    ds_read_b64_tr_b16 a[100:101], v222 offset:36864
    v_mfma_f32_16x16x32_bf16 v[16:19], a[88:91], a[204:207], -4.0
    v_exp_f32 v6, v6
    v_mfma_f32_16x16x32_bf16 v[16:19], a[92:95], a[208:211], v[16:19]
    ds_read_b64_tr_b16 a[102:103], v222 offset:38912
    v_cvt_pk_bf16_f32 v54, v4, v5
    v_mfma_f32_16x16x32_bf16 v[16:19], a[80:83], a[196:199], v[16:19]
    v_exp_f32 v7, v7
    v_mfma_f32_16x16x32_bf16 v[16:19], a[84:87], a[200:203], v[16:19]
    global_load_lds_dwordx4 v229, s[74:75] offset:3072 nt
    v_mfma_f32_16x16x32_bf16 v[188:191], v[84:87], a[112:115], v[188:191]
    v_exp_f32 v8, v8
    v_mfma_f32_16x16x32_bf16 v[188:191], v[88:91], a[116:119], v[188:191]
    ds_read_b128 a[72:75], v214 offset:49152
    v_cvt_pk_bf16_f32 v55, v6, v7
    v_mfma_f32_16x16x32_bf16 v[188:191], v[116:119], a[120:123], v[188:191]
    v_exp_f32 v9, v9
    v_mfma_f32_16x16x32_bf16 v[188:191], v[120:123], a[124:127], v[188:191]
    ds_read_b64_tr_b16 a[104:105], v222 offset:40960
    v_mfma_f32_16x16x32_bf16 v[192:195], v[124:127], a[120:123], v[192:195]
    s_add_u32 m0, s33, 0x4000
    v_exp_f32 v10, v10
    v_mfma_f32_16x16x32_bf16 v[192:195], v[128:131], a[124:127], v[192:195]
    ds_read_b64_tr_b16 a[106:107], v222 offset:43008
    v_cvt_pk_bf16_f32 v62, v8, v9
    v_mfma_f32_16x16x32_bf16 v[192:195], v[92:95], a[112:115], v[192:195]
    v_exp_f32 v11, v11
    v_mfma_f32_16x16x32_bf16 v[192:195], v[96:99], a[116:119], v[192:195]
    global_load_lds_dwordx4 v224, s[72:73] nt
    v_mfma_f32_16x16x32_bf16 a[40:43], v[100:103], a[112:115], a[40:43]
    s_add_u32 s32, s64, 0x78000
    v_exp_f32 v12, v12
    v_mfma_f32_16x16x32_bf16 a[40:43], v[104:107], a[116:119], a[40:43]
    ds_read_b128 a[76:79], v215 offset:49152
    v_cvt_pk_bf16_f32 v63, v10, v11
    v_mfma_f32_16x16x32_bf16 a[40:43], v[132:135], a[120:123], a[40:43]
    s_and_b32 s32, s32, 0x7ffff
    v_exp_f32 v13, v13
    v_mfma_f32_16x16x32_bf16 a[40:43], v[136:139], a[124:127], a[40:43]
    ds_read_b64_tr_b16 a[108:109], v222 offset:45056
    v_mfma_f32_16x16x32_bf16 a[44:47], v[140:143], a[120:123], a[44:47]
    v_exp_f32 v14, v14
    v_mfma_f32_16x16x32_bf16 a[44:47], v[144:147], a[124:127], a[44:47]
    ds_read_b64_tr_b16 a[110:111], v222 offset:47104
    v_cvt_pk_bf16_f32 v70, v12, v13
    v_mfma_f32_16x16x32_bf16 a[44:47], v[108:111], a[112:115], a[44:47]
    s_waitcnt lgkmcnt(2)
    v_exp_f32 v15, v15
    v_mfma_f32_16x16x32_bf16 a[44:47], v[112:115], a[116:119], a[44:47]
    global_load_lds_dwordx4 v225, s[72:73] offset:1024 nt
    v_smfmac_f32_16x16x64_bf16 a[132:135], a[144:147], v[28:35], v236
    v_mfma_f32_16x16x32_bf16 v[4:7], a[64:67], a[148:151], -4.0
    s_add_u32 s74, s12, s32
    v_exp_f32 v16, v16
    v_mfma_f32_16x16x32_bf16 v[4:7], a[68:71], a[152:155], v[4:7]
    ds_read_b128 a[80:83], v212 offset:53248
    v_cvt_pk_bf16_f32 v71, v14, v15
    v_mfma_f32_16x16x32_bf16 v[4:7], a[72:75], a[156:159], v[4:7]
    s_addc_u32 s75, s13, 0
    v_exp_f32 v17, v17
    v_mfma_f32_16x16x32_bf16 v[4:7], a[76:79], a[160:163], v[4:7]
    ds_read_b64_tr_b16 a[112:113], v223 offset:32768
    v_mfma_f32_16x16x32_bf16 v[8:11], a[72:75], a[172:175], -4.0
    v_exp_f32 v18, v18
    v_mfma_f32_16x16x32_bf16 v[8:11], a[76:79], a[176:179], v[8:11]
    ds_read_b64_tr_b16 a[114:115], v223 offset:34816
    v_cvt_pk_bf16_f32 v78, v16, v17
    v_mfma_f32_16x16x32_bf16 v[8:11], a[64:67], a[164:167], v[8:11]
    s_waitcnt lgkmcnt(3)
    v_exp_f32 v19, v19
    v_mfma_f32_16x16x32_bf16 v[8:11], a[68:71], a[168:171], v[8:11]
    global_load_lds_dwordx4 v226, s[72:73] offset:2048 nt
    v_mfma_f32_16x16x32_bf16 v[12:15], a[64:67], a[180:183], -4.0
    v_exp_f32 v4, v4
    v_mfma_f32_16x16x32_bf16 v[12:15], a[68:71], a[184:187], v[12:15]
    ds_read_b128 a[84:87], v213 offset:53248
    v_cvt_pk_bf16_f32 v79, v18, v19
    v_mfma_f32_16x16x32_bf16 v[12:15], a[72:75], a[188:191], v[12:15]
    v_exp_f32 v5, v5
    v_mfma_f32_16x16x32_bf16 v[12:15], a[76:79], a[192:195], v[12:15]
    ds_read_b64_tr_b16 a[116:117], v223 offset:36864
    v_mfma_f32_16x16x32_bf16 v[16:19], a[72:75], a[204:207], -4.0
    v_exp_f32 v6, v6
    v_mfma_f32_16x16x32_bf16 v[16:19], a[76:79], a[208:211], v[16:19]
    ds_read_b64_tr_b16 a[118:119], v223 offset:38912
    v_cvt_pk_bf16_f32 v56, v4, v5
    v_mfma_f32_16x16x32_bf16 v[16:19], a[64:67], a[196:199], v[16:19]
    v_exp_f32 v7, v7
    v_mfma_f32_16x16x32_bf16 v[16:19], a[68:71], a[200:203], v[16:19]
    global_load_lds_dwordx4 v227, s[72:73] offset:3072 nt
    v_mfma_f32_16x16x32_bf16 v[196:199], v[84:87], a[96:99], v[196:199]
    v_exp_f32 v8, v8
    v_mfma_f32_16x16x32_bf16 v[196:199], v[88:91], a[100:103], v[196:199]
    ds_read_b128 a[88:91], v214 offset:53248
    v_cvt_pk_bf16_f32 v57, v6, v7
    v_mfma_f32_16x16x32_bf16 v[196:199], v[116:119], a[104:107], v[196:199]
    v_exp_f32 v9, v9
    v_mfma_f32_16x16x32_bf16 v[196:199], v[120:123], a[108:111], v[196:199]
    ds_read_b64_tr_b16 a[120:121], v223 offset:40960
    v_mfma_f32_16x16x32_bf16 v[200:203], v[124:127], a[104:107], v[200:203]
    s_add_u32 m0, s31, 0x8000
    v_exp_f32 v10, v10
    v_mfma_f32_16x16x32_bf16 v[200:203], v[128:131], a[108:111], v[200:203]
    ds_read_b64_tr_b16 a[122:123], v223 offset:43008
    v_cvt_pk_bf16_f32 v64, v8, v9
    v_mfma_f32_16x16x32_bf16 v[200:203], v[92:95], a[96:99], v[200:203]
    v_exp_f32 v11, v11
    v_mfma_f32_16x16x32_bf16 v[200:203], v[96:99], a[100:103], v[200:203]
    global_load_lds_dwordx4 v228, s[74:75] nt
    v_mfma_f32_16x16x32_bf16 a[48:51], v[100:103], a[96:99], a[48:51]
    ds_read_b128 a[92:95], v215 offset:53248
    v_cvt_pk_bf16_f32 v65, v10, v11
    v_mfma_f32_16x16x32_bf16 a[48:51], v[104:107], a[100:103], a[48:51]
    ds_read_b64_tr_b16 a[124:125], v223 offset:45056
    v_mfma_f32_16x16x32_bf16 a[48:51], v[132:135], a[104:107], a[48:51]
    ds_read_b64_tr_b16 a[126:127], v223 offset:47104
    v_mfma_f32_16x16x32_bf16 a[48:51], v[136:139], a[108:111], a[48:51]
    global_load_lds_dwordx4 v229, s[74:75] offset:1024 nt
    v_mfma_f32_16x16x32_bf16 a[52:55], v[140:143], a[104:107], a[52:55]
    s_add_u32 s32, s67, 0x68000
    v_exp_f32 v12, v12
    v_mfma_f32_16x16x32_bf16 a[52:55], v[144:147], a[108:111], a[52:55]
    s_and_b32 s32, s32, 0x7ffff
    v_exp_f32 v13, v13
    v_mfma_f32_16x16x32_bf16 a[52:55], v[108:111], a[96:99], a[52:55]
    v_exp_f32 v14, v14
    v_mfma_f32_16x16x32_bf16 a[52:55], v[112:115], a[100:103], a[52:55]
    s_waitcnt vmcnt(10) lgkmcnt(0)
    v_exp_f32 v15, v15
    v_smfmac_f32_16x16x64_bf16 a[136:139], a[144:147], v[36:43], v236
    s_barrier
    v_mfma_f32_16x16x32_bf16 v[4:7], a[80:83], a[148:151], -4.0
    s_add_u32 s72, s14, s32
    v_exp_f32 v16, v16
    v_mfma_f32_16x16x32_bf16 v[4:7], a[84:87], a[152:155], v[4:7]
    ds_read_b128 a[64:67], v212
    v_cvt_pk_bf16_f32 v73, v14, v15
    v_mfma_f32_16x16x32_bf16 v[4:7], a[88:91], a[156:159], v[4:7]
    s_addc_u32 s73, s15, 0
    v_exp_f32 v17, v17
    v_mfma_f32_16x16x32_bf16 v[4:7], a[92:95], a[160:163], v[4:7]
    ds_read_b64_tr_b16 a[96:97], v220
    v_cvt_pk_bf16_f32 v72, v12, v13
    v_mfma_f32_16x16x32_bf16 v[8:11], a[88:91], a[172:175], -4.0
    v_exp_f32 v18, v18
    v_mfma_f32_16x16x32_bf16 v[8:11], a[92:95], a[176:179], v[8:11]
    ds_read_b64_tr_b16 a[98:99], v220 offset:2048
    v_cvt_pk_bf16_f32 v80, v16, v17
    v_mfma_f32_16x16x32_bf16 v[8:11], a[80:83], a[164:167], v[8:11]
    v_exp_f32 v19, v19
    v_mfma_f32_16x16x32_bf16 v[8:11], a[84:87], a[168:171], v[8:11]
    global_load_lds_dwordx4 v228, s[74:75] offset:2048 nt
    v_mfma_f32_16x16x32_bf16 v[12:15], a[80:83], a[180:183], -4.0
    v_exp_f32 v4, v4
    v_mfma_f32_16x16x32_bf16 v[12:15], a[84:87], a[184:187], v[12:15]
    ds_read_b128 a[68:71], v213
    v_cvt_pk_bf16_f32 v81, v18, v19
    v_mfma_f32_16x16x32_bf16 v[12:15], a[88:91], a[188:191], v[12:15]
    v_exp_f32 v5, v5
    v_mfma_f32_16x16x32_bf16 v[12:15], a[92:95], a[192:195], v[12:15]
    ds_read_b64_tr_b16 a[100:101], v220 offset:4096
    v_mfma_f32_16x16x32_bf16 v[16:19], a[88:91], a[204:207], -4.0
    v_exp_f32 v6, v6
    v_mfma_f32_16x16x32_bf16 v[16:19], a[92:95], a[208:211], v[16:19]
    ds_read_b64_tr_b16 a[102:103], v220 offset:6144
    v_cvt_pk_bf16_f32 v58, v4, v5
    v_mfma_f32_16x16x32_bf16 v[16:19], a[80:83], a[196:199], v[16:19]
    v_exp_f32 v7, v7
    v_mfma_f32_16x16x32_bf16 v[16:19], a[84:87], a[200:203], v[16:19]
    global_load_lds_dwordx4 v229, s[74:75] offset:3072 nt
    v_mfma_f32_16x16x32_bf16 v[204:207], v[84:87], a[112:115], v[204:207]
    v_exp_f32 v8, v8
    v_mfma_f32_16x16x32_bf16 v[204:207], v[88:91], a[116:119], v[204:207]
    ds_read_b128 a[72:75], v214
    v_cvt_pk_bf16_f32 v59, v6, v7
    v_mfma_f32_16x16x32_bf16 v[204:207], v[116:119], a[120:123], v[204:207]
    v_exp_f32 v9, v9
    v_mfma_f32_16x16x32_bf16 v[204:207], v[120:123], a[124:127], v[204:207]
    ds_read_b64_tr_b16 a[104:105], v220 offset:8192
    v_mfma_f32_16x16x32_bf16 v[208:211], v[124:127], a[120:123], v[208:211]
    s_add_u32 m0, s33, 0x6000
    v_exp_f32 v10, v10
    v_mfma_f32_16x16x32_bf16 v[208:211], v[128:131], a[124:127], v[208:211]
    ds_read_b64_tr_b16 a[106:107], v220 offset:10240
    v_cvt_pk_bf16_f32 v66, v8, v9
    v_mfma_f32_16x16x32_bf16 v[208:211], v[92:95], a[112:115], v[208:211]
    v_exp_f32 v11, v11
    v_mfma_f32_16x16x32_bf16 v[208:211], v[96:99], a[116:119], v[208:211]
    global_load_lds_dwordx4 v224, s[72:73] nt
    v_mfma_f32_16x16x32_bf16 a[56:59], v[100:103], a[112:115], a[56:59]
    s_add_u32 s32, s65, 0x78000
    v_exp_f32 v12, v12
    v_mfma_f32_16x16x32_bf16 a[56:59], v[104:107], a[116:119], a[56:59]
    ds_read_b128 a[76:79], v215
    v_cvt_pk_bf16_f32 v67, v10, v11
    v_mfma_f32_16x16x32_bf16 a[56:59], v[132:135], a[120:123], a[56:59]
    s_and_b32 s32, s32, 0x7ffff
    v_exp_f32 v13, v13
    v_mfma_f32_16x16x32_bf16 a[56:59], v[136:139], a[124:127], a[56:59]
    ds_read_b64_tr_b16 a[108:109], v220 offset:12288
    v_mfma_f32_16x16x32_bf16 a[60:63], v[140:143], a[120:123], a[60:63]
    v_exp_f32 v14, v14
    v_mfma_f32_16x16x32_bf16 a[60:63], v[144:147], a[124:127], a[60:63]
    ds_read_b64_tr_b16 a[110:111], v220 offset:14336
    v_cvt_pk_bf16_f32 v74, v12, v13
    v_mfma_f32_16x16x32_bf16 a[60:63], v[108:111], a[112:115], a[60:63]
    s_waitcnt lgkmcnt(2)
    v_exp_f32 v15, v15
    v_mfma_f32_16x16x32_bf16 a[60:63], v[112:115], a[116:119], a[60:63]
    global_load_lds_dwordx4 v225, s[72:73] offset:1024 nt
    v_smfmac_f32_16x16x64_bf16 a[140:143], a[144:147], v[44:51], v236
    v_mfma_f32_16x16x32_bf16 v[4:7], a[64:67], a[148:151], -4.0
    s_add_u32 s74, s12, s32
    v_exp_f32 v16, v16
    v_mfma_f32_16x16x32_bf16 v[4:7], a[68:71], a[152:155], v[4:7]
    ds_read_b128 a[80:83], v212 offset:4096
    v_cvt_pk_bf16_f32 v75, v14, v15
    v_mfma_f32_16x16x32_bf16 v[4:7], a[72:75], a[156:159], v[4:7]
    s_addc_u32 s75, s13, 0
    v_exp_f32 v17, v17
    v_mfma_f32_16x16x32_bf16 v[4:7], a[76:79], a[160:163], v[4:7]
    ds_read_b64_tr_b16 a[112:113], v221
    v_mfma_f32_16x16x32_bf16 v[8:11], a[72:75], a[172:175], -4.0
    v_exp_f32 v18, v18
    v_mfma_f32_16x16x32_bf16 v[8:11], a[76:79], a[176:179], v[8:11]
    ds_read_b64_tr_b16 a[114:115], v221 offset:2048
    v_cvt_pk_bf16_f32 v82, v16, v17
    v_mfma_f32_16x16x32_bf16 v[8:11], a[64:67], a[164:167], v[8:11]
    s_waitcnt lgkmcnt(3)
    v_exp_f32 v19, v19
    v_mfma_f32_16x16x32_bf16 v[8:11], a[68:71], a[168:171], v[8:11]
    global_load_lds_dwordx4 v226, s[72:73] offset:2048 nt
    v_mfma_f32_16x16x32_bf16 v[12:15], a[64:67], a[180:183], -4.0
    v_exp_f32 v4, v4
    v_mfma_f32_16x16x32_bf16 v[12:15], a[68:71], a[184:187], v[12:15]
    ds_read_b128 a[84:87], v213 offset:4096
    v_cvt_pk_bf16_f32 v83, v18, v19
    v_mfma_f32_16x16x32_bf16 v[12:15], a[72:75], a[188:191], v[12:15]
    v_exp_f32 v5, v5
    v_mfma_f32_16x16x32_bf16 v[12:15], a[76:79], a[192:195], v[12:15]
    ds_read_b64_tr_b16 a[116:117], v221 offset:4096
    v_mfma_f32_16x16x32_bf16 v[16:19], a[72:75], a[204:207], -4.0
    v_exp_f32 v6, v6
    v_mfma_f32_16x16x32_bf16 v[16:19], a[76:79], a[208:211], v[16:19]
    ds_read_b64_tr_b16 a[118:119], v221 offset:6144
    v_cvt_pk_bf16_f32 v84, v4, v5
    v_mfma_f32_16x16x32_bf16 v[16:19], a[64:67], a[196:199], v[16:19]
    v_exp_f32 v7, v7
    v_mfma_f32_16x16x32_bf16 v[16:19], a[68:71], a[200:203], v[16:19]
    global_load_lds_dwordx4 v227, s[72:73] offset:3072 nt
    v_mfma_f32_16x16x32_bf16 v[148:151], v[20:23], a[96:99], v[148:151]
    v_exp_f32 v8, v8
    v_mfma_f32_16x16x32_bf16 v[148:151], v[24:27], a[100:103], v[148:151]
    ds_read_b128 a[88:91], v214 offset:4096
    v_cvt_pk_bf16_f32 v85, v6, v7
    v_mfma_f32_16x16x32_bf16 v[148:151], v[52:55], a[104:107], v[148:151]
    v_exp_f32 v9, v9
    v_mfma_f32_16x16x32_bf16 v[148:151], v[56:59], a[108:111], v[148:151]
    ds_read_b64_tr_b16 a[120:121], v221 offset:8192
    v_mfma_f32_16x16x32_bf16 v[152:155], v[60:63], a[104:107], v[152:155]
    s_add_u32 m0, s31, 0xc000
    v_exp_f32 v10, v10
    v_mfma_f32_16x16x32_bf16 v[152:155], v[64:67], a[108:111], v[152:155]
    ds_read_b64_tr_b16 a[122:123], v221 offset:10240
    v_cvt_pk_bf16_f32 v92, v8, v9
    v_mfma_f32_16x16x32_bf16 v[152:155], v[28:31], a[96:99], v[152:155]
    v_exp_f32 v11, v11
    v_mfma_f32_16x16x32_bf16 v[152:155], v[32:35], a[100:103], v[152:155]
    global_load_lds_dwordx4 v228, s[74:75] nt
    v_mfma_f32_16x16x32_bf16 a[0:3], v[36:39], a[96:99], a[0:3]
    ds_read_b128 a[92:95], v215 offset:4096
    v_cvt_pk_bf16_f32 v93, v10, v11
    v_mfma_f32_16x16x32_bf16 a[0:3], v[40:43], a[100:103], a[0:3]
    ds_read_b64_tr_b16 a[124:125], v221 offset:12288
    v_mfma_f32_16x16x32_bf16 a[0:3], v[68:71], a[104:107], a[0:3]
    ds_read_b64_tr_b16 a[126:127], v221 offset:14336
    v_mfma_f32_16x16x32_bf16 a[0:3], v[72:75], a[108:111], a[0:3]
    global_load_lds_dwordx4 v229, s[74:75] offset:1024 nt
    v_mfma_f32_16x16x32_bf16 a[4:7], v[76:79], a[104:107], a[4:7]
    s_add_u32 s32, s66, 0x70000
    v_exp_f32 v12, v12
    v_mfma_f32_16x16x32_bf16 a[4:7], v[80:83], a[108:111], a[4:7]
    s_and_b32 s32, s32, 0x7ffff
    v_exp_f32 v13, v13
    v_mfma_f32_16x16x32_bf16 a[4:7], v[44:47], a[96:99], a[4:7]
    v_exp_f32 v14, v14
    v_mfma_f32_16x16x32_bf16 a[4:7], v[48:51], a[100:103], a[4:7]
    s_waitcnt vmcnt(14) lgkmcnt(0)
    v_exp_f32 v15, v15
    v_smfmac_f32_16x16x64_bf16 a[128:131], a[144:147], v[52:59], v236
    s_barrier
    v_mfma_f32_16x16x32_bf16 v[4:7], a[80:83], a[148:151], -4.0
    s_add_u32 s72, s14, s32
    v_exp_f32 v16, v16
    v_mfma_f32_16x16x32_bf16 v[4:7], a[84:87], a[152:155], v[4:7]
    ds_read_b128 a[64:67], v212 offset:16384
    v_cvt_pk_bf16_f32 v101, v14, v15
    v_mfma_f32_16x16x32_bf16 v[4:7], a[88:91], a[156:159], v[4:7]
    s_addc_u32 s73, s15, 0
    v_exp_f32 v17, v17
    v_mfma_f32_16x16x32_bf16 v[4:7], a[92:95], a[160:163], v[4:7]
    ds_read_b64_tr_b16 a[96:97], v222
    v_cvt_pk_bf16_f32 v100, v12, v13
    v_mfma_f32_16x16x32_bf16 v[8:11], a[88:91], a[172:175], -4.0
    v_exp_f32 v18, v18
    v_mfma_f32_16x16x32_bf16 v[8:11], a[92:95], a[176:179], v[8:11]
    ds_read_b64_tr_b16 a[98:99], v222 offset:2048
    v_cvt_pk_bf16_f32 v108, v16, v17
    v_mfma_f32_16x16x32_bf16 v[8:11], a[80:83], a[164:167], v[8:11]
    v_exp_f32 v19, v19
    v_mfma_f32_16x16x32_bf16 v[8:11], a[84:87], a[168:171], v[8:11]
    global_load_lds_dwordx4 v228, s[74:75] offset:2048 nt
    v_mfma_f32_16x16x32_bf16 v[12:15], a[80:83], a[180:183], -4.0
    v_exp_f32 v4, v4
    v_mfma_f32_16x16x32_bf16 v[12:15], a[84:87], a[184:187], v[12:15]
    ds_read_b128 a[68:71], v213 offset:16384
    v_cvt_pk_bf16_f32 v109, v18, v19
    v_mfma_f32_16x16x32_bf16 v[12:15], a[88:91], a[188:191], v[12:15]
    v_exp_f32 v5, v5
    v_mfma_f32_16x16x32_bf16 v[12:15], a[92:95], a[192:195], v[12:15]
    ds_read_b64_tr_b16 a[100:101], v222 offset:4096
    v_mfma_f32_16x16x32_bf16 v[16:19], a[88:91], a[204:207], -4.0
    v_exp_f32 v6, v6
    v_mfma_f32_16x16x32_bf16 v[16:19], a[92:95], a[208:211], v[16:19]
    ds_read_b64_tr_b16 a[102:103], v222 offset:6144
    v_cvt_pk_bf16_f32 v86, v4, v5
    v_mfma_f32_16x16x32_bf16 v[16:19], a[80:83], a[196:199], v[16:19]
    v_exp_f32 v7, v7
    v_mfma_f32_16x16x32_bf16 v[16:19], a[84:87], a[200:203], v[16:19]
    global_load_lds_dwordx4 v229, s[74:75] offset:3072 nt
    v_mfma_f32_16x16x32_bf16 v[156:159], v[20:23], a[112:115], v[156:159]
    v_exp_f32 v8, v8
    v_mfma_f32_16x16x32_bf16 v[156:159], v[24:27], a[116:119], v[156:159]
    ds_read_b128 a[72:75], v214 offset:16384
    v_cvt_pk_bf16_f32 v87, v6, v7
    v_mfma_f32_16x16x32_bf16 v[156:159], v[52:55], a[120:123], v[156:159]
    v_exp_f32 v9, v9
    v_mfma_f32_16x16x32_bf16 v[156:159], v[56:59], a[124:127], v[156:159]
    ds_read_b64_tr_b16 a[104:105], v222 offset:8192
    v_mfma_f32_16x16x32_bf16 v[160:163], v[60:63], a[120:123], v[160:163]
    s_add_u32 m0, s33, 0x8000
    v_exp_f32 v10, v10
    v_mfma_f32_16x16x32_bf16 v[160:163], v[64:67], a[124:127], v[160:163]
    ds_read_b64_tr_b16 a[106:107], v222 offset:10240
    v_cvt_pk_bf16_f32 v94, v8, v9
    v_mfma_f32_16x16x32_bf16 v[160:163], v[28:31], a[112:115], v[160:163]
    v_exp_f32 v11, v11
    v_mfma_f32_16x16x32_bf16 v[160:163], v[32:35], a[116:119], v[160:163]
    global_load_lds_dwordx4 v224, s[72:73] nt
    v_mfma_f32_16x16x32_bf16 a[8:11], v[36:39], a[112:115], a[8:11]
    s_add_u32 s32, s66, 0x78000
    v_exp_f32 v12, v12
    v_mfma_f32_16x16x32_bf16 a[8:11], v[40:43], a[116:119], a[8:11]
    ds_read_b128 a[76:79], v215 offset:16384
    v_cvt_pk_bf16_f32 v95, v10, v11
    v_mfma_f32_16x16x32_bf16 a[8:11], v[68:71], a[120:123], a[8:11]
    s_and_b32 s32, s32, 0x7ffff
    v_exp_f32 v13, v13
    v_mfma_f32_16x16x32_bf16 a[8:11], v[72:75], a[124:127], a[8:11]
    ds_read_b64_tr_b16 a[108:109], v222 offset:12288
    v_mfma_f32_16x16x32_bf16 a[12:15], v[76:79], a[120:123], a[12:15]
    v_exp_f32 v14, v14
    v_mfma_f32_16x16x32_bf16 a[12:15], v[80:83], a[124:127], a[12:15]
    ds_read_b64_tr_b16 a[110:111], v222 offset:14336
    v_cvt_pk_bf16_f32 v102, v12, v13
    v_mfma_f32_16x16x32_bf16 a[12:15], v[44:47], a[112:115], a[12:15]
    s_waitcnt lgkmcnt(2)
    v_exp_f32 v15, v15
    v_mfma_f32_16x16x32_bf16 a[12:15], v[48:51], a[116:119], a[12:15]
    global_load_lds_dwordx4 v225, s[72:73] offset:1024 nt
    v_smfmac_f32_16x16x64_bf16 a[132:135], a[144:147], v[60:67], v236
    v_mfma_f32_16x16x32_bf16 v[4:7], a[64:67], a[148:151], -4.0
    s_add_u32 s74, s14, s32
    v_exp_f32 v16, v16
    v_mfma_f32_16x16x32_bf16 v[4:7], a[68:71], a[152:155], v[4:7]
    ds_read_b128 a[80:83], v212 offset:20480
    v_cvt_pk_bf16_f32 v103, v14, v15
    v_mfma_f32_16x16x32_bf16 v[4:7], a[72:75], a[156:159], v[4:7]
    s_addc_u32 s75, s15, 0
    v_exp_f32 v17, v17
    v_mfma_f32_16x16x32_bf16 v[4:7], a[76:79], a[160:163], v[4:7]
    ds_read_b64_tr_b16 a[112:113], v223
    v_mfma_f32_16x16x32_bf16 v[8:11], a[72:75], a[172:175], -4.0
    v_exp_f32 v18, v18
    v_mfma_f32_16x16x32_bf16 v[8:11], a[76:79], a[176:179], v[8:11]
    ds_read_b64_tr_b16 a[114:115], v223 offset:2048
    v_cvt_pk_bf16_f32 v110, v16, v17
    v_mfma_f32_16x16x32_bf16 v[8:11], a[64:67], a[164:167], v[8:11]
    s_waitcnt lgkmcnt(3)
    v_exp_f32 v19, v19
    v_mfma_f32_16x16x32_bf16 v[8:11], a[68:71], a[168:171], v[8:11]
    global_load_lds_dwordx4 v226, s[72:73] offset:2048 nt
    v_mfma_f32_16x16x32_bf16 v[12:15], a[64:67], a[180:183], -4.0
    v_exp_f32 v4, v4
    v_mfma_f32_16x16x32_bf16 v[12:15], a[68:71], a[184:187], v[12:15]
    ds_read_b128 a[84:87], v213 offset:20480
    v_cvt_pk_bf16_f32 v111, v18, v19
    v_mfma_f32_16x16x32_bf16 v[12:15], a[72:75], a[188:191], v[12:15]
    v_exp_f32 v5, v5
    v_mfma_f32_16x16x32_bf16 v[12:15], a[76:79], a[192:195], v[12:15]
    ds_read_b64_tr_b16 a[116:117], v223 offset:4096
    v_mfma_f32_16x16x32_bf16 v[16:19], a[72:75], a[204:207], -4.0
    v_exp_f32 v6, v6
    v_mfma_f32_16x16x32_bf16 v[16:19], a[76:79], a[208:211], v[16:19]
    ds_read_b64_tr_b16 a[118:119], v223 offset:6144
    v_cvt_pk_bf16_f32 v88, v4, v5
    v_mfma_f32_16x16x32_bf16 v[16:19], a[64:67], a[196:199], v[16:19]
    v_exp_f32 v7, v7
    v_mfma_f32_16x16x32_bf16 v[16:19], a[68:71], a[200:203], v[16:19]
    global_load_lds_dwordx4 v227, s[72:73] offset:3072 nt
    v_mfma_f32_16x16x32_bf16 v[164:167], v[20:23], a[96:99], v[164:167]
    v_exp_f32 v8, v8
    v_mfma_f32_16x16x32_bf16 v[164:167], v[24:27], a[100:103], v[164:167]
    ds_read_b128 a[88:91], v214 offset:20480
    v_cvt_pk_bf16_f32 v89, v6, v7
    v_mfma_f32_16x16x32_bf16 v[164:167], v[52:55], a[104:107], v[164:167]
    v_exp_f32 v9, v9
    v_mfma_f32_16x16x32_bf16 v[164:167], v[56:59], a[108:111], v[164:167]
    ds_read_b64_tr_b16 a[120:121], v223 offset:8192
    v_mfma_f32_16x16x32_bf16 v[168:171], v[60:63], a[104:107], v[168:171]
    s_add_u32 m0, s33, 0xa000
    v_exp_f32 v10, v10
    v_mfma_f32_16x16x32_bf16 v[168:171], v[64:67], a[108:111], v[168:171]
    ds_read_b64_tr_b16 a[122:123], v223 offset:10240
    v_cvt_pk_bf16_f32 v96, v8, v9
    v_mfma_f32_16x16x32_bf16 v[168:171], v[28:31], a[96:99], v[168:171]
    v_exp_f32 v11, v11
    v_mfma_f32_16x16x32_bf16 v[168:171], v[32:35], a[100:103], v[168:171]
    global_load_lds_dwordx4 v224, s[74:75] nt
    v_mfma_f32_16x16x32_bf16 a[16:19], v[36:39], a[96:99], a[16:19]
    ds_read_b128 a[92:95], v215 offset:20480
    v_cvt_pk_bf16_f32 v97, v10, v11
    v_mfma_f32_16x16x32_bf16 a[16:19], v[40:43], a[100:103], a[16:19]
    ds_read_b64_tr_b16 a[124:125], v223 offset:12288
    v_mfma_f32_16x16x32_bf16 a[16:19], v[68:71], a[104:107], a[16:19]
    ds_read_b64_tr_b16 a[126:127], v223 offset:14336
    v_mfma_f32_16x16x32_bf16 a[16:19], v[72:75], a[108:111], a[16:19]
    global_load_lds_dwordx4 v225, s[74:75] offset:1024 nt
    v_mfma_f32_16x16x32_bf16 a[20:23], v[76:79], a[104:107], a[20:23]
    s_add_u32 s32, s67, 0x70000
    v_exp_f32 v12, v12
    v_mfma_f32_16x16x32_bf16 a[20:23], v[80:83], a[108:111], a[20:23]
    s_and_b32 s32, s32, 0x7ffff
    v_exp_f32 v13, v13
    v_mfma_f32_16x16x32_bf16 a[20:23], v[44:47], a[96:99], a[20:23]
    v_exp_f32 v14, v14
    v_mfma_f32_16x16x32_bf16 a[20:23], v[48:51], a[100:103], a[20:23]
    s_waitcnt vmcnt(10) lgkmcnt(0)
    v_exp_f32 v15, v15
    v_smfmac_f32_16x16x64_bf16 a[136:139], a[144:147], v[68:75], v236
    s_barrier
    v_mfma_f32_16x16x32_bf16 v[4:7], a[80:83], a[148:151], -4.0
    s_add_u32 s72, s14, s32
    v_exp_f32 v16, v16
    v_mfma_f32_16x16x32_bf16 v[4:7], a[84:87], a[152:155], v[4:7]
    ds_read_b128 a[64:67], v212 offset:32768
    v_cvt_pk_bf16_f32 v105, v14, v15
    v_mfma_f32_16x16x32_bf16 v[4:7], a[88:91], a[156:159], v[4:7]
    s_addc_u32 s73, s15, 0
    v_exp_f32 v17, v17
    v_mfma_f32_16x16x32_bf16 v[4:7], a[92:95], a[160:163], v[4:7]
    ds_read_b64_tr_b16 a[96:97], v220 offset:16384
    v_cvt_pk_bf16_f32 v104, v12, v13
    v_mfma_f32_16x16x32_bf16 v[8:11], a[88:91], a[172:175], -4.0
    v_exp_f32 v18, v18
    v_mfma_f32_16x16x32_bf16 v[8:11], a[92:95], a[176:179], v[8:11]
    ds_read_b64_tr_b16 a[98:99], v220 offset:18432
    v_cvt_pk_bf16_f32 v112, v16, v17
    v_mfma_f32_16x16x32_bf16 v[8:11], a[80:83], a[164:167], v[8:11]
    v_exp_f32 v19, v19
    v_mfma_f32_16x16x32_bf16 v[8:11], a[84:87], a[168:171], v[8:11]
    global_load_lds_dwordx4 v226, s[74:75] offset:2048 nt
    v_mfma_f32_16x16x32_bf16 v[12:15], a[80:83], a[180:183], -4.0
    v_exp_f32 v4, v4
    v_mfma_f32_16x16x32_bf16 v[12:15], a[84:87], a[184:187], v[12:15]
    ds_read_b128 a[68:71], v213 offset:32768
    v_cvt_pk_bf16_f32 v113, v18, v19
    v_mfma_f32_16x16x32_bf16 v[12:15], a[88:91], a[188:191], v[12:15]
    v_exp_f32 v5, v5
    v_mfma_f32_16x16x32_bf16 v[12:15], a[92:95], a[192:195], v[12:15]
    ds_read_b64_tr_b16 a[100:101], v220 offset:20480
    v_mfma_f32_16x16x32_bf16 v[16:19], a[88:91], a[204:207], -4.0
    v_exp_f32 v6, v6
    v_mfma_f32_16x16x32_bf16 v[16:19], a[92:95], a[208:211], v[16:19]
    ds_read_b64_tr_b16 a[102:103], v220 offset:22528
    v_cvt_pk_bf16_f32 v90, v4, v5
    v_mfma_f32_16x16x32_bf16 v[16:19], a[80:83], a[196:199], v[16:19]
    v_exp_f32 v7, v7
    v_mfma_f32_16x16x32_bf16 v[16:19], a[84:87], a[200:203], v[16:19]
    global_load_lds_dwordx4 v227, s[74:75] offset:3072 nt
    v_mfma_f32_16x16x32_bf16 v[172:175], v[20:23], a[112:115], v[172:175]
    v_exp_f32 v8, v8
    v_mfma_f32_16x16x32_bf16 v[172:175], v[24:27], a[116:119], v[172:175]
    ds_read_b128 a[72:75], v214 offset:32768
    v_cvt_pk_bf16_f32 v91, v6, v7
    v_mfma_f32_16x16x32_bf16 v[172:175], v[52:55], a[120:123], v[172:175]
    v_exp_f32 v9, v9
    v_mfma_f32_16x16x32_bf16 v[172:175], v[56:59], a[124:127], v[172:175]
    ds_read_b64_tr_b16 a[104:105], v220 offset:24576
    v_mfma_f32_16x16x32_bf16 v[176:179], v[60:63], a[120:123], v[176:179]
    s_add_u32 m0, s33, 0x0
    v_exp_f32 v10, v10
    v_mfma_f32_16x16x32_bf16 v[176:179], v[64:67], a[124:127], v[176:179]
    ds_read_b64_tr_b16 a[106:107], v220 offset:26624
    v_cvt_pk_bf16_f32 v98, v8, v9
    v_mfma_f32_16x16x32_bf16 v[176:179], v[28:31], a[112:115], v[176:179]
    v_exp_f32 v11, v11
    v_mfma_f32_16x16x32_bf16 v[176:179], v[32:35], a[116:119], v[176:179]
    global_load_lds_dwordx4 v224, s[72:73] nt
    v_mfma_f32_16x16x32_bf16 a[24:27], v[36:39], a[112:115], a[24:27]
    s_add_u32 s32, s67, 0x78000
    v_exp_f32 v12, v12
    v_mfma_f32_16x16x32_bf16 a[24:27], v[40:43], a[116:119], a[24:27]
    ds_read_b128 a[76:79], v215 offset:32768
    v_cvt_pk_bf16_f32 v99, v10, v11
    v_mfma_f32_16x16x32_bf16 a[24:27], v[68:71], a[120:123], a[24:27]
    s_and_b32 s32, s32, 0x7ffff
    v_exp_f32 v13, v13
    v_mfma_f32_16x16x32_bf16 a[24:27], v[72:75], a[124:127], a[24:27]
    ds_read_b64_tr_b16 a[108:109], v220 offset:28672
    v_mfma_f32_16x16x32_bf16 a[28:31], v[76:79], a[120:123], a[28:31]
    v_exp_f32 v14, v14
    v_mfma_f32_16x16x32_bf16 a[28:31], v[80:83], a[124:127], a[28:31]
    ds_read_b64_tr_b16 a[110:111], v220 offset:30720
    v_cvt_pk_bf16_f32 v106, v12, v13
    v_mfma_f32_16x16x32_bf16 a[28:31], v[44:47], a[112:115], a[28:31]
    s_waitcnt lgkmcnt(2)
    v_exp_f32 v15, v15
    v_mfma_f32_16x16x32_bf16 a[28:31], v[48:51], a[116:119], a[28:31]
    global_load_lds_dwordx4 v225, s[72:73] offset:1024 nt
    v_smfmac_f32_16x16x64_bf16 a[140:143], a[144:147], v[76:83], v236
    v_mfma_f32_16x16x32_bf16 v[4:7], a[64:67], a[180:183], -4.0
    s_add_u32 s74, s14, s32
    v_exp_f32 v16, v16
    v_mfma_f32_16x16x32_bf16 v[4:7], a[68:71], a[184:187], v[4:7]
    ds_read_b128 a[80:83], v212 offset:36864
    v_cvt_pk_bf16_f32 v107, v14, v15
    v_mfma_f32_16x16x32_bf16 v[4:7], a[72:75], a[188:191], v[4:7]
    s_addc_u32 s75, s15, 0
    v_exp_f32 v17, v17
    v_mfma_f32_16x16x32_bf16 v[4:7], a[76:79], a[192:195], v[4:7]
    ds_read_b64_tr_b16 a[112:113], v221 offset:16384
    v_mfma_f32_16x16x32_bf16 v[8:11], a[72:75], a[204:207], -4.0
L_stub8:
    s_cbranch_execz L_back
    v_exp_f32 v18, v18
    v_mfma_f32_16x16x32_bf16 v[8:11], a[76:79], a[208:211], v[8:11]
    ds_read_b64_tr_b16 a[114:115], v221 offset:18432
    v_cvt_pk_bf16_f32 v114, v16, v17
    v_mfma_f32_16x16x32_bf16 v[8:11], a[64:67], a[196:199], v[8:11]
    s_waitcnt lgkmcnt(3)
    v_exp_f32 v19, v19
    v_mfma_f32_16x16x32_bf16 v[8:11], a[68:71], a[200:203], v[8:11]
    global_load_lds_dwordx4 v226, s[72:73] offset:2048 nt
    v_mfma_f32_16x16x32_bf16 v[12:15], a[64:67], a[148:151], -4.0
    v_exp_f32 v4, v4
    v_mfma_f32_16x16x32_bf16 v[12:15], a[68:71], a[152:155], v[12:15]
    ds_read_b128 a[84:87], v213 offset:36864
    v_cvt_pk_bf16_f32 v115, v18, v19
    v_mfma_f32_16x16x32_bf16 v[12:15], a[72:75], a[156:159], v[12:15]
    v_exp_f32 v5, v5
    v_mfma_f32_16x16x32_bf16 v[12:15], a[76:79], a[160:163], v[12:15]
    ds_read_b64_tr_b16 a[116:117], v221 offset:20480
    v_mfma_f32_16x16x32_bf16 v[16:19], a[72:75], a[172:175], -4.0
    v_exp_f32 v6, v6
    v_mfma_f32_16x16x32_bf16 v[16:19], a[76:79], a[176:179], v[16:19]
    ds_read_b64_tr_b16 a[118:119], v221 offset:22528
    v_cvt_pk_bf16_f32 v132, v4, v5
    v_mfma_f32_16x16x32_bf16 v[16:19], a[64:67], a[164:167], v[16:19]
    v_exp_f32 v7, v7
    v_mfma_f32_16x16x32_bf16 v[16:19], a[68:71], a[168:171], v[16:19]
    global_load_lds_dwordx4 v227, s[72:73] offset:3072 nt
    v_mfma_f32_16x16x32_bf16 v[180:183], v[20:23], a[96:99], v[180:183]
    v_exp_f32 v8, v8
    v_mfma_f32_16x16x32_bf16 v[180:183], v[24:27], a[100:103], v[180:183]
    ds_read_b128 a[88:91], v214 offset:36864
    v_cvt_pk_bf16_f32 v133, v6, v7
    v_mfma_f32_16x16x32_bf16 v[180:183], v[52:55], a[104:107], v[180:183]
    v_exp_f32 v9, v9
    v_mfma_f32_16x16x32_bf16 v[180:183], v[56:59], a[108:111], v[180:183]
    ds_read_b64_tr_b16 a[120:121], v221 offset:24576
    v_mfma_f32_16x16x32_bf16 v[184:187], v[60:63], a[104:107], v[184:187]
    s_add_u32 m0, s33, 0x2000
    v_exp_f32 v10, v10
    v_mfma_f32_16x16x32_bf16 v[184:187], v[64:67], a[108:111], v[184:187]
    ds_read_b64_tr_b16 a[122:123], v221 offset:26624
    v_cvt_pk_bf16_f32 v140, v8, v9
    v_mfma_f32_16x16x32_bf16 v[184:187], v[28:31], a[96:99], v[184:187]
    v_exp_f32 v11, v11
    v_mfma_f32_16x16x32_bf16 v[184:187], v[32:35], a[100:103], v[184:187]
    global_load_lds_dwordx4 v224, s[74:75] nt
    v_mfma_f32_16x16x32_bf16 a[32:35], v[36:39], a[96:99], a[32:35]
    ds_read_b128 a[92:95], v215 offset:36864
    v_cvt_pk_bf16_f32 v141, v10, v11
    v_mfma_f32_16x16x32_bf16 a[32:35], v[40:43], a[100:103], a[32:35]
    ds_read_b64_tr_b16 a[124:125], v221 offset:28672
    v_mfma_f32_16x16x32_bf16 a[32:35], v[68:71], a[104:107], a[32:35]
    ds_read_b64_tr_b16 a[126:127], v221 offset:30720
    v_mfma_f32_16x16x32_bf16 a[32:35], v[72:75], a[108:111], a[32:35]
    global_load_lds_dwordx4 v225, s[74:75] offset:1024 nt
    v_mfma_f32_16x16x32_bf16 a[36:39], v[76:79], a[104:107], a[36:39]
    s_lshl_b32 s36, s30, 13
    v_exp_f32 v12, v12
    v_mfma_f32_16x16x32_bf16 a[36:39], v[80:83], a[108:111], a[36:39]
    s_add_u32 s36, s36, s68
    v_exp_f32 v13, v13
    v_mfma_f32_16x16x32_bf16 a[36:39], v[44:47], a[96:99], a[36:39]
    v_exp_f32 v14, v14
    v_mfma_f32_16x16x32_bf16 a[36:39], v[48:51], a[100:103], a[36:39]
    s_waitcnt vmcnt(14) lgkmcnt(0)
    v_exp_f32 v15, v15
    v_smfmac_f32_16x16x64_bf16 a[128:131], a[144:147], v[84:91], v236
    s_barrier
    v_mfma_f32_16x16x32_bf16 v[4:7], a[80:83], a[180:183], -4.0
    s_add_u32 s36, s36, s45
    v_exp_f32 v16, v16
    v_mfma_f32_16x16x32_bf16 v[4:7], a[84:87], a[184:187], v[4:7]
    ds_read_b128 a[64:67], v212 offset:49152
    v_cvt_pk_bf16_f32 v117, v14, v15
    v_mfma_f32_16x16x32_bf16 v[4:7], a[88:91], a[188:191], v[4:7]
    s_xor_b32 s37, s36, 0x80
    v_exp_f32 v17, v17
    v_mfma_f32_16x16x32_bf16 v[4:7], a[92:95], a[192:195], v[4:7]
    ds_read_b64_tr_b16 a[96:97], v222 offset:16384
    v_cvt_pk_bf16_f32 v116, v12, v13
    v_mfma_f32_16x16x32_bf16 v[8:11], a[88:91], a[204:207], -4.0
    v_exp_f32 v18, v18
    v_mfma_f32_16x16x32_bf16 v[8:11], a[92:95], a[208:211], v[8:11]
    ds_read_b64_tr_b16 a[98:99], v222 offset:18432
    v_cvt_pk_bf16_f32 v124, v16, v17
    v_mfma_f32_16x16x32_bf16 v[8:11], a[80:83], a[196:199], v[8:11]
    v_exp_f32 v19, v19
    v_mfma_f32_16x16x32_bf16 v[8:11], a[84:87], a[200:203], v[8:11]
    global_load_lds_dwordx4 v226, s[74:75] offset:2048 nt
    v_mfma_f32_16x16x32_bf16 v[12:15], a[80:83], a[148:151], -4.0
    s_add_u32 s38, s36, 4096
    v_exp_f32 v4, v4
    v_mfma_f32_16x16x32_bf16 v[12:15], a[84:87], a[152:155], v[12:15]
    ds_read_b128 a[68:71], v213 offset:49152
    v_cvt_pk_bf16_f32 v125, v18, v19
    v_mfma_f32_16x16x32_bf16 v[12:15], a[88:91], a[156:159], v[12:15]
    s_xor_b32 s39, s38, 0x80
    v_exp_f32 v5, v5
    v_mfma_f32_16x16x32_bf16 v[12:15], a[92:95], a[160:163], v[12:15]
    ds_read_b64_tr_b16 a[100:101], v222 offset:20480
    v_mfma_f32_16x16x32_bf16 v[16:19], a[88:91], a[172:175], -4.0
    v_exp_f32 v6, v6
    v_mfma_f32_16x16x32_bf16 v[16:19], a[92:95], a[176:179], v[16:19]
    ds_read_b64_tr_b16 a[102:103], v222 offset:22528
    v_cvt_pk_bf16_f32 v134, v4, v5
    v_mfma_f32_16x16x32_bf16 v[16:19], a[80:83], a[164:167], v[16:19]
    v_exp_f32 v7, v7
    v_mfma_f32_16x16x32_bf16 v[16:19], a[84:87], a[168:171], v[16:19]
    global_load_lds_dwordx4 v227, s[74:75] offset:3072 nt
    v_mfma_f32_16x16x32_bf16 v[188:191], v[20:23], a[112:115], v[188:191]
    s_add_u32 s20, s10, s36
    v_exp_f32 v8, v8
    v_mfma_f32_16x16x32_bf16 v[188:191], v[24:27], a[116:119], v[188:191]
    ds_read_b128 a[72:75], v214 offset:49152
    v_cvt_pk_bf16_f32 v135, v6, v7
    v_mfma_f32_16x16x32_bf16 v[188:191], v[52:55], a[120:123], v[188:191]
    s_addc_u32 s21, s11, 0
    v_exp_f32 v9, v9
    v_mfma_f32_16x16x32_bf16 v[188:191], v[56:59], a[124:127], v[188:191]
    ds_read_b64_tr_b16 a[104:105], v222 offset:24576
    v_mfma_f32_16x16x32_bf16 v[192:195], v[60:63], a[120:123], v[192:195]
    v_exp_f32 v10, v10
    v_mfma_f32_16x16x32_bf16 v[192:195], v[64:67], a[124:127], v[192:195]
    ds_read_b64_tr_b16 a[106:107], v222 offset:26624
    v_cvt_pk_bf16_f32 v142, v8, v9
    v_mfma_f32_16x16x32_bf16 v[192:195], v[28:31], a[112:115], v[192:195]
    v_exp_f32 v11, v11
    v_mfma_f32_16x16x32_bf16 v[192:195], v[32:35], a[116:119], v[192:195]
    v_mfma_f32_16x16x32_bf16 a[40:43], v[36:39], a[112:115], a[40:43]
    s_add_u32 s22, s10, s37
    v_exp_f32 v12, v12
    v_mfma_f32_16x16x32_bf16 a[40:43], v[40:43], a[116:119], a[40:43]
    ds_read_b128 a[76:79], v215 offset:49152
    v_cvt_pk_bf16_f32 v143, v10, v11
    v_mfma_f32_16x16x32_bf16 a[40:43], v[68:71], a[120:123], a[40:43]
    s_addc_u32 s23, s11, 0
    v_exp_f32 v13, v13
    v_mfma_f32_16x16x32_bf16 a[40:43], v[72:75], a[124:127], a[40:43]
    ds_read_b64_tr_b16 a[108:109], v222 offset:28672
    v_mfma_f32_16x16x32_bf16 a[44:47], v[76:79], a[120:123], a[44:47]
    v_exp_f32 v14, v14
    v_mfma_f32_16x16x32_bf16 a[44:47], v[80:83], a[124:127], a[44:47]
    ds_read_b64_tr_b16 a[110:111], v222 offset:30720
    v_cvt_pk_bf16_f32 v118, v12, v13
    v_mfma_f32_16x16x32_bf16 a[44:47], v[44:47], a[112:115], a[44:47]
    s_waitcnt lgkmcnt(2)
    v_exp_f32 v15, v15
    v_mfma_f32_16x16x32_bf16 a[44:47], v[48:51], a[116:119], a[44:47]
    v_smfmac_f32_16x16x64_bf16 a[132:135], a[144:147], v[92:99], v236
    v_mfma_f32_16x16x32_bf16 v[4:7], a[64:67], a[180:183], -4.0
    s_add_u32 s24, s10, s38
    v_exp_f32 v16, v16
    v_mfma_f32_16x16x32_bf16 v[4:7], a[68:71], a[184:187], v[4:7]
    ds_read_b128 a[80:83], v212 offset:53248
    v_cvt_pk_bf16_f32 v119, v14, v15
    v_mfma_f32_16x16x32_bf16 v[4:7], a[72:75], a[188:191], v[4:7]
    s_addc_u32 s25, s11, 0
    v_exp_f32 v17, v17
    v_mfma_f32_16x16x32_bf16 v[4:7], a[76:79], a[192:195], v[4:7]
    ds_read_b64_tr_b16 a[112:113], v223 offset:16384
    v_mfma_f32_16x16x32_bf16 v[8:11], a[72:75], a[204:207], -4.0
    v_exp_f32 v18, v18
    v_mfma_f32_16x16x32_bf16 v[8:11], a[76:79], a[208:211], v[8:11]
    ds_read_b64_tr_b16 a[114:115], v223 offset:18432
    v_cvt_pk_bf16_f32 v126, v16, v17
    v_mfma_f32_16x16x32_bf16 v[8:11], a[64:67], a[196:199], v[8:11]
    s_waitcnt lgkmcnt(3)
    v_exp_f32 v19, v19
    v_mfma_f32_16x16x32_bf16 v[8:11], a[68:71], a[200:203], v[8:11]
    v_mfma_f32_16x16x32_bf16 v[12:15], a[64:67], a[148:151], -4.0
    s_add_u32 s26, s10, s39
    v_exp_f32 v4, v4
    v_mfma_f32_16x16x32_bf16 v[12:15], a[68:71], a[152:155], v[12:15]
    ds_read_b128 a[84:87], v213 offset:53248
    v_cvt_pk_bf16_f32 v127, v18, v19
    v_mfma_f32_16x16x32_bf16 v[12:15], a[72:75], a[156:159], v[12:15]
    s_addc_u32 s27, s11, 0
    v_exp_f32 v5, v5
    v_mfma_f32_16x16x32_bf16 v[12:15], a[76:79], a[160:163], v[12:15]
    ds_read_b64_tr_b16 a[116:117], v223 offset:20480
    v_mfma_f32_16x16x32_bf16 v[16:19], a[72:75], a[172:175], -4.0
    v_exp_f32 v6, v6
    v_mfma_f32_16x16x32_bf16 v[16:19], a[76:79], a[176:179], v[16:19]
    ds_read_b64_tr_b16 a[118:119], v223 offset:22528
    v_cvt_pk_bf16_f32 v136, v4, v5
    v_mfma_f32_16x16x32_bf16 v[16:19], a[64:67], a[164:167], v[16:19]
    v_exp_f32 v7, v7
    v_mfma_f32_16x16x32_bf16 v[16:19], a[68:71], a[168:171], v[16:19]
    v_mfma_f32_16x16x32_bf16 v[196:199], v[20:23], a[96:99], v[196:199]
    v_exp_f32 v8, v8
    v_mfma_f32_16x16x32_bf16 v[196:199], v[24:27], a[100:103], v[196:199]
    ds_read_b128 a[88:91], v214 offset:53248
    v_cvt_pk_bf16_f32 v137, v6, v7
    v_mfma_f32_16x16x32_bf16 v[196:199], v[52:55], a[104:107], v[196:199]
    v_exp_f32 v9, v9
    v_mfma_f32_16x16x32_bf16 v[196:199], v[56:59], a[108:111], v[196:199]
    ds_read_b64_tr_b16 a[120:121], v223 offset:24576
    v_mfma_f32_16x16x32_bf16 v[200:203], v[60:63], a[104:107], v[200:203]
    v_exp_f32 v10, v10
    v_mfma_f32_16x16x32_bf16 v[200:203], v[64:67], a[108:111], v[200:203]
    ds_read_b64_tr_b16 a[122:123], v223 offset:26624
    v_cvt_pk_bf16_f32 v144, v8, v9
    v_mfma_f32_16x16x32_bf16 v[200:203], v[28:31], a[96:99], v[200:203]
    v_exp_f32 v11, v11
    v_mfma_f32_16x16x32_bf16 v[200:203], v[32:35], a[100:103], v[200:203]
    v_mfma_f32_16x16x32_bf16 a[48:51], v[36:39], a[96:99], a[48:51]
    ds_read_b128 a[92:95], v215 offset:53248
    v_cvt_pk_bf16_f32 v145, v10, v11
    v_mfma_f32_16x16x32_bf16 a[48:51], v[40:43], a[100:103], a[48:51]
    ds_read_b64_tr_b16 a[124:125], v223 offset:28672
    v_mfma_f32_16x16x32_bf16 a[48:51], v[68:71], a[104:107], a[48:51]
    ds_read_b64_tr_b16 a[126:127], v223 offset:30720
    v_mfma_f32_16x16x32_bf16 a[48:51], v[72:75], a[108:111], a[48:51]
    v_mfma_f32_16x16x32_bf16 a[52:55], v[76:79], a[104:107], a[52:55]
    v_exp_f32 v12, v12
    v_mfma_f32_16x16x32_bf16 a[52:55], v[80:83], a[108:111], a[52:55]
    v_exp_f32 v13, v13
    v_mfma_f32_16x16x32_bf16 a[52:55], v[44:47], a[96:99], a[52:55]
    v_exp_f32 v14, v14
    v_mfma_f32_16x16x32_bf16 a[52:55], v[48:51], a[100:103], a[52:55]
    s_waitcnt vmcnt(8) lgkmcnt(0)
    v_exp_f32 v15, v15
    v_smfmac_f32_16x16x64_bf16 a[136:139], a[144:147], v[100:107], v236
    s_barrier
    v_mfma_f32_16x16x32_bf16 v[4:7], a[80:83], a[180:183], -4.0
    v_exp_f32 v16, v16
    v_mfma_f32_16x16x32_bf16 v[4:7], a[84:87], a[184:187], v[4:7]
    ds_read_b64_tr_b16 a[212:213], v221 offset:32768
    v_cvt_pk_bf16_f32 v121, v14, v15
    v_mfma_f32_16x16x32_bf16 v[4:7], a[88:91], a[188:191], v[4:7]
    v_exp_f32 v17, v17
    v_mfma_f32_16x16x32_bf16 v[4:7], a[92:95], a[192:195], v[4:7]
    ds_read_b64_tr_b16 a[96:97], v220 offset:32768
    v_cvt_pk_bf16_f32 v120, v12, v13
    v_mfma_f32_16x16x32_bf16 v[8:11], a[88:91], a[204:207], -4.0
    v_exp_f32 v18, v18
    v_mfma_f32_16x16x32_bf16 v[8:11], a[92:95], a[208:211], v[8:11]
    ds_read_b64_tr_b16 a[98:99], v220 offset:34816
    v_cvt_pk_bf16_f32 v128, v16, v17
    v_mfma_f32_16x16x32_bf16 v[8:11], a[80:83], a[196:199], v[8:11]
    v_exp_f32 v19, v19
    v_mfma_f32_16x16x32_bf16 v[8:11], a[84:87], a[200:203], v[8:11]
    ds_read_b64_tr_b16 a[214:215], v221 offset:34816
    v_mfma_f32_16x16x32_bf16 v[12:15], a[80:83], a[148:151], -4.0
    v_exp_f32 v4, v4
    v_mfma_f32_16x16x32_bf16 v[12:15], a[84:87], a[152:155], v[12:15]
    ds_read_b64_tr_b16 a[216:217], v221 offset:36864
    v_cvt_pk_bf16_f32 v129, v18, v19
    v_mfma_f32_16x16x32_bf16 v[12:15], a[88:91], a[156:159], v[12:15]
    v_exp_f32 v5, v5
    v_mfma_f32_16x16x32_bf16 v[12:15], a[92:95], a[160:163], v[12:15]
    ds_read_b64_tr_b16 a[100:101], v220 offset:36864
    v_mfma_f32_16x16x32_bf16 v[16:19], a[88:91], a[172:175], -4.0
    v_exp_f32 v6, v6
    v_mfma_f32_16x16x32_bf16 v[16:19], a[92:95], a[176:179], v[16:19]
    ds_read_b64_tr_b16 a[102:103], v220 offset:38912
    v_cvt_pk_bf16_f32 v138, v4, v5
    v_mfma_f32_16x16x32_bf16 v[16:19], a[80:83], a[164:167], v[16:19]
    v_exp_f32 v7, v7
    v_mfma_f32_16x16x32_bf16 v[16:19], a[84:87], a[168:171], v[16:19]
    ds_read_b64_tr_b16 a[218:219], v221 offset:38912
    v_mfma_f32_16x16x32_bf16 v[204:207], v[20:23], a[112:115], v[204:207]
    v_exp_f32 v8, v8
    v_mfma_f32_16x16x32_bf16 v[204:207], v[24:27], a[116:119], v[204:207]
    ds_read_b64_tr_b16 a[220:221], v221 offset:40960
    v_cvt_pk_bf16_f32 v139, v6, v7
    v_mfma_f32_16x16x32_bf16 v[204:207], v[52:55], a[120:123], v[204:207]
    v_exp_f32 v9, v9
    v_mfma_f32_16x16x32_bf16 v[204:207], v[56:59], a[124:127], v[204:207]
    ds_read_b64_tr_b16 a[104:105], v220 offset:40960
    v_mfma_f32_16x16x32_bf16 v[208:211], v[60:63], a[120:123], v[208:211]
    v_exp_f32 v10, v10
    v_mfma_f32_16x16x32_bf16 v[208:211], v[64:67], a[124:127], v[208:211]
    ds_read_b64_tr_b16 a[106:107], v220 offset:43008
    v_cvt_pk_bf16_f32 v146, v8, v9
    v_mfma_f32_16x16x32_bf16 v[208:211], v[28:31], a[112:115], v[208:211]
    v_exp_f32 v11, v11
    v_mfma_f32_16x16x32_bf16 v[208:211], v[32:35], a[116:119], v[208:211]
    ds_read_b64_tr_b16 a[222:223], v221 offset:43008
    v_mfma_f32_16x16x32_bf16 a[56:59], v[36:39], a[112:115], a[56:59]
    v_exp_f32 v12, v12
    v_mfma_f32_16x16x32_bf16 a[56:59], v[40:43], a[116:119], a[56:59]
    ds_read_b64_tr_b16 a[224:225], v221 offset:45056
    v_cvt_pk_bf16_f32 v147, v10, v11
    v_mfma_f32_16x16x32_bf16 a[56:59], v[68:71], a[120:123], a[56:59]
    v_exp_f32 v13, v13
    v_mfma_f32_16x16x32_bf16 a[56:59], v[72:75], a[124:127], a[56:59]
    ds_read_b64_tr_b16 a[108:109], v220 offset:45056
    v_mfma_f32_16x16x32_bf16 a[60:63], v[76:79], a[120:123], a[60:63]
    v_exp_f32 v14, v14
    v_mfma_f32_16x16x32_bf16 a[60:63], v[80:83], a[124:127], a[60:63]
    ds_read_b64_tr_b16 a[110:111], v220 offset:47104
    v_cvt_pk_bf16_f32 v122, v12, v13
    v_mfma_f32_16x16x32_bf16 a[60:63], v[44:47], a[112:115], a[60:63]
    v_exp_f32 v15, v15
    v_mfma_f32_16x16x32_bf16 a[60:63], v[48:51], a[116:119], a[60:63]
    v_smfmac_f32_16x16x64_bf16 a[140:143], a[144:147], v[108:115], v236
    ds_read_b64_tr_b16 a[226:227], v221 offset:47104
    s_waitcnt lgkmcnt(13)
    v_mfma_f32_16x16x32_bf16 a[0:3], v[100:103], a[96:99], a[0:3]
    ds_read_b64_tr_b16 a[228:229], v222 offset:32768
    ds_read_b64_tr_b16 a[230:231], v222 offset:34816
    s_waitcnt lgkmcnt(11)
    v_cvt_pk_bf16_f32 v123, v14, v15
    v_mfma_f32_16x16x32_bf16 a[0:3], v[104:107], a[100:103], a[0:3]
    ds_read_b64_tr_b16 a[232:233], v222 offset:36864
    s_waitcnt lgkmcnt(8)
    v_mfma_f32_16x16x32_bf16 a[0:3], v[132:135], a[104:107], a[0:3]
    ds_read_b64_tr_b16 a[234:235], v222 offset:38912
    s_waitcnt lgkmcnt(5)
    v_mfma_f32_16x16x32_bf16 a[0:3], v[136:139], a[108:111], a[0:3]
    ds_read_b64_tr_b16 a[236:237], v222 offset:40960
    v_mfma_f32_16x16x32_bf16 a[8:11], v[132:135], a[220:223], a[8:11]
    ds_read_b64_tr_b16 a[238:239], v222 offset:43008
    s_waitcnt lgkmcnt(6)
    v_mfma_f32_16x16x32_bf16 a[8:11], v[136:139], a[224:227], a[8:11]
    ds_read_b64_tr_b16 a[240:241], v222 offset:45056
    ds_read_b64_tr_b16 a[242:243], v222 offset:47104
    v_mfma_f32_16x16x32_bf16 a[8:11], v[100:103], a[212:215], a[8:11]
    ds_read_b64_tr_b16 a[72:73], v223 offset:40960
    ds_read_b64_tr_b16 a[74:75], v223 offset:43008
    v_mfma_f32_16x16x32_bf16 a[8:11], v[104:107], a[216:219], a[8:11]
    ds_read_b64_tr_b16 a[76:77], v223 offset:45056
    ds_read_b64_tr_b16 a[78:79], v223 offset:47104
    v_smfmac_f32_16x16x64_bf16 a[136:139], a[144:147], v[132:139], v236
    ds_read_b64_tr_b16 a[64:65], v223 offset:32768
    ds_read_b64_tr_b16 a[66:67], v223 offset:34816
    v_smfmac_f32_16x16x64_bf16 a[140:143], a[144:147], v[140:147], v236
    ds_read_b64_tr_b16 a[68:69], v223 offset:36864
    ds_read_b64_tr_b16 a[70:71], v223 offset:38912
    s_waitcnt lgkmcnt(10)
    v_mfma_f32_16x16x32_bf16 a[16:19], v[100:103], a[228:231], a[16:19]
    ds_write_b128 v239, a[0:3]
    v_exp_f32 v16, v16
    v_mfma_f32_16x16x32_bf16 a[16:19], v[104:107], a[232:235], a[16:19]
    v_accvgpr_read_b32 v248, a136
    v_accvgpr_read_b32 v250, a137
    v_add_f32 v248, v248, v250
    v_mfma_f32_16x16x32_bf16 a[16:19], v[132:135], a[236:239], a[16:19]
    ds_write_b128 v239, a[8:11] offset:8192
    s_waitcnt lgkmcnt(4)
    v_accvgpr_read_b32 v249, a140
    v_accvgpr_read_b32 v250, a141
    v_mfma_f32_16x16x32_bf16 a[16:19], v[136:139], a[240:243], a[16:19]
    v_add_f32 v249, v249, v250
    v_mfma_f32_16x16x32_bf16 a[24:27], v[132:135], a[72:75], a[24:27]
    v_exp_f32 v17, v17
    v_mfma_f32_16x16x32_bf16 a[24:27], v[136:139], a[76:79], a[24:27]
    ds_write_b64 v240, v[248:249]
    v_mfma_f32_16x16x32_bf16 a[24:27], v[100:103], a[64:67], a[24:27]
    s_waitcnt lgkmcnt(2)
    v_exp_f32 v18, v18
    v_mfma_f32_16x16x32_bf16 a[24:27], v[104:107], a[68:71], a[24:27]
    v_exp_f32 v19, v19
    v_cvt_pk_bf16_f32 v130, v16, v17
    v_mfma_f32_16x16x32_bf16 a[4:7], v[108:111], a[96:99], a[4:7]
    ds_write_b128 v239, a[16:19] offset:16384
    v_cvt_pk_bf16_f32 v131, v18, v19
    v_mfma_f32_16x16x32_bf16 a[4:7], v[112:115], a[100:103], a[4:7]
    v_mfma_f32_16x16x32_bf16 a[4:7], v[140:143], a[104:107], a[4:7]
    v_mfma_f32_16x16x32_bf16 a[4:7], v[144:147], a[108:111], a[4:7]
    ds_write_b128 v239, a[24:27] offset:24576
    v_mfma_f32_16x16x32_bf16 a[12:15], v[140:143], a[220:223], a[12:15]
    v_mfma_f32_16x16x32_bf16 a[12:15], v[144:147], a[224:227], a[12:15]
    v_mfma_f32_16x16x32_bf16 a[12:15], v[108:111], a[212:215], a[12:15]
    v_mfma_f32_16x16x32_bf16 a[12:15], v[112:115], a[216:219], a[12:15]
    v_smfmac_f32_16x16x64_bf16 a[128:131], a[144:147], v[116:123], v236
    s_waitcnt vmcnt(0) lgkmcnt(0)
    v_smfmac_f32_16x16x64_bf16 a[132:135], a[144:147], v[124:131], v236
    s_barrier
    ds_read_b64 v[250:251], v241
    v_mfma_f32_16x16x32_bf16 a[20:23], v[108:111], a[228:231], a[20:23]
    ds_read_b128 v[20:23], v238
    ds_read_b128 v[24:27], v238 offset:8192
    v_mfma_f32_16x16x32_bf16 a[20:23], v[112:115], a[232:235], a[20:23]
    ds_write_b128 v239, a[4:7] offset:1024
    s_waitcnt lgkmcnt(3)
    v_accvgpr_read_b32 v252, a128
    v_accvgpr_read_b32 v254, a129
    v_add_f32 v252, v252, v254
    v_add_f32 v252, v252, v250
    v_rcp_f32 v254, v252
    v_mfma_f32_16x16x32_bf16 a[20:23], v[140:143], a[236:239], a[20:23]
    ds_write_b128 v239, a[12:15] offset:9216
    s_waitcnt lgkmcnt(3)
    v_add_f32 v148, v20, v148
    v_mfma_f32_16x16x32_bf16 a[20:23], v[144:147], a[240:243], a[20:23]
    ds_read_b128 v[28:31], v238 offset:16384
    v_add_f32 v149, v21, v149
    v_mfma_f32_16x16x4_f32 v[212:215], v254, v237, 0
    ds_read_b128 v[32:35], v238 offset:24576
    ds_read_b64_tr_b16 a[112:113], v220
    ds_read_b64_tr_b16 a[114:115], v220 offset:2048
    ds_read_b64_tr_b16 a[116:117], v220 offset:4096
    ds_read_b64_tr_b16 a[118:119], v220 offset:6144
    v_add_f32 v150, v22, v150
    v_add_f32 v151, v23, v151
    v_mfma_f32_16x16x32_bf16 a[28:31], v[108:111], a[64:67], a[28:31]
    ds_write_b128 v239, a[20:23] offset:17408
    s_waitcnt lgkmcnt(9)
    v_add_f32 v156, v24, v156
    v_add_f32 v157, v25, v157
    v_mfma_f32_16x16x32_bf16 a[28:31], v[112:115], a[68:71], a[28:31]
    ds_read_b64_tr_b16 a[120:121], v220 offset:8192
    v_add_f32 v158, v26, v158
    v_mfma_f32_16x16x32_bf16 a[28:31], v[140:143], a[72:75], a[28:31]
    ds_read_b64_tr_b16 a[122:123], v220 offset:10240
    ds_read_b64_tr_b16 a[124:125], v220 offset:12288
    v_add_f32 v159, v27, v159
    v_mfma_f32_16x16x32_bf16 a[28:31], v[144:147], a[76:79], a[28:31]
    ds_read_b64_tr_b16 a[126:127], v220 offset:14336
    v_accvgpr_read_b32 v253, a132
    v_mfma_f32_16x16x32_bf16 v[148:151], v[84:87], a[96:99], v[148:151]
    ds_read_b64_tr_b16 a[88:89], v221 offset:8192
    v_accvgpr_read_b32 v255, a133
    v_mfma_f32_16x16x32_bf16 v[148:151], v[88:91], a[100:103], v[148:151]
    ds_read_b64_tr_b16 a[90:91], v221 offset:10240
    ds_read_b64_tr_b16 a[92:93], v221 offset:12288
    v_add_f32 v253, v253, v255
    v_mfma_f32_16x16x32_bf16 v[148:151], v[116:119], a[104:107], v[148:151]
    ds_write_b128 v239, a[28:31] offset:25600
    v_add_f32 v253, v253, v251
    v_mfma_f32_16x16x32_bf16 v[148:151], v[120:123], a[108:111], v[148:151]
    ds_read_b64_tr_b16 a[94:95], v221 offset:14336
    v_rcp_f32 v255, v253
    v_mfma_f32_16x16x32_bf16 v[156:159], v[116:119], a[220:223], v[156:159]
    ds_read_b64_tr_b16 a[80:81], v221
    s_waitcnt lgkmcnt(5)
    v_add_f32 v164, v28, v164
    v_mfma_f32_16x16x32_bf16 v[156:159], v[120:123], a[224:227], v[156:159]
    ds_read_b64_tr_b16 a[82:83], v221 offset:2048
    v_add_f32 v165, v29, v165
    v_mfma_f32_16x16x32_bf16 v[156:159], v[84:87], a[212:215], v[156:159]
    ds_read_b64_tr_b16 a[84:85], v221 offset:4096
    ds_read_b64_tr_b16 a[86:87], v221 offset:6144
    v_add_f32 v166, v30, v166
    v_add_f32 v167, v31, v167
    v_mfma_f32_16x16x32_bf16 v[156:159], v[88:91], a[216:219], v[156:159]
    ds_read_b64_tr_b16 a[0:1], v222
    v_add_f32 v172, v32, v172
    s_waitcnt lgkmcnt(6)
    v_mfma_f32_16x16x4_f32 v[216:219], v255, v237, 0
    s_barrier
    ds_read_b64_tr_b16 a[2:3], v222 offset:2048
    ds_read_b64_tr_b16 a[4:5], v222 offset:4096
    ds_read_b64_tr_b16 a[6:7], v222 offset:6144
    ds_read_b64_tr_b16 a[8:9], v222 offset:8192
    v_add_f32 v173, v33, v173
    v_mfma_f32_16x16x32_bf16 v[164:167], v[84:87], a[228:231], v[164:167]
    ds_read_b64_tr_b16 a[10:11], v222 offset:10240
    v_add_f32 v174, v34, v174
    v_mfma_f32_16x16x32_bf16 v[164:167], v[88:91], a[232:235], v[164:167]
    ds_read_b64_tr_b16 a[12:13], v222 offset:12288
    v_add_f32 v175, v35, v175
    v_mfma_f32_16x16x32_bf16 v[164:167], v[116:119], a[236:239], v[164:167]
    ds_read_b64_tr_b16 a[14:15], v222 offset:14336
    v_mul_f32 v148, v148, v212
    v_mfma_f32_16x16x32_bf16 v[164:167], v[120:123], a[240:243], v[164:167]
    ds_read_b64_tr_b16 a[24:25], v223 offset:8192
    ds_read_b64_tr_b16 a[26:27], v223 offset:10240
    v_mul_f32 v149, v149, v213
    v_mfma_f32_16x16x32_bf16 v[172:175], v[116:119], a[72:75], v[172:175]
    ds_read_b64_tr_b16 a[28:29], v223 offset:12288
    v_mul_f32 v150, v150, v214
    v_mfma_f32_16x16x32_bf16 v[172:175], v[120:123], a[76:79], v[172:175]
    ds_read_b64_tr_b16 a[30:31], v223 offset:14336
    v_mul_f32 v151, v151, v215
    v_mfma_f32_16x16x32_bf16 v[172:175], v[84:87], a[64:67], v[172:175]
    ds_read_b64_tr_b16 a[16:17], v223
    ds_read_b64_tr_b16 a[18:19], v223 offset:2048
    v_mul_f32 v156, v156, v212
    v_mfma_f32_16x16x32_bf16 v[172:175], v[88:91], a[68:71], v[172:175]
    ds_read_b128 v[52:55], v238 offset:1024
    v_mul_f32 v157, v157, v213
    v_mfma_f32_16x16x32_bf16 a[32:35], v[100:103], a[112:115], a[32:35]
    ds_read_b64_tr_b16 a[20:21], v223 offset:4096
    v_mul_f32 v158, v158, v214
    v_mfma_f32_16x16x32_bf16 a[32:35], v[104:107], a[116:119], a[32:35]
    ds_read_b64_tr_b16 a[22:23], v223 offset:6144
    ds_read_b128 v[56:59], v238 offset:9216
    v_mul_f32 v159, v159, v215
    v_mfma_f32_16x16x32_bf16 a[32:35], v[132:135], a[120:123], a[32:35]
    ds_read_b128 v[60:63], v238 offset:17408
    v_mul_f32 v164, v164, v212
    v_mfma_f32_16x16x32_bf16 a[32:35], v[136:139], a[124:127], a[32:35]
    ds_read_b128 v[64:67], v238 offset:25600
    v_mul_f32 v165, v165, v213
    v_mfma_f32_16x16x32_bf16 a[40:43], v[132:135], a[88:91], a[40:43]
    s_waitcnt lgkmcnt(6)
    v_mul_f32 v166, v166, v214
    v_mul_f32 v167, v167, v215
    v_mfma_f32_16x16x32_bf16 a[40:43], v[136:139], a[92:95], a[40:43]
    v_mul_f32 v172, v172, v212
    v_cvt_pk_bf16_f32 v5, v164, v172
    v_mul_f32 v173, v173, v213
    v_mfma_f32_16x16x32_bf16 a[40:43], v[100:103], a[80:83], a[40:43]
    ds_write_b128 v239, a[32:35] offset:32768
    v_mul_f32 v174, v174, v214
    v_mfma_f32_16x16x32_bf16 a[40:43], v[104:107], a[84:87], a[40:43]
    v_mul_f32 v175, v175, v215
    v_cvt_pk_bf16_f32 v4, v148, v156
    v_mfma_f32_16x16x32_bf16 a[48:51], v[100:103], a[0:3], a[48:51]
    v_cvt_pk_bf16_f32 v6, v149, v157
    v_cvt_pk_bf16_f32 v8, v150, v158
    v_cvt_pk_bf16_f32 v10, v151, v159
    v_mfma_f32_16x16x32_bf16 a[48:51], v[104:107], a[4:7], a[48:51]
    ds_write_b64 v243, v[4:5]
    v_cvt_pk_bf16_f32 v7, v165, v173
    v_mfma_f32_16x16x32_bf16 a[48:51], v[132:135], a[8:11], a[48:51]
    v_cvt_pk_bf16_f32 v9, v166, v174
    v_cvt_pk_bf16_f32 v11, v167, v175
    v_mfma_f32_16x16x32_bf16 a[48:51], v[136:139], a[12:15], a[48:51]
    ds_write_b64 v243, v[6:7] offset:128
    s_waitcnt lgkmcnt(3)
    v_add_f32 v152, v52, v152
    v_add_f32 v153, v53, v153
    v_mfma_f32_16x16x32_bf16 a[56:59], v[132:135], a[24:27], a[56:59]
    ds_write_b64 v244, v[8:9] offset:256
    v_add_f32 v154, v54, v154
    v_mfma_f32_16x16x32_bf16 a[56:59], v[136:139], a[28:31], a[56:59]
    v_add_f32 v155, v55, v155
    v_add_f32 v160, v56, v160
    v_mfma_f32_16x16x32_bf16 a[56:59], v[100:103], a[16:19], a[56:59]
    ds_write_b64 v244, v[10:11] offset:384
    ds_read_b64_tr_b16 v[6:7], v246
    v_add_f32 v161, v57, v161
    v_mfma_f32_16x16x32_bf16 a[56:59], v[104:107], a[20:23], a[56:59]
    ds_read_b64_tr_b16 v[4:5], v245
    v_add_f32 v162, v58, v162
    v_mfma_f32_16x16x32_bf16 v[152:155], v[92:95], a[96:99], v[152:155]
    ds_read_b64_tr_b16 v[8:9], v245 offset:1024
    v_add_f32 v163, v59, v163
    v_mfma_f32_16x16x32_bf16 v[152:155], v[96:99], a[100:103], v[152:155]
    ds_read_b64_tr_b16 v[10:11], v246 offset:1024
    ds_write_b128 v239, a[40:43] offset:40960
    v_add_f32 v168, v60, v168
    v_mfma_f32_16x16x32_bf16 v[152:155], v[124:127], a[104:107], v[152:155]
    v_add_f32 v169, v61, v169
    v_add_f32 v170, v62, v170
    v_mfma_f32_16x16x32_bf16 v[152:155], v[128:131], a[108:111], v[152:155]
    ds_write_b128 v239, a[48:51] offset:49152
    s_waitcnt lgkmcnt(4)
    v_add_f32 v171, v63, v171
    v_mfma_f32_16x16x32_bf16 v[160:163], v[124:127], a[220:223], v[160:163]
    global_store_dwordx4 v242, v[4:7], s[20:21] sc0 sc1
    v_add_f32 v176, v64, v176
    v_add_f32 v177, v65, v177
    v_mfma_f32_16x16x32_bf16 v[160:163], v[128:131], a[224:227], v[160:163]
    ds_write_b128 v239, a[56:59] offset:57344
    s_waitcnt lgkmcnt(3)
    v_add_f32 v178, v66, v178
    v_mfma_f32_16x16x32_bf16 v[160:163], v[92:95], a[212:215], v[160:163]
    global_store_dwordx4 v242, v[8:11], s[20:21] offset:2048 sc0 sc1
    v_add_f32 v179, v67, v179
    v_mfma_f32_16x16x32_bf16 v[160:163], v[96:99], a[216:219], v[160:163]
    v_mul_f32 v152, v152, v216
    v_mul_f32 v153, v153, v217
    v_mul_f32 v154, v154, v218
    s_waitcnt lgkmcnt(0)
    v_mfma_f32_16x16x32_bf16 v[168:171], v[92:95], a[228:231], v[168:171]
    s_barrier
    v_mul_f32 v155, v155, v219
    v_mfma_f32_16x16x32_bf16 v[168:171], v[96:99], a[232:235], v[168:171]
    ds_read_b128 v[36:39], v238 offset:32768
    v_mul_f32 v160, v160, v216
    v_mfma_f32_16x16x32_bf16 v[168:171], v[124:127], a[236:239], v[168:171]
    ds_read_b128 v[40:43], v238 offset:40960
    v_mul_f32 v161, v161, v217
    v_mfma_f32_16x16x32_bf16 v[168:171], v[128:131], a[240:243], v[168:171]
    ds_read_b128 v[44:47], v238 offset:49152
    ds_read_b128 v[48:51], v238 offset:57344
    v_mul_f32 v162, v162, v218
    v_mfma_f32_16x16x32_bf16 v[176:179], v[124:127], a[72:75], v[176:179]
    v_mul_f32 v163, v163, v219
    v_cvt_pk_bf16_f32 v12, v152, v160
    v_mfma_f32_16x16x32_bf16 v[176:179], v[128:131], a[76:79], v[176:179]
    v_cvt_pk_bf16_f32 v14, v153, v161
    v_mul_f32 v168, v168, v216
    v_mfma_f32_16x16x32_bf16 v[176:179], v[92:95], a[64:67], v[176:179]
    v_mul_f32 v169, v169, v217
    v_mul_f32 v170, v170, v218
    v_mul_f32 v171, v171, v219
    v_mfma_f32_16x16x32_bf16 v[176:179], v[96:99], a[68:71], v[176:179]
    v_cvt_pk_bf16_f32 v16, v154, v162
    v_cvt_pk_bf16_f32 v18, v155, v163
    v_mfma_f32_16x16x32_bf16 a[36:39], v[108:111], a[112:115], a[36:39]
    s_waitcnt lgkmcnt(2)
    v_add_f32 v180, v36, v180
    v_add_f32 v181, v37, v181
    v_mfma_f32_16x16x32_bf16 a[36:39], v[112:115], a[116:119], a[36:39]
    v_add_f32 v182, v38, v182
    v_add_f32 v183, v39, v183
    v_mul_f32 v176, v176, v216
    v_mfma_f32_16x16x32_bf16 a[36:39], v[140:143], a[120:123], a[36:39]
    v_mul_f32 v177, v177, v217
    v_mul_f32 v178, v178, v218
    v_mfma_f32_16x16x32_bf16 a[36:39], v[144:147], a[124:127], a[36:39]
    v_cvt_pk_bf16_f32 v15, v169, v177
    v_cvt_pk_bf16_f32 v17, v170, v178
    v_mfma_f32_16x16x32_bf16 a[44:47], v[140:143], a[88:91], a[44:47]
    ds_write_b64 v243, v[14:15] offset:2176
    v_mul_f32 v179, v179, v219
    v_cvt_pk_bf16_f32 v19, v171, v179
    v_mfma_f32_16x16x32_bf16 a[44:47], v[144:147], a[92:95], a[44:47]
    ds_write_b64 v244, v[16:17] offset:2304
    v_cvt_pk_bf16_f32 v13, v168, v176
    v_mfma_f32_16x16x32_bf16 a[44:47], v[108:111], a[80:83], a[44:47]
L_stub9:
    s_cbranch_execz L_back
    v_add_f32 v188, v40, v188
    v_add_f32 v189, v41, v189
    v_mfma_f32_16x16x32_bf16 a[44:47], v[112:115], a[84:87], a[44:47]
    ds_write_b64 v243, v[12:13] offset:2048
    v_add_f32 v190, v42, v190
    v_add_f32 v191, v43, v191
    v_mfma_f32_16x16x32_bf16 a[52:55], v[108:111], a[0:3], a[52:55]
    ds_write_b64 v244, v[18:19] offset:2432
    s_waitcnt lgkmcnt(4)
    v_add_f32 v196, v44, v196
    v_mfma_f32_16x16x32_bf16 a[52:55], v[112:115], a[4:7], a[52:55]
    ds_read_b64_tr_b16 v[12:13], v245 offset:2048
    v_add_f32 v197, v45, v197
    v_mfma_f32_16x16x32_bf16 a[52:55], v[140:143], a[8:11], a[52:55]
    ds_read_b64_tr_b16 v[14:15], v246 offset:2048
    ds_read_b64_tr_b16 v[16:17], v245 offset:3072
    v_add_f32 v198, v46, v198
    v_mfma_f32_16x16x32_bf16 a[52:55], v[144:147], a[12:15], a[52:55]
    ds_read_b64_tr_b16 v[18:19], v246 offset:3072
    v_add_f32 v199, v47, v199
    v_mfma_f32_16x16x32_bf16 a[60:63], v[140:143], a[24:27], a[60:63]
    ds_write_b128 v239, a[36:39] offset:33792
    v_add_f32 v204, v48, v204
    v_mfma_f32_16x16x32_bf16 a[60:63], v[144:147], a[28:31], a[60:63]
    s_waitcnt lgkmcnt(3)
    v_add_f32 v205, v49, v205
    v_add_f32 v206, v50, v206
    v_add_f32 v207, v51, v207
    v_mfma_f32_16x16x32_bf16 a[60:63], v[108:111], a[16:19], a[60:63]
    global_store_dwordx4 v242, v[12:15], s[24:25] sc0 sc1
    v_mfma_f32_16x16x32_bf16 a[60:63], v[112:115], a[20:23], a[60:63]
    ds_write_b128 v239, a[44:47] offset:41984
    v_mfma_f32_16x16x32_bf16 v[180:183], v[84:87], a[112:115], v[180:183]
    s_waitcnt lgkmcnt(2)
    v_mfma_f32_16x16x32_bf16 v[180:183], v[88:91], a[116:119], v[180:183]
    global_store_dwordx4 v242, v[16:19], s[24:25] offset:2048 sc0 sc1
    ds_write_b128 v239, a[52:55] offset:50176
    v_mfma_f32_16x16x32_bf16 v[180:183], v[116:119], a[120:123], v[180:183]
    v_mfma_f32_16x16x32_bf16 v[180:183], v[120:123], a[124:127], v[180:183]
    v_mfma_f32_16x16x32_bf16 v[188:191], v[116:119], a[88:91], v[188:191]
    ds_write_b128 v239, a[60:63] offset:58368
    v_mfma_f32_16x16x32_bf16 v[188:191], v[120:123], a[92:95], v[188:191]
    v_mfma_f32_16x16x32_bf16 v[188:191], v[84:87], a[80:83], v[188:191]
    v_mfma_f32_16x16x32_bf16 v[188:191], v[88:91], a[84:87], v[188:191]
    s_waitcnt lgkmcnt(0)
    v_mfma_f32_16x16x32_bf16 v[196:199], v[84:87], a[0:3], v[196:199]
    s_barrier
    ds_read_b128 v[68:71], v238 offset:33792
    v_mul_f32 v180, v180, v212
    v_mfma_f32_16x16x32_bf16 v[196:199], v[88:91], a[4:7], v[196:199]
    ds_read_b128 v[72:75], v238 offset:41984
    ds_read_b128 v[76:79], v238 offset:50176
    v_mul_f32 v181, v181, v213
    v_mfma_f32_16x16x32_bf16 v[196:199], v[116:119], a[8:11], v[196:199]
    ds_read_b128 v[80:83], v238 offset:58368
    v_mul_f32 v182, v182, v214
    v_mul_f32 v183, v183, v215
    v_mfma_f32_16x16x32_bf16 v[196:199], v[120:123], a[12:15], v[196:199]
    v_mul_f32 v188, v188, v212
    v_mul_f32 v189, v189, v213
    v_mul_f32 v190, v190, v214
    v_mfma_f32_16x16x32_bf16 v[204:207], v[116:119], a[24:27], v[204:207]
    s_waitcnt lgkmcnt(3)
    v_add_f32 v184, v68, v184
    v_add_f32 v185, v69, v185
    v_add_f32 v186, v70, v186
    v_mfma_f32_16x16x32_bf16 v[204:207], v[120:123], a[28:31], v[204:207]
    v_add_f32 v187, v71, v187
    v_mul_f32 v191, v191, v215
    v_mul_f32 v196, v196, v212
    v_mfma_f32_16x16x32_bf16 v[204:207], v[84:87], a[16:19], v[204:207]
    v_mul_f32 v197, v197, v213
    v_mul_f32 v198, v198, v214
    v_mul_f32 v199, v199, v215
    v_mfma_f32_16x16x32_bf16 v[204:207], v[88:91], a[20:23], v[204:207]
    v_cvt_pk_bf16_f32 v4, v180, v188
    v_cvt_pk_bf16_f32 v6, v181, v189
    v_cvt_pk_bf16_f32 v8, v182, v190
    v_mfma_f32_16x16x32_bf16 v[184:187], v[92:95], a[112:115], v[184:187]
    s_waitcnt lgkmcnt(0)
    v_cvt_pk_bf16_f32 v10, v183, v191
    v_add_f32 v192, v72, v192
    v_add_f32 v193, v73, v193
    v_mfma_f32_16x16x32_bf16 v[184:187], v[96:99], a[116:119], v[184:187]
    v_mul_f32 v204, v204, v212
    v_mul_f32 v205, v205, v213
    v_mul_f32 v206, v206, v214
    v_mfma_f32_16x16x32_bf16 v[184:187], v[124:127], a[120:123], v[184:187]
    v_mul_f32 v207, v207, v215
    v_cvt_pk_bf16_f32 v5, v196, v204
    v_cvt_pk_bf16_f32 v7, v197, v205
    v_mfma_f32_16x16x32_bf16 v[184:187], v[128:131], a[124:127], v[184:187]
    ds_write_b64 v243, v[4:5]
    v_cvt_pk_bf16_f32 v9, v198, v206
    v_cvt_pk_bf16_f32 v11, v199, v207
    v_add_f32 v194, v74, v194
    v_add_f32 v195, v75, v195
    s_nop 1
    v_mfma_f32_16x16x32_bf16 v[192:195], v[124:127], a[88:91], v[192:195]
    ds_write_b64 v243, v[6:7] offset:128
    v_add_f32 v200, v76, v200
    v_add_f32 v201, v77, v201
    v_mfma_f32_16x16x32_bf16 v[192:195], v[128:131], a[92:95], v[192:195]
    ds_write_b64 v244, v[8:9] offset:256
    v_add_f32 v202, v78, v202
    v_add_f32 v203, v79, v203
    v_mfma_f32_16x16x32_bf16 v[192:195], v[92:95], a[80:83], v[192:195]
    ds_write_b64 v244, v[10:11] offset:384
    ds_read_b64_tr_b16 v[4:5], v245
    v_add_f32 v208, v80, v208
    v_mfma_f32_16x16x32_bf16 v[192:195], v[96:99], a[84:87], v[192:195]
    ds_read_b64_tr_b16 v[6:7], v246
    ds_read_b64_tr_b16 v[8:9], v245 offset:1024
    v_add_f32 v209, v81, v209
    v_mfma_f32_16x16x32_bf16 v[200:203], v[92:95], a[0:3], v[200:203]
    ds_read_b64_tr_b16 v[10:11], v246 offset:1024
    v_add_f32 v210, v82, v210
    v_add_f32 v211, v83, v211
    v_mfma_f32_16x16x32_bf16 v[200:203], v[96:99], a[4:7], v[200:203]
    v_mul_f32 v184, v184, v216
    v_mul_f32 v185, v185, v217
    v_mul_f32 v186, v186, v218
    v_mfma_f32_16x16x32_bf16 v[200:203], v[124:127], a[8:11], v[200:203]
    v_mul_f32 v187, v187, v219
    v_mul_f32 v193, v193, v217
    v_mul_f32 v194, v194, v218
    v_mfma_f32_16x16x32_bf16 v[200:203], v[128:131], a[12:15], v[200:203]
    s_waitcnt lgkmcnt(2)
    v_mul_f32 v195, v195, v219
    v_cvt_pk_bf16_f32 v14, v185, v193
    v_cvt_pk_bf16_f32 v16, v186, v194
    v_mfma_f32_16x16x32_bf16 v[208:211], v[124:127], a[24:27], v[208:211]
    global_store_dwordx4 v242, v[4:7], s[22:23] sc0 sc1
    v_cvt_pk_bf16_f32 v18, v187, v195
    v_mul_f32 v192, v192, v216
    v_mfma_f32_16x16x32_bf16 v[208:211], v[128:131], a[28:31], v[208:211]
    v_mul_f32 v200, v200, v216
    v_mul_f32 v201, v201, v217
    v_mul_f32 v202, v202, v218
    v_mfma_f32_16x16x32_bf16 v[208:211], v[92:95], a[16:19], v[208:211]
    v_mul_f32 v203, v203, v219
    v_cvt_pk_bf16_f32 v12, v184, v192
    v_mfma_f32_16x16x32_bf16 v[208:211], v[96:99], a[20:23], v[208:211]
    s_waitcnt lgkmcnt(0)
    global_store_dwordx4 v242, v[8:11], s[22:23] offset:2048 sc0 sc1
    s_nop 5
    v_pk_mul_f32 v[208:209], v[208:209], v[216:217]
    v_pk_mul_f32 v[210:211], v[210:211], v[218:219]
    v_cvt_pk_bf16_f32 v13, v200, v208
    ds_write_b64 v243, v[12:13] offset:2048
    v_cvt_pk_bf16_f32 v15, v201, v209
    ds_write_b64 v243, v[14:15] offset:2176
    v_cvt_pk_bf16_f32 v17, v202, v210
    v_cvt_pk_bf16_f32 v19, v203, v211
    ds_write_b64 v244, v[16:17] offset:2304
    ds_write_b64 v244, v[18:19] offset:2432
    ds_read_b64_tr_b16 v[12:13], v245 offset:2048
    ds_read_b64_tr_b16 v[14:15], v246 offset:2048
    ds_read_b64_tr_b16 v[16:17], v245 offset:3072
    ds_read_b64_tr_b16 v[18:19], v246 offset:3072
    s_waitcnt lgkmcnt(2)
    global_store_dwordx4 v242, v[12:15], s[26:27] sc0 sc1
    s_waitcnt lgkmcnt(0)
    global_store_dwordx4 v242, v[16:19], s[26:27] offset:2048 sc0 sc1
    s_mov_b32 s48, 0x5d800000
    s_mov_b32 s49, 0x33800000
    v_add_f32 v20, v252, v253
    v_min_f32 v21, v252, v253
    v_mov_b32 v24, s87
    v_mov_b32 v25, 0x15000
    v_cmp_nlt_f32 vcc, v20, s48
    v_cmp_lt_f32 s[50:51], v21, s49
    s_or_b64 vcc, vcc, s[50:51]
    v_max3_f32 v28, |v148|, |v156|, |v164|
    v_max3_f32 v29, |v149|, |v157|, |v165|
    v_max3_f32 v30, |v150|, |v158|, |v166|
    v_max3_f32 v31, |v151|, |v159|, |v167|
    v_max3_f32 v32, |v152|, |v160|, |v168|
    v_max3_f32 v33, |v153|, |v161|, |v169|
    v_max3_f32 v34, |v154|, |v162|, |v170|
    v_max3_f32 v35, |v155|, |v163|, |v171|
    v_max3_f32 v28, v28, |v172|, |v180|
    v_max3_f32 v29, v29, |v173|, |v181|
    v_max3_f32 v30, v30, |v174|, |v182|
    v_max3_f32 v31, v31, |v175|, |v183|
    v_max3_f32 v32, v32, |v176|, |v184|
    v_max3_f32 v33, v33, |v177|, |v185|
    v_max3_f32 v34, v34, |v178|, |v186|
    v_max3_f32 v35, v35, |v179|, |v187|
    v_max3_f32 v28, v28, |v188|, |v196|
    v_max3_f32 v29, v29, |v189|, |v197|
    v_max3_f32 v30, v30, |v190|, |v198|
    v_max3_f32 v31, v31, |v191|, |v199|
    v_max3_f32 v32, v32, |v192|, |v200|
    v_max3_f32 v33, v33, |v193|, |v201|
    v_max3_f32 v34, v34, |v194|, |v202|
    v_max3_f32 v35, v35, |v195|, |v203|
    v_max3_f32 v28, v28, |v204|, |v204|
    v_max3_f32 v29, v29, |v205|, |v205|
    v_max3_f32 v30, v30, |v206|, |v206|
    v_max3_f32 v31, v31, |v207|, |v207|
    v_max3_f32 v32, v32, |v208|, |v208|
    v_max3_f32 v33, v33, |v209|, |v209|
    v_max3_f32 v34, v34, |v210|, |v210|
    v_max3_f32 v35, v35, |v211|, |v211|
    s_mov_b32 s49, 0x7f800000
    v_max3_f32 v36, v28, v29, v30
    v_max3_f32 v37, v31, v32, v33
    v_max3_f32 v36, v36, v34, v35
    v_max_f32 v36, v36, v37
    v_cmp_nlt_f32 s[50:51], v36, s49
    s_or_b64 vcc, vcc, s[50:51]
    s_cmp_lg_u64 vcc, 0
    s_cselect_b32 s48, 1, 0
    v_mov_b32 v26, s48
    ds_write_b32 v24, v26
    s_waitcnt lgkmcnt(0)
    s_barrier
    ds_read_b128 v[20:23], v25
    s_waitcnt lgkmcnt(0)
    v_or3_b32 v20, v20, v21, v22
    v_or_b32 v20, v20, v23
    v_cmp_ne_u32 vcc, 0, v20
    s_nop 2
    s_cbranch_vccnz L_slow
L_done:
L_exit:
    s_endpgm
M_restart:
    s_and_b32 s44, s2, 7
    s_lshr_b32 s45, s2, 3
    s_lshl_b32 s44, s44, 3
    s_lshr_b32 s46, s45, 2
    s_add_u32 s44, s44, s46
    s_and_b32 s43, s45, 3
    s_lshl_b32 s46, s44, 2
    s_add_u32 s45, s43, s46
    s_and_b32 s68, s44, 1
    s_lshl_b32 s68, s68, 7
    s_and_b32 s46, s44, 15
    s_lshl_b32 s64, s46, 15
    s_xor_b32 s65, s64, 0x2000
    s_add_u32 s66, s64, s68
    s_xor_b32 s67, s66, 0x80
    s_lshl_b32 s44, s44, 19
    s_lshl_b32 s45, s45, 15
    s_and_b32 s29, s28, 1
    s_lshr_b32 s30, s28, 1
    s_lshl_b32 s31, s28, 12
    v_and_b32 v1, 15, v0
    v_lshrrev_b32 v2, 4, v0
    s_lshl_b32 s46, s30, 14
    s_lshl_b32 s47, s29, 12
    s_add_u32 s46, s46, s47
    v_lshlrev_b32 v246, 1, v2
    v_xor_b32 v246, v246, v1
    v_lshlrev_b32 v246, 4, v246
    v_lshl_add_u32 v246, v2, 8, v246
    v_add_u32 v228, s46, v246
    v_xor_b32 v229, 0x80, v228
    s_lshl_b32 s48, s29, 1
    s_add_u32 s48, s48, s30
    s_lshl_b32 s48, s48, 13
    s_add_u32 s49, s48, s45
    s_add_u32 s49, s49, 4096
    s_mul_i32 s55, s29, 49152
    s_add_u32 s55, s55, 0x18000
    s_lshl_b32 s46, s30, 13
    s_add_u32 s50, s55, s46
    v_lshlrev_b32 v247, 4, v0
    v_add_u32 v248, s50, v246
    v_xor_b32 v249, 0x80, v248
    s_lshl_b32 s51, s28, 13
    v_and_b32 v250, 7, v0
    v_xor_b32 v250, v250, v2
    v_lshlrev_b32 v250, 4, v250
    v_lshrrev_b32 v251, 3, v0
    v_lshl_add_u32 v250, v251, 8, v250
    v_add_u32 v224, s51, v250
    v_add_u32 v225, 0x400, v224
    v_add_u32 v226, 0x800, v224
    v_add_u32 v227, 0xc00, v224
    v_and_b32 v250, 7, v1
    v_lshlrev_b32 v250, 1, v250
    v_xor_b32 v250, v250, v2
    v_lshlrev_b32 v250, 4, v250
    v_lshl_add_u32 v250, v1, 8, v250
    v_add_u32 v212, s46, v250
    v_xor_b32 v213, 0x40, v212
    v_xor_b32 v214, 0x80, v212
    v_xor_b32 v215, 0xc0, v212
    v_add_u32 v180, s55, v212
    v_add_u32 v181, s55, v213
    v_add_u32 v182, s55, v214
    v_add_u32 v183, s55, v215
    v_xor_b32 v184, 0x2000, v180
    v_xor_b32 v185, 0x2000, v181
    v_xor_b32 v186, 0x2000, v182
    v_xor_b32 v187, 0x2000, v183
    s_mul_i32 s46, s30, 49152
    s_add_u32 s46, s46, 0x10000
    s_add_u32 s33, s46, s47
    v_lshrrev_b32 v252, 1, v0
    v_bfe_u32 v253, v0, 3, 2
    v_and_b32 v251, 1, v0
    v_lshlrev_b32 v250, 6, v252
    v_lshl_add_u32 v250, v253, 4, v250
    v_lshl_add_u32 v250, v251, 3, v250
    v_add_u32 v220, s46, v250
    v_xor_b32 v221, 0x10, v220
    v_xor_b32 v222, 0x20, v220
    v_xor_b32 v223, 0x30, v220
    v_and_b32 v251, 3, v0
    s_waitcnt lgkmcnt(0)
    s_add_u32 s12, s6, s44
    s_addc_u32 s13, s7, 0
    s_add_u32 m0, s31, 0x0
    s_add_u32 s32, s64, 0x0
    s_and_b32 s32, s32, 0x7ffff
    s_add_u32 s72, s12, s32
    s_addc_u32 s73, s13, 0
    global_load_lds_dwordx4 v228, s[72:73] nt
    global_load_lds_dwordx4 v229, s[72:73] offset:1024 nt
    global_load_lds_dwordx4 v228, s[72:73] offset:2048 nt
    global_load_lds_dwordx4 v229, s[72:73] offset:3072 nt
    s_add_u32 s16, s4, s49
    s_addc_u32 s17, s5, 0
    global_load_dwordx4 v[148:151], v247, s[16:17] offset:-4096 nt
    global_load_dwordx4 v[152:155], v247, s[16:17] offset:-3072 nt
    global_load_dwordx4 v[156:159], v247, s[16:17] offset:-2048 nt
    global_load_dwordx4 v[160:163], v247, s[16:17] offset:-1024 nt
    s_add_u32 m0, s31, 0x4000
    s_add_u32 s32, s65, 0x0
    s_and_b32 s32, s32, 0x7ffff
    s_add_u32 s74, s12, s32
    s_addc_u32 s75, s13, 0
    global_load_lds_dwordx4 v228, s[74:75] nt
    global_load_lds_dwordx4 v229, s[74:75] offset:1024 nt
    global_load_lds_dwordx4 v228, s[74:75] offset:2048 nt
    global_load_lds_dwordx4 v229, s[74:75] offset:3072 nt
    s_add_u32 s14, s8, s44
    s_addc_u32 s15, s9, 0
    s_waitcnt vmcnt(12)
    s_mov_b64 exec, 0
    s_cmp_eq_u32 s28, 0
    s_cbranch_scc1 M_stub0
    s_cmp_eq_u32 s28, 1
    s_cbranch_scc1 M_stub1
    s_cmp_eq_u32 s28, 2
    s_cbranch_scc1 M_stub2
    s_branch M_stub3
M_back:
    s_mov_b64 exec, -1
    v_cmp_gt_u32 vcc, 2, v251
    v_mov_b32 v250, 0x3f803f80
    s_mov_b32 s40, 0x3e0293ee
    v_cndmask_b32 v250, 0, v250, vcc
    v_cmp_eq_u32 vcc, 1, v251
    v_mov_b32 v251, 0x44444444
    v_mov_b32 v252, 0xeeeeeeee
    s_mov_b32 s41, 0x3e0293ee
    v_cndmask_b32 v236, v251, v252, vcc
    s_mov_b32 s42, 0xffff0000
    v_accvgpr_write_b32 a144, v250
    v_accvgpr_write_b32 a145, v250
    v_accvgpr_write_b32 a146, v250
    v_accvgpr_write_b32 a147, v250
    v_accvgpr_write_b32 a128, 0
    v_accvgpr_write_b32 a129, 0
    v_accvgpr_write_b32 a130, 0
    v_accvgpr_write_b32 a131, 0
    v_accvgpr_write_b32 a132, 0
    v_accvgpr_write_b32 a133, 0
    v_accvgpr_write_b32 a134, 0
    v_accvgpr_write_b32 a135, 0
    v_accvgpr_write_b32 a136, 0
    v_accvgpr_write_b32 a137, 0
    v_accvgpr_write_b32 a138, 0
    v_accvgpr_write_b32 a139, 0
    v_accvgpr_write_b32 a140, 0
    v_accvgpr_write_b32 a141, 0
    v_accvgpr_write_b32 a142, 0
    v_accvgpr_write_b32 a143, 0
    s_add_u32 s84, s33, 0x6000
    s_lshl_b32 s85, s28, 11
    s_lshl_b32 s86, s28, 10
    s_add_u32 s86, s86, 0x14000
    s_lshl_b32 s87, s28, 2
    s_add_u32 s87, s87, 0x15000
    s_lshl_b32 s47, s29, 14
    global_load_dwordx4 v[164:167], v247, s[16:17] nt
    global_load_dwordx4 v[168:171], v247, s[16:17] offset:1024 nt
    global_load_dwordx4 v[172:175], v247, s[16:17] offset:2048 nt
    global_load_dwordx4 v[176:179], v247, s[16:17] offset:3072 nt
    s_waitcnt vmcnt(11)
    v_lshlrev_b32 v188, 16, v148
    v_and_b32 v189, s42, v148
    v_lshlrev_b32 v190, 16, v149
    v_and_b32 v191, s42, v149
    v_pk_mul_f32 v[188:189], v[188:189], s[40:41]
    v_pk_mul_f32 v[190:191], v[190:191], s[40:41]
    v_cvt_pk_bf16_f32 v148, v188, v189
    v_cvt_pk_bf16_f32 v149, v190, v191
    v_lshlrev_b32 v188, 16, v150
    v_and_b32 v189, s42, v150
    v_lshlrev_b32 v190, 16, v151
    v_and_b32 v191, s42, v151
    v_pk_mul_f32 v[188:189], v[188:189], s[40:41]
    v_pk_mul_f32 v[190:191], v[190:191], s[40:41]
    v_cvt_pk_bf16_f32 v150, v188, v189
    v_cvt_pk_bf16_f32 v151, v190, v191
    ds_write_b128 v248, v[148:151]
    s_add_u32 m0, s31, 0x8000
    s_add_u32 s32, s64, 0x8000
    s_and_b32 s32, s32, 0x7ffff
    s_add_u32 s72, s12, s32
    s_addc_u32 s73, s13, 0
    global_load_lds_dwordx4 v228, s[72:73] nt
    s_waitcnt vmcnt(11)
    v_lshlrev_b32 v188, 16, v152
    v_and_b32 v189, s42, v152
    v_lshlrev_b32 v190, 16, v153
    v_and_b32 v191, s42, v153
    v_pk_mul_f32 v[188:189], v[188:189], s[40:41]
    v_pk_mul_f32 v[190:191], v[190:191], s[40:41]
    v_cvt_pk_bf16_f32 v152, v188, v189
    v_cvt_pk_bf16_f32 v153, v190, v191
    v_lshlrev_b32 v188, 16, v154
    v_and_b32 v189, s42, v154
    v_lshlrev_b32 v190, 16, v155
    v_and_b32 v191, s42, v155
    v_pk_mul_f32 v[188:189], v[188:189], s[40:41]
    v_pk_mul_f32 v[190:191], v[190:191], s[40:41]
    v_cvt_pk_bf16_f32 v154, v188, v189
    v_cvt_pk_bf16_f32 v155, v190, v191
    ds_write_b128 v249, v[152:155] offset:1024
    global_load_lds_dwordx4 v229, s[72:73] offset:1024 nt
    s_waitcnt vmcnt(11)
    v_lshlrev_b32 v188, 16, v156
    v_and_b32 v189, s42, v156
    v_lshlrev_b32 v190, 16, v157
    v_and_b32 v191, s42, v157
    v_pk_mul_f32 v[188:189], v[188:189], s[40:41]
    v_pk_mul_f32 v[190:191], v[190:191], s[40:41]
    v_cvt_pk_bf16_f32 v156, v188, v189
    v_cvt_pk_bf16_f32 v157, v190, v191
    v_lshlrev_b32 v188, 16, v158
    v_and_b32 v189, s42, v158
    v_lshlrev_b32 v190, 16, v159
    v_and_b32 v191, s42, v159
    v_pk_mul_f32 v[188:189], v[188:189], s[40:41]
    v_pk_mul_f32 v[190:191], v[190:191], s[40:41]
    v_cvt_pk_bf16_f32 v158, v188, v189
    v_cvt_pk_bf16_f32 v159, v190, v191
    ds_write_b128 v248, v[156:159] offset:2048
    global_load_lds_dwordx4 v228, s[72:73] offset:2048 nt
    s_waitcnt vmcnt(11)
    v_lshlrev_b32 v188, 16, v160
    v_and_b32 v189, s42, v160
    v_lshlrev_b32 v190, 16, v161
    v_and_b32 v191, s42, v161
    v_pk_mul_f32 v[188:189], v[188:189], s[40:41]
    v_pk_mul_f32 v[190:191], v[190:191], s[40:41]
    v_cvt_pk_bf16_f32 v160, v188, v189
    v_cvt_pk_bf16_f32 v161, v190, v191
    v_lshlrev_b32 v188, 16, v162
    v_and_b32 v189, s42, v162
    v_lshlrev_b32 v190, 16, v163
    v_and_b32 v191, s42, v163
    v_pk_mul_f32 v[188:189], v[188:189], s[40:41]
    v_pk_mul_f32 v[190:191], v[190:191], s[40:41]
    v_cvt_pk_bf16_f32 v162, v188, v189
    v_cvt_pk_bf16_f32 v163, v190, v191
    ds_write_b128 v249, v[160:163] offset:3072
    global_load_lds_dwordx4 v229, s[72:73] offset:3072 nt
    s_waitcnt vmcnt(8) lgkmcnt(0)
    s_barrier
    ds_read_b128 a[64:67], v212
    ds_read_b128 a[148:151], v180
    ds_read_b128 a[68:71], v213
    ds_read_b128 a[152:155], v181
    ds_read_b128 a[72:75], v214
    ds_read_b128 a[156:159], v182
    ds_read_b128 a[76:79], v215
    ds_read_b128 a[160:163], v183
    ds_read_b128 a[180:183], v184
    ds_read_b128 a[184:187], v185
    ds_read_b128 a[188:191], v186
    ds_read_b128 a[192:195], v187
    s_branch M_main
.p2align 12
M_main:
M_stub0:
    s_cbranch_execz M_stub4
    s_waitcnt lgkmcnt(4)
    v_mfma_f32_16x16x32_bf16 v[84:87], a[64:67], a[148:151], 0
    ds_read_b128 a[80:83], v212 offset:4096
    s_add_u32 m0, s31, 0xc000
    v_mfma_f32_16x16x32_bf16 v[84:87], a[68:71], a[152:155], v[84:87]
    ds_read_b128 a[84:87], v213 offset:4096
    s_add_u32 s32, s65, 0x8000
    v_mfma_f32_16x16x32_bf16 v[84:87], a[72:75], a[156:159], v[84:87]
    ds_read_b128 a[88:91], v214 offset:4096
    s_and_b32 s32, s32, 0x7ffff
    v_mfma_f32_16x16x32_bf16 v[84:87], a[76:79], a[160:163], v[84:87]
    ds_read_b128 a[92:95], v215 offset:4096
    s_add_u32 s74, s12, s32
    s_waitcnt lgkmcnt(4)
    v_mfma_f32_16x16x32_bf16 v[88:91], a[72:75], a[188:191], 0
    ds_read_b128 a[212:215], v212 offset:16384
    s_addc_u32 s75, s13, 0
    v_mfma_f32_16x16x32_bf16 v[88:91], a[76:79], a[192:195], v[88:91]
    ds_read_b128 a[216:219], v213 offset:16384
    global_load_lds_dwordx4 v228, s[74:75] nt
    v_mfma_f32_16x16x32_bf16 v[88:91], a[64:67], a[180:183], v[88:91]
    ds_read_b128 a[220:223], v214 offset:16384
    global_load_lds_dwordx4 v229, s[74:75] offset:1024 nt
    v_mfma_f32_16x16x32_bf16 v[88:91], a[68:71], a[184:187], v[88:91]
    ds_read_b128 a[224:227], v215 offset:16384
    s_waitcnt lgkmcnt(4)
    v_mfma_f32_16x16x32_bf16 v[92:95], a[80:83], a[148:151], 0
    ds_read_b128 a[228:231], v212 offset:20480
    global_load_lds_dwordx4 v228, s[74:75] offset:2048 nt
    v_sub_f32 v84, v84, v232
    v_exp_f32 v84, v84
    v_sub_f32 v85, v85, v232
    v_exp_f32 v85, v85
    v_mfma_f32_16x16x32_bf16 v[92:95], a[84:87], a[152:155], v[92:95]
    ds_read_b128 a[232:235], v213 offset:20480
    global_load_lds_dwordx4 v229, s[74:75] offset:3072 nt
    v_sub_f32 v86, v86, v232
    v_exp_f32 v86, v86
    v_cvt_pk_bf16_f32 v20, v84, v85
    v_mfma_f32_16x16x32_bf16 v[92:95], a[88:91], a[156:159], v[92:95]
    ds_read_b128 a[236:239], v214 offset:20480
    s_add_u32 m0, s33, 0x0
    v_sub_f32 v87, v87, v232
    v_exp_f32 v87, v87
    v_sub_f32 v88, v88, v234
    v_exp_f32 v88, v88
    v_mfma_f32_16x16x32_bf16 v[92:95], a[92:95], a[160:163], v[92:95]
    ds_read_b128 a[240:243], v215 offset:20480
    v_cvt_pk_bf16_f32 v21, v86, v87
    v_sub_f32 v89, v89, v234
    v_exp_f32 v89, v89
    v_sub_f32 v90, v90, v234
    v_exp_f32 v90, v90
    v_mfma_f32_16x16x32_bf16 v[96:99], a[88:91], a[188:191], 0
    s_add_u32 s32, s66, 0x0
    v_cvt_pk_bf16_f32 v36, v88, v89
    s_waitcnt vmcnt(11)
    v_lshlrev_b32 v188, 16, v164
    v_and_b32 v189, s42, v164
    v_lshlrev_b32 v190, 16, v165
    v_mfma_f32_16x16x32_bf16 v[96:99], a[92:95], a[192:195], v[96:99]
    s_and_b32 s32, s32, 0x7ffff
    v_and_b32 v191, s42, v165
    v_mul_f32 v188, s40, v188
    v_mul_f32 v189, s40, v189
    v_mul_f32 v190, s40, v190
    v_mul_f32 v191, s40, v191
    v_mfma_f32_16x16x32_bf16 v[96:99], a[80:83], a[180:183], v[96:99]
    s_add_u32 s72, s14, s32
    v_cvt_pk_bf16_f32 v164, v188, v189
    v_cvt_pk_bf16_f32 v165, v190, v191
    v_lshlrev_b32 v188, 16, v166
    v_and_b32 v189, s42, v166
    v_lshlrev_b32 v190, 16, v167
    v_mfma_f32_16x16x32_bf16 v[96:99], a[84:87], a[184:187], v[96:99]
    v_and_b32 v191, s42, v167
    v_mul_f32 v188, s40, v188
    v_mul_f32 v189, s40, v189
    v_mul_f32 v190, s40, v190
    v_mul_f32 v191, s40, v191
    s_waitcnt lgkmcnt(4)
    v_mfma_f32_16x16x32_bf16 v[100:103], a[212:215], a[148:151], 0
    s_addc_u32 s73, s15, 0
    v_cvt_pk_bf16_f32 v166, v188, v189
    v_cvt_pk_bf16_f32 v167, v190, v191
    v_mfma_f32_16x16x32_bf16 v[100:103], a[216:219], a[152:155], v[100:103]
    global_load_lds_dwordx4 v224, s[72:73] nt
    ds_write_b128 v248, v[164:167] offset:4096
    s_waitcnt vmcnt(11)
    v_lshlrev_b32 v188, 16, v168
    v_and_b32 v189, s42, v168
    v_lshlrev_b32 v190, 16, v169
    v_and_b32 v191, s42, v169
    v_mul_f32 v188, s40, v188
    v_mul_f32 v189, s40, v189
    v_mfma_f32_16x16x32_bf16 v[100:103], a[220:223], a[156:159], v[100:103]
    global_load_lds_dwordx4 v225, s[72:73] offset:1024 nt
    v_mul_f32 v190, s40, v190
    v_mul_f32 v191, s40, v191
    v_cvt_pk_bf16_f32 v168, v188, v189
    v_cvt_pk_bf16_f32 v169, v190, v191
    v_mfma_f32_16x16x32_bf16 v[100:103], a[224:227], a[160:163], v[100:103]
    v_lshlrev_b32 v188, 16, v170
    v_and_b32 v189, s42, v170
    v_lshlrev_b32 v190, 16, v171
    v_and_b32 v191, s42, v171
    v_mul_f32 v188, s40, v188
    v_mfma_f32_16x16x32_bf16 v[104:107], a[220:223], a[188:191], 0
    global_load_lds_dwordx4 v226, s[72:73] offset:2048 nt
    v_mul_f32 v189, s40, v189
    v_mul_f32 v190, s40, v190
    v_mul_f32 v191, s40, v191
    v_cvt_pk_bf16_f32 v170, v188, v189
    v_cvt_pk_bf16_f32 v171, v190, v191
    v_mfma_f32_16x16x32_bf16 v[104:107], a[224:227], a[192:195], v[104:107]
    global_load_lds_dwordx4 v227, s[72:73] offset:3072 nt
    ds_write_b128 v249, v[168:171] offset:5120
    s_waitcnt vmcnt(13)
    v_lshlrev_b32 v188, 16, v172
    v_and_b32 v189, s42, v172
    v_lshlrev_b32 v190, 16, v173
    v_mfma_f32_16x16x32_bf16 v[104:107], a[212:215], a[180:183], v[104:107]
    s_add_u32 m0, s33, 0x2000
    v_and_b32 v191, s42, v173
    v_mul_f32 v188, s40, v188
    v_mul_f32 v189, s40, v189
    v_mul_f32 v190, s40, v190
    v_mul_f32 v191, s40, v191
    v_mfma_f32_16x16x32_bf16 v[104:107], a[216:219], a[184:187], v[104:107]
    v_cvt_pk_bf16_f32 v172, v188, v189
    v_cvt_pk_bf16_f32 v173, v190, v191
    v_lshlrev_b32 v188, 16, v174
    v_and_b32 v189, s42, v174
    v_lshlrev_b32 v190, 16, v175
    s_waitcnt lgkmcnt(2)
    v_mfma_f32_16x16x32_bf16 v[108:111], a[228:231], a[148:151], 0
    s_add_u32 s32, s66, 0x8000
    v_and_b32 v191, s42, v175
    v_mul_f32 v188, s40, v188
    v_mul_f32 v189, s40, v189
    v_mul_f32 v190, s40, v190
    v_mul_f32 v191, s40, v191
    v_mfma_f32_16x16x32_bf16 v[108:111], a[232:235], a[152:155], v[108:111]
    s_and_b32 s32, s32, 0x7ffff
    v_cvt_pk_bf16_f32 v174, v188, v189
    v_cvt_pk_bf16_f32 v175, v190, v191
    v_mfma_f32_16x16x32_bf16 v[108:111], a[236:239], a[156:159], v[108:111]
    s_add_u32 s74, s14, s32
    ds_write_b128 v248, v[172:175] offset:6144
    s_waitcnt vmcnt(12)
    v_lshlrev_b32 v188, 16, v176
    v_and_b32 v189, s42, v176
    v_lshlrev_b32 v190, 16, v177
    v_and_b32 v191, s42, v177
    v_mul_f32 v188, s40, v188
    v_mul_f32 v189, s40, v189
    v_mul_f32 v190, s40, v190
    v_mfma_f32_16x16x32_bf16 v[108:111], a[240:243], a[160:163], v[108:111]
    v_mul_f32 v191, s40, v191
    v_cvt_pk_bf16_f32 v176, v188, v189
    v_cvt_pk_bf16_f32 v177, v190, v191
    v_lshlrev_b32 v188, 16, v178
    v_and_b32 v189, s42, v178
    v_mfma_f32_16x16x32_bf16 v[112:115], a[236:239], a[188:191], 0
    s_addc_u32 s75, s15, 0
    v_lshlrev_b32 v190, 16, v179
    v_and_b32 v191, s42, v179
    v_mul_f32 v188, s40, v188
    v_mul_f32 v189, s40, v189
    v_mul_f32 v190, s40, v190
    v_mfma_f32_16x16x32_bf16 v[112:115], a[240:243], a[192:195], v[112:115]
    global_load_lds_dwordx4 v224, s[74:75] nt
    v_mul_f32 v191, s40, v191
    v_cvt_pk_bf16_f32 v178, v188, v189
    v_cvt_pk_bf16_f32 v179, v190, v191
    v_mfma_f32_16x16x32_bf16 v[112:115], a[228:231], a[180:183], v[112:115]
    global_load_lds_dwordx4 v225, s[74:75] offset:1024 nt
    ds_write_b128 v249, v[176:179] offset:7168
    v_sub_f32 v91, v91, v234
    v_exp_f32 v91, v91
    v_sub_f32 v92, v92, v232
    v_exp_f32 v92, v92
    v_mfma_f32_16x16x32_bf16 v[112:115], a[232:235], a[184:187], v[112:115]
    s_waitcnt lgkmcnt(0)
    s_barrier
    ds_read_b128 a[164:167], v180 offset:4096
    ds_read_b128 a[168:171], v181 offset:4096
    ds_read_b128 a[172:175], v182 offset:4096
    ds_read_b128 a[176:179], v183 offset:4096
    ds_read_b128 a[196:199], v184 offset:4096
    ds_read_b128 a[200:203], v185 offset:4096
    ds_read_b128 a[204:207], v186 offset:4096
    ds_read_b128 a[208:211], v187 offset:4096
    v_cvt_pk_bf16_f32 v37, v90, v91
    v_sub_f32 v93, v93, v232
    v_exp_f32 v93, v93
    v_sub_f32 v94, v94, v232
    v_exp_f32 v94, v94
    v_cvt_pk_bf16_f32 v22, v92, v93
    v_sub_f32 v95, v95, v232
    v_exp_f32 v95, v95
    v_sub_f32 v96, v96, v234
    v_exp_f32 v96, v96
    v_cvt_pk_bf16_f32 v23, v94, v95
    v_sub_f32 v97, v97, v234
    v_exp_f32 v97, v97
    v_sub_f32 v98, v98, v234
    v_exp_f32 v98, v98
    v_cvt_pk_bf16_f32 v38, v96, v97
    v_sub_f32 v99, v99, v234
    v_exp_f32 v99, v99
    s_waitcnt lgkmcnt(4)
    v_mfma_f32_16x16x32_bf16 v[116:119], a[64:67], a[164:167], 0
    global_load_lds_dwordx4 v226, s[74:75] offset:2048 nt
    v_sub_f32 v100, v100, v232
    v_exp_f32 v100, v100
    v_cvt_pk_bf16_f32 v39, v98, v99
    v_mfma_f32_16x16x32_bf16 v[116:119], a[68:71], a[168:171], v[116:119]
    global_load_lds_dwordx4 v227, s[74:75] offset:3072 nt
    v_sub_f32 v101, v101, v232
    v_exp_f32 v101, v101
    v_mfma_f32_16x16x32_bf16 v[116:119], a[72:75], a[172:175], v[116:119]
    v_sub_f32 v102, v102, v232
    v_exp_f32 v102, v102
    v_cvt_pk_bf16_f32 v24, v100, v101
    v_mfma_f32_16x16x32_bf16 v[116:119], a[76:79], a[176:179], v[116:119]
    s_add_u32 m0, s31, 0x0
    v_sub_f32 v103, v103, v232
    v_exp_f32 v103, v103
    v_sub_f32 v104, v104, v234
    v_exp_f32 v104, v104
    s_waitcnt lgkmcnt(0)
    v_mfma_f32_16x16x32_bf16 v[120:123], a[72:75], a[204:207], 0
    v_cvt_pk_bf16_f32 v25, v102, v103
    v_sub_f32 v105, v105, v234
    v_exp_f32 v105, v105
    v_mfma_f32_16x16x32_bf16 v[120:123], a[76:79], a[208:211], v[120:123]
    s_add_u32 s32, s64, 0x10000
    v_sub_f32 v106, v106, v234
    v_exp_f32 v106, v106
    v_mfma_f32_16x16x32_bf16 v[120:123], a[64:67], a[196:199], v[120:123]
    v_cvt_pk_bf16_f32 v40, v104, v105
    v_sub_f32 v107, v107, v234
    v_exp_f32 v107, v107
    v_mfma_f32_16x16x32_bf16 v[120:123], a[68:71], a[200:203], v[120:123]
    s_and_b32 s32, s32, 0x7ffff
    v_sub_f32 v108, v108, v232
    v_exp_f32 v108, v108
    v_cvt_pk_bf16_f32 v41, v106, v107
    v_mfma_f32_16x16x32_bf16 v[124:127], a[80:83], a[164:167], 0
    s_add_u32 s72, s12, s32
    v_sub_f32 v109, v109, v232
    v_exp_f32 v109, v109
    v_sub_f32 v110, v110, v232
    v_exp_f32 v110, v110
    v_mfma_f32_16x16x32_bf16 v[124:127], a[84:87], a[168:171], v[124:127]
    v_cvt_pk_bf16_f32 v26, v108, v109
    v_sub_f32 v111, v111, v232
    v_exp_f32 v111, v111
    v_mfma_f32_16x16x32_bf16 v[124:127], a[88:91], a[172:175], v[124:127]
    s_addc_u32 s73, s13, 0
    v_sub_f32 v112, v112, v234
    v_exp_f32 v112, v112
    v_mfma_f32_16x16x32_bf16 v[124:127], a[92:95], a[176:179], v[124:127]
    v_cvt_pk_bf16_f32 v27, v110, v111
    v_sub_f32 v113, v113, v234
    v_exp_f32 v113, v113
    v_mfma_f32_16x16x32_bf16 v[128:131], a[88:91], a[204:207], 0
    global_load_lds_dwordx4 v228, s[72:73] nt
    v_sub_f32 v114, v114, v234
    v_exp_f32 v114, v114
    v_mfma_f32_16x16x32_bf16 v[128:131], a[92:95], a[208:211], v[128:131]
    v_cvt_pk_bf16_f32 v42, v112, v113
    v_sub_f32 v115, v115, v234
    v_exp_f32 v115, v115
    v_mfma_f32_16x16x32_bf16 v[128:131], a[80:83], a[196:199], v[128:131]
    global_load_lds_dwordx4 v229, s[72:73] offset:1024 nt
    v_sub_f32 v116, v116, v233
    v_exp_f32 v116, v116
    v_mfma_f32_16x16x32_bf16 v[128:131], a[84:87], a[200:203], v[128:131]
    s_waitcnt vmcnt(14) lgkmcnt(0)
    s_barrier
    v_cvt_pk_bf16_f32 v43, v114, v115
    v_sub_f32 v117, v117, v233
    v_exp_f32 v117, v117
    v_mfma_f32_16x16x32_bf16 v[132:135], a[212:215], a[164:167], 0
    ds_read_b128 a[64:67], v212 offset:32768
    global_load_lds_dwordx4 v228, s[72:73] offset:2048 nt
    v_sub_f32 v118, v118, v233
    v_exp_f32 v118, v118
    v_mfma_f32_16x16x32_bf16 v[132:135], a[216:219], a[168:171], v[132:135]
    ds_read_b128 a[68:71], v213 offset:32768
    global_load_lds_dwordx4 v229, s[72:73] offset:3072 nt
    v_cvt_pk_bf16_f32 v28, v116, v117
    v_mfma_f32_16x16x32_bf16 v[132:135], a[220:223], a[172:175], v[132:135]
    ds_read_b128 a[72:75], v214 offset:32768
    v_sub_f32 v119, v119, v233
    v_exp_f32 v119, v119
    v_mfma_f32_16x16x32_bf16 v[132:135], a[224:227], a[176:179], v[132:135]
    ds_read_b128 a[76:79], v215 offset:32768
    s_add_u32 m0, s31, 0x4000
    v_sub_f32 v120, v120, v235
    v_exp_f32 v120, v120
    v_cvt_pk_bf16_f32 v29, v118, v119
    v_mfma_f32_16x16x32_bf16 v[136:139], a[220:223], a[204:207], 0
    v_sub_f32 v121, v121, v235
    v_exp_f32 v121, v121
    v_sub_f32 v122, v122, v235
    v_exp_f32 v122, v122
    v_mfma_f32_16x16x32_bf16 v[136:139], a[224:227], a[208:211], v[136:139]
    s_add_u32 s32, s65, 0x10000
    v_cvt_pk_bf16_f32 v44, v120, v121
    v_sub_f32 v123, v123, v235
    v_exp_f32 v123, v123
    v_mfma_f32_16x16x32_bf16 v[136:139], a[212:215], a[196:199], v[136:139]
    v_sub_f32 v124, v124, v233
    v_exp_f32 v124, v124
    v_cvt_pk_bf16_f32 v45, v122, v123
    v_mfma_f32_16x16x32_bf16 v[136:139], a[216:219], a[200:203], v[136:139]
    s_and_b32 s32, s32, 0x7ffff
    v_sub_f32 v125, v125, v233
    v_exp_f32 v125, v125
    v_sub_f32 v126, v126, v233
    v_exp_f32 v126, v126
    v_mfma_f32_16x16x32_bf16 v[140:143], a[228:231], a[164:167], 0
    s_add_u32 s74, s12, s32
    v_cvt_pk_bf16_f32 v30, v124, v125
    v_sub_f32 v127, v127, v233
    v_exp_f32 v127, v127
    v_mfma_f32_16x16x32_bf16 v[140:143], a[232:235], a[168:171], v[140:143]
    v_sub_f32 v128, v128, v235
    v_exp_f32 v128, v128
    v_cvt_pk_bf16_f32 v31, v126, v127
    v_mfma_f32_16x16x32_bf16 v[140:143], a[236:239], a[172:175], v[140:143]
    s_addc_u32 s75, s13, 0
    v_sub_f32 v129, v129, v235
    v_exp_f32 v129, v129
    v_sub_f32 v130, v130, v235
    v_exp_f32 v130, v130
    v_mfma_f32_16x16x32_bf16 v[140:143], a[240:243], a[176:179], v[140:143]
    v_cvt_pk_bf16_f32 v46, v128, v129
    v_sub_f32 v131, v131, v235
    v_exp_f32 v131, v131
    v_mfma_f32_16x16x32_bf16 v[144:147], a[236:239], a[204:207], 0
    global_load_lds_dwordx4 v228, s[74:75] nt
    v_sub_f32 v132, v132, v233
    v_exp_f32 v132, v132
    v_mfma_f32_16x16x32_bf16 v[144:147], a[240:243], a[208:211], v[144:147]
    v_cvt_pk_bf16_f32 v47, v130, v131
    v_sub_f32 v133, v133, v233
    v_exp_f32 v133, v133
    v_mfma_f32_16x16x32_bf16 v[144:147], a[228:231], a[196:199], v[144:147]
    global_load_lds_dwordx4 v229, s[74:75] offset:1024 nt
    v_sub_f32 v134, v134, v233
    v_exp_f32 v134, v134
    v_mfma_f32_16x16x32_bf16 v[144:147], a[232:235], a[200:203], v[144:147]
    v_cvt_pk_bf16_f32 v32, v132, v133
    v_sub_f32 v135, v135, v233
    v_exp_f32 v135, v135
    s_waitcnt lgkmcnt(0)
    v_mfma_f32_16x16x32_bf16 v[84:87], a[64:67], a[148:151], 0
    ds_read_b128 a[80:83], v212 offset:36864
    global_load_lds_dwordx4 v228, s[74:75] offset:2048 nt
    v_sub_f32 v136, v136, v235
    v_exp_f32 v136, v136
    v_mfma_f32_16x16x32_bf16 v[84:87], a[68:71], a[152:155], v[84:87]
    ds_read_b128 a[84:87], v213 offset:36864
    v_cvt_pk_bf16_f32 v33, v134, v135
    v_sub_f32 v137, v137, v235
    v_exp_f32 v137, v137
    v_mfma_f32_16x16x32_bf16 v[84:87], a[72:75], a[156:159], v[84:87]
    ds_read_b128 a[88:91], v214 offset:36864
    global_load_lds_dwordx4 v229, s[74:75] offset:3072 nt
    v_mfma_f32_16x16x32_bf16 v[84:87], a[76:79], a[160:163], v[84:87]
    ds_read_b128 a[92:95], v215 offset:36864
    v_sub_f32 v138, v138, v235
    v_exp_f32 v138, v138
    v_mfma_f32_16x16x32_bf16 v[88:91], a[72:75], a[172:175], 0
    s_add_u32 m0, s33, 0x4000
    v_cvt_pk_bf16_f32 v48, v136, v137
    v_sub_f32 v139, v139, v235
    v_exp_f32 v139, v139
    v_sub_f32 v140, v140, v233
    v_exp_f32 v140, v140
    v_mfma_f32_16x16x32_bf16 v[88:91], a[76:79], a[176:179], v[88:91]
    v_cvt_pk_bf16_f32 v49, v138, v139
    v_sub_f32 v141, v141, v233
    v_exp_f32 v141, v141
    v_mfma_f32_16x16x32_bf16 v[88:91], a[64:67], a[164:167], v[88:91]
    s_add_u32 s32, s67, 0x0
    v_sub_f32 v142, v142, v233
    v_exp_f32 v142, v142
    v_mfma_f32_16x16x32_bf16 v[88:91], a[68:71], a[168:171], v[88:91]
    v_cvt_pk_bf16_f32 v34, v140, v141
    v_sub_f32 v143, v143, v233
    v_exp_f32 v143, v143
    v_mfma_f32_16x16x32_bf16 v[92:95], a[64:67], a[180:183], 0
    s_and_b32 s32, s32, 0x7ffff
    v_sub_f32 v144, v144, v235
    v_exp_f32 v144, v144
    v_cvt_pk_bf16_f32 v35, v142, v143
    v_sub_f32 v145, v145, v235
    v_exp_f32 v145, v145
    v_mfma_f32_16x16x32_bf16 v[92:95], a[68:71], a[184:187], v[92:95]
    v_sub_f32 v146, v146, v235
    v_exp_f32 v146, v146
    v_mfma_f32_16x16x32_bf16 v[92:95], a[72:75], a[188:191], v[92:95]
    s_add_u32 s72, s14, s32
    v_cvt_pk_bf16_f32 v50, v144, v145
    v_sub_f32 v147, v147, v235
    v_exp_f32 v147, v147
    v_mfma_f32_16x16x32_bf16 v[92:95], a[76:79], a[192:195], v[92:95]
    v_sub_f32 v84, v84, v232
    v_exp_f32 v84, v84
    v_cvt_pk_bf16_f32 v51, v146, v147
    v_mfma_f32_16x16x32_bf16 v[96:99], a[72:75], a[204:207], 0
    s_addc_u32 s73, s15, 0
    v_sub_f32 v85, v85, v232
    v_exp_f32 v85, v85
    v_sub_f32 v86, v86, v232
    v_exp_f32 v86, v86
    v_mfma_f32_16x16x32_bf16 v[96:99], a[76:79], a[208:211], v[96:99]
    v_cvt_pk_bf16_f32 v52, v84, v85
    v_sub_f32 v87, v87, v232
    v_exp_f32 v87, v87
    v_mfma_f32_16x16x32_bf16 v[96:99], a[64:67], a[196:199], v[96:99]
    global_load_lds_dwordx4 v224, s[72:73] nt
    v_sub_f32 v88, v88, v233
    v_exp_f32 v88, v88
    v_mfma_f32_16x16x32_bf16 v[96:99], a[68:71], a[200:203], v[96:99]
    s_waitcnt vmcnt(17) lgkmcnt(0)
    s_barrier
    v_cvt_pk_bf16_f32 v53, v86, v87
    v_sub_f32 v89, v89, v233
    v_exp_f32 v89, v89
    v_mfma_f32_16x16x32_bf16 v[100:103], a[80:83], a[148:151], 0
    ds_read_b128 a[64:67], v212 offset:49152
    global_load_lds_dwordx4 v225, s[72:73] offset:1024 nt
    v_sub_f32 v90, v90, v233
    v_exp_f32 v90, v90
    v_mfma_f32_16x16x32_bf16 v[100:103], a[84:87], a[152:155], v[100:103]
    ds_read_b128 a[68:71], v213 offset:49152
    v_cvt_pk_bf16_f32 v60, v88, v89
    v_sub_f32 v91, v91, v233
    v_exp_f32 v91, v91
    v_mfma_f32_16x16x32_bf16 v[100:103], a[88:91], a[156:159], v[100:103]
    ds_read_b128 a[72:75], v214 offset:49152
    v_sub_f32 v92, v92, v234
    v_exp_f32 v92, v92
    v_mfma_f32_16x16x32_bf16 v[100:103], a[92:95], a[160:163], v[100:103]
    ds_read_b128 a[76:79], v215 offset:49152
    v_cvt_pk_bf16_f32 v61, v90, v91
    v_mfma_f32_16x16x32_bf16 v[104:107], a[88:91], a[172:175], 0
    v_sub_f32 v93, v93, v234
    v_exp_f32 v93, v93
    v_sub_f32 v94, v94, v234
    v_exp_f32 v94, v94
    v_mfma_f32_16x16x32_bf16 v[104:107], a[92:95], a[176:179], v[104:107]
    global_load_lds_dwordx4 v226, s[72:73] offset:2048 nt
    v_cvt_pk_bf16_f32 v68, v92, v93
    v_mfma_f32_16x16x32_bf16 v[104:107], a[80:83], a[164:167], v[104:107]
    v_sub_f32 v95, v95, v234
    v_exp_f32 v95, v95
    v_sub_f32 v96, v96, v235
    v_exp_f32 v96, v96
    v_mfma_f32_16x16x32_bf16 v[104:107], a[84:87], a[168:171], v[104:107]
    v_cvt_pk_bf16_f32 v69, v94, v95
    v_sub_f32 v97, v97, v235
    v_exp_f32 v97, v97
    v_mfma_f32_16x16x32_bf16 v[108:111], a[80:83], a[180:183], 0
    v_sub_f32 v98, v98, v235
    v_exp_f32 v98, v98
    v_mfma_f32_16x16x32_bf16 v[108:111], a[84:87], a[184:187], v[108:111]
    v_cvt_pk_bf16_f32 v76, v96, v97
    v_sub_f32 v99, v99, v235
    v_exp_f32 v99, v99
    v_mfma_f32_16x16x32_bf16 v[108:111], a[88:91], a[188:191], v[108:111]
    global_load_lds_dwordx4 v227, s[72:73] offset:3072 nt
    v_sub_f32 v100, v100, v232
    v_exp_f32 v100, v100
    v_mfma_f32_16x16x32_bf16 v[108:111], a[92:95], a[192:195], v[108:111]
    v_cvt_pk_bf16_f32 v77, v98, v99
    v_sub_f32 v101, v101, v232
    v_exp_f32 v101, v101
    v_mfma_f32_16x16x32_bf16 v[112:115], a[88:91], a[204:207], 0
    v_sub_f32 v102, v102, v232
    v_exp_f32 v102, v102
    v_cvt_pk_bf16_f32 v54, v100, v101
    v_mfma_f32_16x16x32_bf16 v[112:115], a[92:95], a[208:211], v[112:115]
    v_sub_f32 v103, v103, v232
    v_exp_f32 v103, v103
    v_sub_f32 v104, v104, v233
    v_exp_f32 v104, v104
    v_mfma_f32_16x16x32_bf16 v[112:115], a[80:83], a[196:199], v[112:115]
    v_cvt_pk_bf16_f32 v55, v102, v103
    v_sub_f32 v105, v105, v233
    v_exp_f32 v105, v105
    v_mfma_f32_16x16x32_bf16 v[112:115], a[84:87], a[200:203], v[112:115]
    v_sub_f32 v106, v106, v233
    v_exp_f32 v106, v106
    v_smfmac_f32_16x16x64_bf16 a[128:131], a[144:147], v[20:27], v236
    v_cvt_pk_bf16_f32 v62, v104, v105
    v_sub_f32 v107, v107, v233
    v_exp_f32 v107, v107
    s_waitcnt lgkmcnt(0)
    v_mfma_f32_16x16x32_bf16 v[116:119], a[64:67], a[148:151], 0
    ds_read_b128 a[80:83], v212 offset:53248
    s_add_u32 m0, s31, 0x8000
    v_sub_f32 v108, v108, v234
    v_exp_f32 v108, v108
    v_cvt_pk_bf16_f32 v63, v106, v107
    v_mfma_f32_16x16x32_bf16 v[116:119], a[68:71], a[152:155], v[116:119]
    ds_read_b128 a[84:87], v213 offset:53248
    v_sub_f32 v109, v109, v234
    v_exp_f32 v109, v109
    v_mfma_f32_16x16x32_bf16 v[116:119], a[72:75], a[156:159], v[116:119]
    ds_read_b128 a[88:91], v214 offset:53248
    s_add_u32 s32, s64, 0x18000
    v_sub_f32 v110, v110, v234
    v_exp_f32 v110, v110
    v_mfma_f32_16x16x32_bf16 v[116:119], a[76:79], a[160:163], v[116:119]
    ds_read_b128 a[92:95], v215 offset:53248
    v_cvt_pk_bf16_f32 v70, v108, v109
    v_sub_f32 v111, v111, v234
    v_exp_f32 v111, v111
    v_mfma_f32_16x16x32_bf16 v[120:123], a[72:75], a[172:175], 0
    s_and_b32 s32, s32, 0x7ffff
    v_sub_f32 v112, v112, v235
    v_exp_f32 v112, v112
    v_mfma_f32_16x16x32_bf16 v[120:123], a[76:79], a[176:179], v[120:123]
    v_cvt_pk_bf16_f32 v71, v110, v111
    v_sub_f32 v113, v113, v235
    v_exp_f32 v113, v113
    v_mfma_f32_16x16x32_bf16 v[120:123], a[64:67], a[164:167], v[120:123]
    s_add_u32 s74, s12, s32
    v_sub_f32 v114, v114, v235
    v_exp_f32 v114, v114
    v_cvt_pk_bf16_f32 v78, v112, v113
    v_mfma_f32_16x16x32_bf16 v[120:123], a[68:71], a[168:171], v[120:123]
    v_sub_f32 v115, v115, v235
    v_exp_f32 v115, v115
    v_sub_f32 v116, v116, v232
    v_exp_f32 v116, v116
    v_mfma_f32_16x16x32_bf16 v[124:127], a[64:67], a[180:183], 0
    s_addc_u32 s75, s13, 0
    v_cvt_pk_bf16_f32 v79, v114, v115
    v_sub_f32 v117, v117, v232
    v_exp_f32 v117, v117
    v_mfma_f32_16x16x32_bf16 v[124:127], a[68:71], a[184:187], v[124:127]
    v_sub_f32 v118, v118, v232
    v_exp_f32 v118, v118
    v_mfma_f32_16x16x32_bf16 v[124:127], a[72:75], a[188:191], v[124:127]
    global_load_lds_dwordx4 v228, s[74:75] nt
    v_cvt_pk_bf16_f32 v56, v116, v117
    v_sub_f32 v119, v119, v232
    v_exp_f32 v119, v119
    v_mfma_f32_16x16x32_bf16 v[124:127], a[76:79], a[192:195], v[124:127]
    v_sub_f32 v120, v120, v233
    v_exp_f32 v120, v120
    v_mfma_f32_16x16x32_bf16 v[128:131], a[72:75], a[204:207], 0
    global_load_lds_dwordx4 v229, s[74:75] offset:1024 nt
    v_cvt_pk_bf16_f32 v57, v118, v119
    v_sub_f32 v121, v121, v233
    v_exp_f32 v121, v121
    v_mfma_f32_16x16x32_bf16 v[128:131], a[76:79], a[208:211], v[128:131]
    v_sub_f32 v122, v122, v233
    v_exp_f32 v122, v122
    v_mfma_f32_16x16x32_bf16 v[128:131], a[64:67], a[196:199], v[128:131]
    global_load_lds_dwordx4 v228, s[74:75] offset:2048 nt
    v_cvt_pk_bf16_f32 v64, v120, v121
    v_sub_f32 v123, v123, v233
    v_exp_f32 v123, v123
    v_mfma_f32_16x16x32_bf16 v[128:131], a[68:71], a[200:203], v[128:131]
    v_sub_f32 v124, v124, v234
    v_exp_f32 v124, v124
    v_smfmac_f32_16x16x64_bf16 a[136:139], a[144:147], v[36:43], v236
    s_waitcnt vmcnt(11) lgkmcnt(0)
    s_barrier
    v_cvt_pk_bf16_f32 v65, v122, v123
    v_sub_f32 v125, v125, v234
    v_exp_f32 v125, v125
    v_mfma_f32_16x16x32_bf16 v[132:135], a[80:83], a[148:151], 0
    ds_read_b128 a[64:67], v212
    global_load_lds_dwordx4 v229, s[74:75] offset:3072 nt
    v_sub_f32 v126, v126, v234
    v_exp_f32 v126, v126
    v_mfma_f32_16x16x32_bf16 v[132:135], a[84:87], a[152:155], v[132:135]
    ds_read_b64_tr_b16 a[96:97], v220
    v_cvt_pk_bf16_f32 v72, v124, v125
    v_sub_f32 v127, v127, v234
    v_exp_f32 v127, v127
    v_mfma_f32_16x16x32_bf16 v[132:135], a[88:91], a[156:159], v[132:135]
    ds_read_b64_tr_b16 a[98:99], v220 offset:2048
    s_add_u32 m0, s33, 0x6000
    v_sub_f32 v128, v128, v235
    v_exp_f32 v128, v128
    v_mfma_f32_16x16x32_bf16 v[132:135], a[92:95], a[160:163], v[132:135]
    ds_read_b128 a[68:71], v213
    v_cvt_pk_bf16_f32 v73, v126, v127
    v_mfma_f32_16x16x32_bf16 v[136:139], a[88:91], a[172:175], 0
    ds_read_b64_tr_b16 a[100:101], v220 offset:4096
    s_add_u32 s32, s67, 0x8000
    v_sub_f32 v129, v129, v235
    v_exp_f32 v129, v129
    v_mfma_f32_16x16x32_bf16 v[136:139], a[92:95], a[176:179], v[136:139]
    ds_read_b64_tr_b16 a[102:103], v220 offset:6144
    v_sub_f32 v130, v130, v235
    v_exp_f32 v130, v130
    v_mfma_f32_16x16x32_bf16 v[136:139], a[80:83], a[164:167], v[136:139]
    ds_read_b128 a[72:75], v214
    s_and_b32 s32, s32, 0x7ffff
    v_cvt_pk_bf16_f32 v80, v128, v129
    v_sub_f32 v131, v131, v235
    v_exp_f32 v131, v131
    v_mfma_f32_16x16x32_bf16 v[136:139], a[84:87], a[168:171], v[136:139]
    ds_read_b64_tr_b16 a[104:105], v220 offset:8192
    v_sub_f32 v132, v132, v232
    v_exp_f32 v132, v132
    v_mfma_f32_16x16x32_bf16 v[140:143], a[80:83], a[180:183], 0
    ds_read_b64_tr_b16 a[106:107], v220 offset:10240
    s_add_u32 s72, s14, s32
    v_cvt_pk_bf16_f32 v81, v130, v131
    v_mfma_f32_16x16x32_bf16 v[140:143], a[84:87], a[184:187], v[140:143]
    ds_read_b128 a[76:79], v215
    v_sub_f32 v133, v133, v232
    v_exp_f32 v133, v133
    v_mfma_f32_16x16x32_bf16 v[140:143], a[88:91], a[188:191], v[140:143]
    ds_read_b64_tr_b16 a[108:109], v220 offset:12288
    s_addc_u32 s73, s15, 0
    v_sub_f32 v134, v134, v232
    v_exp_f32 v134, v134
    v_mfma_f32_16x16x32_bf16 v[140:143], a[92:95], a[192:195], v[140:143]
    ds_read_b64_tr_b16 a[110:111], v220 offset:14336
    v_cvt_pk_bf16_f32 v58, v132, v133
    v_sub_f32 v135, v135, v232
    v_exp_f32 v135, v135
    v_mfma_f32_16x16x32_bf16 v[144:147], a[88:91], a[204:207], 0
    global_load_lds_dwordx4 v224, s[72:73] nt
    v_sub_f32 v136, v136, v233
    v_exp_f32 v136, v136
    v_mfma_f32_16x16x32_bf16 v[144:147], a[92:95], a[208:211], v[144:147]
    v_cvt_pk_bf16_f32 v59, v134, v135
    v_sub_f32 v137, v137, v233
    v_exp_f32 v137, v137
    v_mfma_f32_16x16x32_bf16 v[144:147], a[80:83], a[196:199], v[144:147]
    global_load_lds_dwordx4 v225, s[72:73] offset:1024 nt
    v_sub_f32 v138, v138, v233
    v_exp_f32 v138, v138
    v_mfma_f32_16x16x32_bf16 v[144:147], a[84:87], a[200:203], v[144:147]
    v_cvt_pk_bf16_f32 v66, v136, v137
    v_sub_f32 v139, v139, v233
    v_exp_f32 v139, v139
    v_smfmac_f32_16x16x64_bf16 a[132:135], a[144:147], v[28:35], v236
    v_sub_f32 v140, v140, v234
    v_exp_f32 v140, v140
    v_smfmac_f32_16x16x64_bf16 a[140:143], a[144:147], v[44:51], v236
    v_cvt_pk_bf16_f32 v67, v138, v139
    v_sub_f32 v141, v141, v234
    v_exp_f32 v141, v141
    v_sub_f32 v142, v142, v234
    v_exp_f32 v142, v142
    v_cvt_pk_bf16_f32 v74, v140, v141
    v_sub_f32 v143, v143, v234
    v_exp_f32 v143, v143
    s_waitcnt lgkmcnt(2)
    v_mfma_f32_16x16x32_bf16 v[4:7], a[64:67], a[148:151], 0
    v_sub_f32 v144, v144, v235
    v_exp_f32 v144, v144
    v_mfma_f32_16x16x32_bf16 v[4:7], a[68:71], a[152:155], v[4:7]
    ds_read_b128 a[80:83], v212 offset:4096
    v_cvt_pk_bf16_f32 v75, v142, v143
    v_mfma_f32_16x16x32_bf16 v[4:7], a[72:75], a[156:159], v[4:7]
    v_sub_f32 v145, v145, v235
    v_exp_f32 v145, v145
    v_mfma_f32_16x16x32_bf16 v[4:7], a[76:79], a[160:163], v[4:7]
    ds_read_b64_tr_b16 a[112:113], v221
    v_mfma_f32_16x16x32_bf16 v[8:11], a[72:75], a[172:175], 0
    v_sub_f32 v146, v146, v235
    v_exp_f32 v146, v146
    v_mfma_f32_16x16x32_bf16 v[8:11], a[76:79], a[176:179], v[8:11]
    ds_read_b64_tr_b16 a[114:115], v221 offset:2048
    v_cvt_pk_bf16_f32 v82, v144, v145
    v_mfma_f32_16x16x32_bf16 v[8:11], a[64:67], a[164:167], v[8:11]
    s_waitcnt lgkmcnt(3)
    v_sub_f32 v147, v147, v235
    v_exp_f32 v147, v147
    v_mfma_f32_16x16x32_bf16 v[8:11], a[68:71], a[168:171], v[8:11]
    global_load_lds_dwordx4 v226, s[72:73] offset:2048 nt
    v_mfma_f32_16x16x32_bf16 v[12:15], a[64:67], a[180:183], 0
    s_add_u32 s32, s65, 0x18000
    v_sub_f32 v4, v4, v232
    v_exp_f32 v4, v4
    v_mfma_f32_16x16x32_bf16 v[12:15], a[68:71], a[184:187], v[12:15]
    ds_read_b128 a[84:87], v213 offset:4096
    v_cvt_pk_bf16_f32 v83, v146, v147
    v_mfma_f32_16x16x32_bf16 v[12:15], a[72:75], a[188:191], v[12:15]
    s_and_b32 s32, s32, 0x7ffff
    v_sub_f32 v5, v5, v232
    v_exp_f32 v5, v5
    v_mfma_f32_16x16x32_bf16 v[12:15], a[76:79], a[192:195], v[12:15]
    ds_read_b64_tr_b16 a[116:117], v221 offset:4096
    v_mfma_f32_16x16x32_bf16 v[16:19], a[72:75], a[204:207], 0
M_stub1:
    s_cbranch_execz M_stub5
    v_sub_f32 v6, v6, v232
    v_exp_f32 v6, v6
    v_mfma_f32_16x16x32_bf16 v[16:19], a[76:79], a[208:211], v[16:19]
    ds_read_b64_tr_b16 a[118:119], v221 offset:6144
    v_cvt_pk_bf16_f32 v84, v4, v5
    v_mfma_f32_16x16x32_bf16 v[16:19], a[64:67], a[196:199], v[16:19]
    v_sub_f32 v7, v7, v232
    v_exp_f32 v7, v7
    v_mfma_f32_16x16x32_bf16 v[16:19], a[68:71], a[200:203], v[16:19]
    global_load_lds_dwordx4 v227, s[72:73] offset:3072 nt
    v_mfma_f32_16x16x32_bf16 v[148:151], v[20:23], a[96:99], 0
    s_add_u32 s74, s12, s32
    v_sub_f32 v8, v8, v233
    v_exp_f32 v8, v8
    v_mfma_f32_16x16x32_bf16 v[148:151], v[24:27], a[100:103], v[148:151]
    ds_read_b128 a[88:91], v214 offset:4096
    v_cvt_pk_bf16_f32 v85, v6, v7
    v_mfma_f32_16x16x32_bf16 v[148:151], v[52:55], a[104:107], v[148:151]
    s_addc_u32 s75, s13, 0
    v_sub_f32 v9, v9, v233
    v_exp_f32 v9, v9
    v_mfma_f32_16x16x32_bf16 v[148:151], v[56:59], a[108:111], v[148:151]
    ds_read_b64_tr_b16 a[120:121], v221 offset:8192
    v_mfma_f32_16x16x32_bf16 v[152:155], v[60:63], a[104:107], 0
    s_add_u32 m0, s31, 0xc000
    v_sub_f32 v10, v10, v233
    v_exp_f32 v10, v10
    v_mfma_f32_16x16x32_bf16 v[152:155], v[64:67], a[108:111], v[152:155]
    ds_read_b64_tr_b16 a[122:123], v221 offset:10240
    v_cvt_pk_bf16_f32 v92, v8, v9
    v_mfma_f32_16x16x32_bf16 v[152:155], v[28:31], a[96:99], v[152:155]
    v_sub_f32 v11, v11, v233
    v_exp_f32 v11, v11
    v_mfma_f32_16x16x32_bf16 v[152:155], v[32:35], a[100:103], v[152:155]
    global_load_lds_dwordx4 v228, s[74:75] nt
    v_mfma_f32_16x16x32_bf16 a[0:3], v[36:39], a[96:99], 0
    ds_read_b128 a[92:95], v215 offset:4096
    v_cvt_pk_bf16_f32 v93, v10, v11
    v_mfma_f32_16x16x32_bf16 a[0:3], v[40:43], a[100:103], a[0:3]
    ds_read_b64_tr_b16 a[124:125], v221 offset:12288
    v_mfma_f32_16x16x32_bf16 a[0:3], v[68:71], a[104:107], a[0:3]
    ds_read_b64_tr_b16 a[126:127], v221 offset:14336
    v_mfma_f32_16x16x32_bf16 a[0:3], v[72:75], a[108:111], a[0:3]
    global_load_lds_dwordx4 v229, s[74:75] offset:1024 nt
    v_mfma_f32_16x16x32_bf16 a[4:7], v[76:79], a[104:107], 0
    s_add_u32 s32, s66, 0x10000
    v_sub_f32 v12, v12, v234
    v_exp_f32 v12, v12
    v_mfma_f32_16x16x32_bf16 a[4:7], v[80:83], a[108:111], a[4:7]
    s_and_b32 s32, s32, 0x7ffff
    v_sub_f32 v13, v13, v234
    v_exp_f32 v13, v13
    v_mfma_f32_16x16x32_bf16 a[4:7], v[44:47], a[96:99], a[4:7]
    v_sub_f32 v14, v14, v234
    v_exp_f32 v14, v14
    v_mfma_f32_16x16x32_bf16 a[4:7], v[48:51], a[100:103], a[4:7]
    s_waitcnt vmcnt(14) lgkmcnt(0)
    v_sub_f32 v15, v15, v234
    v_exp_f32 v15, v15
    v_smfmac_f32_16x16x64_bf16 a[128:131], a[144:147], v[52:59], v236
    s_barrier
    v_mfma_f32_16x16x32_bf16 v[4:7], a[80:83], a[148:151], 0
    s_add_u32 s72, s14, s32
    v_sub_f32 v16, v16, v235
    v_exp_f32 v16, v16
    v_mfma_f32_16x16x32_bf16 v[4:7], a[84:87], a[152:155], v[4:7]
    ds_read_b128 a[64:67], v212 offset:16384
    v_cvt_pk_bf16_f32 v101, v14, v15
    v_mfma_f32_16x16x32_bf16 v[4:7], a[88:91], a[156:159], v[4:7]
    s_addc_u32 s73, s15, 0
    v_sub_f32 v17, v17, v235
    v_exp_f32 v17, v17
    v_mfma_f32_16x16x32_bf16 v[4:7], a[92:95], a[160:163], v[4:7]
    ds_read_b64_tr_b16 a[96:97], v222
    v_cvt_pk_bf16_f32 v100, v12, v13
    v_mfma_f32_16x16x32_bf16 v[8:11], a[88:91], a[172:175], 0
    v_sub_f32 v18, v18, v235
    v_exp_f32 v18, v18
    v_mfma_f32_16x16x32_bf16 v[8:11], a[92:95], a[176:179], v[8:11]
    ds_read_b64_tr_b16 a[98:99], v222 offset:2048
    v_cvt_pk_bf16_f32 v108, v16, v17
    v_mfma_f32_16x16x32_bf16 v[8:11], a[80:83], a[164:167], v[8:11]
    v_sub_f32 v19, v19, v235
    v_exp_f32 v19, v19
    v_mfma_f32_16x16x32_bf16 v[8:11], a[84:87], a[168:171], v[8:11]
    global_load_lds_dwordx4 v228, s[74:75] offset:2048 nt
    v_mfma_f32_16x16x32_bf16 v[12:15], a[80:83], a[180:183], 0
    v_sub_f32 v4, v4, v232
    v_exp_f32 v4, v4
    v_mfma_f32_16x16x32_bf16 v[12:15], a[84:87], a[184:187], v[12:15]
    ds_read_b128 a[68:71], v213 offset:16384
    v_cvt_pk_bf16_f32 v109, v18, v19
    v_mfma_f32_16x16x32_bf16 v[12:15], a[88:91], a[188:191], v[12:15]
    v_sub_f32 v5, v5, v232
    v_exp_f32 v5, v5
    v_mfma_f32_16x16x32_bf16 v[12:15], a[92:95], a[192:195], v[12:15]
    ds_read_b64_tr_b16 a[100:101], v222 offset:4096
    v_mfma_f32_16x16x32_bf16 v[16:19], a[88:91], a[204:207], 0
    v_sub_f32 v6, v6, v232
    v_exp_f32 v6, v6
    v_mfma_f32_16x16x32_bf16 v[16:19], a[92:95], a[208:211], v[16:19]
    ds_read_b64_tr_b16 a[102:103], v222 offset:6144
    v_cvt_pk_bf16_f32 v86, v4, v5
    v_mfma_f32_16x16x32_bf16 v[16:19], a[80:83], a[196:199], v[16:19]
    v_sub_f32 v7, v7, v232
    v_exp_f32 v7, v7
    v_mfma_f32_16x16x32_bf16 v[16:19], a[84:87], a[200:203], v[16:19]
    global_load_lds_dwordx4 v229, s[74:75] offset:3072 nt
    v_mfma_f32_16x16x32_bf16 v[156:159], v[20:23], a[112:115], 0
    v_sub_f32 v8, v8, v233
    v_exp_f32 v8, v8
    v_mfma_f32_16x16x32_bf16 v[156:159], v[24:27], a[116:119], v[156:159]
    ds_read_b128 a[72:75], v214 offset:16384
    v_cvt_pk_bf16_f32 v87, v6, v7
    v_mfma_f32_16x16x32_bf16 v[156:159], v[52:55], a[120:123], v[156:159]
    v_sub_f32 v9, v9, v233
    v_exp_f32 v9, v9
    v_mfma_f32_16x16x32_bf16 v[156:159], v[56:59], a[124:127], v[156:159]
    ds_read_b64_tr_b16 a[104:105], v222 offset:8192
    v_mfma_f32_16x16x32_bf16 v[160:163], v[60:63], a[120:123], 0
    s_add_u32 m0, s33, 0x8000
    v_sub_f32 v10, v10, v233
    v_exp_f32 v10, v10
    v_mfma_f32_16x16x32_bf16 v[160:163], v[64:67], a[124:127], v[160:163]
    ds_read_b64_tr_b16 a[106:107], v222 offset:10240
    v_cvt_pk_bf16_f32 v94, v8, v9
    v_mfma_f32_16x16x32_bf16 v[160:163], v[28:31], a[112:115], v[160:163]
    v_sub_f32 v11, v11, v233
    v_exp_f32 v11, v11
    v_mfma_f32_16x16x32_bf16 v[160:163], v[32:35], a[116:119], v[160:163]
    global_load_lds_dwordx4 v224, s[72:73] nt
    v_mfma_f32_16x16x32_bf16 a[8:11], v[36:39], a[112:115], 0
    s_add_u32 s32, s64, 0x20000
    v_sub_f32 v12, v12, v234
    v_exp_f32 v12, v12
    v_mfma_f32_16x16x32_bf16 a[8:11], v[40:43], a[116:119], a[8:11]
    ds_read_b128 a[76:79], v215 offset:16384
    v_cvt_pk_bf16_f32 v95, v10, v11
    v_mfma_f32_16x16x32_bf16 a[8:11], v[68:71], a[120:123], a[8:11]
    s_and_b32 s32, s32, 0x7ffff
    v_sub_f32 v13, v13, v234
    v_exp_f32 v13, v13
    v_mfma_f32_16x16x32_bf16 a[8:11], v[72:75], a[124:127], a[8:11]
    ds_read_b64_tr_b16 a[108:109], v222 offset:12288
    v_mfma_f32_16x16x32_bf16 a[12:15], v[76:79], a[120:123], 0
    v_sub_f32 v14, v14, v234
    v_exp_f32 v14, v14
    v_mfma_f32_16x16x32_bf16 a[12:15], v[80:83], a[124:127], a[12:15]
    ds_read_b64_tr_b16 a[110:111], v222 offset:14336
    v_cvt_pk_bf16_f32 v102, v12, v13
    v_mfma_f32_16x16x32_bf16 a[12:15], v[44:47], a[112:115], a[12:15]
    s_waitcnt lgkmcnt(2)
    v_sub_f32 v15, v15, v234
    v_exp_f32 v15, v15
    v_mfma_f32_16x16x32_bf16 a[12:15], v[48:51], a[116:119], a[12:15]
    global_load_lds_dwordx4 v225, s[72:73] offset:1024 nt
    v_smfmac_f32_16x16x64_bf16 a[132:135], a[144:147], v[60:67], v236
    v_mfma_f32_16x16x32_bf16 v[4:7], a[64:67], a[148:151], 0
    s_add_u32 s74, s12, s32
    v_sub_f32 v16, v16, v235
    v_exp_f32 v16, v16
    v_mfma_f32_16x16x32_bf16 v[4:7], a[68:71], a[152:155], v[4:7]
    ds_read_b128 a[80:83], v212 offset:20480
    v_cvt_pk_bf16_f32 v103, v14, v15
    v_mfma_f32_16x16x32_bf16 v[4:7], a[72:75], a[156:159], v[4:7]
    s_addc_u32 s75, s13, 0
    v_sub_f32 v17, v17, v235
    v_exp_f32 v17, v17
    v_mfma_f32_16x16x32_bf16 v[4:7], a[76:79], a[160:163], v[4:7]
    ds_read_b64_tr_b16 a[112:113], v223
    v_mfma_f32_16x16x32_bf16 v[8:11], a[72:75], a[172:175], 0
    v_sub_f32 v18, v18, v235
    v_exp_f32 v18, v18
    v_mfma_f32_16x16x32_bf16 v[8:11], a[76:79], a[176:179], v[8:11]
    ds_read_b64_tr_b16 a[114:115], v223 offset:2048
    v_cvt_pk_bf16_f32 v110, v16, v17
    v_mfma_f32_16x16x32_bf16 v[8:11], a[64:67], a[164:167], v[8:11]
    s_waitcnt lgkmcnt(3)
    v_sub_f32 v19, v19, v235
    v_exp_f32 v19, v19
    v_mfma_f32_16x16x32_bf16 v[8:11], a[68:71], a[168:171], v[8:11]
    global_load_lds_dwordx4 v226, s[72:73] offset:2048 nt
    v_mfma_f32_16x16x32_bf16 v[12:15], a[64:67], a[180:183], 0
    v_sub_f32 v4, v4, v232
    v_exp_f32 v4, v4
    v_mfma_f32_16x16x32_bf16 v[12:15], a[68:71], a[184:187], v[12:15]
    ds_read_b128 a[84:87], v213 offset:20480
    v_cvt_pk_bf16_f32 v111, v18, v19
    v_mfma_f32_16x16x32_bf16 v[12:15], a[72:75], a[188:191], v[12:15]
    v_sub_f32 v5, v5, v232
    v_exp_f32 v5, v5
    v_mfma_f32_16x16x32_bf16 v[12:15], a[76:79], a[192:195], v[12:15]
    ds_read_b64_tr_b16 a[116:117], v223 offset:4096
    v_mfma_f32_16x16x32_bf16 v[16:19], a[72:75], a[204:207], 0
    v_sub_f32 v6, v6, v232
    v_exp_f32 v6, v6
    v_mfma_f32_16x16x32_bf16 v[16:19], a[76:79], a[208:211], v[16:19]
    ds_read_b64_tr_b16 a[118:119], v223 offset:6144
    v_cvt_pk_bf16_f32 v88, v4, v5
    v_mfma_f32_16x16x32_bf16 v[16:19], a[64:67], a[196:199], v[16:19]
    v_sub_f32 v7, v7, v232
    v_exp_f32 v7, v7
    v_mfma_f32_16x16x32_bf16 v[16:19], a[68:71], a[200:203], v[16:19]
    global_load_lds_dwordx4 v227, s[72:73] offset:3072 nt
    v_mfma_f32_16x16x32_bf16 v[164:167], v[20:23], a[96:99], 0
    v_sub_f32 v8, v8, v233
    v_exp_f32 v8, v8
    v_mfma_f32_16x16x32_bf16 v[164:167], v[24:27], a[100:103], v[164:167]
    ds_read_b128 a[88:91], v214 offset:20480
    v_cvt_pk_bf16_f32 v89, v6, v7
    v_mfma_f32_16x16x32_bf16 v[164:167], v[52:55], a[104:107], v[164:167]
    v_sub_f32 v9, v9, v233
    v_exp_f32 v9, v9
    v_mfma_f32_16x16x32_bf16 v[164:167], v[56:59], a[108:111], v[164:167]
    ds_read_b64_tr_b16 a[120:121], v223 offset:8192
    v_mfma_f32_16x16x32_bf16 v[168:171], v[60:63], a[104:107], 0
    s_add_u32 m0, s31, 0x0
    v_sub_f32 v10, v10, v233
    v_exp_f32 v10, v10
    v_mfma_f32_16x16x32_bf16 v[168:171], v[64:67], a[108:111], v[168:171]
    ds_read_b64_tr_b16 a[122:123], v223 offset:10240
    v_cvt_pk_bf16_f32 v96, v8, v9
    v_mfma_f32_16x16x32_bf16 v[168:171], v[28:31], a[96:99], v[168:171]
    v_sub_f32 v11, v11, v233
    v_exp_f32 v11, v11
    v_mfma_f32_16x16x32_bf16 v[168:171], v[32:35], a[100:103], v[168:171]
    global_load_lds_dwordx4 v228, s[74:75] nt
    v_mfma_f32_16x16x32_bf16 a[16:19], v[36:39], a[96:99], 0
    ds_read_b128 a[92:95], v215 offset:20480
    v_cvt_pk_bf16_f32 v97, v10, v11
    v_mfma_f32_16x16x32_bf16 a[16:19], v[40:43], a[100:103], a[16:19]
    ds_read_b64_tr_b16 a[124:125], v223 offset:12288
    v_mfma_f32_16x16x32_bf16 a[16:19], v[68:71], a[104:107], a[16:19]
    ds_read_b64_tr_b16 a[126:127], v223 offset:14336
    v_mfma_f32_16x16x32_bf16 a[16:19], v[72:75], a[108:111], a[16:19]
    global_load_lds_dwordx4 v229, s[74:75] offset:1024 nt
    v_mfma_f32_16x16x32_bf16 a[20:23], v[76:79], a[104:107], 0
    s_add_u32 s32, s66, 0x18000
    v_sub_f32 v12, v12, v234
    v_exp_f32 v12, v12
    v_mfma_f32_16x16x32_bf16 a[20:23], v[80:83], a[108:111], a[20:23]
    s_and_b32 s32, s32, 0x7ffff
    v_sub_f32 v13, v13, v234
    v_exp_f32 v13, v13
    v_mfma_f32_16x16x32_bf16 a[20:23], v[44:47], a[96:99], a[20:23]
    v_sub_f32 v14, v14, v234
    v_exp_f32 v14, v14
    v_mfma_f32_16x16x32_bf16 a[20:23], v[48:51], a[100:103], a[20:23]
    s_waitcnt vmcnt(10) lgkmcnt(0)
    v_sub_f32 v15, v15, v234
    v_exp_f32 v15, v15
    v_smfmac_f32_16x16x64_bf16 a[136:139], a[144:147], v[68:75], v236
    s_barrier
    v_mfma_f32_16x16x32_bf16 v[4:7], a[80:83], a[148:151], 0
    s_add_u32 s72, s14, s32
    v_sub_f32 v16, v16, v235
    v_exp_f32 v16, v16
    v_mfma_f32_16x16x32_bf16 v[4:7], a[84:87], a[152:155], v[4:7]
    ds_read_b128 a[64:67], v212 offset:32768
    v_cvt_pk_bf16_f32 v105, v14, v15
    v_mfma_f32_16x16x32_bf16 v[4:7], a[88:91], a[156:159], v[4:7]
    s_addc_u32 s73, s15, 0
    v_sub_f32 v17, v17, v235
    v_exp_f32 v17, v17
    v_mfma_f32_16x16x32_bf16 v[4:7], a[92:95], a[160:163], v[4:7]
    ds_read_b64_tr_b16 a[96:97], v220 offset:16384
    v_cvt_pk_bf16_f32 v104, v12, v13
    v_mfma_f32_16x16x32_bf16 v[8:11], a[88:91], a[172:175], 0
    v_sub_f32 v18, v18, v235
    v_exp_f32 v18, v18
    v_mfma_f32_16x16x32_bf16 v[8:11], a[92:95], a[176:179], v[8:11]
    ds_read_b64_tr_b16 a[98:99], v220 offset:18432
    v_cvt_pk_bf16_f32 v112, v16, v17
    v_mfma_f32_16x16x32_bf16 v[8:11], a[80:83], a[164:167], v[8:11]
    v_sub_f32 v19, v19, v235
    v_exp_f32 v19, v19
    v_mfma_f32_16x16x32_bf16 v[8:11], a[84:87], a[168:171], v[8:11]
    global_load_lds_dwordx4 v228, s[74:75] offset:2048 nt
    v_mfma_f32_16x16x32_bf16 v[12:15], a[80:83], a[180:183], 0
    v_sub_f32 v4, v4, v232
    v_exp_f32 v4, v4
    v_mfma_f32_16x16x32_bf16 v[12:15], a[84:87], a[184:187], v[12:15]
    ds_read_b128 a[68:71], v213 offset:32768
    v_cvt_pk_bf16_f32 v113, v18, v19
    v_mfma_f32_16x16x32_bf16 v[12:15], a[88:91], a[188:191], v[12:15]
    v_sub_f32 v5, v5, v232
    v_exp_f32 v5, v5
    v_mfma_f32_16x16x32_bf16 v[12:15], a[92:95], a[192:195], v[12:15]
    ds_read_b64_tr_b16 a[100:101], v220 offset:20480
    v_mfma_f32_16x16x32_bf16 v[16:19], a[88:91], a[204:207], 0
    v_sub_f32 v6, v6, v232
    v_exp_f32 v6, v6
    v_mfma_f32_16x16x32_bf16 v[16:19], a[92:95], a[208:211], v[16:19]
    ds_read_b64_tr_b16 a[102:103], v220 offset:22528
    v_cvt_pk_bf16_f32 v90, v4, v5
    v_mfma_f32_16x16x32_bf16 v[16:19], a[80:83], a[196:199], v[16:19]
    v_sub_f32 v7, v7, v232
    v_exp_f32 v7, v7
    v_mfma_f32_16x16x32_bf16 v[16:19], a[84:87], a[200:203], v[16:19]
    global_load_lds_dwordx4 v229, s[74:75] offset:3072 nt
    v_mfma_f32_16x16x32_bf16 v[172:175], v[20:23], a[112:115], 0
    v_sub_f32 v8, v8, v233
    v_exp_f32 v8, v8
    v_mfma_f32_16x16x32_bf16 v[172:175], v[24:27], a[116:119], v[172:175]
    ds_read_b128 a[72:75], v214 offset:32768
    v_cvt_pk_bf16_f32 v91, v6, v7
    v_mfma_f32_16x16x32_bf16 v[172:175], v[52:55], a[120:123], v[172:175]
    v_sub_f32 v9, v9, v233
    v_exp_f32 v9, v9
    v_mfma_f32_16x16x32_bf16 v[172:175], v[56:59], a[124:127], v[172:175]
    ds_read_b64_tr_b16 a[104:105], v220 offset:24576
    v_mfma_f32_16x16x32_bf16 v[176:179], v[60:63], a[120:123], 0
    s_add_u32 m0, s33, 0xa000
    v_sub_f32 v10, v10, v233
    v_exp_f32 v10, v10
    v_mfma_f32_16x16x32_bf16 v[176:179], v[64:67], a[124:127], v[176:179]
    ds_read_b64_tr_b16 a[106:107], v220 offset:26624
    v_cvt_pk_bf16_f32 v98, v8, v9
    v_mfma_f32_16x16x32_bf16 v[176:179], v[28:31], a[112:115], v[176:179]
    v_sub_f32 v11, v11, v233
    v_exp_f32 v11, v11
    v_mfma_f32_16x16x32_bf16 v[176:179], v[32:35], a[116:119], v[176:179]
    global_load_lds_dwordx4 v224, s[72:73] nt
    v_mfma_f32_16x16x32_bf16 a[24:27], v[36:39], a[112:115], 0
    s_add_u32 s32, s65, 0x20000
    v_sub_f32 v12, v12, v234
    v_exp_f32 v12, v12
    v_mfma_f32_16x16x32_bf16 a[24:27], v[40:43], a[116:119], a[24:27]
    ds_read_b128 a[76:79], v215 offset:32768
    v_cvt_pk_bf16_f32 v99, v10, v11
    v_mfma_f32_16x16x32_bf16 a[24:27], v[68:71], a[120:123], a[24:27]
    s_and_b32 s32, s32, 0x7ffff
    v_sub_f32 v13, v13, v234
    v_exp_f32 v13, v13
    v_mfma_f32_16x16x32_bf16 a[24:27], v[72:75], a[124:127], a[24:27]
    ds_read_b64_tr_b16 a[108:109], v220 offset:28672
    v_mfma_f32_16x16x32_bf16 a[28:31], v[76:79], a[120:123], 0
    v_sub_f32 v14, v14, v234
    v_exp_f32 v14, v14
    v_mfma_f32_16x16x32_bf16 a[28:31], v[80:83], a[124:127], a[28:31]
    ds_read_b64_tr_b16 a[110:111], v220 offset:30720
    v_cvt_pk_bf16_f32 v106, v12, v13
    v_mfma_f32_16x16x32_bf16 a[28:31], v[44:47], a[112:115], a[28:31]
    s_waitcnt lgkmcnt(2)
    v_sub_f32 v15, v15, v234
    v_exp_f32 v15, v15
    v_mfma_f32_16x16x32_bf16 a[28:31], v[48:51], a[116:119], a[28:31]
    global_load_lds_dwordx4 v225, s[72:73] offset:1024 nt
    v_smfmac_f32_16x16x64_bf16 a[140:143], a[144:147], v[76:83], v236
    v_mfma_f32_16x16x32_bf16 v[4:7], a[64:67], a[148:151], 0
    s_add_u32 s74, s12, s32
    v_sub_f32 v16, v16, v235
    v_exp_f32 v16, v16
    v_mfma_f32_16x16x32_bf16 v[4:7], a[68:71], a[152:155], v[4:7]
    ds_read_b128 a[80:83], v212 offset:36864
    v_cvt_pk_bf16_f32 v107, v14, v15
    v_mfma_f32_16x16x32_bf16 v[4:7], a[72:75], a[156:159], v[4:7]
    s_addc_u32 s75, s13, 0
    v_sub_f32 v17, v17, v235
    v_exp_f32 v17, v17
    v_mfma_f32_16x16x32_bf16 v[4:7], a[76:79], a[160:163], v[4:7]
    ds_read_b64_tr_b16 a[112:113], v221 offset:16384
    v_mfma_f32_16x16x32_bf16 v[8:11], a[72:75], a[172:175], 0
    v_sub_f32 v18, v18, v235
    v_exp_f32 v18, v18
    v_mfma_f32_16x16x32_bf16 v[8:11], a[76:79], a[176:179], v[8:11]
    ds_read_b64_tr_b16 a[114:115], v221 offset:18432
    v_cvt_pk_bf16_f32 v114, v16, v17
    v_mfma_f32_16x16x32_bf16 v[8:11], a[64:67], a[164:167], v[8:11]
    s_waitcnt lgkmcnt(3)
    v_sub_f32 v19, v19, v235
    v_exp_f32 v19, v19
    v_mfma_f32_16x16x32_bf16 v[8:11], a[68:71], a[168:171], v[8:11]
    global_load_lds_dwordx4 v226, s[72:73] offset:2048 nt
    v_mfma_f32_16x16x32_bf16 v[12:15], a[64:67], a[180:183], 0
    v_sub_f32 v4, v4, v232
    v_exp_f32 v4, v4
    v_mfma_f32_16x16x32_bf16 v[12:15], a[68:71], a[184:187], v[12:15]
    ds_read_b128 a[84:87], v213 offset:36864
    v_cvt_pk_bf16_f32 v115, v18, v19
    v_mfma_f32_16x16x32_bf16 v[12:15], a[72:75], a[188:191], v[12:15]
    v_sub_f32 v5, v5, v232
    v_exp_f32 v5, v5
    v_mfma_f32_16x16x32_bf16 v[12:15], a[76:79], a[192:195], v[12:15]
    ds_read_b64_tr_b16 a[116:117], v221 offset:20480
    v_mfma_f32_16x16x32_bf16 v[16:19], a[72:75], a[204:207], 0
    v_sub_f32 v6, v6, v232
    v_exp_f32 v6, v6
    v_mfma_f32_16x16x32_bf16 v[16:19], a[76:79], a[208:211], v[16:19]
    ds_read_b64_tr_b16 a[118:119], v221 offset:22528
    v_cvt_pk_bf16_f32 v116, v4, v5
    v_mfma_f32_16x16x32_bf16 v[16:19], a[64:67], a[196:199], v[16:19]
    v_sub_f32 v7, v7, v232
    v_exp_f32 v7, v7
    v_mfma_f32_16x16x32_bf16 v[16:19], a[68:71], a[200:203], v[16:19]
    global_load_lds_dwordx4 v227, s[72:73] offset:3072 nt
    v_mfma_f32_16x16x32_bf16 v[180:183], v[20:23], a[96:99], 0
    v_sub_f32 v8, v8, v233
    v_exp_f32 v8, v8
    v_mfma_f32_16x16x32_bf16 v[180:183], v[24:27], a[100:103], v[180:183]
    ds_read_b128 a[88:91], v214 offset:36864
    v_cvt_pk_bf16_f32 v117, v6, v7
    v_mfma_f32_16x16x32_bf16 v[180:183], v[52:55], a[104:107], v[180:183]
    v_sub_f32 v9, v9, v233
    v_exp_f32 v9, v9
    v_mfma_f32_16x16x32_bf16 v[180:183], v[56:59], a[108:111], v[180:183]
    ds_read_b64_tr_b16 a[120:121], v221 offset:24576
    v_mfma_f32_16x16x32_bf16 v[184:187], v[60:63], a[104:107], 0
    s_add_u32 m0, s31, 0x4000
    v_sub_f32 v10, v10, v233
    v_exp_f32 v10, v10
    v_mfma_f32_16x16x32_bf16 v[184:187], v[64:67], a[108:111], v[184:187]
    ds_read_b64_tr_b16 a[122:123], v221 offset:26624
    v_cvt_pk_bf16_f32 v124, v8, v9
    v_mfma_f32_16x16x32_bf16 v[184:187], v[28:31], a[96:99], v[184:187]
    v_sub_f32 v11, v11, v233
    v_exp_f32 v11, v11
    v_mfma_f32_16x16x32_bf16 v[184:187], v[32:35], a[100:103], v[184:187]
    global_load_lds_dwordx4 v228, s[74:75] nt
    v_mfma_f32_16x16x32_bf16 a[32:35], v[36:39], a[96:99], 0
    ds_read_b128 a[92:95], v215 offset:36864
    v_cvt_pk_bf16_f32 v125, v10, v11
    v_mfma_f32_16x16x32_bf16 a[32:35], v[40:43], a[100:103], a[32:35]
    ds_read_b64_tr_b16 a[124:125], v221 offset:28672
    v_mfma_f32_16x16x32_bf16 a[32:35], v[68:71], a[104:107], a[32:35]
    ds_read_b64_tr_b16 a[126:127], v221 offset:30720
    v_mfma_f32_16x16x32_bf16 a[32:35], v[72:75], a[108:111], a[32:35]
    global_load_lds_dwordx4 v229, s[74:75] offset:1024 nt
    v_mfma_f32_16x16x32_bf16 a[36:39], v[76:79], a[104:107], 0
    s_add_u32 s32, s67, 0x10000
    v_sub_f32 v12, v12, v234
    v_exp_f32 v12, v12
    v_mfma_f32_16x16x32_bf16 a[36:39], v[80:83], a[108:111], a[36:39]
    s_and_b32 s32, s32, 0x7ffff
    v_sub_f32 v13, v13, v234
    v_exp_f32 v13, v13
    v_mfma_f32_16x16x32_bf16 a[36:39], v[44:47], a[96:99], a[36:39]
    v_sub_f32 v14, v14, v234
    v_exp_f32 v14, v14
    v_mfma_f32_16x16x32_bf16 a[36:39], v[48:51], a[100:103], a[36:39]
    s_waitcnt vmcnt(14) lgkmcnt(0)
    v_sub_f32 v15, v15, v234
    v_exp_f32 v15, v15
    v_smfmac_f32_16x16x64_bf16 a[128:131], a[144:147], v[84:91], v236
    s_barrier
    v_mfma_f32_16x16x32_bf16 v[4:7], a[80:83], a[148:151], 0
    s_add_u32 s72, s14, s32
    v_sub_f32 v16, v16, v235
    v_exp_f32 v16, v16
    v_mfma_f32_16x16x32_bf16 v[4:7], a[84:87], a[152:155], v[4:7]
    ds_read_b128 a[64:67], v212 offset:49152
    v_cvt_pk_bf16_f32 v133, v14, v15
    v_mfma_f32_16x16x32_bf16 v[4:7], a[88:91], a[156:159], v[4:7]
    s_addc_u32 s73, s15, 0
    v_sub_f32 v17, v17, v235
    v_exp_f32 v17, v17
    v_mfma_f32_16x16x32_bf16 v[4:7], a[92:95], a[160:163], v[4:7]
    ds_read_b64_tr_b16 a[96:97], v222 offset:16384
    v_cvt_pk_bf16_f32 v132, v12, v13
    v_mfma_f32_16x16x32_bf16 v[8:11], a[88:91], a[172:175], 0
    v_sub_f32 v18, v18, v235
    v_exp_f32 v18, v18
    v_mfma_f32_16x16x32_bf16 v[8:11], a[92:95], a[176:179], v[8:11]
    ds_read_b64_tr_b16 a[98:99], v222 offset:18432
    v_cvt_pk_bf16_f32 v140, v16, v17
    v_mfma_f32_16x16x32_bf16 v[8:11], a[80:83], a[164:167], v[8:11]
    v_sub_f32 v19, v19, v235
    v_exp_f32 v19, v19
    v_mfma_f32_16x16x32_bf16 v[8:11], a[84:87], a[168:171], v[8:11]
    global_load_lds_dwordx4 v228, s[74:75] offset:2048 nt
    v_mfma_f32_16x16x32_bf16 v[12:15], a[80:83], a[180:183], 0
    v_sub_f32 v4, v4, v232
    v_exp_f32 v4, v4
    v_mfma_f32_16x16x32_bf16 v[12:15], a[84:87], a[184:187], v[12:15]
    ds_read_b128 a[68:71], v213 offset:49152
    v_cvt_pk_bf16_f32 v141, v18, v19
    v_mfma_f32_16x16x32_bf16 v[12:15], a[88:91], a[188:191], v[12:15]
    v_sub_f32 v5, v5, v232
    v_exp_f32 v5, v5
    v_mfma_f32_16x16x32_bf16 v[12:15], a[92:95], a[192:195], v[12:15]
    ds_read_b64_tr_b16 a[100:101], v222 offset:20480
    v_mfma_f32_16x16x32_bf16 v[16:19], a[88:91], a[204:207], 0
    v_sub_f32 v6, v6, v232
    v_exp_f32 v6, v6
    v_mfma_f32_16x16x32_bf16 v[16:19], a[92:95], a[208:211], v[16:19]
    ds_read_b64_tr_b16 a[102:103], v222 offset:22528
    v_cvt_pk_bf16_f32 v118, v4, v5
    v_mfma_f32_16x16x32_bf16 v[16:19], a[80:83], a[196:199], v[16:19]
    v_sub_f32 v7, v7, v232
    v_exp_f32 v7, v7
    v_mfma_f32_16x16x32_bf16 v[16:19], a[84:87], a[200:203], v[16:19]
    global_load_lds_dwordx4 v229, s[74:75] offset:3072 nt
    v_mfma_f32_16x16x32_bf16 v[188:191], v[20:23], a[112:115], 0
    v_sub_f32 v8, v8, v233
    v_exp_f32 v8, v8
    v_mfma_f32_16x16x32_bf16 v[188:191], v[24:27], a[116:119], v[188:191]
    ds_read_b128 a[72:75], v214 offset:49152
    v_cvt_pk_bf16_f32 v119, v6, v7
    v_mfma_f32_16x16x32_bf16 v[188:191], v[52:55], a[120:123], v[188:191]
    v_sub_f32 v9, v9, v233
    v_exp_f32 v9, v9
    v_mfma_f32_16x16x32_bf16 v[188:191], v[56:59], a[124:127], v[188:191]
    ds_read_b64_tr_b16 a[104:105], v222 offset:24576
    v_mfma_f32_16x16x32_bf16 v[192:195], v[60:63], a[120:123], 0
    s_add_u32 m0, s33, 0x0
    v_sub_f32 v10, v10, v233
    v_exp_f32 v10, v10
    v_mfma_f32_16x16x32_bf16 v[192:195], v[64:67], a[124:127], v[192:195]
    ds_read_b64_tr_b16 a[106:107], v222 offset:26624
    v_cvt_pk_bf16_f32 v126, v8, v9
    v_mfma_f32_16x16x32_bf16 v[192:195], v[28:31], a[112:115], v[192:195]
    v_sub_f32 v11, v11, v233
    v_exp_f32 v11, v11
    v_mfma_f32_16x16x32_bf16 v[192:195], v[32:35], a[116:119], v[192:195]
    global_load_lds_dwordx4 v224, s[72:73] nt
    v_mfma_f32_16x16x32_bf16 a[40:43], v[36:39], a[112:115], 0
    s_add_u32 s32, s64, 0x28000
    v_sub_f32 v12, v12, v234
    v_exp_f32 v12, v12
    v_mfma_f32_16x16x32_bf16 a[40:43], v[40:43], a[116:119], a[40:43]
    ds_read_b128 a[76:79], v215 offset:49152
    v_cvt_pk_bf16_f32 v127, v10, v11
    v_mfma_f32_16x16x32_bf16 a[40:43], v[68:71], a[120:123], a[40:43]
    s_and_b32 s32, s32, 0x7ffff
    v_sub_f32 v13, v13, v234
    v_exp_f32 v13, v13
    v_mfma_f32_16x16x32_bf16 a[40:43], v[72:75], a[124:127], a[40:43]
    ds_read_b64_tr_b16 a[108:109], v222 offset:28672
    v_mfma_f32_16x16x32_bf16 a[44:47], v[76:79], a[120:123], 0
    v_sub_f32 v14, v14, v234
    v_exp_f32 v14, v14
    v_mfma_f32_16x16x32_bf16 a[44:47], v[80:83], a[124:127], a[44:47]
    ds_read_b64_tr_b16 a[110:111], v222 offset:30720
    v_cvt_pk_bf16_f32 v134, v12, v13
    v_mfma_f32_16x16x32_bf16 a[44:47], v[44:47], a[112:115], a[44:47]
    s_waitcnt lgkmcnt(2)
    v_sub_f32 v15, v15, v234
    v_exp_f32 v15, v15
    v_mfma_f32_16x16x32_bf16 a[44:47], v[48:51], a[116:119], a[44:47]
    global_load_lds_dwordx4 v225, s[72:73] offset:1024 nt
    v_smfmac_f32_16x16x64_bf16 a[132:135], a[144:147], v[92:99], v236
    v_mfma_f32_16x16x32_bf16 v[4:7], a[64:67], a[148:151], 0
    s_add_u32 s74, s12, s32
    v_sub_f32 v16, v16, v235
    v_exp_f32 v16, v16
    v_mfma_f32_16x16x32_bf16 v[4:7], a[68:71], a[152:155], v[4:7]
    ds_read_b128 a[80:83], v212 offset:53248
    v_cvt_pk_bf16_f32 v135, v14, v15
    v_mfma_f32_16x16x32_bf16 v[4:7], a[72:75], a[156:159], v[4:7]
    s_addc_u32 s75, s13, 0
    v_sub_f32 v17, v17, v235
    v_exp_f32 v17, v17
    v_mfma_f32_16x16x32_bf16 v[4:7], a[76:79], a[160:163], v[4:7]
    ds_read_b64_tr_b16 a[112:113], v223 offset:16384
    v_mfma_f32_16x16x32_bf16 v[8:11], a[72:75], a[172:175], 0
    v_sub_f32 v18, v18, v235
    v_exp_f32 v18, v18
    v_mfma_f32_16x16x32_bf16 v[8:11], a[76:79], a[176:179], v[8:11]
    ds_read_b64_tr_b16 a[114:115], v223 offset:18432
    v_cvt_pk_bf16_f32 v142, v16, v17
    v_mfma_f32_16x16x32_bf16 v[8:11], a[64:67], a[164:167], v[8:11]
    s_waitcnt lgkmcnt(3)
    v_sub_f32 v19, v19, v235
    v_exp_f32 v19, v19
    v_mfma_f32_16x16x32_bf16 v[8:11], a[68:71], a[168:171], v[8:11]
    global_load_lds_dwordx4 v226, s[72:73] offset:2048 nt
    v_mfma_f32_16x16x32_bf16 v[12:15], a[64:67], a[180:183], 0
    v_sub_f32 v4, v4, v232
    v_exp_f32 v4, v4
    v_mfma_f32_16x16x32_bf16 v[12:15], a[68:71], a[184:187], v[12:15]
    ds_read_b128 a[84:87], v213 offset:53248
    v_cvt_pk_bf16_f32 v143, v18, v19
    v_mfma_f32_16x16x32_bf16 v[12:15], a[72:75], a[188:191], v[12:15]
    v_sub_f32 v5, v5, v232
    v_exp_f32 v5, v5
    v_mfma_f32_16x16x32_bf16 v[12:15], a[76:79], a[192:195], v[12:15]
    ds_read_b64_tr_b16 a[116:117], v223 offset:20480
    v_mfma_f32_16x16x32_bf16 v[16:19], a[72:75], a[204:207], 0
    v_sub_f32 v6, v6, v232
    v_exp_f32 v6, v6
    v_mfma_f32_16x16x32_bf16 v[16:19], a[76:79], a[208:211], v[16:19]
    ds_read_b64_tr_b16 a[118:119], v223 offset:22528
    v_cvt_pk_bf16_f32 v120, v4, v5
    v_mfma_f32_16x16x32_bf16 v[16:19], a[64:67], a[196:199], v[16:19]
    v_sub_f32 v7, v7, v232
    v_exp_f32 v7, v7
    v_mfma_f32_16x16x32_bf16 v[16:19], a[68:71], a[200:203], v[16:19]
    global_load_lds_dwordx4 v227, s[72:73] offset:3072 nt
    v_mfma_f32_16x16x32_bf16 v[196:199], v[20:23], a[96:99], 0
    v_sub_f32 v8, v8, v233
    v_exp_f32 v8, v8
    v_mfma_f32_16x16x32_bf16 v[196:199], v[24:27], a[100:103], v[196:199]
    ds_read_b128 a[88:91], v214 offset:53248
    v_cvt_pk_bf16_f32 v121, v6, v7
    v_mfma_f32_16x16x32_bf16 v[196:199], v[52:55], a[104:107], v[196:199]
    v_sub_f32 v9, v9, v233
    v_exp_f32 v9, v9
    v_mfma_f32_16x16x32_bf16 v[196:199], v[56:59], a[108:111], v[196:199]
    ds_read_b64_tr_b16 a[120:121], v223 offset:24576
    v_mfma_f32_16x16x32_bf16 v[200:203], v[60:63], a[104:107], 0
    s_add_u32 m0, s31, 0x8000
    v_sub_f32 v10, v10, v233
    v_exp_f32 v10, v10
    v_mfma_f32_16x16x32_bf16 v[200:203], v[64:67], a[108:111], v[200:203]
    ds_read_b64_tr_b16 a[122:123], v223 offset:26624
    v_cvt_pk_bf16_f32 v128, v8, v9
    v_mfma_f32_16x16x32_bf16 v[200:203], v[28:31], a[96:99], v[200:203]
    v_sub_f32 v11, v11, v233
    v_exp_f32 v11, v11
    v_mfma_f32_16x16x32_bf16 v[200:203], v[32:35], a[100:103], v[200:203]
    global_load_lds_dwordx4 v228, s[74:75] nt
    v_mfma_f32_16x16x32_bf16 a[48:51], v[36:39], a[96:99], 0
    ds_read_b128 a[92:95], v215 offset:53248
    v_cvt_pk_bf16_f32 v129, v10, v11
    v_mfma_f32_16x16x32_bf16 a[48:51], v[40:43], a[100:103], a[48:51]
    ds_read_b64_tr_b16 a[124:125], v223 offset:28672
    v_mfma_f32_16x16x32_bf16 a[48:51], v[68:71], a[104:107], a[48:51]
    ds_read_b64_tr_b16 a[126:127], v223 offset:30720
    v_mfma_f32_16x16x32_bf16 a[48:51], v[72:75], a[108:111], a[48:51]
    global_load_lds_dwordx4 v229, s[74:75] offset:1024 nt
    v_mfma_f32_16x16x32_bf16 a[52:55], v[76:79], a[104:107], 0
    s_add_u32 s32, s67, 0x18000
    v_sub_f32 v12, v12, v234
    v_exp_f32 v12, v12
    v_mfma_f32_16x16x32_bf16 a[52:55], v[80:83], a[108:111], a[52:55]
    s_and_b32 s32, s32, 0x7ffff
    v_sub_f32 v13, v13, v234
    v_exp_f32 v13, v13
    v_mfma_f32_16x16x32_bf16 a[52:55], v[44:47], a[96:99], a[52:55]
M_stub2:
    s_cbranch_execz M_stub6
    v_sub_f32 v14, v14, v234
    v_exp_f32 v14, v14
    v_mfma_f32_16x16x32_bf16 a[52:55], v[48:51], a[100:103], a[52:55]
    s_waitcnt vmcnt(10) lgkmcnt(0)
    v_sub_f32 v15, v15, v234
    v_exp_f32 v15, v15
    v_smfmac_f32_16x16x64_bf16 a[136:139], a[144:147], v[100:107], v236
    s_barrier
    v_mfma_f32_16x16x32_bf16 v[4:7], a[80:83], a[148:151], 0
    s_add_u32 s72, s14, s32
    v_sub_f32 v16, v16, v235
    v_exp_f32 v16, v16
    v_mfma_f32_16x16x32_bf16 v[4:7], a[84:87], a[152:155], v[4:7]
    ds_read_b128 a[64:67], v212
    v_cvt_pk_bf16_f32 v137, v14, v15
    v_mfma_f32_16x16x32_bf16 v[4:7], a[88:91], a[156:159], v[4:7]
    s_addc_u32 s73, s15, 0
    v_sub_f32 v17, v17, v235
    v_exp_f32 v17, v17
    v_mfma_f32_16x16x32_bf16 v[4:7], a[92:95], a[160:163], v[4:7]
    ds_read_b64_tr_b16 a[96:97], v220 offset:32768
    v_cvt_pk_bf16_f32 v136, v12, v13
    v_mfma_f32_16x16x32_bf16 v[8:11], a[88:91], a[172:175], 0
    v_sub_f32 v18, v18, v235
    v_exp_f32 v18, v18
    v_mfma_f32_16x16x32_bf16 v[8:11], a[92:95], a[176:179], v[8:11]
    ds_read_b64_tr_b16 a[98:99], v220 offset:34816
    v_cvt_pk_bf16_f32 v144, v16, v17
    v_mfma_f32_16x16x32_bf16 v[8:11], a[80:83], a[164:167], v[8:11]
    v_sub_f32 v19, v19, v235
    v_exp_f32 v19, v19
    v_mfma_f32_16x16x32_bf16 v[8:11], a[84:87], a[168:171], v[8:11]
    global_load_lds_dwordx4 v228, s[74:75] offset:2048 nt
    v_mfma_f32_16x16x32_bf16 v[12:15], a[80:83], a[180:183], 0
    v_sub_f32 v4, v4, v232
    v_exp_f32 v4, v4
    v_mfma_f32_16x16x32_bf16 v[12:15], a[84:87], a[184:187], v[12:15]
    ds_read_b128 a[68:71], v213
    v_cvt_pk_bf16_f32 v145, v18, v19
    v_mfma_f32_16x16x32_bf16 v[12:15], a[88:91], a[188:191], v[12:15]
    v_sub_f32 v5, v5, v232
    v_exp_f32 v5, v5
    v_mfma_f32_16x16x32_bf16 v[12:15], a[92:95], a[192:195], v[12:15]
    ds_read_b64_tr_b16 a[100:101], v220 offset:36864
    v_mfma_f32_16x16x32_bf16 v[16:19], a[88:91], a[204:207], 0
    v_sub_f32 v6, v6, v232
    v_exp_f32 v6, v6
    v_mfma_f32_16x16x32_bf16 v[16:19], a[92:95], a[208:211], v[16:19]
    ds_read_b64_tr_b16 a[102:103], v220 offset:38912
    v_cvt_pk_bf16_f32 v122, v4, v5
    v_mfma_f32_16x16x32_bf16 v[16:19], a[80:83], a[196:199], v[16:19]
    v_sub_f32 v7, v7, v232
    v_exp_f32 v7, v7
    v_mfma_f32_16x16x32_bf16 v[16:19], a[84:87], a[200:203], v[16:19]
    global_load_lds_dwordx4 v229, s[74:75] offset:3072 nt
    v_mfma_f32_16x16x32_bf16 v[204:207], v[20:23], a[112:115], 0
    v_sub_f32 v8, v8, v233
    v_exp_f32 v8, v8
    v_mfma_f32_16x16x32_bf16 v[204:207], v[24:27], a[116:119], v[204:207]
    ds_read_b128 a[72:75], v214
    v_cvt_pk_bf16_f32 v123, v6, v7
    v_mfma_f32_16x16x32_bf16 v[204:207], v[52:55], a[120:123], v[204:207]
    v_sub_f32 v9, v9, v233
    v_exp_f32 v9, v9
    v_mfma_f32_16x16x32_bf16 v[204:207], v[56:59], a[124:127], v[204:207]
    ds_read_b64_tr_b16 a[104:105], v220 offset:40960
    v_mfma_f32_16x16x32_bf16 v[208:211], v[60:63], a[120:123], 0
    s_add_u32 m0, s33, 0x2000
    v_sub_f32 v10, v10, v233
    v_exp_f32 v10, v10
    v_mfma_f32_16x16x32_bf16 v[208:211], v[64:67], a[124:127], v[208:211]
    ds_read_b64_tr_b16 a[106:107], v220 offset:43008
    v_cvt_pk_bf16_f32 v130, v8, v9
    v_mfma_f32_16x16x32_bf16 v[208:211], v[28:31], a[112:115], v[208:211]
    v_sub_f32 v11, v11, v233
    v_exp_f32 v11, v11
    v_mfma_f32_16x16x32_bf16 v[208:211], v[32:35], a[116:119], v[208:211]
    global_load_lds_dwordx4 v224, s[72:73] nt
    v_mfma_f32_16x16x32_bf16 a[56:59], v[36:39], a[112:115], 0
    s_add_u32 s32, s65, 0x28000
    v_sub_f32 v12, v12, v234
    v_exp_f32 v12, v12
    v_mfma_f32_16x16x32_bf16 a[56:59], v[40:43], a[116:119], a[56:59]
    ds_read_b128 a[76:79], v215
    v_cvt_pk_bf16_f32 v131, v10, v11
    v_mfma_f32_16x16x32_bf16 a[56:59], v[68:71], a[120:123], a[56:59]
    s_and_b32 s32, s32, 0x7ffff
    v_sub_f32 v13, v13, v234
    v_exp_f32 v13, v13
    v_mfma_f32_16x16x32_bf16 a[56:59], v[72:75], a[124:127], a[56:59]
    ds_read_b64_tr_b16 a[108:109], v220 offset:45056
    v_mfma_f32_16x16x32_bf16 a[60:63], v[76:79], a[120:123], 0
    v_sub_f32 v14, v14, v234
    v_exp_f32 v14, v14
    v_mfma_f32_16x16x32_bf16 a[60:63], v[80:83], a[124:127], a[60:63]
    ds_read_b64_tr_b16 a[110:111], v220 offset:47104
    v_cvt_pk_bf16_f32 v138, v12, v13
    v_mfma_f32_16x16x32_bf16 a[60:63], v[44:47], a[112:115], a[60:63]
    s_waitcnt lgkmcnt(2)
    v_sub_f32 v15, v15, v234
    v_exp_f32 v15, v15
    v_mfma_f32_16x16x32_bf16 a[60:63], v[48:51], a[116:119], a[60:63]
    global_load_lds_dwordx4 v225, s[72:73] offset:1024 nt
    v_smfmac_f32_16x16x64_bf16 a[140:143], a[144:147], v[108:115], v236
    v_mfma_f32_16x16x32_bf16 v[4:7], a[64:67], a[148:151], 0
    s_add_u32 s74, s12, s32
    v_sub_f32 v16, v16, v235
    v_exp_f32 v16, v16
    v_mfma_f32_16x16x32_bf16 v[4:7], a[68:71], a[152:155], v[4:7]
    ds_read_b128 a[80:83], v212 offset:4096
    v_cvt_pk_bf16_f32 v139, v14, v15
    v_mfma_f32_16x16x32_bf16 v[4:7], a[72:75], a[156:159], v[4:7]
    s_addc_u32 s75, s13, 0
    v_sub_f32 v17, v17, v235
    v_exp_f32 v17, v17
    v_mfma_f32_16x16x32_bf16 v[4:7], a[76:79], a[160:163], v[4:7]
    ds_read_b64_tr_b16 a[112:113], v221 offset:32768
    v_lshlrev_b32 v248, 4, v0
    v_mfma_f32_16x16x32_bf16 v[8:11], a[72:75], a[172:175], 0
    v_sub_f32 v18, v18, v235
    v_exp_f32 v18, v18
    v_mfma_f32_16x16x32_bf16 v[8:11], a[76:79], a[176:179], v[8:11]
    ds_read_b64_tr_b16 a[114:115], v221 offset:34816
    v_cvt_pk_bf16_f32 v146, v16, v17
    v_mfma_f32_16x16x32_bf16 v[8:11], a[64:67], a[164:167], v[8:11]
    s_waitcnt lgkmcnt(3)
    v_sub_f32 v19, v19, v235
    v_exp_f32 v19, v19
    v_mfma_f32_16x16x32_bf16 v[8:11], a[68:71], a[168:171], v[8:11]
    global_load_lds_dwordx4 v226, s[72:73] offset:2048 nt
    v_add_u32 v240, s86, v248
    v_mfma_f32_16x16x32_bf16 v[12:15], a[64:67], a[180:183], 0
    v_sub_f32 v4, v4, v232
    v_exp_f32 v4, v4
    v_mfma_f32_16x16x32_bf16 v[12:15], a[68:71], a[184:187], v[12:15]
    ds_read_b128 a[84:87], v213 offset:4096
    v_cvt_pk_bf16_f32 v147, v18, v19
    v_mfma_f32_16x16x32_bf16 v[12:15], a[72:75], a[188:191], v[12:15]
    v_sub_f32 v5, v5, v232
    v_exp_f32 v5, v5
    v_mfma_f32_16x16x32_bf16 v[12:15], a[76:79], a[192:195], v[12:15]
    ds_read_b64_tr_b16 a[116:117], v221 offset:36864
    v_xor_b32 v241, 0x800, v240
    v_mfma_f32_16x16x32_bf16 v[16:19], a[72:75], a[204:207], 0
    v_sub_f32 v6, v6, v232
    v_exp_f32 v6, v6
    v_mfma_f32_16x16x32_bf16 v[16:19], a[76:79], a[208:211], v[16:19]
    ds_read_b64_tr_b16 a[118:119], v221 offset:38912
    v_cvt_pk_bf16_f32 v20, v4, v5
    v_mfma_f32_16x16x32_bf16 v[16:19], a[64:67], a[196:199], v[16:19]
    v_sub_f32 v7, v7, v232
    v_exp_f32 v7, v7
    v_mfma_f32_16x16x32_bf16 v[16:19], a[68:71], a[200:203], v[16:19]
    global_load_lds_dwordx4 v227, s[72:73] offset:3072 nt
    v_add_u32 v239, s85, v248
    v_mfma_f32_16x16x32_bf16 v[148:151], v[84:87], a[96:99], v[148:151]
    v_sub_f32 v8, v8, v233
    v_exp_f32 v8, v8
    v_mfma_f32_16x16x32_bf16 v[148:151], v[88:91], a[100:103], v[148:151]
    ds_read_b128 a[88:91], v214 offset:4096
    v_cvt_pk_bf16_f32 v21, v6, v7
    v_mfma_f32_16x16x32_bf16 v[148:151], v[116:119], a[104:107], v[148:151]
    v_sub_f32 v9, v9, v233
    v_exp_f32 v9, v9
    v_mfma_f32_16x16x32_bf16 v[148:151], v[120:123], a[108:111], v[148:151]
    ds_read_b64_tr_b16 a[120:121], v221 offset:40960
    v_xor_b32 v238, 0x1000, v239
    v_mfma_f32_16x16x32_bf16 v[152:155], v[124:127], a[104:107], v[152:155]
    s_add_u32 m0, s31, 0xc000
    v_sub_f32 v10, v10, v233
    v_exp_f32 v10, v10
    v_mfma_f32_16x16x32_bf16 v[152:155], v[128:131], a[108:111], v[152:155]
    ds_read_b64_tr_b16 a[122:123], v221 offset:43008
    v_cvt_pk_bf16_f32 v28, v8, v9
    v_mfma_f32_16x16x32_bf16 v[152:155], v[92:95], a[96:99], v[152:155]
    v_sub_f32 v11, v11, v233
    v_exp_f32 v11, v11
    v_mfma_f32_16x16x32_bf16 v[152:155], v[96:99], a[100:103], v[152:155]
    global_load_lds_dwordx4 v228, s[74:75] nt
    v_lshrrev_b32 v249, 2, v0
    v_mfma_f32_16x16x32_bf16 a[0:3], v[100:103], a[96:99], a[0:3]
    ds_read_b128 a[92:95], v215 offset:4096
    v_cvt_pk_bf16_f32 v29, v10, v11
    v_mfma_f32_16x16x32_bf16 a[0:3], v[104:107], a[100:103], a[0:3]
    ds_read_b64_tr_b16 a[124:125], v221 offset:45056
    v_lshrrev_b32 v250, 3, v0
    v_mfma_f32_16x16x32_bf16 a[0:3], v[132:135], a[104:107], a[0:3]
    ds_read_b64_tr_b16 a[126:127], v221 offset:47104
    v_lshlrev_b32 v242, 8, v250
    v_mfma_f32_16x16x32_bf16 a[0:3], v[136:139], a[108:111], a[0:3]
    global_load_lds_dwordx4 v229, s[74:75] offset:1024 nt
    v_mfma_f32_16x16x32_bf16 a[4:7], v[140:143], a[104:107], a[4:7]
    s_add_u32 s32, s66, 0x20000
    v_sub_f32 v12, v12, v234
    v_exp_f32 v12, v12
    v_mfma_f32_16x16x32_bf16 a[4:7], v[144:147], a[108:111], a[4:7]
    s_and_b32 s32, s32, 0x7ffff
    v_sub_f32 v13, v13, v234
    v_exp_f32 v13, v13
    v_mfma_f32_16x16x32_bf16 a[4:7], v[108:111], a[96:99], a[4:7]
    v_sub_f32 v14, v14, v234
    v_exp_f32 v14, v14
    v_mfma_f32_16x16x32_bf16 a[4:7], v[112:115], a[100:103], a[4:7]
    s_waitcnt vmcnt(14) lgkmcnt(0)
    v_sub_f32 v15, v15, v234
    v_exp_f32 v15, v15
    v_smfmac_f32_16x16x64_bf16 a[128:131], a[144:147], v[116:123], v236
    s_barrier
    v_mfma_f32_16x16x32_bf16 v[4:7], a[80:83], a[148:151], 0
    s_add_u32 s72, s14, s32
    v_sub_f32 v16, v16, v235
    v_exp_f32 v16, v16
    v_mfma_f32_16x16x32_bf16 v[4:7], a[84:87], a[152:155], v[4:7]
    ds_read_b128 a[64:67], v212 offset:16384
    v_cvt_pk_bf16_f32 v37, v14, v15
    v_mfma_f32_16x16x32_bf16 v[4:7], a[88:91], a[156:159], v[4:7]
    s_addc_u32 s73, s15, 0
    v_sub_f32 v17, v17, v235
    v_exp_f32 v17, v17
    v_mfma_f32_16x16x32_bf16 v[4:7], a[92:95], a[160:163], v[4:7]
    ds_read_b64_tr_b16 a[96:97], v222 offset:32768
    v_cvt_pk_bf16_f32 v36, v12, v13
    v_mfma_f32_16x16x32_bf16 v[8:11], a[88:91], a[172:175], 0
    v_sub_f32 v18, v18, v235
    v_exp_f32 v18, v18
    v_mfma_f32_16x16x32_bf16 v[8:11], a[92:95], a[176:179], v[8:11]
    ds_read_b64_tr_b16 a[98:99], v222 offset:34816
    v_cvt_pk_bf16_f32 v44, v16, v17
    v_mfma_f32_16x16x32_bf16 v[8:11], a[80:83], a[164:167], v[8:11]
    v_sub_f32 v19, v19, v235
    v_exp_f32 v19, v19
    v_mfma_f32_16x16x32_bf16 v[8:11], a[84:87], a[168:171], v[8:11]
    global_load_lds_dwordx4 v228, s[74:75] offset:2048 nt
    v_and_b32 v250, 7, v0
    v_mfma_f32_16x16x32_bf16 v[12:15], a[80:83], a[180:183], 0
    v_sub_f32 v4, v4, v232
    v_exp_f32 v4, v4
    v_mfma_f32_16x16x32_bf16 v[12:15], a[84:87], a[184:187], v[12:15]
    ds_read_b128 a[68:71], v213 offset:16384
    v_cvt_pk_bf16_f32 v45, v18, v19
    v_mfma_f32_16x16x32_bf16 v[12:15], a[88:91], a[188:191], v[12:15]
    v_sub_f32 v5, v5, v232
    v_exp_f32 v5, v5
    v_mfma_f32_16x16x32_bf16 v[12:15], a[92:95], a[192:195], v[12:15]
    ds_read_b64_tr_b16 a[100:101], v222 offset:36864
    v_lshl_add_u32 v242, v250, 4, v242
    v_mfma_f32_16x16x32_bf16 v[16:19], a[88:91], a[204:207], 0
    v_sub_f32 v6, v6, v232
    v_exp_f32 v6, v6
    v_mfma_f32_16x16x32_bf16 v[16:19], a[92:95], a[208:211], v[16:19]
    ds_read_b64_tr_b16 a[102:103], v222 offset:38912
    v_cvt_pk_bf16_f32 v22, v4, v5
    v_mfma_f32_16x16x32_bf16 v[16:19], a[80:83], a[196:199], v[16:19]
    v_sub_f32 v7, v7, v232
    v_exp_f32 v7, v7
    v_mfma_f32_16x16x32_bf16 v[16:19], a[84:87], a[200:203], v[16:19]
    global_load_lds_dwordx4 v229, s[74:75] offset:3072 nt
    v_add_u32 v242, s47, v242
    v_mfma_f32_16x16x32_bf16 v[156:159], v[84:87], a[112:115], v[156:159]
    v_sub_f32 v8, v8, v233
    v_exp_f32 v8, v8
    v_mfma_f32_16x16x32_bf16 v[156:159], v[88:91], a[116:119], v[156:159]
    ds_read_b128 a[72:75], v214 offset:16384
    v_cvt_pk_bf16_f32 v23, v6, v7
    v_mfma_f32_16x16x32_bf16 v[156:159], v[116:119], a[120:123], v[156:159]
    v_sub_f32 v9, v9, v233
    v_exp_f32 v9, v9
    v_mfma_f32_16x16x32_bf16 v[156:159], v[120:123], a[124:127], v[156:159]
    ds_read_b64_tr_b16 a[104:105], v222 offset:40960
    v_and_b32 v248, 1, v2
    v_mfma_f32_16x16x32_bf16 v[160:163], v[124:127], a[120:123], v[160:163]
    s_add_u32 m0, s33, 0x4000
    v_sub_f32 v10, v10, v233
    v_exp_f32 v10, v10
    v_mfma_f32_16x16x32_bf16 v[160:163], v[128:131], a[124:127], v[160:163]
    ds_read_b64_tr_b16 a[106:107], v222 offset:43008
    v_cvt_pk_bf16_f32 v30, v8, v9
    v_mfma_f32_16x16x32_bf16 v[160:163], v[92:95], a[112:115], v[160:163]
    v_sub_f32 v11, v11, v233
    v_exp_f32 v11, v11
    v_mfma_f32_16x16x32_bf16 v[160:163], v[96:99], a[116:119], v[160:163]
    global_load_lds_dwordx4 v224, s[72:73] nt
    v_lshlrev_b32 v248, 3, v248
    v_mfma_f32_16x16x32_bf16 a[8:11], v[100:103], a[112:115], a[8:11]
    s_add_u32 s32, s64, 0x30000
    v_sub_f32 v12, v12, v234
    v_exp_f32 v12, v12
    v_mfma_f32_16x16x32_bf16 a[8:11], v[104:107], a[116:119], a[8:11]
    ds_read_b128 a[76:79], v215 offset:16384
    v_cvt_pk_bf16_f32 v31, v10, v11
    v_mfma_f32_16x16x32_bf16 a[8:11], v[132:135], a[120:123], a[8:11]
    s_and_b32 s32, s32, 0x7ffff
    v_sub_f32 v13, v13, v234
    v_exp_f32 v13, v13
    v_mfma_f32_16x16x32_bf16 a[8:11], v[136:139], a[124:127], a[8:11]
    ds_read_b64_tr_b16 a[108:109], v222 offset:45056
    v_xor_b32 v248, v248, v1
    v_mfma_f32_16x16x32_bf16 a[12:15], v[140:143], a[120:123], a[12:15]
    v_sub_f32 v14, v14, v234
    v_exp_f32 v14, v14
    v_mfma_f32_16x16x32_bf16 a[12:15], v[144:147], a[124:127], a[12:15]
    ds_read_b64_tr_b16 a[110:111], v222 offset:47104
    v_cvt_pk_bf16_f32 v38, v12, v13
    v_mfma_f32_16x16x32_bf16 a[12:15], v[108:111], a[112:115], a[12:15]
    s_waitcnt lgkmcnt(2)
    v_sub_f32 v15, v15, v234
    v_exp_f32 v15, v15
    v_mfma_f32_16x16x32_bf16 a[12:15], v[112:115], a[116:119], a[12:15]
    global_load_lds_dwordx4 v225, s[72:73] offset:1024 nt
    v_lshlrev_b32 v248, 3, v248
    v_smfmac_f32_16x16x64_bf16 a[132:135], a[144:147], v[124:131], v236
    v_lshl_add_u32 v248, v2, 9, v248
    v_mfma_f32_16x16x32_bf16 v[4:7], a[64:67], a[148:151], 0
    s_add_u32 s74, s12, s32
    v_sub_f32 v16, v16, v235
    v_exp_f32 v16, v16
    v_mfma_f32_16x16x32_bf16 v[4:7], a[68:71], a[152:155], v[4:7]
    ds_read_b128 a[80:83], v212 offset:20480
    v_cvt_pk_bf16_f32 v39, v14, v15
    v_mfma_f32_16x16x32_bf16 v[4:7], a[72:75], a[156:159], v[4:7]
    s_addc_u32 s75, s13, 0
    v_sub_f32 v17, v17, v235
    v_exp_f32 v17, v17
    v_mfma_f32_16x16x32_bf16 v[4:7], a[76:79], a[160:163], v[4:7]
    ds_read_b64_tr_b16 a[112:113], v223 offset:32768
    v_add_u32 v243, s84, v248
    v_mfma_f32_16x16x32_bf16 v[8:11], a[72:75], a[172:175], 0
    v_sub_f32 v18, v18, v235
    v_exp_f32 v18, v18
    v_mfma_f32_16x16x32_bf16 v[8:11], a[76:79], a[176:179], v[8:11]
    ds_read_b64_tr_b16 a[114:115], v223 offset:34816
    v_cvt_pk_bf16_f32 v46, v16, v17
    v_mfma_f32_16x16x32_bf16 v[8:11], a[64:67], a[164:167], v[8:11]
    s_waitcnt lgkmcnt(3)
    v_sub_f32 v19, v19, v235
    v_exp_f32 v19, v19
    v_mfma_f32_16x16x32_bf16 v[8:11], a[68:71], a[168:171], v[8:11]
    global_load_lds_dwordx4 v226, s[72:73] offset:2048 nt
    v_xor_b32 v244, 32, v243
    v_mfma_f32_16x16x32_bf16 v[12:15], a[64:67], a[180:183], 0
    v_sub_f32 v4, v4, v232
    v_exp_f32 v4, v4
    v_mfma_f32_16x16x32_bf16 v[12:15], a[68:71], a[184:187], v[12:15]
    ds_read_b128 a[84:87], v213 offset:20480
    v_cvt_pk_bf16_f32 v47, v18, v19
    v_mfma_f32_16x16x32_bf16 v[12:15], a[72:75], a[188:191], v[12:15]
    v_sub_f32 v5, v5, v232
    v_exp_f32 v5, v5
    v_mfma_f32_16x16x32_bf16 v[12:15], a[76:79], a[192:195], v[12:15]
    ds_read_b64_tr_b16 a[116:117], v223 offset:36864
    v_bfe_u32 v248, v0, 1, 1
    v_mfma_f32_16x16x32_bf16 v[16:19], a[72:75], a[204:207], 0
    v_sub_f32 v6, v6, v232
    v_exp_f32 v6, v6
    v_mfma_f32_16x16x32_bf16 v[16:19], a[76:79], a[208:211], v[16:19]
    ds_read_b64_tr_b16 a[118:119], v223 offset:38912
    v_cvt_pk_bf16_f32 v24, v4, v5
    v_mfma_f32_16x16x32_bf16 v[16:19], a[64:67], a[196:199], v[16:19]
    v_sub_f32 v7, v7, v232
    v_exp_f32 v7, v7
    v_mfma_f32_16x16x32_bf16 v[16:19], a[68:71], a[200:203], v[16:19]
    global_load_lds_dwordx4 v227, s[72:73] offset:3072 nt
    v_lshl_add_u32 v248, v2, 1, v248
    v_mfma_f32_16x16x32_bf16 v[164:167], v[84:87], a[96:99], v[164:167]
    v_sub_f32 v8, v8, v233
    v_exp_f32 v8, v8
    v_mfma_f32_16x16x32_bf16 v[164:167], v[88:91], a[100:103], v[164:167]
    ds_read_b128 a[88:91], v214 offset:20480
    v_cvt_pk_bf16_f32 v25, v6, v7
    v_mfma_f32_16x16x32_bf16 v[164:167], v[116:119], a[104:107], v[164:167]
    v_sub_f32 v9, v9, v233
    v_exp_f32 v9, v9
    v_mfma_f32_16x16x32_bf16 v[164:167], v[120:123], a[108:111], v[164:167]
    ds_read_b64_tr_b16 a[120:121], v223 offset:40960
    v_lshlrev_b32 v248, 7, v248
    v_mfma_f32_16x16x32_bf16 v[168:171], v[124:127], a[104:107], v[168:171]
    s_add_u32 m0, s31, 0x0
    v_sub_f32 v10, v10, v233
    v_exp_f32 v10, v10
    v_mfma_f32_16x16x32_bf16 v[168:171], v[128:131], a[108:111], v[168:171]
    ds_read_b64_tr_b16 a[122:123], v223 offset:43008
    v_cvt_pk_bf16_f32 v32, v8, v9
    v_mfma_f32_16x16x32_bf16 v[168:171], v[92:95], a[96:99], v[168:171]
    v_sub_f32 v11, v11, v233
    v_exp_f32 v11, v11
    v_mfma_f32_16x16x32_bf16 v[168:171], v[96:99], a[100:103], v[168:171]
    global_load_lds_dwordx4 v228, s[74:75] nt
    v_and_b32 v250, 1, v0
    v_mfma_f32_16x16x32_bf16 a[16:19], v[100:103], a[96:99], a[16:19]
    ds_read_b128 a[92:95], v215 offset:20480
    v_cvt_pk_bf16_f32 v33, v10, v11
    v_mfma_f32_16x16x32_bf16 a[16:19], v[104:107], a[100:103], a[16:19]
    ds_read_b64_tr_b16 a[124:125], v223 offset:45056
    v_lshlrev_b32 v250, 1, v250
    v_mfma_f32_16x16x32_bf16 a[16:19], v[132:135], a[104:107], a[16:19]
    ds_read_b64_tr_b16 a[126:127], v223 offset:47104
    v_xor_b32 v250, v250, v2
    v_mfma_f32_16x16x32_bf16 a[16:19], v[136:139], a[108:111], a[16:19]
    global_load_lds_dwordx4 v229, s[74:75] offset:1024 nt
    v_mfma_f32_16x16x32_bf16 a[20:23], v[140:143], a[104:107], a[20:23]
    s_add_u32 s32, s66, 0x28000
    v_sub_f32 v12, v12, v234
    v_exp_f32 v12, v12
    v_mfma_f32_16x16x32_bf16 a[20:23], v[144:147], a[108:111], a[20:23]
    s_and_b32 s32, s32, 0x7ffff
    v_sub_f32 v13, v13, v234
    v_exp_f32 v13, v13
    v_mfma_f32_16x16x32_bf16 a[20:23], v[108:111], a[96:99], a[20:23]
    v_sub_f32 v14, v14, v234
    v_exp_f32 v14, v14
    v_mfma_f32_16x16x32_bf16 a[20:23], v[112:115], a[100:103], a[20:23]
    s_waitcnt vmcnt(10) lgkmcnt(0)
    v_sub_f32 v15, v15, v234
    v_exp_f32 v15, v15
    v_smfmac_f32_16x16x64_bf16 a[136:139], a[144:147], v[132:139], v236
    s_barrier
    v_mfma_f32_16x16x32_bf16 v[4:7], a[80:83], a[148:151], 0
    s_add_u32 s72, s14, s32
    v_sub_f32 v16, v16, v235
    v_exp_f32 v16, v16
    v_mfma_f32_16x16x32_bf16 v[4:7], a[84:87], a[152:155], v[4:7]
    ds_read_b128 a[64:67], v212 offset:32768
    v_cvt_pk_bf16_f32 v41, v14, v15
    v_mfma_f32_16x16x32_bf16 v[4:7], a[88:91], a[156:159], v[4:7]
    s_addc_u32 s73, s15, 0
    v_sub_f32 v17, v17, v235
    v_exp_f32 v17, v17
    v_mfma_f32_16x16x32_bf16 v[4:7], a[92:95], a[160:163], v[4:7]
    ds_read_b64_tr_b16 a[96:97], v220
    v_cvt_pk_bf16_f32 v40, v12, v13
    v_mfma_f32_16x16x32_bf16 v[8:11], a[88:91], a[172:175], 0
    v_sub_f32 v18, v18, v235
    v_exp_f32 v18, v18
    v_mfma_f32_16x16x32_bf16 v[8:11], a[92:95], a[176:179], v[8:11]
    ds_read_b64_tr_b16 a[98:99], v220 offset:2048
    v_cvt_pk_bf16_f32 v48, v16, v17
    v_mfma_f32_16x16x32_bf16 v[8:11], a[80:83], a[164:167], v[8:11]
    v_sub_f32 v19, v19, v235
    v_exp_f32 v19, v19
    v_mfma_f32_16x16x32_bf16 v[8:11], a[84:87], a[168:171], v[8:11]
    global_load_lds_dwordx4 v228, s[74:75] offset:2048 nt
    v_lshl_add_u32 v248, v250, 5, v248
    v_mfma_f32_16x16x32_bf16 v[12:15], a[80:83], a[180:183], 0
    v_sub_f32 v4, v4, v232
    v_exp_f32 v4, v4
    v_mfma_f32_16x16x32_bf16 v[12:15], a[84:87], a[184:187], v[12:15]
    ds_read_b128 a[68:71], v213 offset:32768
    v_cvt_pk_bf16_f32 v49, v18, v19
    v_mfma_f32_16x16x32_bf16 v[12:15], a[88:91], a[188:191], v[12:15]
    v_sub_f32 v5, v5, v232
    v_exp_f32 v5, v5
    v_mfma_f32_16x16x32_bf16 v[12:15], a[92:95], a[192:195], v[12:15]
    ds_read_b64_tr_b16 a[100:101], v220 offset:4096
    v_and_b32 v249, 3, v249
    v_mfma_f32_16x16x32_bf16 v[16:19], a[88:91], a[204:207], 0
    v_sub_f32 v6, v6, v232
    v_exp_f32 v6, v6
    v_mfma_f32_16x16x32_bf16 v[16:19], a[92:95], a[208:211], v[16:19]
    ds_read_b64_tr_b16 a[102:103], v220 offset:6144
    v_cvt_pk_bf16_f32 v26, v4, v5
    v_mfma_f32_16x16x32_bf16 v[16:19], a[80:83], a[196:199], v[16:19]
    v_sub_f32 v7, v7, v232
    v_exp_f32 v7, v7
    v_mfma_f32_16x16x32_bf16 v[16:19], a[84:87], a[200:203], v[16:19]
    global_load_lds_dwordx4 v229, s[74:75] offset:3072 nt
    v_lshl_add_u32 v248, v249, 3, v248
    v_mfma_f32_16x16x32_bf16 v[172:175], v[84:87], a[112:115], v[172:175]
    v_sub_f32 v8, v8, v233
    v_exp_f32 v8, v8
    v_mfma_f32_16x16x32_bf16 v[172:175], v[88:91], a[116:119], v[172:175]
    ds_read_b128 a[72:75], v214 offset:32768
    v_cvt_pk_bf16_f32 v27, v6, v7
    v_mfma_f32_16x16x32_bf16 v[172:175], v[116:119], a[120:123], v[172:175]
    v_sub_f32 v9, v9, v233
    v_exp_f32 v9, v9
    v_mfma_f32_16x16x32_bf16 v[172:175], v[120:123], a[124:127], v[172:175]
    ds_read_b64_tr_b16 a[104:105], v220 offset:8192
    v_add_u32 v245, s84, v248
    v_mfma_f32_16x16x32_bf16 v[176:179], v[124:127], a[120:123], v[176:179]
    s_add_u32 m0, s33, 0x6000
    v_sub_f32 v10, v10, v233
    v_exp_f32 v10, v10
    v_mfma_f32_16x16x32_bf16 v[176:179], v[128:131], a[124:127], v[176:179]
    ds_read_b64_tr_b16 a[106:107], v220 offset:10240
    v_cvt_pk_bf16_f32 v34, v8, v9
    v_mfma_f32_16x16x32_bf16 v[176:179], v[92:95], a[112:115], v[176:179]
    v_sub_f32 v11, v11, v233
    v_exp_f32 v11, v11
    v_mfma_f32_16x16x32_bf16 v[176:179], v[96:99], a[116:119], v[176:179]
    global_load_lds_dwordx4 v224, s[72:73] nt
    v_xor_b32 v246, 32, v245
    v_mfma_f32_16x16x32_bf16 a[24:27], v[100:103], a[112:115], a[24:27]
    s_add_u32 s32, s65, 0x30000
    v_sub_f32 v12, v12, v234
    v_exp_f32 v12, v12
    v_mfma_f32_16x16x32_bf16 a[24:27], v[104:107], a[116:119], a[24:27]
    ds_read_b128 a[76:79], v215 offset:32768
    v_cvt_pk_bf16_f32 v35, v10, v11
    v_mfma_f32_16x16x32_bf16 a[24:27], v[132:135], a[120:123], a[24:27]
    s_and_b32 s32, s32, 0x7ffff
    v_sub_f32 v13, v13, v234
    v_exp_f32 v13, v13
    v_mfma_f32_16x16x32_bf16 a[24:27], v[136:139], a[124:127], a[24:27]
    ds_read_b64_tr_b16 a[108:109], v220 offset:12288
    v_mov_b32 v237, 0x3e800000
    v_mfma_f32_16x16x32_bf16 a[28:31], v[140:143], a[120:123], a[28:31]
    v_sub_f32 v14, v14, v234
    v_exp_f32 v14, v14
    v_mfma_f32_16x16x32_bf16 a[28:31], v[144:147], a[124:127], a[28:31]
    ds_read_b64_tr_b16 a[110:111], v220 offset:14336
    v_cvt_pk_bf16_f32 v42, v12, v13
    v_mfma_f32_16x16x32_bf16 a[28:31], v[108:111], a[112:115], a[28:31]
    s_waitcnt lgkmcnt(2)
    v_sub_f32 v15, v15, v234
    v_exp_f32 v15, v15
    v_mfma_f32_16x16x32_bf16 a[28:31], v[112:115], a[116:119], a[28:31]
    global_load_lds_dwordx4 v225, s[72:73] offset:1024 nt
    v_smfmac_f32_16x16x64_bf16 a[140:143], a[144:147], v[140:147], v236
    v_mfma_f32_16x16x32_bf16 v[4:7], a[64:67], a[148:151], 0
    s_add_u32 s74, s12, s32
    v_sub_f32 v16, v16, v235
    v_exp_f32 v16, v16
    v_mfma_f32_16x16x32_bf16 v[4:7], a[68:71], a[152:155], v[4:7]
    ds_read_b128 a[80:83], v212 offset:36864
    v_cvt_pk_bf16_f32 v43, v14, v15
    v_mfma_f32_16x16x32_bf16 v[4:7], a[72:75], a[156:159], v[4:7]
    s_addc_u32 s75, s13, 0
    v_sub_f32 v17, v17, v235
    v_exp_f32 v17, v17
    v_mfma_f32_16x16x32_bf16 v[4:7], a[76:79], a[160:163], v[4:7]
    ds_read_b64_tr_b16 a[112:113], v221
    v_mfma_f32_16x16x32_bf16 v[8:11], a[72:75], a[172:175], 0
    v_sub_f32 v18, v18, v235
    v_exp_f32 v18, v18
    v_mfma_f32_16x16x32_bf16 v[8:11], a[76:79], a[176:179], v[8:11]
    ds_read_b64_tr_b16 a[114:115], v221 offset:2048
    v_cvt_pk_bf16_f32 v50, v16, v17
    v_mfma_f32_16x16x32_bf16 v[8:11], a[64:67], a[164:167], v[8:11]
    s_waitcnt lgkmcnt(3)
    v_sub_f32 v19, v19, v235
    v_exp_f32 v19, v19
    v_mfma_f32_16x16x32_bf16 v[8:11], a[68:71], a[168:171], v[8:11]
    global_load_lds_dwordx4 v226, s[72:73] offset:2048 nt
    v_mfma_f32_16x16x32_bf16 v[12:15], a[64:67], a[180:183], 0
    v_sub_f32 v4, v4, v232
    v_exp_f32 v4, v4
    v_mfma_f32_16x16x32_bf16 v[12:15], a[68:71], a[184:187], v[12:15]
    ds_read_b128 a[84:87], v213 offset:36864
    v_cvt_pk_bf16_f32 v51, v18, v19
    v_mfma_f32_16x16x32_bf16 v[12:15], a[72:75], a[188:191], v[12:15]
    v_sub_f32 v5, v5, v232
    v_exp_f32 v5, v5
    v_mfma_f32_16x16x32_bf16 v[12:15], a[76:79], a[192:195], v[12:15]
    ds_read_b64_tr_b16 a[116:117], v221 offset:4096
    v_mfma_f32_16x16x32_bf16 v[16:19], a[72:75], a[204:207], 0
    v_sub_f32 v6, v6, v232
    v_exp_f32 v6, v6
    v_mfma_f32_16x16x32_bf16 v[16:19], a[76:79], a[208:211], v[16:19]
    ds_read_b64_tr_b16 a[118:119], v221 offset:6144
    v_cvt_pk_bf16_f32 v52, v4, v5
    v_mfma_f32_16x16x32_bf16 v[16:19], a[64:67], a[196:199], v[16:19]
    v_sub_f32 v7, v7, v232
    v_exp_f32 v7, v7
    v_mfma_f32_16x16x32_bf16 v[16:19], a[68:71], a[200:203], v[16:19]
    global_load_lds_dwordx4 v227, s[72:73] offset:3072 nt
    v_mfma_f32_16x16x32_bf16 v[180:183], v[84:87], a[96:99], v[180:183]
    v_sub_f32 v8, v8, v233
    v_exp_f32 v8, v8
    v_mfma_f32_16x16x32_bf16 v[180:183], v[88:91], a[100:103], v[180:183]
    ds_read_b128 a[88:91], v214 offset:36864
    v_cvt_pk_bf16_f32 v53, v6, v7
    v_mfma_f32_16x16x32_bf16 v[180:183], v[116:119], a[104:107], v[180:183]
    v_sub_f32 v9, v9, v233
    v_exp_f32 v9, v9
    v_mfma_f32_16x16x32_bf16 v[180:183], v[120:123], a[108:111], v[180:183]
    ds_read_b64_tr_b16 a[120:121], v221 offset:8192
    v_mfma_f32_16x16x32_bf16 v[184:187], v[124:127], a[104:107], v[184:187]
    s_add_u32 m0, s31, 0x4000
    v_sub_f32 v10, v10, v233
    v_exp_f32 v10, v10
    v_mfma_f32_16x16x32_bf16 v[184:187], v[128:131], a[108:111], v[184:187]
    ds_read_b64_tr_b16 a[122:123], v221 offset:10240
    v_cvt_pk_bf16_f32 v60, v8, v9
    v_mfma_f32_16x16x32_bf16 v[184:187], v[92:95], a[96:99], v[184:187]
    v_sub_f32 v11, v11, v233
    v_exp_f32 v11, v11
    v_mfma_f32_16x16x32_bf16 v[184:187], v[96:99], a[100:103], v[184:187]
    global_load_lds_dwordx4 v228, s[74:75] nt
    v_mfma_f32_16x16x32_bf16 a[32:35], v[100:103], a[96:99], a[32:35]
    ds_read_b128 a[92:95], v215 offset:36864
    v_cvt_pk_bf16_f32 v61, v10, v11
    v_mfma_f32_16x16x32_bf16 a[32:35], v[104:107], a[100:103], a[32:35]
    ds_read_b64_tr_b16 a[124:125], v221 offset:12288
    v_mfma_f32_16x16x32_bf16 a[32:35], v[132:135], a[104:107], a[32:35]
    ds_read_b64_tr_b16 a[126:127], v221 offset:14336
    v_mfma_f32_16x16x32_bf16 a[32:35], v[136:139], a[108:111], a[32:35]
    global_load_lds_dwordx4 v229, s[74:75] offset:1024 nt
    v_mfma_f32_16x16x32_bf16 a[36:39], v[140:143], a[104:107], a[36:39]
    s_add_u32 s32, s67, 0x20000
    v_sub_f32 v12, v12, v234
    v_exp_f32 v12, v12
    v_mfma_f32_16x16x32_bf16 a[36:39], v[144:147], a[108:111], a[36:39]
    s_and_b32 s32, s32, 0x7ffff
    v_sub_f32 v13, v13, v234
    v_exp_f32 v13, v13
    v_mfma_f32_16x16x32_bf16 a[36:39], v[108:111], a[96:99], a[36:39]
    v_sub_f32 v14, v14, v234
    v_exp_f32 v14, v14
    v_mfma_f32_16x16x32_bf16 a[36:39], v[112:115], a[100:103], a[36:39]
    s_waitcnt vmcnt(14) lgkmcnt(0)
    v_sub_f32 v15, v15, v234
    v_exp_f32 v15, v15
    v_smfmac_f32_16x16x64_bf16 a[128:131], a[144:147], v[20:27], v236
    s_barrier
    v_mfma_f32_16x16x32_bf16 v[4:7], a[80:83], a[148:151], 0
    s_add_u32 s72, s14, s32
    v_sub_f32 v16, v16, v235
    v_exp_f32 v16, v16
    v_mfma_f32_16x16x32_bf16 v[4:7], a[84:87], a[152:155], v[4:7]
    ds_read_b128 a[64:67], v212 offset:49152
    v_cvt_pk_bf16_f32 v69, v14, v15
    v_mfma_f32_16x16x32_bf16 v[4:7], a[88:91], a[156:159], v[4:7]
    s_addc_u32 s73, s15, 0
    v_sub_f32 v17, v17, v235
    v_exp_f32 v17, v17
    v_mfma_f32_16x16x32_bf16 v[4:7], a[92:95], a[160:163], v[4:7]
    ds_read_b64_tr_b16 a[96:97], v222
    v_cvt_pk_bf16_f32 v68, v12, v13
    v_mfma_f32_16x16x32_bf16 v[8:11], a[88:91], a[172:175], 0
    v_sub_f32 v18, v18, v235
    v_exp_f32 v18, v18
    v_mfma_f32_16x16x32_bf16 v[8:11], a[92:95], a[176:179], v[8:11]
    ds_read_b64_tr_b16 a[98:99], v222 offset:2048
    v_cvt_pk_bf16_f32 v76, v16, v17
    v_mfma_f32_16x16x32_bf16 v[8:11], a[80:83], a[164:167], v[8:11]
M_stub3:
    s_cbranch_execz M_stub7
    v_sub_f32 v19, v19, v235
    v_exp_f32 v19, v19
    v_mfma_f32_16x16x32_bf16 v[8:11], a[84:87], a[168:171], v[8:11]
    global_load_lds_dwordx4 v228, s[74:75] offset:2048 nt
    v_mfma_f32_16x16x32_bf16 v[12:15], a[80:83], a[180:183], 0
    v_sub_f32 v4, v4, v232
    v_exp_f32 v4, v4
    v_mfma_f32_16x16x32_bf16 v[12:15], a[84:87], a[184:187], v[12:15]
    ds_read_b128 a[68:71], v213 offset:49152
    v_cvt_pk_bf16_f32 v77, v18, v19
    v_mfma_f32_16x16x32_bf16 v[12:15], a[88:91], a[188:191], v[12:15]
    v_sub_f32 v5, v5, v232
    v_exp_f32 v5, v5
    v_mfma_f32_16x16x32_bf16 v[12:15], a[92:95], a[192:195], v[12:15]
    ds_read_b64_tr_b16 a[100:101], v222 offset:4096
    v_mfma_f32_16x16x32_bf16 v[16:19], a[88:91], a[204:207], 0
    v_sub_f32 v6, v6, v232
    v_exp_f32 v6, v6
    v_mfma_f32_16x16x32_bf16 v[16:19], a[92:95], a[208:211], v[16:19]
    ds_read_b64_tr_b16 a[102:103], v222 offset:6144
    v_cvt_pk_bf16_f32 v54, v4, v5
    v_mfma_f32_16x16x32_bf16 v[16:19], a[80:83], a[196:199], v[16:19]
    v_sub_f32 v7, v7, v232
    v_exp_f32 v7, v7
    v_mfma_f32_16x16x32_bf16 v[16:19], a[84:87], a[200:203], v[16:19]
    global_load_lds_dwordx4 v229, s[74:75] offset:3072 nt
    v_mfma_f32_16x16x32_bf16 v[188:191], v[84:87], a[112:115], v[188:191]
    v_sub_f32 v8, v8, v233
    v_exp_f32 v8, v8
    v_mfma_f32_16x16x32_bf16 v[188:191], v[88:91], a[116:119], v[188:191]
    ds_read_b128 a[72:75], v214 offset:49152
    v_cvt_pk_bf16_f32 v55, v6, v7
    v_mfma_f32_16x16x32_bf16 v[188:191], v[116:119], a[120:123], v[188:191]
    v_sub_f32 v9, v9, v233
    v_exp_f32 v9, v9
    v_mfma_f32_16x16x32_bf16 v[188:191], v[120:123], a[124:127], v[188:191]
    ds_read_b64_tr_b16 a[104:105], v222 offset:8192
    v_mfma_f32_16x16x32_bf16 v[192:195], v[124:127], a[120:123], v[192:195]
    s_add_u32 m0, s33, 0x8000
    v_sub_f32 v10, v10, v233
    v_exp_f32 v10, v10
    v_mfma_f32_16x16x32_bf16 v[192:195], v[128:131], a[124:127], v[192:195]
    ds_read_b64_tr_b16 a[106:107], v222 offset:10240
    v_cvt_pk_bf16_f32 v62, v8, v9
    v_mfma_f32_16x16x32_bf16 v[192:195], v[92:95], a[112:115], v[192:195]
    v_sub_f32 v11, v11, v233
    v_exp_f32 v11, v11
    v_mfma_f32_16x16x32_bf16 v[192:195], v[96:99], a[116:119], v[192:195]
    global_load_lds_dwordx4 v224, s[72:73] nt
    v_mfma_f32_16x16x32_bf16 a[40:43], v[100:103], a[112:115], a[40:43]
    s_add_u32 s32, s64, 0x38000
    v_sub_f32 v12, v12, v234
    v_exp_f32 v12, v12
    v_mfma_f32_16x16x32_bf16 a[40:43], v[104:107], a[116:119], a[40:43]
    ds_read_b128 a[76:79], v215 offset:49152
    v_cvt_pk_bf16_f32 v63, v10, v11
    v_mfma_f32_16x16x32_bf16 a[40:43], v[132:135], a[120:123], a[40:43]
    s_and_b32 s32, s32, 0x7ffff
    v_sub_f32 v13, v13, v234
    v_exp_f32 v13, v13
    v_mfma_f32_16x16x32_bf16 a[40:43], v[136:139], a[124:127], a[40:43]
    ds_read_b64_tr_b16 a[108:109], v222 offset:12288
    v_mfma_f32_16x16x32_bf16 a[44:47], v[140:143], a[120:123], a[44:47]
    v_sub_f32 v14, v14, v234
    v_exp_f32 v14, v14
    v_mfma_f32_16x16x32_bf16 a[44:47], v[144:147], a[124:127], a[44:47]
    ds_read_b64_tr_b16 a[110:111], v222 offset:14336
    v_cvt_pk_bf16_f32 v70, v12, v13
    v_mfma_f32_16x16x32_bf16 a[44:47], v[108:111], a[112:115], a[44:47]
    s_waitcnt lgkmcnt(2)
    v_sub_f32 v15, v15, v234
    v_exp_f32 v15, v15
    v_mfma_f32_16x16x32_bf16 a[44:47], v[112:115], a[116:119], a[44:47]
    global_load_lds_dwordx4 v225, s[72:73] offset:1024 nt
    v_smfmac_f32_16x16x64_bf16 a[132:135], a[144:147], v[28:35], v236
    v_mfma_f32_16x16x32_bf16 v[4:7], a[64:67], a[148:151], 0
    s_add_u32 s74, s12, s32
    v_sub_f32 v16, v16, v235
    v_exp_f32 v16, v16
    v_mfma_f32_16x16x32_bf16 v[4:7], a[68:71], a[152:155], v[4:7]
    ds_read_b128 a[80:83], v212 offset:53248
    v_cvt_pk_bf16_f32 v71, v14, v15
    v_mfma_f32_16x16x32_bf16 v[4:7], a[72:75], a[156:159], v[4:7]
    s_addc_u32 s75, s13, 0
    v_sub_f32 v17, v17, v235
    v_exp_f32 v17, v17
    v_mfma_f32_16x16x32_bf16 v[4:7], a[76:79], a[160:163], v[4:7]
    ds_read_b64_tr_b16 a[112:113], v223
    v_mfma_f32_16x16x32_bf16 v[8:11], a[72:75], a[172:175], 0
    v_sub_f32 v18, v18, v235
    v_exp_f32 v18, v18
    v_mfma_f32_16x16x32_bf16 v[8:11], a[76:79], a[176:179], v[8:11]
    ds_read_b64_tr_b16 a[114:115], v223 offset:2048
    v_cvt_pk_bf16_f32 v78, v16, v17
    v_mfma_f32_16x16x32_bf16 v[8:11], a[64:67], a[164:167], v[8:11]
    s_waitcnt lgkmcnt(3)
    v_sub_f32 v19, v19, v235
    v_exp_f32 v19, v19
    v_mfma_f32_16x16x32_bf16 v[8:11], a[68:71], a[168:171], v[8:11]
    global_load_lds_dwordx4 v226, s[72:73] offset:2048 nt
    v_mfma_f32_16x16x32_bf16 v[12:15], a[64:67], a[180:183], 0
    v_sub_f32 v4, v4, v232
    v_exp_f32 v4, v4
    v_mfma_f32_16x16x32_bf16 v[12:15], a[68:71], a[184:187], v[12:15]
    ds_read_b128 a[84:87], v213 offset:53248
    v_cvt_pk_bf16_f32 v79, v18, v19
    v_mfma_f32_16x16x32_bf16 v[12:15], a[72:75], a[188:191], v[12:15]
    v_sub_f32 v5, v5, v232
    v_exp_f32 v5, v5
    v_mfma_f32_16x16x32_bf16 v[12:15], a[76:79], a[192:195], v[12:15]
    ds_read_b64_tr_b16 a[116:117], v223 offset:4096
    v_mfma_f32_16x16x32_bf16 v[16:19], a[72:75], a[204:207], 0
    v_sub_f32 v6, v6, v232
    v_exp_f32 v6, v6
    v_mfma_f32_16x16x32_bf16 v[16:19], a[76:79], a[208:211], v[16:19]
    ds_read_b64_tr_b16 a[118:119], v223 offset:6144
    v_cvt_pk_bf16_f32 v56, v4, v5
    v_mfma_f32_16x16x32_bf16 v[16:19], a[64:67], a[196:199], v[16:19]
    v_sub_f32 v7, v7, v232
    v_exp_f32 v7, v7
    v_mfma_f32_16x16x32_bf16 v[16:19], a[68:71], a[200:203], v[16:19]
    global_load_lds_dwordx4 v227, s[72:73] offset:3072 nt
    v_mfma_f32_16x16x32_bf16 v[196:199], v[84:87], a[96:99], v[196:199]
    v_sub_f32 v8, v8, v233
    v_exp_f32 v8, v8
    v_mfma_f32_16x16x32_bf16 v[196:199], v[88:91], a[100:103], v[196:199]
    ds_read_b128 a[88:91], v214 offset:53248
    v_cvt_pk_bf16_f32 v57, v6, v7
    v_mfma_f32_16x16x32_bf16 v[196:199], v[116:119], a[104:107], v[196:199]
    v_sub_f32 v9, v9, v233
    v_exp_f32 v9, v9
    v_mfma_f32_16x16x32_bf16 v[196:199], v[120:123], a[108:111], v[196:199]
    ds_read_b64_tr_b16 a[120:121], v223 offset:8192
    v_mfma_f32_16x16x32_bf16 v[200:203], v[124:127], a[104:107], v[200:203]
    s_add_u32 m0, s31, 0x8000
    v_sub_f32 v10, v10, v233
    v_exp_f32 v10, v10
    v_mfma_f32_16x16x32_bf16 v[200:203], v[128:131], a[108:111], v[200:203]
    ds_read_b64_tr_b16 a[122:123], v223 offset:10240
    v_cvt_pk_bf16_f32 v64, v8, v9
    v_mfma_f32_16x16x32_bf16 v[200:203], v[92:95], a[96:99], v[200:203]
    v_sub_f32 v11, v11, v233
    v_exp_f32 v11, v11
    v_mfma_f32_16x16x32_bf16 v[200:203], v[96:99], a[100:103], v[200:203]
    global_load_lds_dwordx4 v228, s[74:75] nt
    v_mfma_f32_16x16x32_bf16 a[48:51], v[100:103], a[96:99], a[48:51]
    ds_read_b128 a[92:95], v215 offset:53248
    v_cvt_pk_bf16_f32 v65, v10, v11
    v_mfma_f32_16x16x32_bf16 a[48:51], v[104:107], a[100:103], a[48:51]
    ds_read_b64_tr_b16 a[124:125], v223 offset:12288
    v_mfma_f32_16x16x32_bf16 a[48:51], v[132:135], a[104:107], a[48:51]
    ds_read_b64_tr_b16 a[126:127], v223 offset:14336
    v_mfma_f32_16x16x32_bf16 a[48:51], v[136:139], a[108:111], a[48:51]
    global_load_lds_dwordx4 v229, s[74:75] offset:1024 nt
    v_mfma_f32_16x16x32_bf16 a[52:55], v[140:143], a[104:107], a[52:55]
    s_add_u32 s32, s67, 0x28000
    v_sub_f32 v12, v12, v234
    v_exp_f32 v12, v12
    v_mfma_f32_16x16x32_bf16 a[52:55], v[144:147], a[108:111], a[52:55]
    s_and_b32 s32, s32, 0x7ffff
    v_sub_f32 v13, v13, v234
    v_exp_f32 v13, v13
    v_mfma_f32_16x16x32_bf16 a[52:55], v[108:111], a[96:99], a[52:55]
    v_sub_f32 v14, v14, v234
    v_exp_f32 v14, v14
    v_mfma_f32_16x16x32_bf16 a[52:55], v[112:115], a[100:103], a[52:55]
    s_waitcnt vmcnt(10) lgkmcnt(0)
    v_sub_f32 v15, v15, v234
    v_exp_f32 v15, v15
    v_smfmac_f32_16x16x64_bf16 a[136:139], a[144:147], v[36:43], v236
    s_barrier
    v_mfma_f32_16x16x32_bf16 v[4:7], a[80:83], a[148:151], 0
    s_add_u32 s72, s14, s32
    v_sub_f32 v16, v16, v235
    v_exp_f32 v16, v16
    v_mfma_f32_16x16x32_bf16 v[4:7], a[84:87], a[152:155], v[4:7]
    ds_read_b128 a[64:67], v212
    v_cvt_pk_bf16_f32 v73, v14, v15
    v_mfma_f32_16x16x32_bf16 v[4:7], a[88:91], a[156:159], v[4:7]
    s_addc_u32 s73, s15, 0
    v_sub_f32 v17, v17, v235
    v_exp_f32 v17, v17
    v_mfma_f32_16x16x32_bf16 v[4:7], a[92:95], a[160:163], v[4:7]
    ds_read_b64_tr_b16 a[96:97], v220 offset:16384
    v_cvt_pk_bf16_f32 v72, v12, v13
    v_mfma_f32_16x16x32_bf16 v[8:11], a[88:91], a[172:175], 0
    v_sub_f32 v18, v18, v235
    v_exp_f32 v18, v18
    v_mfma_f32_16x16x32_bf16 v[8:11], a[92:95], a[176:179], v[8:11]
    ds_read_b64_tr_b16 a[98:99], v220 offset:18432
    v_cvt_pk_bf16_f32 v80, v16, v17
    v_mfma_f32_16x16x32_bf16 v[8:11], a[80:83], a[164:167], v[8:11]
    v_sub_f32 v19, v19, v235
    v_exp_f32 v19, v19
    v_mfma_f32_16x16x32_bf16 v[8:11], a[84:87], a[168:171], v[8:11]
    global_load_lds_dwordx4 v228, s[74:75] offset:2048 nt
    v_mfma_f32_16x16x32_bf16 v[12:15], a[80:83], a[180:183], 0
    v_sub_f32 v4, v4, v232
    v_exp_f32 v4, v4
    v_mfma_f32_16x16x32_bf16 v[12:15], a[84:87], a[184:187], v[12:15]
    ds_read_b128 a[68:71], v213
    v_cvt_pk_bf16_f32 v81, v18, v19
    v_mfma_f32_16x16x32_bf16 v[12:15], a[88:91], a[188:191], v[12:15]
    v_sub_f32 v5, v5, v232
    v_exp_f32 v5, v5
    v_mfma_f32_16x16x32_bf16 v[12:15], a[92:95], a[192:195], v[12:15]
    ds_read_b64_tr_b16 a[100:101], v220 offset:20480
    v_mfma_f32_16x16x32_bf16 v[16:19], a[88:91], a[204:207], 0
    v_sub_f32 v6, v6, v232
    v_exp_f32 v6, v6
    v_mfma_f32_16x16x32_bf16 v[16:19], a[92:95], a[208:211], v[16:19]
    ds_read_b64_tr_b16 a[102:103], v220 offset:22528
    v_cvt_pk_bf16_f32 v58, v4, v5
    v_mfma_f32_16x16x32_bf16 v[16:19], a[80:83], a[196:199], v[16:19]
    v_sub_f32 v7, v7, v232
    v_exp_f32 v7, v7
    v_mfma_f32_16x16x32_bf16 v[16:19], a[84:87], a[200:203], v[16:19]
    global_load_lds_dwordx4 v229, s[74:75] offset:3072 nt
    v_mfma_f32_16x16x32_bf16 v[204:207], v[84:87], a[112:115], v[204:207]
    v_sub_f32 v8, v8, v233
    v_exp_f32 v8, v8
    v_mfma_f32_16x16x32_bf16 v[204:207], v[88:91], a[116:119], v[204:207]
    ds_read_b128 a[72:75], v214
    v_cvt_pk_bf16_f32 v59, v6, v7
    v_mfma_f32_16x16x32_bf16 v[204:207], v[116:119], a[120:123], v[204:207]
    v_sub_f32 v9, v9, v233
    v_exp_f32 v9, v9
    v_mfma_f32_16x16x32_bf16 v[204:207], v[120:123], a[124:127], v[204:207]
    ds_read_b64_tr_b16 a[104:105], v220 offset:24576
    v_mfma_f32_16x16x32_bf16 v[208:211], v[124:127], a[120:123], v[208:211]
    s_add_u32 m0, s33, 0xa000
    v_sub_f32 v10, v10, v233
    v_exp_f32 v10, v10
    v_mfma_f32_16x16x32_bf16 v[208:211], v[128:131], a[124:127], v[208:211]
    ds_read_b64_tr_b16 a[106:107], v220 offset:26624
    v_cvt_pk_bf16_f32 v66, v8, v9
    v_mfma_f32_16x16x32_bf16 v[208:211], v[92:95], a[112:115], v[208:211]
    v_sub_f32 v11, v11, v233
    v_exp_f32 v11, v11
    v_mfma_f32_16x16x32_bf16 v[208:211], v[96:99], a[116:119], v[208:211]
    global_load_lds_dwordx4 v224, s[72:73] nt
    v_mfma_f32_16x16x32_bf16 a[56:59], v[100:103], a[112:115], a[56:59]
    s_add_u32 s32, s65, 0x38000
    v_sub_f32 v12, v12, v234
    v_exp_f32 v12, v12
    v_mfma_f32_16x16x32_bf16 a[56:59], v[104:107], a[116:119], a[56:59]
    ds_read_b128 a[76:79], v215
    v_cvt_pk_bf16_f32 v67, v10, v11
    v_mfma_f32_16x16x32_bf16 a[56:59], v[132:135], a[120:123], a[56:59]
    s_and_b32 s32, s32, 0x7ffff
    v_sub_f32 v13, v13, v234
    v_exp_f32 v13, v13
    v_mfma_f32_16x16x32_bf16 a[56:59], v[136:139], a[124:127], a[56:59]
    ds_read_b64_tr_b16 a[108:109], v220 offset:28672
    v_mfma_f32_16x16x32_bf16 a[60:63], v[140:143], a[120:123], a[60:63]
    v_sub_f32 v14, v14, v234
    v_exp_f32 v14, v14
    v_mfma_f32_16x16x32_bf16 a[60:63], v[144:147], a[124:127], a[60:63]
    ds_read_b64_tr_b16 a[110:111], v220 offset:30720
    v_cvt_pk_bf16_f32 v74, v12, v13
    v_mfma_f32_16x16x32_bf16 a[60:63], v[108:111], a[112:115], a[60:63]
    s_waitcnt lgkmcnt(2)
    v_sub_f32 v15, v15, v234
    v_exp_f32 v15, v15
    v_mfma_f32_16x16x32_bf16 a[60:63], v[112:115], a[116:119], a[60:63]
    global_load_lds_dwordx4 v225, s[72:73] offset:1024 nt
    v_smfmac_f32_16x16x64_bf16 a[140:143], a[144:147], v[44:51], v236
    v_mfma_f32_16x16x32_bf16 v[4:7], a[64:67], a[148:151], 0
    s_add_u32 s74, s12, s32
    v_sub_f32 v16, v16, v235
    v_exp_f32 v16, v16
    v_mfma_f32_16x16x32_bf16 v[4:7], a[68:71], a[152:155], v[4:7]
    ds_read_b128 a[80:83], v212 offset:4096
    v_cvt_pk_bf16_f32 v75, v14, v15
    v_mfma_f32_16x16x32_bf16 v[4:7], a[72:75], a[156:159], v[4:7]
    s_addc_u32 s75, s13, 0
    v_sub_f32 v17, v17, v235
    v_exp_f32 v17, v17
    v_mfma_f32_16x16x32_bf16 v[4:7], a[76:79], a[160:163], v[4:7]
    ds_read_b64_tr_b16 a[112:113], v221 offset:16384
    v_mfma_f32_16x16x32_bf16 v[8:11], a[72:75], a[172:175], 0
    v_sub_f32 v18, v18, v235
    v_exp_f32 v18, v18
    v_mfma_f32_16x16x32_bf16 v[8:11], a[76:79], a[176:179], v[8:11]
    ds_read_b64_tr_b16 a[114:115], v221 offset:18432
    v_cvt_pk_bf16_f32 v82, v16, v17
    v_mfma_f32_16x16x32_bf16 v[8:11], a[64:67], a[164:167], v[8:11]
    s_waitcnt lgkmcnt(3)
    v_sub_f32 v19, v19, v235
    v_exp_f32 v19, v19
    v_mfma_f32_16x16x32_bf16 v[8:11], a[68:71], a[168:171], v[8:11]
    global_load_lds_dwordx4 v226, s[72:73] offset:2048 nt
    v_mfma_f32_16x16x32_bf16 v[12:15], a[64:67], a[180:183], 0
    v_sub_f32 v4, v4, v232
    v_exp_f32 v4, v4
    v_mfma_f32_16x16x32_bf16 v[12:15], a[68:71], a[184:187], v[12:15]
    ds_read_b128 a[84:87], v213 offset:4096
    v_cvt_pk_bf16_f32 v83, v18, v19
    v_mfma_f32_16x16x32_bf16 v[12:15], a[72:75], a[188:191], v[12:15]
    v_sub_f32 v5, v5, v232
    v_exp_f32 v5, v5
    v_mfma_f32_16x16x32_bf16 v[12:15], a[76:79], a[192:195], v[12:15]
    ds_read_b64_tr_b16 a[116:117], v221 offset:20480
    v_mfma_f32_16x16x32_bf16 v[16:19], a[72:75], a[204:207], 0
    v_sub_f32 v6, v6, v232
    v_exp_f32 v6, v6
    v_mfma_f32_16x16x32_bf16 v[16:19], a[76:79], a[208:211], v[16:19]
    ds_read_b64_tr_b16 a[118:119], v221 offset:22528
    v_cvt_pk_bf16_f32 v84, v4, v5
    v_mfma_f32_16x16x32_bf16 v[16:19], a[64:67], a[196:199], v[16:19]
    v_sub_f32 v7, v7, v232
    v_exp_f32 v7, v7
    v_mfma_f32_16x16x32_bf16 v[16:19], a[68:71], a[200:203], v[16:19]
    global_load_lds_dwordx4 v227, s[72:73] offset:3072 nt
    v_mfma_f32_16x16x32_bf16 v[148:151], v[20:23], a[96:99], v[148:151]
    v_sub_f32 v8, v8, v233
    v_exp_f32 v8, v8
    v_mfma_f32_16x16x32_bf16 v[148:151], v[24:27], a[100:103], v[148:151]
    ds_read_b128 a[88:91], v214 offset:4096
    v_cvt_pk_bf16_f32 v85, v6, v7
    v_mfma_f32_16x16x32_bf16 v[148:151], v[52:55], a[104:107], v[148:151]
    v_sub_f32 v9, v9, v233
    v_exp_f32 v9, v9
    v_mfma_f32_16x16x32_bf16 v[148:151], v[56:59], a[108:111], v[148:151]
    ds_read_b64_tr_b16 a[120:121], v221 offset:24576
    v_mfma_f32_16x16x32_bf16 v[152:155], v[60:63], a[104:107], v[152:155]
    s_add_u32 m0, s31, 0xc000
    v_sub_f32 v10, v10, v233
    v_exp_f32 v10, v10
    v_mfma_f32_16x16x32_bf16 v[152:155], v[64:67], a[108:111], v[152:155]
    ds_read_b64_tr_b16 a[122:123], v221 offset:26624
    v_cvt_pk_bf16_f32 v92, v8, v9
    v_mfma_f32_16x16x32_bf16 v[152:155], v[28:31], a[96:99], v[152:155]
    v_sub_f32 v11, v11, v233
    v_exp_f32 v11, v11
    v_mfma_f32_16x16x32_bf16 v[152:155], v[32:35], a[100:103], v[152:155]
    global_load_lds_dwordx4 v228, s[74:75] nt
    v_mfma_f32_16x16x32_bf16 a[0:3], v[36:39], a[96:99], a[0:3]
    ds_read_b128 a[92:95], v215 offset:4096
    v_cvt_pk_bf16_f32 v93, v10, v11
    v_mfma_f32_16x16x32_bf16 a[0:3], v[40:43], a[100:103], a[0:3]
    ds_read_b64_tr_b16 a[124:125], v221 offset:28672
    v_mfma_f32_16x16x32_bf16 a[0:3], v[68:71], a[104:107], a[0:3]
    ds_read_b64_tr_b16 a[126:127], v221 offset:30720
    v_mfma_f32_16x16x32_bf16 a[0:3], v[72:75], a[108:111], a[0:3]
    global_load_lds_dwordx4 v229, s[74:75] offset:1024 nt
    v_mfma_f32_16x16x32_bf16 a[4:7], v[76:79], a[104:107], a[4:7]
    s_add_u32 s32, s66, 0x30000
    v_sub_f32 v12, v12, v234
    v_exp_f32 v12, v12
    v_mfma_f32_16x16x32_bf16 a[4:7], v[80:83], a[108:111], a[4:7]
    s_and_b32 s32, s32, 0x7ffff
    v_sub_f32 v13, v13, v234
    v_exp_f32 v13, v13
    v_mfma_f32_16x16x32_bf16 a[4:7], v[44:47], a[96:99], a[4:7]
    v_sub_f32 v14, v14, v234
    v_exp_f32 v14, v14
    v_mfma_f32_16x16x32_bf16 a[4:7], v[48:51], a[100:103], a[4:7]
    s_waitcnt vmcnt(14) lgkmcnt(0)
    v_sub_f32 v15, v15, v234
    v_exp_f32 v15, v15
    v_smfmac_f32_16x16x64_bf16 a[128:131], a[144:147], v[52:59], v236
    s_barrier
    v_mfma_f32_16x16x32_bf16 v[4:7], a[80:83], a[148:151], 0
    s_add_u32 s72, s14, s32
    v_sub_f32 v16, v16, v235
    v_exp_f32 v16, v16
    v_mfma_f32_16x16x32_bf16 v[4:7], a[84:87], a[152:155], v[4:7]
    ds_read_b128 a[64:67], v212 offset:16384
    v_cvt_pk_bf16_f32 v101, v14, v15
    v_mfma_f32_16x16x32_bf16 v[4:7], a[88:91], a[156:159], v[4:7]
    s_addc_u32 s73, s15, 0
    v_sub_f32 v17, v17, v235
    v_exp_f32 v17, v17
    v_mfma_f32_16x16x32_bf16 v[4:7], a[92:95], a[160:163], v[4:7]
    ds_read_b64_tr_b16 a[96:97], v222 offset:16384
    v_cvt_pk_bf16_f32 v100, v12, v13
    v_mfma_f32_16x16x32_bf16 v[8:11], a[88:91], a[172:175], 0
    v_sub_f32 v18, v18, v235
    v_exp_f32 v18, v18
    v_mfma_f32_16x16x32_bf16 v[8:11], a[92:95], a[176:179], v[8:11]
    ds_read_b64_tr_b16 a[98:99], v222 offset:18432
    v_cvt_pk_bf16_f32 v108, v16, v17
    v_mfma_f32_16x16x32_bf16 v[8:11], a[80:83], a[164:167], v[8:11]
    v_sub_f32 v19, v19, v235
    v_exp_f32 v19, v19
    v_mfma_f32_16x16x32_bf16 v[8:11], a[84:87], a[168:171], v[8:11]
    global_load_lds_dwordx4 v228, s[74:75] offset:2048 nt
    v_mfma_f32_16x16x32_bf16 v[12:15], a[80:83], a[180:183], 0
    v_sub_f32 v4, v4, v232
    v_exp_f32 v4, v4
    v_mfma_f32_16x16x32_bf16 v[12:15], a[84:87], a[184:187], v[12:15]
    ds_read_b128 a[68:71], v213 offset:16384
    v_cvt_pk_bf16_f32 v109, v18, v19
    v_mfma_f32_16x16x32_bf16 v[12:15], a[88:91], a[188:191], v[12:15]
    v_sub_f32 v5, v5, v232
    v_exp_f32 v5, v5
    v_mfma_f32_16x16x32_bf16 v[12:15], a[92:95], a[192:195], v[12:15]
    ds_read_b64_tr_b16 a[100:101], v222 offset:20480
    v_mfma_f32_16x16x32_bf16 v[16:19], a[88:91], a[204:207], 0
    v_sub_f32 v6, v6, v232
    v_exp_f32 v6, v6
    v_mfma_f32_16x16x32_bf16 v[16:19], a[92:95], a[208:211], v[16:19]
    ds_read_b64_tr_b16 a[102:103], v222 offset:22528
    v_cvt_pk_bf16_f32 v86, v4, v5
    v_mfma_f32_16x16x32_bf16 v[16:19], a[80:83], a[196:199], v[16:19]
    v_sub_f32 v7, v7, v232
    v_exp_f32 v7, v7
    v_mfma_f32_16x16x32_bf16 v[16:19], a[84:87], a[200:203], v[16:19]
    global_load_lds_dwordx4 v229, s[74:75] offset:3072 nt
    v_mfma_f32_16x16x32_bf16 v[156:159], v[20:23], a[112:115], v[156:159]
    v_sub_f32 v8, v8, v233
    v_exp_f32 v8, v8
    v_mfma_f32_16x16x32_bf16 v[156:159], v[24:27], a[116:119], v[156:159]
    ds_read_b128 a[72:75], v214 offset:16384
    v_cvt_pk_bf16_f32 v87, v6, v7
    v_mfma_f32_16x16x32_bf16 v[156:159], v[52:55], a[120:123], v[156:159]
    v_sub_f32 v9, v9, v233
    v_exp_f32 v9, v9
    v_mfma_f32_16x16x32_bf16 v[156:159], v[56:59], a[124:127], v[156:159]
    ds_read_b64_tr_b16 a[104:105], v222 offset:24576
    v_mfma_f32_16x16x32_bf16 v[160:163], v[60:63], a[120:123], v[160:163]
    s_add_u32 m0, s33, 0x0
    v_sub_f32 v10, v10, v233
    v_exp_f32 v10, v10
    v_mfma_f32_16x16x32_bf16 v[160:163], v[64:67], a[124:127], v[160:163]
    ds_read_b64_tr_b16 a[106:107], v222 offset:26624
    v_cvt_pk_bf16_f32 v94, v8, v9
    v_mfma_f32_16x16x32_bf16 v[160:163], v[28:31], a[112:115], v[160:163]
    v_sub_f32 v11, v11, v233
    v_exp_f32 v11, v11
    v_mfma_f32_16x16x32_bf16 v[160:163], v[32:35], a[116:119], v[160:163]
    global_load_lds_dwordx4 v224, s[72:73] nt
    v_mfma_f32_16x16x32_bf16 a[8:11], v[36:39], a[112:115], a[8:11]
    s_add_u32 s32, s64, 0x40000
    v_sub_f32 v12, v12, v234
    v_exp_f32 v12, v12
    v_mfma_f32_16x16x32_bf16 a[8:11], v[40:43], a[116:119], a[8:11]
    ds_read_b128 a[76:79], v215 offset:16384
    v_cvt_pk_bf16_f32 v95, v10, v11
    v_mfma_f32_16x16x32_bf16 a[8:11], v[68:71], a[120:123], a[8:11]
    s_and_b32 s32, s32, 0x7ffff
    v_sub_f32 v13, v13, v234
    v_exp_f32 v13, v13
    v_mfma_f32_16x16x32_bf16 a[8:11], v[72:75], a[124:127], a[8:11]
    ds_read_b64_tr_b16 a[108:109], v222 offset:28672
    v_mfma_f32_16x16x32_bf16 a[12:15], v[76:79], a[120:123], a[12:15]
    v_sub_f32 v14, v14, v234
    v_exp_f32 v14, v14
    v_mfma_f32_16x16x32_bf16 a[12:15], v[80:83], a[124:127], a[12:15]
    ds_read_b64_tr_b16 a[110:111], v222 offset:30720
    v_cvt_pk_bf16_f32 v102, v12, v13
    v_mfma_f32_16x16x32_bf16 a[12:15], v[44:47], a[112:115], a[12:15]
    s_waitcnt lgkmcnt(2)
    v_sub_f32 v15, v15, v234
    v_exp_f32 v15, v15
    v_mfma_f32_16x16x32_bf16 a[12:15], v[48:51], a[116:119], a[12:15]
    global_load_lds_dwordx4 v225, s[72:73] offset:1024 nt
    v_smfmac_f32_16x16x64_bf16 a[132:135], a[144:147], v[60:67], v236
    v_mfma_f32_16x16x32_bf16 v[4:7], a[64:67], a[148:151], 0
    s_add_u32 s74, s12, s32
    v_sub_f32 v16, v16, v235
    v_exp_f32 v16, v16
    v_mfma_f32_16x16x32_bf16 v[4:7], a[68:71], a[152:155], v[4:7]
    ds_read_b128 a[80:83], v212 offset:20480
    v_cvt_pk_bf16_f32 v103, v14, v15
    v_mfma_f32_16x16x32_bf16 v[4:7], a[72:75], a[156:159], v[4:7]
    s_addc_u32 s75, s13, 0
    v_sub_f32 v17, v17, v235
    v_exp_f32 v17, v17
    v_mfma_f32_16x16x32_bf16 v[4:7], a[76:79], a[160:163], v[4:7]
    ds_read_b64_tr_b16 a[112:113], v223 offset:16384
    v_mfma_f32_16x16x32_bf16 v[8:11], a[72:75], a[172:175], 0
    v_sub_f32 v18, v18, v235
    v_exp_f32 v18, v18
    v_mfma_f32_16x16x32_bf16 v[8:11], a[76:79], a[176:179], v[8:11]
    ds_read_b64_tr_b16 a[114:115], v223 offset:18432
    v_cvt_pk_bf16_f32 v110, v16, v17
    v_mfma_f32_16x16x32_bf16 v[8:11], a[64:67], a[164:167], v[8:11]
    s_waitcnt lgkmcnt(3)
    v_sub_f32 v19, v19, v235
    v_exp_f32 v19, v19
    v_mfma_f32_16x16x32_bf16 v[8:11], a[68:71], a[168:171], v[8:11]
    global_load_lds_dwordx4 v226, s[72:73] offset:2048 nt
    v_mfma_f32_16x16x32_bf16 v[12:15], a[64:67], a[180:183], 0
    v_sub_f32 v4, v4, v232
    v_exp_f32 v4, v4
    v_mfma_f32_16x16x32_bf16 v[12:15], a[68:71], a[184:187], v[12:15]
    ds_read_b128 a[84:87], v213 offset:20480
    v_cvt_pk_bf16_f32 v111, v18, v19
    v_mfma_f32_16x16x32_bf16 v[12:15], a[72:75], a[188:191], v[12:15]
    v_sub_f32 v5, v5, v232
    v_exp_f32 v5, v5
    v_mfma_f32_16x16x32_bf16 v[12:15], a[76:79], a[192:195], v[12:15]
    ds_read_b64_tr_b16 a[116:117], v223 offset:20480
    v_mfma_f32_16x16x32_bf16 v[16:19], a[72:75], a[204:207], 0
    v_sub_f32 v6, v6, v232
    v_exp_f32 v6, v6
    v_mfma_f32_16x16x32_bf16 v[16:19], a[76:79], a[208:211], v[16:19]
    ds_read_b64_tr_b16 a[118:119], v223 offset:22528
    v_cvt_pk_bf16_f32 v88, v4, v5
    v_mfma_f32_16x16x32_bf16 v[16:19], a[64:67], a[196:199], v[16:19]
    v_sub_f32 v7, v7, v232
    v_exp_f32 v7, v7
    v_mfma_f32_16x16x32_bf16 v[16:19], a[68:71], a[200:203], v[16:19]
    global_load_lds_dwordx4 v227, s[72:73] offset:3072 nt
    v_mfma_f32_16x16x32_bf16 v[164:167], v[20:23], a[96:99], v[164:167]
    v_sub_f32 v8, v8, v233
    v_exp_f32 v8, v8
    v_mfma_f32_16x16x32_bf16 v[164:167], v[24:27], a[100:103], v[164:167]
    ds_read_b128 a[88:91], v214 offset:20480
    v_cvt_pk_bf16_f32 v89, v6, v7
    v_mfma_f32_16x16x32_bf16 v[164:167], v[52:55], a[104:107], v[164:167]
    v_sub_f32 v9, v9, v233
    v_exp_f32 v9, v9
    v_mfma_f32_16x16x32_bf16 v[164:167], v[56:59], a[108:111], v[164:167]
    ds_read_b64_tr_b16 a[120:121], v223 offset:24576
    v_mfma_f32_16x16x32_bf16 v[168:171], v[60:63], a[104:107], v[168:171]
    s_add_u32 m0, s31, 0x0
    v_sub_f32 v10, v10, v233
    v_exp_f32 v10, v10
    v_mfma_f32_16x16x32_bf16 v[168:171], v[64:67], a[108:111], v[168:171]
    ds_read_b64_tr_b16 a[122:123], v223 offset:26624
    v_cvt_pk_bf16_f32 v96, v8, v9
    v_mfma_f32_16x16x32_bf16 v[168:171], v[28:31], a[96:99], v[168:171]
    v_sub_f32 v11, v11, v233
    v_exp_f32 v11, v11
    v_mfma_f32_16x16x32_bf16 v[168:171], v[32:35], a[100:103], v[168:171]
    global_load_lds_dwordx4 v228, s[74:75] nt
    v_mfma_f32_16x16x32_bf16 a[16:19], v[36:39], a[96:99], a[16:19]
    ds_read_b128 a[92:95], v215 offset:20480
    v_cvt_pk_bf16_f32 v97, v10, v11
    v_mfma_f32_16x16x32_bf16 a[16:19], v[40:43], a[100:103], a[16:19]
    ds_read_b64_tr_b16 a[124:125], v223 offset:28672
    v_mfma_f32_16x16x32_bf16 a[16:19], v[68:71], a[104:107], a[16:19]
    ds_read_b64_tr_b16 a[126:127], v223 offset:30720
    v_mfma_f32_16x16x32_bf16 a[16:19], v[72:75], a[108:111], a[16:19]
    global_load_lds_dwordx4 v229, s[74:75] offset:1024 nt
    v_mfma_f32_16x16x32_bf16 a[20:23], v[76:79], a[104:107], a[20:23]
    s_add_u32 s32, s66, 0x38000
    v_sub_f32 v12, v12, v234
    v_exp_f32 v12, v12
    v_mfma_f32_16x16x32_bf16 a[20:23], v[80:83], a[108:111], a[20:23]
    s_and_b32 s32, s32, 0x7ffff
    v_sub_f32 v13, v13, v234
    v_exp_f32 v13, v13
    v_mfma_f32_16x16x32_bf16 a[20:23], v[44:47], a[96:99], a[20:23]
    v_sub_f32 v14, v14, v234
    v_exp_f32 v14, v14
    v_mfma_f32_16x16x32_bf16 a[20:23], v[48:51], a[100:103], a[20:23]
    s_waitcnt vmcnt(10) lgkmcnt(0)
    v_sub_f32 v15, v15, v234
    v_exp_f32 v15, v15
    v_smfmac_f32_16x16x64_bf16 a[136:139], a[144:147], v[68:75], v236
    s_barrier
    v_mfma_f32_16x16x32_bf16 v[4:7], a[80:83], a[148:151], 0
    s_add_u32 s72, s14, s32
    v_sub_f32 v16, v16, v235
    v_exp_f32 v16, v16
    v_mfma_f32_16x16x32_bf16 v[4:7], a[84:87], a[152:155], v[4:7]
    ds_read_b128 a[64:67], v212 offset:32768
    v_cvt_pk_bf16_f32 v105, v14, v15
    v_mfma_f32_16x16x32_bf16 v[4:7], a[88:91], a[156:159], v[4:7]
    s_addc_u32 s73, s15, 0
    v_sub_f32 v17, v17, v235
    v_exp_f32 v17, v17
    v_mfma_f32_16x16x32_bf16 v[4:7], a[92:95], a[160:163], v[4:7]
    ds_read_b64_tr_b16 a[96:97], v220 offset:32768
    v_cvt_pk_bf16_f32 v104, v12, v13
    v_mfma_f32_16x16x32_bf16 v[8:11], a[88:91], a[172:175], 0
    v_sub_f32 v18, v18, v235
    v_exp_f32 v18, v18
    v_mfma_f32_16x16x32_bf16 v[8:11], a[92:95], a[176:179], v[8:11]
    ds_read_b64_tr_b16 a[98:99], v220 offset:34816
    v_cvt_pk_bf16_f32 v112, v16, v17
    v_mfma_f32_16x16x32_bf16 v[8:11], a[80:83], a[164:167], v[8:11]
    v_sub_f32 v19, v19, v235
    v_exp_f32 v19, v19
    v_mfma_f32_16x16x32_bf16 v[8:11], a[84:87], a[168:171], v[8:11]
    global_load_lds_dwordx4 v228, s[74:75] offset:2048 nt
    v_mfma_f32_16x16x32_bf16 v[12:15], a[80:83], a[180:183], 0
    v_sub_f32 v4, v4, v232
    v_exp_f32 v4, v4
    v_mfma_f32_16x16x32_bf16 v[12:15], a[84:87], a[184:187], v[12:15]
    ds_read_b128 a[68:71], v213 offset:32768
    v_cvt_pk_bf16_f32 v113, v18, v19
    v_mfma_f32_16x16x32_bf16 v[12:15], a[88:91], a[188:191], v[12:15]
    v_sub_f32 v5, v5, v232
    v_exp_f32 v5, v5
    v_mfma_f32_16x16x32_bf16 v[12:15], a[92:95], a[192:195], v[12:15]
    ds_read_b64_tr_b16 a[100:101], v220 offset:36864
    v_mfma_f32_16x16x32_bf16 v[16:19], a[88:91], a[204:207], 0
    v_sub_f32 v6, v6, v232
    v_exp_f32 v6, v6
    v_mfma_f32_16x16x32_bf16 v[16:19], a[92:95], a[208:211], v[16:19]
    ds_read_b64_tr_b16 a[102:103], v220 offset:38912
    v_cvt_pk_bf16_f32 v90, v4, v5
    v_mfma_f32_16x16x32_bf16 v[16:19], a[80:83], a[196:199], v[16:19]
    v_sub_f32 v7, v7, v232
    v_exp_f32 v7, v7
    v_mfma_f32_16x16x32_bf16 v[16:19], a[84:87], a[200:203], v[16:19]
    global_load_lds_dwordx4 v229, s[74:75] offset:3072 nt
    v_mfma_f32_16x16x32_bf16 v[172:175], v[20:23], a[112:115], v[172:175]
    v_sub_f32 v8, v8, v233
    v_exp_f32 v8, v8
    v_mfma_f32_16x16x32_bf16 v[172:175], v[24:27], a[116:119], v[172:175]
    ds_read_b128 a[72:75], v214 offset:32768
    v_cvt_pk_bf16_f32 v91, v6, v7
    v_mfma_f32_16x16x32_bf16 v[172:175], v[52:55], a[120:123], v[172:175]
    v_sub_f32 v9, v9, v233
    v_exp_f32 v9, v9
    v_mfma_f32_16x16x32_bf16 v[172:175], v[56:59], a[124:127], v[172:175]
    ds_read_b64_tr_b16 a[104:105], v220 offset:40960
    v_mfma_f32_16x16x32_bf16 v[176:179], v[60:63], a[120:123], v[176:179]
    s_add_u32 m0, s33, 0x2000
    v_sub_f32 v10, v10, v233
    v_exp_f32 v10, v10
    v_mfma_f32_16x16x32_bf16 v[176:179], v[64:67], a[124:127], v[176:179]
    ds_read_b64_tr_b16 a[106:107], v220 offset:43008
    v_cvt_pk_bf16_f32 v98, v8, v9
    v_mfma_f32_16x16x32_bf16 v[176:179], v[28:31], a[112:115], v[176:179]
    v_sub_f32 v11, v11, v233
    v_exp_f32 v11, v11
    v_mfma_f32_16x16x32_bf16 v[176:179], v[32:35], a[116:119], v[176:179]
    global_load_lds_dwordx4 v224, s[72:73] nt
    v_mfma_f32_16x16x32_bf16 a[24:27], v[36:39], a[112:115], a[24:27]
M_stub4:
    s_cbranch_execz M_stub8
    s_add_u32 s32, s65, 0x40000
    v_sub_f32 v12, v12, v234
    v_exp_f32 v12, v12
    v_mfma_f32_16x16x32_bf16 a[24:27], v[40:43], a[116:119], a[24:27]
    ds_read_b128 a[76:79], v215 offset:32768
    v_cvt_pk_bf16_f32 v99, v10, v11
    v_mfma_f32_16x16x32_bf16 a[24:27], v[68:71], a[120:123], a[24:27]
    s_and_b32 s32, s32, 0x7ffff
    v_sub_f32 v13, v13, v234
    v_exp_f32 v13, v13
    v_mfma_f32_16x16x32_bf16 a[24:27], v[72:75], a[124:127], a[24:27]
    ds_read_b64_tr_b16 a[108:109], v220 offset:45056
    v_mfma_f32_16x16x32_bf16 a[28:31], v[76:79], a[120:123], a[28:31]
    v_sub_f32 v14, v14, v234
    v_exp_f32 v14, v14
    v_mfma_f32_16x16x32_bf16 a[28:31], v[80:83], a[124:127], a[28:31]
    ds_read_b64_tr_b16 a[110:111], v220 offset:47104
    v_cvt_pk_bf16_f32 v106, v12, v13
    v_mfma_f32_16x16x32_bf16 a[28:31], v[44:47], a[112:115], a[28:31]
    s_waitcnt lgkmcnt(2)
    v_sub_f32 v15, v15, v234
    v_exp_f32 v15, v15
    v_mfma_f32_16x16x32_bf16 a[28:31], v[48:51], a[116:119], a[28:31]
    global_load_lds_dwordx4 v225, s[72:73] offset:1024 nt
    v_smfmac_f32_16x16x64_bf16 a[140:143], a[144:147], v[76:83], v236
    v_mfma_f32_16x16x32_bf16 v[4:7], a[64:67], a[148:151], 0
    s_add_u32 s74, s12, s32
    v_sub_f32 v16, v16, v235
    v_exp_f32 v16, v16
    v_mfma_f32_16x16x32_bf16 v[4:7], a[68:71], a[152:155], v[4:7]
    ds_read_b128 a[80:83], v212 offset:36864
    v_cvt_pk_bf16_f32 v107, v14, v15
    v_mfma_f32_16x16x32_bf16 v[4:7], a[72:75], a[156:159], v[4:7]
    s_addc_u32 s75, s13, 0
    v_sub_f32 v17, v17, v235
    v_exp_f32 v17, v17
    v_mfma_f32_16x16x32_bf16 v[4:7], a[76:79], a[160:163], v[4:7]
    ds_read_b64_tr_b16 a[112:113], v221 offset:32768
    v_mfma_f32_16x16x32_bf16 v[8:11], a[72:75], a[172:175], 0
    v_sub_f32 v18, v18, v235
    v_exp_f32 v18, v18
    v_mfma_f32_16x16x32_bf16 v[8:11], a[76:79], a[176:179], v[8:11]
    ds_read_b64_tr_b16 a[114:115], v221 offset:34816
    v_cvt_pk_bf16_f32 v114, v16, v17
    v_mfma_f32_16x16x32_bf16 v[8:11], a[64:67], a[164:167], v[8:11]
    s_waitcnt lgkmcnt(3)
    v_sub_f32 v19, v19, v235
    v_exp_f32 v19, v19
    v_mfma_f32_16x16x32_bf16 v[8:11], a[68:71], a[168:171], v[8:11]
    global_load_lds_dwordx4 v226, s[72:73] offset:2048 nt
    v_mfma_f32_16x16x32_bf16 v[12:15], a[64:67], a[180:183], 0
    v_sub_f32 v4, v4, v232
    v_exp_f32 v4, v4
    v_mfma_f32_16x16x32_bf16 v[12:15], a[68:71], a[184:187], v[12:15]
    ds_read_b128 a[84:87], v213 offset:36864
    v_cvt_pk_bf16_f32 v115, v18, v19
    v_mfma_f32_16x16x32_bf16 v[12:15], a[72:75], a[188:191], v[12:15]
    v_sub_f32 v5, v5, v232
    v_exp_f32 v5, v5
    v_mfma_f32_16x16x32_bf16 v[12:15], a[76:79], a[192:195], v[12:15]
    ds_read_b64_tr_b16 a[116:117], v221 offset:36864
    v_mfma_f32_16x16x32_bf16 v[16:19], a[72:75], a[204:207], 0
    v_sub_f32 v6, v6, v232
    v_exp_f32 v6, v6
    v_mfma_f32_16x16x32_bf16 v[16:19], a[76:79], a[208:211], v[16:19]
    ds_read_b64_tr_b16 a[118:119], v221 offset:38912
    v_cvt_pk_bf16_f32 v116, v4, v5
    v_mfma_f32_16x16x32_bf16 v[16:19], a[64:67], a[196:199], v[16:19]
    v_sub_f32 v7, v7, v232
    v_exp_f32 v7, v7
    v_mfma_f32_16x16x32_bf16 v[16:19], a[68:71], a[200:203], v[16:19]
    global_load_lds_dwordx4 v227, s[72:73] offset:3072 nt
    v_mfma_f32_16x16x32_bf16 v[180:183], v[20:23], a[96:99], v[180:183]
    v_sub_f32 v8, v8, v233
    v_exp_f32 v8, v8
    v_mfma_f32_16x16x32_bf16 v[180:183], v[24:27], a[100:103], v[180:183]
    ds_read_b128 a[88:91], v214 offset:36864
    v_cvt_pk_bf16_f32 v117, v6, v7
    v_mfma_f32_16x16x32_bf16 v[180:183], v[52:55], a[104:107], v[180:183]
    v_sub_f32 v9, v9, v233
    v_exp_f32 v9, v9
    v_mfma_f32_16x16x32_bf16 v[180:183], v[56:59], a[108:111], v[180:183]
    ds_read_b64_tr_b16 a[120:121], v221 offset:40960
    v_mfma_f32_16x16x32_bf16 v[184:187], v[60:63], a[104:107], v[184:187]
    s_add_u32 m0, s31, 0x4000
    v_sub_f32 v10, v10, v233
    v_exp_f32 v10, v10
    v_mfma_f32_16x16x32_bf16 v[184:187], v[64:67], a[108:111], v[184:187]
    ds_read_b64_tr_b16 a[122:123], v221 offset:43008
    v_cvt_pk_bf16_f32 v124, v8, v9
    v_mfma_f32_16x16x32_bf16 v[184:187], v[28:31], a[96:99], v[184:187]
    v_sub_f32 v11, v11, v233
    v_exp_f32 v11, v11
    v_mfma_f32_16x16x32_bf16 v[184:187], v[32:35], a[100:103], v[184:187]
    global_load_lds_dwordx4 v228, s[74:75] nt
    v_mfma_f32_16x16x32_bf16 a[32:35], v[36:39], a[96:99], a[32:35]
    ds_read_b128 a[92:95], v215 offset:36864
    v_cvt_pk_bf16_f32 v125, v10, v11
    v_mfma_f32_16x16x32_bf16 a[32:35], v[40:43], a[100:103], a[32:35]
    ds_read_b64_tr_b16 a[124:125], v221 offset:45056
    v_mfma_f32_16x16x32_bf16 a[32:35], v[68:71], a[104:107], a[32:35]
    ds_read_b64_tr_b16 a[126:127], v221 offset:47104
    v_mfma_f32_16x16x32_bf16 a[32:35], v[72:75], a[108:111], a[32:35]
    global_load_lds_dwordx4 v229, s[74:75] offset:1024 nt
    v_mfma_f32_16x16x32_bf16 a[36:39], v[76:79], a[104:107], a[36:39]
    s_add_u32 s32, s67, 0x30000
    v_sub_f32 v12, v12, v234
    v_exp_f32 v12, v12
    v_mfma_f32_16x16x32_bf16 a[36:39], v[80:83], a[108:111], a[36:39]
    s_and_b32 s32, s32, 0x7ffff
    v_sub_f32 v13, v13, v234
    v_exp_f32 v13, v13
    v_mfma_f32_16x16x32_bf16 a[36:39], v[44:47], a[96:99], a[36:39]
    v_sub_f32 v14, v14, v234
    v_exp_f32 v14, v14
    v_mfma_f32_16x16x32_bf16 a[36:39], v[48:51], a[100:103], a[36:39]
    s_waitcnt vmcnt(14) lgkmcnt(0)
    v_sub_f32 v15, v15, v234
    v_exp_f32 v15, v15
    v_smfmac_f32_16x16x64_bf16 a[128:131], a[144:147], v[84:91], v236
    s_barrier
    v_mfma_f32_16x16x32_bf16 v[4:7], a[80:83], a[148:151], 0
    s_add_u32 s72, s14, s32
    v_sub_f32 v16, v16, v235
    v_exp_f32 v16, v16
    v_mfma_f32_16x16x32_bf16 v[4:7], a[84:87], a[152:155], v[4:7]
    ds_read_b128 a[64:67], v212 offset:49152
    v_cvt_pk_bf16_f32 v133, v14, v15
    v_mfma_f32_16x16x32_bf16 v[4:7], a[88:91], a[156:159], v[4:7]
    s_addc_u32 s73, s15, 0
    v_sub_f32 v17, v17, v235
    v_exp_f32 v17, v17
    v_mfma_f32_16x16x32_bf16 v[4:7], a[92:95], a[160:163], v[4:7]
    ds_read_b64_tr_b16 a[96:97], v222 offset:32768
    v_cvt_pk_bf16_f32 v132, v12, v13
    v_mfma_f32_16x16x32_bf16 v[8:11], a[88:91], a[172:175], 0
    v_sub_f32 v18, v18, v235
    v_exp_f32 v18, v18
    v_mfma_f32_16x16x32_bf16 v[8:11], a[92:95], a[176:179], v[8:11]
    ds_read_b64_tr_b16 a[98:99], v222 offset:34816
    v_cvt_pk_bf16_f32 v140, v16, v17
    v_mfma_f32_16x16x32_bf16 v[8:11], a[80:83], a[164:167], v[8:11]
    v_sub_f32 v19, v19, v235
    v_exp_f32 v19, v19
    v_mfma_f32_16x16x32_bf16 v[8:11], a[84:87], a[168:171], v[8:11]
    global_load_lds_dwordx4 v228, s[74:75] offset:2048 nt
    v_mfma_f32_16x16x32_bf16 v[12:15], a[80:83], a[180:183], 0
    v_sub_f32 v4, v4, v232
    v_exp_f32 v4, v4
    v_mfma_f32_16x16x32_bf16 v[12:15], a[84:87], a[184:187], v[12:15]
    ds_read_b128 a[68:71], v213 offset:49152
    v_cvt_pk_bf16_f32 v141, v18, v19
    v_mfma_f32_16x16x32_bf16 v[12:15], a[88:91], a[188:191], v[12:15]
    v_sub_f32 v5, v5, v232
    v_exp_f32 v5, v5
    v_mfma_f32_16x16x32_bf16 v[12:15], a[92:95], a[192:195], v[12:15]
    ds_read_b64_tr_b16 a[100:101], v222 offset:36864
    v_mfma_f32_16x16x32_bf16 v[16:19], a[88:91], a[204:207], 0
    v_sub_f32 v6, v6, v232
    v_exp_f32 v6, v6
    v_mfma_f32_16x16x32_bf16 v[16:19], a[92:95], a[208:211], v[16:19]
    ds_read_b64_tr_b16 a[102:103], v222 offset:38912
    v_cvt_pk_bf16_f32 v118, v4, v5
    v_mfma_f32_16x16x32_bf16 v[16:19], a[80:83], a[196:199], v[16:19]
    v_sub_f32 v7, v7, v232
    v_exp_f32 v7, v7
    v_mfma_f32_16x16x32_bf16 v[16:19], a[84:87], a[200:203], v[16:19]
    global_load_lds_dwordx4 v229, s[74:75] offset:3072 nt
    v_mfma_f32_16x16x32_bf16 v[188:191], v[20:23], a[112:115], v[188:191]
    v_sub_f32 v8, v8, v233
    v_exp_f32 v8, v8
    v_mfma_f32_16x16x32_bf16 v[188:191], v[24:27], a[116:119], v[188:191]
    ds_read_b128 a[72:75], v214 offset:49152
    v_cvt_pk_bf16_f32 v119, v6, v7
    v_mfma_f32_16x16x32_bf16 v[188:191], v[52:55], a[120:123], v[188:191]
    v_sub_f32 v9, v9, v233
    v_exp_f32 v9, v9
    v_mfma_f32_16x16x32_bf16 v[188:191], v[56:59], a[124:127], v[188:191]
    ds_read_b64_tr_b16 a[104:105], v222 offset:40960
    v_mfma_f32_16x16x32_bf16 v[192:195], v[60:63], a[120:123], v[192:195]
    s_add_u32 m0, s33, 0x4000
    v_sub_f32 v10, v10, v233
    v_exp_f32 v10, v10
    v_mfma_f32_16x16x32_bf16 v[192:195], v[64:67], a[124:127], v[192:195]
    ds_read_b64_tr_b16 a[106:107], v222 offset:43008
    v_cvt_pk_bf16_f32 v126, v8, v9
    v_mfma_f32_16x16x32_bf16 v[192:195], v[28:31], a[112:115], v[192:195]
    v_sub_f32 v11, v11, v233
    v_exp_f32 v11, v11
    v_mfma_f32_16x16x32_bf16 v[192:195], v[32:35], a[116:119], v[192:195]
    global_load_lds_dwordx4 v224, s[72:73] nt
    v_mfma_f32_16x16x32_bf16 a[40:43], v[36:39], a[112:115], a[40:43]
    s_add_u32 s32, s64, 0x48000
    v_sub_f32 v12, v12, v234
    v_exp_f32 v12, v12
    v_mfma_f32_16x16x32_bf16 a[40:43], v[40:43], a[116:119], a[40:43]
    ds_read_b128 a[76:79], v215 offset:49152
    v_cvt_pk_bf16_f32 v127, v10, v11
    v_mfma_f32_16x16x32_bf16 a[40:43], v[68:71], a[120:123], a[40:43]
    s_and_b32 s32, s32, 0x7ffff
    v_sub_f32 v13, v13, v234
    v_exp_f32 v13, v13
    v_mfma_f32_16x16x32_bf16 a[40:43], v[72:75], a[124:127], a[40:43]
    ds_read_b64_tr_b16 a[108:109], v222 offset:45056
    v_mfma_f32_16x16x32_bf16 a[44:47], v[76:79], a[120:123], a[44:47]
    v_sub_f32 v14, v14, v234
    v_exp_f32 v14, v14
    v_mfma_f32_16x16x32_bf16 a[44:47], v[80:83], a[124:127], a[44:47]
    ds_read_b64_tr_b16 a[110:111], v222 offset:47104
    v_cvt_pk_bf16_f32 v134, v12, v13
    v_mfma_f32_16x16x32_bf16 a[44:47], v[44:47], a[112:115], a[44:47]
    s_waitcnt lgkmcnt(2)
    v_sub_f32 v15, v15, v234
    v_exp_f32 v15, v15
    v_mfma_f32_16x16x32_bf16 a[44:47], v[48:51], a[116:119], a[44:47]
    global_load_lds_dwordx4 v225, s[72:73] offset:1024 nt
    v_smfmac_f32_16x16x64_bf16 a[132:135], a[144:147], v[92:99], v236
    v_mfma_f32_16x16x32_bf16 v[4:7], a[64:67], a[148:151], 0
    s_add_u32 s74, s12, s32
    v_sub_f32 v16, v16, v235
    v_exp_f32 v16, v16
    v_mfma_f32_16x16x32_bf16 v[4:7], a[68:71], a[152:155], v[4:7]
    ds_read_b128 a[80:83], v212 offset:53248
    v_cvt_pk_bf16_f32 v135, v14, v15
    v_mfma_f32_16x16x32_bf16 v[4:7], a[72:75], a[156:159], v[4:7]
    s_addc_u32 s75, s13, 0
    v_sub_f32 v17, v17, v235
    v_exp_f32 v17, v17
    v_mfma_f32_16x16x32_bf16 v[4:7], a[76:79], a[160:163], v[4:7]
    ds_read_b64_tr_b16 a[112:113], v223 offset:32768
    v_mfma_f32_16x16x32_bf16 v[8:11], a[72:75], a[172:175], 0
    v_sub_f32 v18, v18, v235
    v_exp_f32 v18, v18
    v_mfma_f32_16x16x32_bf16 v[8:11], a[76:79], a[176:179], v[8:11]
    ds_read_b64_tr_b16 a[114:115], v223 offset:34816
    v_cvt_pk_bf16_f32 v142, v16, v17
    v_mfma_f32_16x16x32_bf16 v[8:11], a[64:67], a[164:167], v[8:11]
    s_waitcnt lgkmcnt(3)
    v_sub_f32 v19, v19, v235
    v_exp_f32 v19, v19
    v_mfma_f32_16x16x32_bf16 v[8:11], a[68:71], a[168:171], v[8:11]
    global_load_lds_dwordx4 v226, s[72:73] offset:2048 nt
    v_mfma_f32_16x16x32_bf16 v[12:15], a[64:67], a[180:183], 0
    v_sub_f32 v4, v4, v232
    v_exp_f32 v4, v4
    v_mfma_f32_16x16x32_bf16 v[12:15], a[68:71], a[184:187], v[12:15]
    ds_read_b128 a[84:87], v213 offset:53248
    v_cvt_pk_bf16_f32 v143, v18, v19
    v_mfma_f32_16x16x32_bf16 v[12:15], a[72:75], a[188:191], v[12:15]
    v_sub_f32 v5, v5, v232
    v_exp_f32 v5, v5
    v_mfma_f32_16x16x32_bf16 v[12:15], a[76:79], a[192:195], v[12:15]
    ds_read_b64_tr_b16 a[116:117], v223 offset:36864
    v_mfma_f32_16x16x32_bf16 v[16:19], a[72:75], a[204:207], 0
    v_sub_f32 v6, v6, v232
    v_exp_f32 v6, v6
    v_mfma_f32_16x16x32_bf16 v[16:19], a[76:79], a[208:211], v[16:19]
    ds_read_b64_tr_b16 a[118:119], v223 offset:38912
    v_cvt_pk_bf16_f32 v120, v4, v5
    v_mfma_f32_16x16x32_bf16 v[16:19], a[64:67], a[196:199], v[16:19]
    v_sub_f32 v7, v7, v232
    v_exp_f32 v7, v7
    v_mfma_f32_16x16x32_bf16 v[16:19], a[68:71], a[200:203], v[16:19]
    global_load_lds_dwordx4 v227, s[72:73] offset:3072 nt
    v_mfma_f32_16x16x32_bf16 v[196:199], v[20:23], a[96:99], v[196:199]
    v_sub_f32 v8, v8, v233
    v_exp_f32 v8, v8
    v_mfma_f32_16x16x32_bf16 v[196:199], v[24:27], a[100:103], v[196:199]
    ds_read_b128 a[88:91], v214 offset:53248
    v_cvt_pk_bf16_f32 v121, v6, v7
    v_mfma_f32_16x16x32_bf16 v[196:199], v[52:55], a[104:107], v[196:199]
    v_sub_f32 v9, v9, v233
    v_exp_f32 v9, v9
    v_mfma_f32_16x16x32_bf16 v[196:199], v[56:59], a[108:111], v[196:199]
    ds_read_b64_tr_b16 a[120:121], v223 offset:40960
    v_mfma_f32_16x16x32_bf16 v[200:203], v[60:63], a[104:107], v[200:203]
    s_add_u32 m0, s31, 0x8000
    v_sub_f32 v10, v10, v233
    v_exp_f32 v10, v10
    v_mfma_f32_16x16x32_bf16 v[200:203], v[64:67], a[108:111], v[200:203]
    ds_read_b64_tr_b16 a[122:123], v223 offset:43008
    v_cvt_pk_bf16_f32 v128, v8, v9
    v_mfma_f32_16x16x32_bf16 v[200:203], v[28:31], a[96:99], v[200:203]
    v_sub_f32 v11, v11, v233
    v_exp_f32 v11, v11
    v_mfma_f32_16x16x32_bf16 v[200:203], v[32:35], a[100:103], v[200:203]
    global_load_lds_dwordx4 v228, s[74:75] nt
    v_mfma_f32_16x16x32_bf16 a[48:51], v[36:39], a[96:99], a[48:51]
    ds_read_b128 a[92:95], v215 offset:53248
    v_cvt_pk_bf16_f32 v129, v10, v11
    v_mfma_f32_16x16x32_bf16 a[48:51], v[40:43], a[100:103], a[48:51]
    ds_read_b64_tr_b16 a[124:125], v223 offset:45056
    v_mfma_f32_16x16x32_bf16 a[48:51], v[68:71], a[104:107], a[48:51]
    ds_read_b64_tr_b16 a[126:127], v223 offset:47104
    v_mfma_f32_16x16x32_bf16 a[48:51], v[72:75], a[108:111], a[48:51]
    global_load_lds_dwordx4 v229, s[74:75] offset:1024 nt
    v_mfma_f32_16x16x32_bf16 a[52:55], v[76:79], a[104:107], a[52:55]
    s_add_u32 s32, s67, 0x38000
    v_sub_f32 v12, v12, v234
    v_exp_f32 v12, v12
    v_mfma_f32_16x16x32_bf16 a[52:55], v[80:83], a[108:111], a[52:55]
    s_and_b32 s32, s32, 0x7ffff
    v_sub_f32 v13, v13, v234
    v_exp_f32 v13, v13
    v_mfma_f32_16x16x32_bf16 a[52:55], v[44:47], a[96:99], a[52:55]
    v_sub_f32 v14, v14, v234
    v_exp_f32 v14, v14
    v_mfma_f32_16x16x32_bf16 a[52:55], v[48:51], a[100:103], a[52:55]
    s_waitcnt vmcnt(10) lgkmcnt(0)
    v_sub_f32 v15, v15, v234
    v_exp_f32 v15, v15
    v_smfmac_f32_16x16x64_bf16 a[136:139], a[144:147], v[100:107], v236
    s_barrier
    v_mfma_f32_16x16x32_bf16 v[4:7], a[80:83], a[148:151], 0
    s_add_u32 s72, s14, s32
    v_sub_f32 v16, v16, v235
    v_exp_f32 v16, v16
    v_mfma_f32_16x16x32_bf16 v[4:7], a[84:87], a[152:155], v[4:7]
    ds_read_b128 a[64:67], v212
    v_cvt_pk_bf16_f32 v137, v14, v15
    v_mfma_f32_16x16x32_bf16 v[4:7], a[88:91], a[156:159], v[4:7]
    s_addc_u32 s73, s15, 0
    v_sub_f32 v17, v17, v235
    v_exp_f32 v17, v17
    v_mfma_f32_16x16x32_bf16 v[4:7], a[92:95], a[160:163], v[4:7]
    ds_read_b64_tr_b16 a[96:97], v220
    v_cvt_pk_bf16_f32 v136, v12, v13
    v_mfma_f32_16x16x32_bf16 v[8:11], a[88:91], a[172:175], 0
    v_sub_f32 v18, v18, v235
    v_exp_f32 v18, v18
    v_mfma_f32_16x16x32_bf16 v[8:11], a[92:95], a[176:179], v[8:11]
    ds_read_b64_tr_b16 a[98:99], v220 offset:2048
    v_cvt_pk_bf16_f32 v144, v16, v17
    v_mfma_f32_16x16x32_bf16 v[8:11], a[80:83], a[164:167], v[8:11]
    v_sub_f32 v19, v19, v235
    v_exp_f32 v19, v19
    v_mfma_f32_16x16x32_bf16 v[8:11], a[84:87], a[168:171], v[8:11]
    global_load_lds_dwordx4 v228, s[74:75] offset:2048 nt
    v_mfma_f32_16x16x32_bf16 v[12:15], a[80:83], a[180:183], 0
    v_sub_f32 v4, v4, v232
    v_exp_f32 v4, v4
    v_mfma_f32_16x16x32_bf16 v[12:15], a[84:87], a[184:187], v[12:15]
    ds_read_b128 a[68:71], v213
    v_cvt_pk_bf16_f32 v145, v18, v19
    v_mfma_f32_16x16x32_bf16 v[12:15], a[88:91], a[188:191], v[12:15]
    v_sub_f32 v5, v5, v232
    v_exp_f32 v5, v5
    v_mfma_f32_16x16x32_bf16 v[12:15], a[92:95], a[192:195], v[12:15]
    ds_read_b64_tr_b16 a[100:101], v220 offset:4096
    v_mfma_f32_16x16x32_bf16 v[16:19], a[88:91], a[204:207], 0
    v_sub_f32 v6, v6, v232
    v_exp_f32 v6, v6
    v_mfma_f32_16x16x32_bf16 v[16:19], a[92:95], a[208:211], v[16:19]
    ds_read_b64_tr_b16 a[102:103], v220 offset:6144
    v_cvt_pk_bf16_f32 v122, v4, v5
    v_mfma_f32_16x16x32_bf16 v[16:19], a[80:83], a[196:199], v[16:19]
    v_sub_f32 v7, v7, v232
    v_exp_f32 v7, v7
    v_mfma_f32_16x16x32_bf16 v[16:19], a[84:87], a[200:203], v[16:19]
    global_load_lds_dwordx4 v229, s[74:75] offset:3072 nt
    v_mfma_f32_16x16x32_bf16 v[204:207], v[20:23], a[112:115], v[204:207]
    v_sub_f32 v8, v8, v233
    v_exp_f32 v8, v8
    v_mfma_f32_16x16x32_bf16 v[204:207], v[24:27], a[116:119], v[204:207]
    ds_read_b128 a[72:75], v214
    v_cvt_pk_bf16_f32 v123, v6, v7
    v_mfma_f32_16x16x32_bf16 v[204:207], v[52:55], a[120:123], v[204:207]
    v_sub_f32 v9, v9, v233
    v_exp_f32 v9, v9
    v_mfma_f32_16x16x32_bf16 v[204:207], v[56:59], a[124:127], v[204:207]
    ds_read_b64_tr_b16 a[104:105], v220 offset:8192
    v_mfma_f32_16x16x32_bf16 v[208:211], v[60:63], a[120:123], v[208:211]
    s_add_u32 m0, s33, 0x6000
    v_sub_f32 v10, v10, v233
    v_exp_f32 v10, v10
    v_mfma_f32_16x16x32_bf16 v[208:211], v[64:67], a[124:127], v[208:211]
    ds_read_b64_tr_b16 a[106:107], v220 offset:10240
    v_cvt_pk_bf16_f32 v130, v8, v9
    v_mfma_f32_16x16x32_bf16 v[208:211], v[28:31], a[112:115], v[208:211]
    v_sub_f32 v11, v11, v233
    v_exp_f32 v11, v11
    v_mfma_f32_16x16x32_bf16 v[208:211], v[32:35], a[116:119], v[208:211]
    global_load_lds_dwordx4 v224, s[72:73] nt
    v_mfma_f32_16x16x32_bf16 a[56:59], v[36:39], a[112:115], a[56:59]
    s_add_u32 s32, s65, 0x48000
    v_sub_f32 v12, v12, v234
    v_exp_f32 v12, v12
    v_mfma_f32_16x16x32_bf16 a[56:59], v[40:43], a[116:119], a[56:59]
    ds_read_b128 a[76:79], v215
    v_cvt_pk_bf16_f32 v131, v10, v11
    v_mfma_f32_16x16x32_bf16 a[56:59], v[68:71], a[120:123], a[56:59]
    s_and_b32 s32, s32, 0x7ffff
    v_sub_f32 v13, v13, v234
    v_exp_f32 v13, v13
    v_mfma_f32_16x16x32_bf16 a[56:59], v[72:75], a[124:127], a[56:59]
    ds_read_b64_tr_b16 a[108:109], v220 offset:12288
    v_mfma_f32_16x16x32_bf16 a[60:63], v[76:79], a[120:123], a[60:63]
    v_sub_f32 v14, v14, v234
    v_exp_f32 v14, v14
    v_mfma_f32_16x16x32_bf16 a[60:63], v[80:83], a[124:127], a[60:63]
    ds_read_b64_tr_b16 a[110:111], v220 offset:14336
    v_cvt_pk_bf16_f32 v138, v12, v13
    v_mfma_f32_16x16x32_bf16 a[60:63], v[44:47], a[112:115], a[60:63]
    s_waitcnt lgkmcnt(2)
    v_sub_f32 v15, v15, v234
    v_exp_f32 v15, v15
    v_mfma_f32_16x16x32_bf16 a[60:63], v[48:51], a[116:119], a[60:63]
    global_load_lds_dwordx4 v225, s[72:73] offset:1024 nt
    v_smfmac_f32_16x16x64_bf16 a[140:143], a[144:147], v[108:115], v236
    v_mfma_f32_16x16x32_bf16 v[4:7], a[64:67], a[148:151], 0
    s_add_u32 s74, s12, s32
    v_sub_f32 v16, v16, v235
    v_exp_f32 v16, v16
    v_mfma_f32_16x16x32_bf16 v[4:7], a[68:71], a[152:155], v[4:7]
    ds_read_b128 a[80:83], v212 offset:4096
    v_cvt_pk_bf16_f32 v139, v14, v15
    v_mfma_f32_16x16x32_bf16 v[4:7], a[72:75], a[156:159], v[4:7]
    s_addc_u32 s75, s13, 0
    v_sub_f32 v17, v17, v235
    v_exp_f32 v17, v17
    v_mfma_f32_16x16x32_bf16 v[4:7], a[76:79], a[160:163], v[4:7]
    ds_read_b64_tr_b16 a[112:113], v221
    v_mfma_f32_16x16x32_bf16 v[8:11], a[72:75], a[172:175], 0
    v_sub_f32 v18, v18, v235
    v_exp_f32 v18, v18
    v_mfma_f32_16x16x32_bf16 v[8:11], a[76:79], a[176:179], v[8:11]
    ds_read_b64_tr_b16 a[114:115], v221 offset:2048
    v_cvt_pk_bf16_f32 v146, v16, v17
    v_mfma_f32_16x16x32_bf16 v[8:11], a[64:67], a[164:167], v[8:11]
    s_waitcnt lgkmcnt(3)
    v_sub_f32 v19, v19, v235
    v_exp_f32 v19, v19
    v_mfma_f32_16x16x32_bf16 v[8:11], a[68:71], a[168:171], v[8:11]
    global_load_lds_dwordx4 v226, s[72:73] offset:2048 nt
    v_mfma_f32_16x16x32_bf16 v[12:15], a[64:67], a[180:183], 0
    v_sub_f32 v4, v4, v232
    v_exp_f32 v4, v4
    v_mfma_f32_16x16x32_bf16 v[12:15], a[68:71], a[184:187], v[12:15]
    ds_read_b128 a[84:87], v213 offset:4096
    v_cvt_pk_bf16_f32 v147, v18, v19
    v_mfma_f32_16x16x32_bf16 v[12:15], a[72:75], a[188:191], v[12:15]
    v_sub_f32 v5, v5, v232
    v_exp_f32 v5, v5
    v_mfma_f32_16x16x32_bf16 v[12:15], a[76:79], a[192:195], v[12:15]
    ds_read_b64_tr_b16 a[116:117], v221 offset:4096
    v_mfma_f32_16x16x32_bf16 v[16:19], a[72:75], a[204:207], 0
    v_sub_f32 v6, v6, v232
    v_exp_f32 v6, v6
    v_mfma_f32_16x16x32_bf16 v[16:19], a[76:79], a[208:211], v[16:19]
    ds_read_b64_tr_b16 a[118:119], v221 offset:6144
    v_cvt_pk_bf16_f32 v20, v4, v5
    v_mfma_f32_16x16x32_bf16 v[16:19], a[64:67], a[196:199], v[16:19]
    v_sub_f32 v7, v7, v232
    v_exp_f32 v7, v7
    v_mfma_f32_16x16x32_bf16 v[16:19], a[68:71], a[200:203], v[16:19]
    global_load_lds_dwordx4 v227, s[72:73] offset:3072 nt
    v_mfma_f32_16x16x32_bf16 v[148:151], v[84:87], a[96:99], v[148:151]
    v_sub_f32 v8, v8, v233
    v_exp_f32 v8, v8
    v_mfma_f32_16x16x32_bf16 v[148:151], v[88:91], a[100:103], v[148:151]
    ds_read_b128 a[88:91], v214 offset:4096
    v_cvt_pk_bf16_f32 v21, v6, v7
    v_mfma_f32_16x16x32_bf16 v[148:151], v[116:119], a[104:107], v[148:151]
    v_sub_f32 v9, v9, v233
    v_exp_f32 v9, v9
    v_mfma_f32_16x16x32_bf16 v[148:151], v[120:123], a[108:111], v[148:151]
    ds_read_b64_tr_b16 a[120:121], v221 offset:8192
    v_mfma_f32_16x16x32_bf16 v[152:155], v[124:127], a[104:107], v[152:155]
    s_add_u32 m0, s31, 0xc000
    v_sub_f32 v10, v10, v233
    v_exp_f32 v10, v10
    v_mfma_f32_16x16x32_bf16 v[152:155], v[128:131], a[108:111], v[152:155]
    ds_read_b64_tr_b16 a[122:123], v221 offset:10240
    v_cvt_pk_bf16_f32 v28, v8, v9
    v_mfma_f32_16x16x32_bf16 v[152:155], v[92:95], a[96:99], v[152:155]
    v_sub_f32 v11, v11, v233
    v_exp_f32 v11, v11
    v_mfma_f32_16x16x32_bf16 v[152:155], v[96:99], a[100:103], v[152:155]
    global_load_lds_dwordx4 v228, s[74:75] nt
    v_mfma_f32_16x16x32_bf16 a[0:3], v[100:103], a[96:99], a[0:3]
    ds_read_b128 a[92:95], v215 offset:4096
    v_cvt_pk_bf16_f32 v29, v10, v11
    v_mfma_f32_16x16x32_bf16 a[0:3], v[104:107], a[100:103], a[0:3]
    ds_read_b64_tr_b16 a[124:125], v221 offset:12288
    v_mfma_f32_16x16x32_bf16 a[0:3], v[132:135], a[104:107], a[0:3]
    ds_read_b64_tr_b16 a[126:127], v221 offset:14336
    v_mfma_f32_16x16x32_bf16 a[0:3], v[136:139], a[108:111], a[0:3]
    global_load_lds_dwordx4 v229, s[74:75] offset:1024 nt
    v_mfma_f32_16x16x32_bf16 a[4:7], v[140:143], a[104:107], a[4:7]
    s_add_u32 s32, s66, 0x40000
    v_sub_f32 v12, v12, v234
    v_exp_f32 v12, v12
    v_mfma_f32_16x16x32_bf16 a[4:7], v[144:147], a[108:111], a[4:7]
    s_and_b32 s32, s32, 0x7ffff
    v_sub_f32 v13, v13, v234
    v_exp_f32 v13, v13
    v_mfma_f32_16x16x32_bf16 a[4:7], v[108:111], a[96:99], a[4:7]
    v_sub_f32 v14, v14, v234
    v_exp_f32 v14, v14
    v_mfma_f32_16x16x32_bf16 a[4:7], v[112:115], a[100:103], a[4:7]
    s_waitcnt vmcnt(14) lgkmcnt(0)
    v_sub_f32 v15, v15, v234
    v_exp_f32 v15, v15
    v_smfmac_f32_16x16x64_bf16 a[128:131], a[144:147], v[116:123], v236
    s_barrier
    v_mfma_f32_16x16x32_bf16 v[4:7], a[80:83], a[148:151], 0
    s_add_u32 s72, s14, s32
    v_sub_f32 v16, v16, v235
    v_exp_f32 v16, v16
    v_mfma_f32_16x16x32_bf16 v[4:7], a[84:87], a[152:155], v[4:7]
    ds_read_b128 a[64:67], v212 offset:16384
    v_cvt_pk_bf16_f32 v37, v14, v15
    v_mfma_f32_16x16x32_bf16 v[4:7], a[88:91], a[156:159], v[4:7]
    s_addc_u32 s73, s15, 0
    v_sub_f32 v17, v17, v235
    v_exp_f32 v17, v17
    v_mfma_f32_16x16x32_bf16 v[4:7], a[92:95], a[160:163], v[4:7]
    ds_read_b64_tr_b16 a[96:97], v222
    v_cvt_pk_bf16_f32 v36, v12, v13
    v_mfma_f32_16x16x32_bf16 v[8:11], a[88:91], a[172:175], 0
    v_sub_f32 v18, v18, v235
    v_exp_f32 v18, v18
    v_mfma_f32_16x16x32_bf16 v[8:11], a[92:95], a[176:179], v[8:11]
    ds_read_b64_tr_b16 a[98:99], v222 offset:2048
    v_cvt_pk_bf16_f32 v44, v16, v17
    v_mfma_f32_16x16x32_bf16 v[8:11], a[80:83], a[164:167], v[8:11]
    v_sub_f32 v19, v19, v235
    v_exp_f32 v19, v19
    v_mfma_f32_16x16x32_bf16 v[8:11], a[84:87], a[168:171], v[8:11]
    global_load_lds_dwordx4 v228, s[74:75] offset:2048 nt
    v_mfma_f32_16x16x32_bf16 v[12:15], a[80:83], a[180:183], 0
    v_sub_f32 v4, v4, v232
    v_exp_f32 v4, v4
    v_mfma_f32_16x16x32_bf16 v[12:15], a[84:87], a[184:187], v[12:15]
    ds_read_b128 a[68:71], v213 offset:16384
    v_cvt_pk_bf16_f32 v45, v18, v19
    v_mfma_f32_16x16x32_bf16 v[12:15], a[88:91], a[188:191], v[12:15]
    v_sub_f32 v5, v5, v232
    v_exp_f32 v5, v5
    v_mfma_f32_16x16x32_bf16 v[12:15], a[92:95], a[192:195], v[12:15]
    ds_read_b64_tr_b16 a[100:101], v222 offset:4096
    v_mfma_f32_16x16x32_bf16 v[16:19], a[88:91], a[204:207], 0
    v_sub_f32 v6, v6, v232
    v_exp_f32 v6, v6
    v_mfma_f32_16x16x32_bf16 v[16:19], a[92:95], a[208:211], v[16:19]
    ds_read_b64_tr_b16 a[102:103], v222 offset:6144
    v_cvt_pk_bf16_f32 v22, v4, v5
    v_mfma_f32_16x16x32_bf16 v[16:19], a[80:83], a[196:199], v[16:19]
    v_sub_f32 v7, v7, v232
    v_exp_f32 v7, v7
    v_mfma_f32_16x16x32_bf16 v[16:19], a[84:87], a[200:203], v[16:19]
    global_load_lds_dwordx4 v229, s[74:75] offset:3072 nt
    v_mfma_f32_16x16x32_bf16 v[156:159], v[84:87], a[112:115], v[156:159]
    v_sub_f32 v8, v8, v233
    v_exp_f32 v8, v8
    v_mfma_f32_16x16x32_bf16 v[156:159], v[88:91], a[116:119], v[156:159]
    ds_read_b128 a[72:75], v214 offset:16384
    v_cvt_pk_bf16_f32 v23, v6, v7
    v_mfma_f32_16x16x32_bf16 v[156:159], v[116:119], a[120:123], v[156:159]
    v_sub_f32 v9, v9, v233
    v_exp_f32 v9, v9
    v_mfma_f32_16x16x32_bf16 v[156:159], v[120:123], a[124:127], v[156:159]
    ds_read_b64_tr_b16 a[104:105], v222 offset:8192
    v_mfma_f32_16x16x32_bf16 v[160:163], v[124:127], a[120:123], v[160:163]
    s_add_u32 m0, s33, 0x8000
    v_sub_f32 v10, v10, v233
    v_exp_f32 v10, v10
    v_mfma_f32_16x16x32_bf16 v[160:163], v[128:131], a[124:127], v[160:163]
    ds_read_b64_tr_b16 a[106:107], v222 offset:10240
    v_cvt_pk_bf16_f32 v30, v8, v9
    v_mfma_f32_16x16x32_bf16 v[160:163], v[92:95], a[112:115], v[160:163]
    v_sub_f32 v11, v11, v233
    v_exp_f32 v11, v11
    v_mfma_f32_16x16x32_bf16 v[160:163], v[96:99], a[116:119], v[160:163]
    global_load_lds_dwordx4 v224, s[72:73] nt
    v_mfma_f32_16x16x32_bf16 a[8:11], v[100:103], a[112:115], a[8:11]
    s_add_u32 s32, s64, 0x50000
    v_sub_f32 v12, v12, v234
    v_exp_f32 v12, v12
    v_mfma_f32_16x16x32_bf16 a[8:11], v[104:107], a[116:119], a[8:11]
    ds_read_b128 a[76:79], v215 offset:16384
    v_cvt_pk_bf16_f32 v31, v10, v11
    v_mfma_f32_16x16x32_bf16 a[8:11], v[132:135], a[120:123], a[8:11]
    s_and_b32 s32, s32, 0x7ffff
    v_sub_f32 v13, v13, v234
    v_exp_f32 v13, v13
    v_mfma_f32_16x16x32_bf16 a[8:11], v[136:139], a[124:127], a[8:11]
    ds_read_b64_tr_b16 a[108:109], v222 offset:12288
    v_mfma_f32_16x16x32_bf16 a[12:15], v[140:143], a[120:123], a[12:15]
    v_sub_f32 v14, v14, v234
    v_exp_f32 v14, v14
    v_mfma_f32_16x16x32_bf16 a[12:15], v[144:147], a[124:127], a[12:15]
    ds_read_b64_tr_b16 a[110:111], v222 offset:14336
    v_cvt_pk_bf16_f32 v38, v12, v13
    v_mfma_f32_16x16x32_bf16 a[12:15], v[108:111], a[112:115], a[12:15]
    s_waitcnt lgkmcnt(2)
    v_sub_f32 v15, v15, v234
    v_exp_f32 v15, v15
    v_mfma_f32_16x16x32_bf16 a[12:15], v[112:115], a[116:119], a[12:15]
    global_load_lds_dwordx4 v225, s[72:73] offset:1024 nt
    v_smfmac_f32_16x16x64_bf16 a[132:135], a[144:147], v[124:131], v236
    v_mfma_f32_16x16x32_bf16 v[4:7], a[64:67], a[148:151], 0
    s_add_u32 s74, s12, s32
    v_sub_f32 v16, v16, v235
    v_exp_f32 v16, v16
    v_mfma_f32_16x16x32_bf16 v[4:7], a[68:71], a[152:155], v[4:7]
    ds_read_b128 a[80:83], v212 offset:20480
    v_cvt_pk_bf16_f32 v39, v14, v15
    v_mfma_f32_16x16x32_bf16 v[4:7], a[72:75], a[156:159], v[4:7]
    s_addc_u32 s75, s13, 0
    v_sub_f32 v17, v17, v235
    v_exp_f32 v17, v17
    v_mfma_f32_16x16x32_bf16 v[4:7], a[76:79], a[160:163], v[4:7]
    ds_read_b64_tr_b16 a[112:113], v223
    v_mfma_f32_16x16x32_bf16 v[8:11], a[72:75], a[172:175], 0
    v_sub_f32 v18, v18, v235
    v_exp_f32 v18, v18
    v_mfma_f32_16x16x32_bf16 v[8:11], a[76:79], a[176:179], v[8:11]
    ds_read_b64_tr_b16 a[114:115], v223 offset:2048
    v_cvt_pk_bf16_f32 v46, v16, v17
    v_mfma_f32_16x16x32_bf16 v[8:11], a[64:67], a[164:167], v[8:11]
    s_waitcnt lgkmcnt(3)
    v_sub_f32 v19, v19, v235
    v_exp_f32 v19, v19
    v_mfma_f32_16x16x32_bf16 v[8:11], a[68:71], a[168:171], v[8:11]
    global_load_lds_dwordx4 v226, s[72:73] offset:2048 nt
    v_mfma_f32_16x16x32_bf16 v[12:15], a[64:67], a[180:183], 0
    v_sub_f32 v4, v4, v232
    v_exp_f32 v4, v4
    v_mfma_f32_16x16x32_bf16 v[12:15], a[68:71], a[184:187], v[12:15]
    ds_read_b128 a[84:87], v213 offset:20480
    v_cvt_pk_bf16_f32 v47, v18, v19
    v_mfma_f32_16x16x32_bf16 v[12:15], a[72:75], a[188:191], v[12:15]
M_stub5:
    s_cbranch_execz M_stub9
    v_sub_f32 v5, v5, v232
    v_exp_f32 v5, v5
    v_mfma_f32_16x16x32_bf16 v[12:15], a[76:79], a[192:195], v[12:15]
    ds_read_b64_tr_b16 a[116:117], v223 offset:4096
    v_mfma_f32_16x16x32_bf16 v[16:19], a[72:75], a[204:207], 0
    v_sub_f32 v6, v6, v232
    v_exp_f32 v6, v6
    v_mfma_f32_16x16x32_bf16 v[16:19], a[76:79], a[208:211], v[16:19]
    ds_read_b64_tr_b16 a[118:119], v223 offset:6144
    v_cvt_pk_bf16_f32 v24, v4, v5
    v_mfma_f32_16x16x32_bf16 v[16:19], a[64:67], a[196:199], v[16:19]
    v_sub_f32 v7, v7, v232
    v_exp_f32 v7, v7
    v_mfma_f32_16x16x32_bf16 v[16:19], a[68:71], a[200:203], v[16:19]
    global_load_lds_dwordx4 v227, s[72:73] offset:3072 nt
    v_mfma_f32_16x16x32_bf16 v[164:167], v[84:87], a[96:99], v[164:167]
    v_sub_f32 v8, v8, v233
    v_exp_f32 v8, v8
    v_mfma_f32_16x16x32_bf16 v[164:167], v[88:91], a[100:103], v[164:167]
    ds_read_b128 a[88:91], v214 offset:20480
    v_cvt_pk_bf16_f32 v25, v6, v7
    v_mfma_f32_16x16x32_bf16 v[164:167], v[116:119], a[104:107], v[164:167]
    v_sub_f32 v9, v9, v233
    v_exp_f32 v9, v9
    v_mfma_f32_16x16x32_bf16 v[164:167], v[120:123], a[108:111], v[164:167]
    ds_read_b64_tr_b16 a[120:121], v223 offset:8192
    v_mfma_f32_16x16x32_bf16 v[168:171], v[124:127], a[104:107], v[168:171]
    s_add_u32 m0, s31, 0x0
    v_sub_f32 v10, v10, v233
    v_exp_f32 v10, v10
    v_mfma_f32_16x16x32_bf16 v[168:171], v[128:131], a[108:111], v[168:171]
    ds_read_b64_tr_b16 a[122:123], v223 offset:10240
    v_cvt_pk_bf16_f32 v32, v8, v9
    v_mfma_f32_16x16x32_bf16 v[168:171], v[92:95], a[96:99], v[168:171]
    v_sub_f32 v11, v11, v233
    v_exp_f32 v11, v11
    v_mfma_f32_16x16x32_bf16 v[168:171], v[96:99], a[100:103], v[168:171]
    global_load_lds_dwordx4 v228, s[74:75] nt
    v_mfma_f32_16x16x32_bf16 a[16:19], v[100:103], a[96:99], a[16:19]
    ds_read_b128 a[92:95], v215 offset:20480
    v_cvt_pk_bf16_f32 v33, v10, v11
    v_mfma_f32_16x16x32_bf16 a[16:19], v[104:107], a[100:103], a[16:19]
    ds_read_b64_tr_b16 a[124:125], v223 offset:12288
    v_mfma_f32_16x16x32_bf16 a[16:19], v[132:135], a[104:107], a[16:19]
    ds_read_b64_tr_b16 a[126:127], v223 offset:14336
    v_mfma_f32_16x16x32_bf16 a[16:19], v[136:139], a[108:111], a[16:19]
    global_load_lds_dwordx4 v229, s[74:75] offset:1024 nt
    v_mfma_f32_16x16x32_bf16 a[20:23], v[140:143], a[104:107], a[20:23]
    s_add_u32 s32, s66, 0x48000
    v_sub_f32 v12, v12, v234
    v_exp_f32 v12, v12
    v_mfma_f32_16x16x32_bf16 a[20:23], v[144:147], a[108:111], a[20:23]
    s_and_b32 s32, s32, 0x7ffff
    v_sub_f32 v13, v13, v234
    v_exp_f32 v13, v13
    v_mfma_f32_16x16x32_bf16 a[20:23], v[108:111], a[96:99], a[20:23]
    v_sub_f32 v14, v14, v234
    v_exp_f32 v14, v14
    v_mfma_f32_16x16x32_bf16 a[20:23], v[112:115], a[100:103], a[20:23]
    s_waitcnt vmcnt(10) lgkmcnt(0)
    v_sub_f32 v15, v15, v234
    v_exp_f32 v15, v15
    v_smfmac_f32_16x16x64_bf16 a[136:139], a[144:147], v[132:139], v236
    s_barrier
    v_mfma_f32_16x16x32_bf16 v[4:7], a[80:83], a[148:151], 0
    s_add_u32 s72, s14, s32
    v_sub_f32 v16, v16, v235
    v_exp_f32 v16, v16
    v_mfma_f32_16x16x32_bf16 v[4:7], a[84:87], a[152:155], v[4:7]
    ds_read_b128 a[64:67], v212 offset:32768
    v_cvt_pk_bf16_f32 v41, v14, v15
    v_mfma_f32_16x16x32_bf16 v[4:7], a[88:91], a[156:159], v[4:7]
    s_addc_u32 s73, s15, 0
    v_sub_f32 v17, v17, v235
    v_exp_f32 v17, v17
    v_mfma_f32_16x16x32_bf16 v[4:7], a[92:95], a[160:163], v[4:7]
    ds_read_b64_tr_b16 a[96:97], v220 offset:16384
    v_cvt_pk_bf16_f32 v40, v12, v13
    v_mfma_f32_16x16x32_bf16 v[8:11], a[88:91], a[172:175], 0
    v_sub_f32 v18, v18, v235
    v_exp_f32 v18, v18
    v_mfma_f32_16x16x32_bf16 v[8:11], a[92:95], a[176:179], v[8:11]
    ds_read_b64_tr_b16 a[98:99], v220 offset:18432
    v_cvt_pk_bf16_f32 v48, v16, v17
    v_mfma_f32_16x16x32_bf16 v[8:11], a[80:83], a[164:167], v[8:11]
    v_sub_f32 v19, v19, v235
    v_exp_f32 v19, v19
    v_mfma_f32_16x16x32_bf16 v[8:11], a[84:87], a[168:171], v[8:11]
    global_load_lds_dwordx4 v228, s[74:75] offset:2048 nt
    v_mfma_f32_16x16x32_bf16 v[12:15], a[80:83], a[180:183], 0
    v_sub_f32 v4, v4, v232
    v_exp_f32 v4, v4
    v_mfma_f32_16x16x32_bf16 v[12:15], a[84:87], a[184:187], v[12:15]
    ds_read_b128 a[68:71], v213 offset:32768
    v_cvt_pk_bf16_f32 v49, v18, v19
    v_mfma_f32_16x16x32_bf16 v[12:15], a[88:91], a[188:191], v[12:15]
    v_sub_f32 v5, v5, v232
    v_exp_f32 v5, v5
    v_mfma_f32_16x16x32_bf16 v[12:15], a[92:95], a[192:195], v[12:15]
    ds_read_b64_tr_b16 a[100:101], v220 offset:20480
    v_mfma_f32_16x16x32_bf16 v[16:19], a[88:91], a[204:207], 0
    v_sub_f32 v6, v6, v232
    v_exp_f32 v6, v6
    v_mfma_f32_16x16x32_bf16 v[16:19], a[92:95], a[208:211], v[16:19]
    ds_read_b64_tr_b16 a[102:103], v220 offset:22528
    v_cvt_pk_bf16_f32 v26, v4, v5
    v_mfma_f32_16x16x32_bf16 v[16:19], a[80:83], a[196:199], v[16:19]
    v_sub_f32 v7, v7, v232
    v_exp_f32 v7, v7
    v_mfma_f32_16x16x32_bf16 v[16:19], a[84:87], a[200:203], v[16:19]
    global_load_lds_dwordx4 v229, s[74:75] offset:3072 nt
    v_mfma_f32_16x16x32_bf16 v[172:175], v[84:87], a[112:115], v[172:175]
    v_sub_f32 v8, v8, v233
    v_exp_f32 v8, v8
    v_mfma_f32_16x16x32_bf16 v[172:175], v[88:91], a[116:119], v[172:175]
    ds_read_b128 a[72:75], v214 offset:32768
    v_cvt_pk_bf16_f32 v27, v6, v7
    v_mfma_f32_16x16x32_bf16 v[172:175], v[116:119], a[120:123], v[172:175]
    v_sub_f32 v9, v9, v233
    v_exp_f32 v9, v9
    v_mfma_f32_16x16x32_bf16 v[172:175], v[120:123], a[124:127], v[172:175]
    ds_read_b64_tr_b16 a[104:105], v220 offset:24576
    v_mfma_f32_16x16x32_bf16 v[176:179], v[124:127], a[120:123], v[176:179]
    s_add_u32 m0, s33, 0xa000
    v_sub_f32 v10, v10, v233
    v_exp_f32 v10, v10
    v_mfma_f32_16x16x32_bf16 v[176:179], v[128:131], a[124:127], v[176:179]
    ds_read_b64_tr_b16 a[106:107], v220 offset:26624
    v_cvt_pk_bf16_f32 v34, v8, v9
    v_mfma_f32_16x16x32_bf16 v[176:179], v[92:95], a[112:115], v[176:179]
    v_sub_f32 v11, v11, v233
    v_exp_f32 v11, v11
    v_mfma_f32_16x16x32_bf16 v[176:179], v[96:99], a[116:119], v[176:179]
    global_load_lds_dwordx4 v224, s[72:73] nt
    v_mfma_f32_16x16x32_bf16 a[24:27], v[100:103], a[112:115], a[24:27]
    s_add_u32 s32, s65, 0x50000
    v_sub_f32 v12, v12, v234
    v_exp_f32 v12, v12
    v_mfma_f32_16x16x32_bf16 a[24:27], v[104:107], a[116:119], a[24:27]
    ds_read_b128 a[76:79], v215 offset:32768
    v_cvt_pk_bf16_f32 v35, v10, v11
    v_mfma_f32_16x16x32_bf16 a[24:27], v[132:135], a[120:123], a[24:27]
    s_and_b32 s32, s32, 0x7ffff
    v_sub_f32 v13, v13, v234
    v_exp_f32 v13, v13
    v_mfma_f32_16x16x32_bf16 a[24:27], v[136:139], a[124:127], a[24:27]
    ds_read_b64_tr_b16 a[108:109], v220 offset:28672
    v_mfma_f32_16x16x32_bf16 a[28:31], v[140:143], a[120:123], a[28:31]
    v_sub_f32 v14, v14, v234
    v_exp_f32 v14, v14
    v_mfma_f32_16x16x32_bf16 a[28:31], v[144:147], a[124:127], a[28:31]
    ds_read_b64_tr_b16 a[110:111], v220 offset:30720
    v_cvt_pk_bf16_f32 v42, v12, v13
    v_mfma_f32_16x16x32_bf16 a[28:31], v[108:111], a[112:115], a[28:31]
    s_waitcnt lgkmcnt(2)
    v_sub_f32 v15, v15, v234
    v_exp_f32 v15, v15
    v_mfma_f32_16x16x32_bf16 a[28:31], v[112:115], a[116:119], a[28:31]
    global_load_lds_dwordx4 v225, s[72:73] offset:1024 nt
    v_smfmac_f32_16x16x64_bf16 a[140:143], a[144:147], v[140:147], v236
    v_mfma_f32_16x16x32_bf16 v[4:7], a[64:67], a[148:151], 0
    s_add_u32 s74, s12, s32
    v_sub_f32 v16, v16, v235
    v_exp_f32 v16, v16
    v_mfma_f32_16x16x32_bf16 v[4:7], a[68:71], a[152:155], v[4:7]
    ds_read_b128 a[80:83], v212 offset:36864
    v_cvt_pk_bf16_f32 v43, v14, v15
    v_mfma_f32_16x16x32_bf16 v[4:7], a[72:75], a[156:159], v[4:7]
    s_addc_u32 s75, s13, 0
    v_sub_f32 v17, v17, v235
    v_exp_f32 v17, v17
    v_mfma_f32_16x16x32_bf16 v[4:7], a[76:79], a[160:163], v[4:7]
    ds_read_b64_tr_b16 a[112:113], v221 offset:16384
    v_mfma_f32_16x16x32_bf16 v[8:11], a[72:75], a[172:175], 0
    v_sub_f32 v18, v18, v235
    v_exp_f32 v18, v18
    v_mfma_f32_16x16x32_bf16 v[8:11], a[76:79], a[176:179], v[8:11]
    ds_read_b64_tr_b16 a[114:115], v221 offset:18432
    v_cvt_pk_bf16_f32 v50, v16, v17
    v_mfma_f32_16x16x32_bf16 v[8:11], a[64:67], a[164:167], v[8:11]
    s_waitcnt lgkmcnt(3)
    v_sub_f32 v19, v19, v235
    v_exp_f32 v19, v19
    v_mfma_f32_16x16x32_bf16 v[8:11], a[68:71], a[168:171], v[8:11]
    global_load_lds_dwordx4 v226, s[72:73] offset:2048 nt
    v_mfma_f32_16x16x32_bf16 v[12:15], a[64:67], a[180:183], 0
    v_sub_f32 v4, v4, v232
    v_exp_f32 v4, v4
    v_mfma_f32_16x16x32_bf16 v[12:15], a[68:71], a[184:187], v[12:15]
    ds_read_b128 a[84:87], v213 offset:36864
    v_cvt_pk_bf16_f32 v51, v18, v19
    v_mfma_f32_16x16x32_bf16 v[12:15], a[72:75], a[188:191], v[12:15]
    v_sub_f32 v5, v5, v232
    v_exp_f32 v5, v5
    v_mfma_f32_16x16x32_bf16 v[12:15], a[76:79], a[192:195], v[12:15]
    ds_read_b64_tr_b16 a[116:117], v221 offset:20480
    v_mfma_f32_16x16x32_bf16 v[16:19], a[72:75], a[204:207], 0
    v_sub_f32 v6, v6, v232
    v_exp_f32 v6, v6
    v_mfma_f32_16x16x32_bf16 v[16:19], a[76:79], a[208:211], v[16:19]
    ds_read_b64_tr_b16 a[118:119], v221 offset:22528
    v_cvt_pk_bf16_f32 v52, v4, v5
    v_mfma_f32_16x16x32_bf16 v[16:19], a[64:67], a[196:199], v[16:19]
    v_sub_f32 v7, v7, v232
    v_exp_f32 v7, v7
    v_mfma_f32_16x16x32_bf16 v[16:19], a[68:71], a[200:203], v[16:19]
    global_load_lds_dwordx4 v227, s[72:73] offset:3072 nt
    v_mfma_f32_16x16x32_bf16 v[180:183], v[84:87], a[96:99], v[180:183]
    v_sub_f32 v8, v8, v233
    v_exp_f32 v8, v8
    v_mfma_f32_16x16x32_bf16 v[180:183], v[88:91], a[100:103], v[180:183]
    ds_read_b128 a[88:91], v214 offset:36864
    v_cvt_pk_bf16_f32 v53, v6, v7
    v_mfma_f32_16x16x32_bf16 v[180:183], v[116:119], a[104:107], v[180:183]
    v_sub_f32 v9, v9, v233
    v_exp_f32 v9, v9
    v_mfma_f32_16x16x32_bf16 v[180:183], v[120:123], a[108:111], v[180:183]
    ds_read_b64_tr_b16 a[120:121], v221 offset:24576
    v_mfma_f32_16x16x32_bf16 v[184:187], v[124:127], a[104:107], v[184:187]
    s_add_u32 m0, s31, 0x4000
    v_sub_f32 v10, v10, v233
    v_exp_f32 v10, v10
    v_mfma_f32_16x16x32_bf16 v[184:187], v[128:131], a[108:111], v[184:187]
    ds_read_b64_tr_b16 a[122:123], v221 offset:26624
    v_cvt_pk_bf16_f32 v60, v8, v9
    v_mfma_f32_16x16x32_bf16 v[184:187], v[92:95], a[96:99], v[184:187]
    v_sub_f32 v11, v11, v233
    v_exp_f32 v11, v11
    v_mfma_f32_16x16x32_bf16 v[184:187], v[96:99], a[100:103], v[184:187]
    global_load_lds_dwordx4 v228, s[74:75] nt
    v_mfma_f32_16x16x32_bf16 a[32:35], v[100:103], a[96:99], a[32:35]
    ds_read_b128 a[92:95], v215 offset:36864
    v_cvt_pk_bf16_f32 v61, v10, v11
    v_mfma_f32_16x16x32_bf16 a[32:35], v[104:107], a[100:103], a[32:35]
    ds_read_b64_tr_b16 a[124:125], v221 offset:28672
    v_mfma_f32_16x16x32_bf16 a[32:35], v[132:135], a[104:107], a[32:35]
    ds_read_b64_tr_b16 a[126:127], v221 offset:30720
    v_mfma_f32_16x16x32_bf16 a[32:35], v[136:139], a[108:111], a[32:35]
    global_load_lds_dwordx4 v229, s[74:75] offset:1024 nt
    v_mfma_f32_16x16x32_bf16 a[36:39], v[140:143], a[104:107], a[36:39]
    s_add_u32 s32, s67, 0x40000
    v_sub_f32 v12, v12, v234
    v_exp_f32 v12, v12
    v_mfma_f32_16x16x32_bf16 a[36:39], v[144:147], a[108:111], a[36:39]
    s_and_b32 s32, s32, 0x7ffff
    v_sub_f32 v13, v13, v234
    v_exp_f32 v13, v13
    v_mfma_f32_16x16x32_bf16 a[36:39], v[108:111], a[96:99], a[36:39]
    v_sub_f32 v14, v14, v234
    v_exp_f32 v14, v14
    v_mfma_f32_16x16x32_bf16 a[36:39], v[112:115], a[100:103], a[36:39]
    s_waitcnt vmcnt(14) lgkmcnt(0)
    v_sub_f32 v15, v15, v234
    v_exp_f32 v15, v15
    v_smfmac_f32_16x16x64_bf16 a[128:131], a[144:147], v[20:27], v236
    s_barrier
    v_mfma_f32_16x16x32_bf16 v[4:7], a[80:83], a[148:151], 0
    s_add_u32 s72, s14, s32
    v_sub_f32 v16, v16, v235
    v_exp_f32 v16, v16
    v_mfma_f32_16x16x32_bf16 v[4:7], a[84:87], a[152:155], v[4:7]
    ds_read_b128 a[64:67], v212 offset:49152
    v_cvt_pk_bf16_f32 v69, v14, v15
    v_mfma_f32_16x16x32_bf16 v[4:7], a[88:91], a[156:159], v[4:7]
    s_addc_u32 s73, s15, 0
    v_sub_f32 v17, v17, v235
    v_exp_f32 v17, v17
    v_mfma_f32_16x16x32_bf16 v[4:7], a[92:95], a[160:163], v[4:7]
    ds_read_b64_tr_b16 a[96:97], v222 offset:16384
    v_cvt_pk_bf16_f32 v68, v12, v13
    v_mfma_f32_16x16x32_bf16 v[8:11], a[88:91], a[172:175], 0
    v_sub_f32 v18, v18, v235
    v_exp_f32 v18, v18
    v_mfma_f32_16x16x32_bf16 v[8:11], a[92:95], a[176:179], v[8:11]
    ds_read_b64_tr_b16 a[98:99], v222 offset:18432
    v_cvt_pk_bf16_f32 v76, v16, v17
    v_mfma_f32_16x16x32_bf16 v[8:11], a[80:83], a[164:167], v[8:11]
    v_sub_f32 v19, v19, v235
    v_exp_f32 v19, v19
    v_mfma_f32_16x16x32_bf16 v[8:11], a[84:87], a[168:171], v[8:11]
    global_load_lds_dwordx4 v228, s[74:75] offset:2048 nt
    v_mfma_f32_16x16x32_bf16 v[12:15], a[80:83], a[180:183], 0
    v_sub_f32 v4, v4, v232
    v_exp_f32 v4, v4
    v_mfma_f32_16x16x32_bf16 v[12:15], a[84:87], a[184:187], v[12:15]
    ds_read_b128 a[68:71], v213 offset:49152
    v_cvt_pk_bf16_f32 v77, v18, v19
    v_mfma_f32_16x16x32_bf16 v[12:15], a[88:91], a[188:191], v[12:15]
    v_sub_f32 v5, v5, v232
    v_exp_f32 v5, v5
    v_mfma_f32_16x16x32_bf16 v[12:15], a[92:95], a[192:195], v[12:15]
    ds_read_b64_tr_b16 a[100:101], v222 offset:20480
    v_mfma_f32_16x16x32_bf16 v[16:19], a[88:91], a[204:207], 0
    v_sub_f32 v6, v6, v232
    v_exp_f32 v6, v6
    v_mfma_f32_16x16x32_bf16 v[16:19], a[92:95], a[208:211], v[16:19]
    ds_read_b64_tr_b16 a[102:103], v222 offset:22528
    v_cvt_pk_bf16_f32 v54, v4, v5
    v_mfma_f32_16x16x32_bf16 v[16:19], a[80:83], a[196:199], v[16:19]
    v_sub_f32 v7, v7, v232
    v_exp_f32 v7, v7
    v_mfma_f32_16x16x32_bf16 v[16:19], a[84:87], a[200:203], v[16:19]
    global_load_lds_dwordx4 v229, s[74:75] offset:3072 nt
    v_mfma_f32_16x16x32_bf16 v[188:191], v[84:87], a[112:115], v[188:191]
    v_sub_f32 v8, v8, v233
    v_exp_f32 v8, v8
    v_mfma_f32_16x16x32_bf16 v[188:191], v[88:91], a[116:119], v[188:191]
    ds_read_b128 a[72:75], v214 offset:49152
    v_cvt_pk_bf16_f32 v55, v6, v7
    v_mfma_f32_16x16x32_bf16 v[188:191], v[116:119], a[120:123], v[188:191]
    v_sub_f32 v9, v9, v233
    v_exp_f32 v9, v9
    v_mfma_f32_16x16x32_bf16 v[188:191], v[120:123], a[124:127], v[188:191]
    ds_read_b64_tr_b16 a[104:105], v222 offset:24576
    v_mfma_f32_16x16x32_bf16 v[192:195], v[124:127], a[120:123], v[192:195]
    s_add_u32 m0, s33, 0x0
    v_sub_f32 v10, v10, v233
    v_exp_f32 v10, v10
    v_mfma_f32_16x16x32_bf16 v[192:195], v[128:131], a[124:127], v[192:195]
    ds_read_b64_tr_b16 a[106:107], v222 offset:26624
    v_cvt_pk_bf16_f32 v62, v8, v9
    v_mfma_f32_16x16x32_bf16 v[192:195], v[92:95], a[112:115], v[192:195]
    v_sub_f32 v11, v11, v233
    v_exp_f32 v11, v11
    v_mfma_f32_16x16x32_bf16 v[192:195], v[96:99], a[116:119], v[192:195]
    global_load_lds_dwordx4 v224, s[72:73] nt
    v_mfma_f32_16x16x32_bf16 a[40:43], v[100:103], a[112:115], a[40:43]
    s_add_u32 s32, s64, 0x58000
    v_sub_f32 v12, v12, v234
    v_exp_f32 v12, v12
    v_mfma_f32_16x16x32_bf16 a[40:43], v[104:107], a[116:119], a[40:43]
    ds_read_b128 a[76:79], v215 offset:49152
    v_cvt_pk_bf16_f32 v63, v10, v11
    v_mfma_f32_16x16x32_bf16 a[40:43], v[132:135], a[120:123], a[40:43]
    s_and_b32 s32, s32, 0x7ffff
    v_sub_f32 v13, v13, v234
    v_exp_f32 v13, v13
    v_mfma_f32_16x16x32_bf16 a[40:43], v[136:139], a[124:127], a[40:43]
    ds_read_b64_tr_b16 a[108:109], v222 offset:28672
    v_mfma_f32_16x16x32_bf16 a[44:47], v[140:143], a[120:123], a[44:47]
    v_sub_f32 v14, v14, v234
    v_exp_f32 v14, v14
    v_mfma_f32_16x16x32_bf16 a[44:47], v[144:147], a[124:127], a[44:47]
    ds_read_b64_tr_b16 a[110:111], v222 offset:30720
    v_cvt_pk_bf16_f32 v70, v12, v13
    v_mfma_f32_16x16x32_bf16 a[44:47], v[108:111], a[112:115], a[44:47]
    s_waitcnt lgkmcnt(2)
    v_sub_f32 v15, v15, v234
    v_exp_f32 v15, v15
    v_mfma_f32_16x16x32_bf16 a[44:47], v[112:115], a[116:119], a[44:47]
    global_load_lds_dwordx4 v225, s[72:73] offset:1024 nt
    v_smfmac_f32_16x16x64_bf16 a[132:135], a[144:147], v[28:35], v236
    v_mfma_f32_16x16x32_bf16 v[4:7], a[64:67], a[148:151], 0
    s_add_u32 s74, s12, s32
    v_sub_f32 v16, v16, v235
    v_exp_f32 v16, v16
    v_mfma_f32_16x16x32_bf16 v[4:7], a[68:71], a[152:155], v[4:7]
    ds_read_b128 a[80:83], v212 offset:53248
    v_cvt_pk_bf16_f32 v71, v14, v15
    v_mfma_f32_16x16x32_bf16 v[4:7], a[72:75], a[156:159], v[4:7]
    s_addc_u32 s75, s13, 0
    v_sub_f32 v17, v17, v235
    v_exp_f32 v17, v17
    v_mfma_f32_16x16x32_bf16 v[4:7], a[76:79], a[160:163], v[4:7]
    ds_read_b64_tr_b16 a[112:113], v223 offset:16384
    v_mfma_f32_16x16x32_bf16 v[8:11], a[72:75], a[172:175], 0
    v_sub_f32 v18, v18, v235
    v_exp_f32 v18, v18
    v_mfma_f32_16x16x32_bf16 v[8:11], a[76:79], a[176:179], v[8:11]
    ds_read_b64_tr_b16 a[114:115], v223 offset:18432
    v_cvt_pk_bf16_f32 v78, v16, v17
    v_mfma_f32_16x16x32_bf16 v[8:11], a[64:67], a[164:167], v[8:11]
    s_waitcnt lgkmcnt(3)
    v_sub_f32 v19, v19, v235
    v_exp_f32 v19, v19
    v_mfma_f32_16x16x32_bf16 v[8:11], a[68:71], a[168:171], v[8:11]
    global_load_lds_dwordx4 v226, s[72:73] offset:2048 nt
    v_mfma_f32_16x16x32_bf16 v[12:15], a[64:67], a[180:183], 0
    v_sub_f32 v4, v4, v232
    v_exp_f32 v4, v4
    v_mfma_f32_16x16x32_bf16 v[12:15], a[68:71], a[184:187], v[12:15]
    ds_read_b128 a[84:87], v213 offset:53248
    v_cvt_pk_bf16_f32 v79, v18, v19
    v_mfma_f32_16x16x32_bf16 v[12:15], a[72:75], a[188:191], v[12:15]
    v_sub_f32 v5, v5, v232
    v_exp_f32 v5, v5
    v_mfma_f32_16x16x32_bf16 v[12:15], a[76:79], a[192:195], v[12:15]
    ds_read_b64_tr_b16 a[116:117], v223 offset:20480
    v_mfma_f32_16x16x32_bf16 v[16:19], a[72:75], a[204:207], 0
    v_sub_f32 v6, v6, v232
    v_exp_f32 v6, v6
    v_mfma_f32_16x16x32_bf16 v[16:19], a[76:79], a[208:211], v[16:19]
    ds_read_b64_tr_b16 a[118:119], v223 offset:22528
    v_cvt_pk_bf16_f32 v56, v4, v5
    v_mfma_f32_16x16x32_bf16 v[16:19], a[64:67], a[196:199], v[16:19]
    v_sub_f32 v7, v7, v232
    v_exp_f32 v7, v7
    v_mfma_f32_16x16x32_bf16 v[16:19], a[68:71], a[200:203], v[16:19]
    global_load_lds_dwordx4 v227, s[72:73] offset:3072 nt
    v_mfma_f32_16x16x32_bf16 v[196:199], v[84:87], a[96:99], v[196:199]
    v_sub_f32 v8, v8, v233
    v_exp_f32 v8, v8
    v_mfma_f32_16x16x32_bf16 v[196:199], v[88:91], a[100:103], v[196:199]
    ds_read_b128 a[88:91], v214 offset:53248
    v_cvt_pk_bf16_f32 v57, v6, v7
    v_mfma_f32_16x16x32_bf16 v[196:199], v[116:119], a[104:107], v[196:199]
    v_sub_f32 v9, v9, v233
    v_exp_f32 v9, v9
    v_mfma_f32_16x16x32_bf16 v[196:199], v[120:123], a[108:111], v[196:199]
    ds_read_b64_tr_b16 a[120:121], v223 offset:24576
    v_mfma_f32_16x16x32_bf16 v[200:203], v[124:127], a[104:107], v[200:203]
    s_add_u32 m0, s31, 0x8000
    v_sub_f32 v10, v10, v233
    v_exp_f32 v10, v10
    v_mfma_f32_16x16x32_bf16 v[200:203], v[128:131], a[108:111], v[200:203]
    ds_read_b64_tr_b16 a[122:123], v223 offset:26624
    v_cvt_pk_bf16_f32 v64, v8, v9
    v_mfma_f32_16x16x32_bf16 v[200:203], v[92:95], a[96:99], v[200:203]
    v_sub_f32 v11, v11, v233
    v_exp_f32 v11, v11
    v_mfma_f32_16x16x32_bf16 v[200:203], v[96:99], a[100:103], v[200:203]
    global_load_lds_dwordx4 v228, s[74:75] nt
    v_mfma_f32_16x16x32_bf16 a[48:51], v[100:103], a[96:99], a[48:51]
    ds_read_b128 a[92:95], v215 offset:53248
    v_cvt_pk_bf16_f32 v65, v10, v11
    v_mfma_f32_16x16x32_bf16 a[48:51], v[104:107], a[100:103], a[48:51]
    ds_read_b64_tr_b16 a[124:125], v223 offset:28672
    v_mfma_f32_16x16x32_bf16 a[48:51], v[132:135], a[104:107], a[48:51]
    ds_read_b64_tr_b16 a[126:127], v223 offset:30720
    v_mfma_f32_16x16x32_bf16 a[48:51], v[136:139], a[108:111], a[48:51]
    global_load_lds_dwordx4 v229, s[74:75] offset:1024 nt
    v_mfma_f32_16x16x32_bf16 a[52:55], v[140:143], a[104:107], a[52:55]
    s_add_u32 s32, s67, 0x48000
    v_sub_f32 v12, v12, v234
    v_exp_f32 v12, v12
    v_mfma_f32_16x16x32_bf16 a[52:55], v[144:147], a[108:111], a[52:55]
    s_and_b32 s32, s32, 0x7ffff
    v_sub_f32 v13, v13, v234
    v_exp_f32 v13, v13
    v_mfma_f32_16x16x32_bf16 a[52:55], v[108:111], a[96:99], a[52:55]
    v_sub_f32 v14, v14, v234
    v_exp_f32 v14, v14
    v_mfma_f32_16x16x32_bf16 a[52:55], v[112:115], a[100:103], a[52:55]
    s_waitcnt vmcnt(10) lgkmcnt(0)
    v_sub_f32 v15, v15, v234
    v_exp_f32 v15, v15
    v_smfmac_f32_16x16x64_bf16 a[136:139], a[144:147], v[36:43], v236
    s_barrier
    v_mfma_f32_16x16x32_bf16 v[4:7], a[80:83], a[148:151], 0
    s_add_u32 s72, s14, s32
    v_sub_f32 v16, v16, v235
    v_exp_f32 v16, v16
    v_mfma_f32_16x16x32_bf16 v[4:7], a[84:87], a[152:155], v[4:7]
    ds_read_b128 a[64:67], v212
    v_cvt_pk_bf16_f32 v73, v14, v15
    v_mfma_f32_16x16x32_bf16 v[4:7], a[88:91], a[156:159], v[4:7]
    s_addc_u32 s73, s15, 0
    v_sub_f32 v17, v17, v235
    v_exp_f32 v17, v17
    v_mfma_f32_16x16x32_bf16 v[4:7], a[92:95], a[160:163], v[4:7]
    ds_read_b64_tr_b16 a[96:97], v220 offset:32768
    v_cvt_pk_bf16_f32 v72, v12, v13
    v_mfma_f32_16x16x32_bf16 v[8:11], a[88:91], a[172:175], 0
    v_sub_f32 v18, v18, v235
    v_exp_f32 v18, v18
    v_mfma_f32_16x16x32_bf16 v[8:11], a[92:95], a[176:179], v[8:11]
    ds_read_b64_tr_b16 a[98:99], v220 offset:34816
    v_cvt_pk_bf16_f32 v80, v16, v17
    v_mfma_f32_16x16x32_bf16 v[8:11], a[80:83], a[164:167], v[8:11]
    v_sub_f32 v19, v19, v235
    v_exp_f32 v19, v19
    v_mfma_f32_16x16x32_bf16 v[8:11], a[84:87], a[168:171], v[8:11]
    global_load_lds_dwordx4 v228, s[74:75] offset:2048 nt
    v_mfma_f32_16x16x32_bf16 v[12:15], a[80:83], a[180:183], 0
    v_sub_f32 v4, v4, v232
    v_exp_f32 v4, v4
    v_mfma_f32_16x16x32_bf16 v[12:15], a[84:87], a[184:187], v[12:15]
    ds_read_b128 a[68:71], v213
    v_cvt_pk_bf16_f32 v81, v18, v19
    v_mfma_f32_16x16x32_bf16 v[12:15], a[88:91], a[188:191], v[12:15]
    v_sub_f32 v5, v5, v232
    v_exp_f32 v5, v5
    v_mfma_f32_16x16x32_bf16 v[12:15], a[92:95], a[192:195], v[12:15]
    ds_read_b64_tr_b16 a[100:101], v220 offset:36864
    v_mfma_f32_16x16x32_bf16 v[16:19], a[88:91], a[204:207], 0
    v_sub_f32 v6, v6, v232
    v_exp_f32 v6, v6
    v_mfma_f32_16x16x32_bf16 v[16:19], a[92:95], a[208:211], v[16:19]
    ds_read_b64_tr_b16 a[102:103], v220 offset:38912
    v_cvt_pk_bf16_f32 v58, v4, v5
    v_mfma_f32_16x16x32_bf16 v[16:19], a[80:83], a[196:199], v[16:19]
    v_sub_f32 v7, v7, v232
    v_exp_f32 v7, v7
    v_mfma_f32_16x16x32_bf16 v[16:19], a[84:87], a[200:203], v[16:19]
    global_load_lds_dwordx4 v229, s[74:75] offset:3072 nt
    v_mfma_f32_16x16x32_bf16 v[204:207], v[84:87], a[112:115], v[204:207]
    v_sub_f32 v8, v8, v233
    v_exp_f32 v8, v8
    v_mfma_f32_16x16x32_bf16 v[204:207], v[88:91], a[116:119], v[204:207]
    ds_read_b128 a[72:75], v214
    v_cvt_pk_bf16_f32 v59, v6, v7
    v_mfma_f32_16x16x32_bf16 v[204:207], v[116:119], a[120:123], v[204:207]
    v_sub_f32 v9, v9, v233
    v_exp_f32 v9, v9
    v_mfma_f32_16x16x32_bf16 v[204:207], v[120:123], a[124:127], v[204:207]
    ds_read_b64_tr_b16 a[104:105], v220 offset:40960
    v_mfma_f32_16x16x32_bf16 v[208:211], v[124:127], a[120:123], v[208:211]
    s_add_u32 m0, s33, 0x2000
    v_sub_f32 v10, v10, v233
    v_exp_f32 v10, v10
    v_mfma_f32_16x16x32_bf16 v[208:211], v[128:131], a[124:127], v[208:211]
    ds_read_b64_tr_b16 a[106:107], v220 offset:43008
    v_cvt_pk_bf16_f32 v66, v8, v9
    v_mfma_f32_16x16x32_bf16 v[208:211], v[92:95], a[112:115], v[208:211]
    v_sub_f32 v11, v11, v233
    v_exp_f32 v11, v11
    v_mfma_f32_16x16x32_bf16 v[208:211], v[96:99], a[116:119], v[208:211]
    global_load_lds_dwordx4 v224, s[72:73] nt
    v_mfma_f32_16x16x32_bf16 a[56:59], v[100:103], a[112:115], a[56:59]
    s_add_u32 s32, s65, 0x58000
    v_sub_f32 v12, v12, v234
    v_exp_f32 v12, v12
    v_mfma_f32_16x16x32_bf16 a[56:59], v[104:107], a[116:119], a[56:59]
    ds_read_b128 a[76:79], v215
    v_cvt_pk_bf16_f32 v67, v10, v11
    v_mfma_f32_16x16x32_bf16 a[56:59], v[132:135], a[120:123], a[56:59]
    s_and_b32 s32, s32, 0x7ffff
    v_sub_f32 v13, v13, v234
    v_exp_f32 v13, v13
    v_mfma_f32_16x16x32_bf16 a[56:59], v[136:139], a[124:127], a[56:59]
    ds_read_b64_tr_b16 a[108:109], v220 offset:45056
    v_mfma_f32_16x16x32_bf16 a[60:63], v[140:143], a[120:123], a[60:63]
    v_sub_f32 v14, v14, v234
    v_exp_f32 v14, v14
    v_mfma_f32_16x16x32_bf16 a[60:63], v[144:147], a[124:127], a[60:63]
    ds_read_b64_tr_b16 a[110:111], v220 offset:47104
    v_cvt_pk_bf16_f32 v74, v12, v13
    v_mfma_f32_16x16x32_bf16 a[60:63], v[108:111], a[112:115], a[60:63]
    s_waitcnt lgkmcnt(2)
    v_sub_f32 v15, v15, v234
    v_exp_f32 v15, v15
    v_mfma_f32_16x16x32_bf16 a[60:63], v[112:115], a[116:119], a[60:63]
    global_load_lds_dwordx4 v225, s[72:73] offset:1024 nt
    v_smfmac_f32_16x16x64_bf16 a[140:143], a[144:147], v[44:51], v236
    v_mfma_f32_16x16x32_bf16 v[4:7], a[64:67], a[148:151], 0
    s_add_u32 s74, s12, s32
    v_sub_f32 v16, v16, v235
    v_exp_f32 v16, v16
    v_mfma_f32_16x16x32_bf16 v[4:7], a[68:71], a[152:155], v[4:7]
    ds_read_b128 a[80:83], v212 offset:4096
    v_cvt_pk_bf16_f32 v75, v14, v15
    v_mfma_f32_16x16x32_bf16 v[4:7], a[72:75], a[156:159], v[4:7]
    s_addc_u32 s75, s13, 0
    v_sub_f32 v17, v17, v235
    v_exp_f32 v17, v17
    v_mfma_f32_16x16x32_bf16 v[4:7], a[76:79], a[160:163], v[4:7]
    ds_read_b64_tr_b16 a[112:113], v221 offset:32768
    v_mfma_f32_16x16x32_bf16 v[8:11], a[72:75], a[172:175], 0
    v_sub_f32 v18, v18, v235
    v_exp_f32 v18, v18
    v_mfma_f32_16x16x32_bf16 v[8:11], a[76:79], a[176:179], v[8:11]
    ds_read_b64_tr_b16 a[114:115], v221 offset:34816
    v_cvt_pk_bf16_f32 v82, v16, v17
    v_mfma_f32_16x16x32_bf16 v[8:11], a[64:67], a[164:167], v[8:11]
    s_waitcnt lgkmcnt(3)
    v_sub_f32 v19, v19, v235
    v_exp_f32 v19, v19
    v_mfma_f32_16x16x32_bf16 v[8:11], a[68:71], a[168:171], v[8:11]
    global_load_lds_dwordx4 v226, s[72:73] offset:2048 nt
    v_mfma_f32_16x16x32_bf16 v[12:15], a[64:67], a[180:183], 0
    v_sub_f32 v4, v4, v232
    v_exp_f32 v4, v4
    v_mfma_f32_16x16x32_bf16 v[12:15], a[68:71], a[184:187], v[12:15]
    ds_read_b128 a[84:87], v213 offset:4096
    v_cvt_pk_bf16_f32 v83, v18, v19
    v_mfma_f32_16x16x32_bf16 v[12:15], a[72:75], a[188:191], v[12:15]
    v_sub_f32 v5, v5, v232
    v_exp_f32 v5, v5
    v_mfma_f32_16x16x32_bf16 v[12:15], a[76:79], a[192:195], v[12:15]
    ds_read_b64_tr_b16 a[116:117], v221 offset:36864
    v_mfma_f32_16x16x32_bf16 v[16:19], a[72:75], a[204:207], 0
    v_sub_f32 v6, v6, v232
    v_exp_f32 v6, v6
    v_mfma_f32_16x16x32_bf16 v[16:19], a[76:79], a[208:211], v[16:19]
    ds_read_b64_tr_b16 a[118:119], v221 offset:38912
    v_cvt_pk_bf16_f32 v84, v4, v5
    v_mfma_f32_16x16x32_bf16 v[16:19], a[64:67], a[196:199], v[16:19]
    v_sub_f32 v7, v7, v232
    v_exp_f32 v7, v7
    v_mfma_f32_16x16x32_bf16 v[16:19], a[68:71], a[200:203], v[16:19]
    global_load_lds_dwordx4 v227, s[72:73] offset:3072 nt
    v_mfma_f32_16x16x32_bf16 v[148:151], v[20:23], a[96:99], v[148:151]
    v_sub_f32 v8, v8, v233
    v_exp_f32 v8, v8
    v_mfma_f32_16x16x32_bf16 v[148:151], v[24:27], a[100:103], v[148:151]
    ds_read_b128 a[88:91], v214 offset:4096
    v_cvt_pk_bf16_f32 v85, v6, v7
    v_mfma_f32_16x16x32_bf16 v[148:151], v[52:55], a[104:107], v[148:151]
    v_sub_f32 v9, v9, v233
    v_exp_f32 v9, v9
    v_mfma_f32_16x16x32_bf16 v[148:151], v[56:59], a[108:111], v[148:151]
    ds_read_b64_tr_b16 a[120:121], v221 offset:40960
    v_mfma_f32_16x16x32_bf16 v[152:155], v[60:63], a[104:107], v[152:155]
    s_add_u32 m0, s31, 0xc000
    v_sub_f32 v10, v10, v233
    v_exp_f32 v10, v10
    v_mfma_f32_16x16x32_bf16 v[152:155], v[64:67], a[108:111], v[152:155]
    ds_read_b64_tr_b16 a[122:123], v221 offset:43008
    v_cvt_pk_bf16_f32 v92, v8, v9
    v_mfma_f32_16x16x32_bf16 v[152:155], v[28:31], a[96:99], v[152:155]
    v_sub_f32 v11, v11, v233
    v_exp_f32 v11, v11
    v_mfma_f32_16x16x32_bf16 v[152:155], v[32:35], a[100:103], v[152:155]
    global_load_lds_dwordx4 v228, s[74:75] nt
    v_mfma_f32_16x16x32_bf16 a[0:3], v[36:39], a[96:99], a[0:3]
    ds_read_b128 a[92:95], v215 offset:4096
    v_cvt_pk_bf16_f32 v93, v10, v11
    v_mfma_f32_16x16x32_bf16 a[0:3], v[40:43], a[100:103], a[0:3]
    ds_read_b64_tr_b16 a[124:125], v221 offset:45056
    v_mfma_f32_16x16x32_bf16 a[0:3], v[68:71], a[104:107], a[0:3]
    ds_read_b64_tr_b16 a[126:127], v221 offset:47104
    v_mfma_f32_16x16x32_bf16 a[0:3], v[72:75], a[108:111], a[0:3]
    global_load_lds_dwordx4 v229, s[74:75] offset:1024 nt
    v_mfma_f32_16x16x32_bf16 a[4:7], v[76:79], a[104:107], a[4:7]
    s_add_u32 s32, s66, 0x50000
    v_sub_f32 v12, v12, v234
    v_exp_f32 v12, v12
    v_mfma_f32_16x16x32_bf16 a[4:7], v[80:83], a[108:111], a[4:7]
    s_and_b32 s32, s32, 0x7ffff
    v_sub_f32 v13, v13, v234
    v_exp_f32 v13, v13
    v_mfma_f32_16x16x32_bf16 a[4:7], v[44:47], a[96:99], a[4:7]
M_stub6:
    s_cbranch_execz M_stub10
    v_sub_f32 v14, v14, v234
    v_exp_f32 v14, v14
    v_mfma_f32_16x16x32_bf16 a[4:7], v[48:51], a[100:103], a[4:7]
    s_waitcnt vmcnt(14) lgkmcnt(0)
    v_sub_f32 v15, v15, v234
    v_exp_f32 v15, v15
    v_smfmac_f32_16x16x64_bf16 a[128:131], a[144:147], v[52:59], v236
    s_barrier
    v_mfma_f32_16x16x32_bf16 v[4:7], a[80:83], a[148:151], 0
    s_add_u32 s72, s14, s32
    v_sub_f32 v16, v16, v235
    v_exp_f32 v16, v16
    v_mfma_f32_16x16x32_bf16 v[4:7], a[84:87], a[152:155], v[4:7]
    ds_read_b128 a[64:67], v212 offset:16384
    v_cvt_pk_bf16_f32 v101, v14, v15
    v_mfma_f32_16x16x32_bf16 v[4:7], a[88:91], a[156:159], v[4:7]
    s_addc_u32 s73, s15, 0
    v_sub_f32 v17, v17, v235
    v_exp_f32 v17, v17
    v_mfma_f32_16x16x32_bf16 v[4:7], a[92:95], a[160:163], v[4:7]
    ds_read_b64_tr_b16 a[96:97], v222 offset:32768
    v_cvt_pk_bf16_f32 v100, v12, v13
    v_mfma_f32_16x16x32_bf16 v[8:11], a[88:91], a[172:175], 0
    v_sub_f32 v18, v18, v235
    v_exp_f32 v18, v18
    v_mfma_f32_16x16x32_bf16 v[8:11], a[92:95], a[176:179], v[8:11]
    ds_read_b64_tr_b16 a[98:99], v222 offset:34816
    v_cvt_pk_bf16_f32 v108, v16, v17
    v_mfma_f32_16x16x32_bf16 v[8:11], a[80:83], a[164:167], v[8:11]
    v_sub_f32 v19, v19, v235
    v_exp_f32 v19, v19
    v_mfma_f32_16x16x32_bf16 v[8:11], a[84:87], a[168:171], v[8:11]
    global_load_lds_dwordx4 v228, s[74:75] offset:2048 nt
    v_mfma_f32_16x16x32_bf16 v[12:15], a[80:83], a[180:183], 0
    v_sub_f32 v4, v4, v232
    v_exp_f32 v4, v4
    v_mfma_f32_16x16x32_bf16 v[12:15], a[84:87], a[184:187], v[12:15]
    ds_read_b128 a[68:71], v213 offset:16384
    v_cvt_pk_bf16_f32 v109, v18, v19
    v_mfma_f32_16x16x32_bf16 v[12:15], a[88:91], a[188:191], v[12:15]
    v_sub_f32 v5, v5, v232
    v_exp_f32 v5, v5
    v_mfma_f32_16x16x32_bf16 v[12:15], a[92:95], a[192:195], v[12:15]
    ds_read_b64_tr_b16 a[100:101], v222 offset:36864
    v_mfma_f32_16x16x32_bf16 v[16:19], a[88:91], a[204:207], 0
    v_sub_f32 v6, v6, v232
    v_exp_f32 v6, v6
    v_mfma_f32_16x16x32_bf16 v[16:19], a[92:95], a[208:211], v[16:19]
    ds_read_b64_tr_b16 a[102:103], v222 offset:38912
    v_cvt_pk_bf16_f32 v86, v4, v5
    v_mfma_f32_16x16x32_bf16 v[16:19], a[80:83], a[196:199], v[16:19]
    v_sub_f32 v7, v7, v232
    v_exp_f32 v7, v7
    v_mfma_f32_16x16x32_bf16 v[16:19], a[84:87], a[200:203], v[16:19]
    global_load_lds_dwordx4 v229, s[74:75] offset:3072 nt
    v_mfma_f32_16x16x32_bf16 v[156:159], v[20:23], a[112:115], v[156:159]
    v_sub_f32 v8, v8, v233
    v_exp_f32 v8, v8
    v_mfma_f32_16x16x32_bf16 v[156:159], v[24:27], a[116:119], v[156:159]
    ds_read_b128 a[72:75], v214 offset:16384
    v_cvt_pk_bf16_f32 v87, v6, v7
    v_mfma_f32_16x16x32_bf16 v[156:159], v[52:55], a[120:123], v[156:159]
    v_sub_f32 v9, v9, v233
    v_exp_f32 v9, v9
    v_mfma_f32_16x16x32_bf16 v[156:159], v[56:59], a[124:127], v[156:159]
    ds_read_b64_tr_b16 a[104:105], v222 offset:40960
    v_mfma_f32_16x16x32_bf16 v[160:163], v[60:63], a[120:123], v[160:163]
    s_add_u32 m0, s33, 0x4000
    v_sub_f32 v10, v10, v233
    v_exp_f32 v10, v10
    v_mfma_f32_16x16x32_bf16 v[160:163], v[64:67], a[124:127], v[160:163]
    ds_read_b64_tr_b16 a[106:107], v222 offset:43008
    v_cvt_pk_bf16_f32 v94, v8, v9
    v_mfma_f32_16x16x32_bf16 v[160:163], v[28:31], a[112:115], v[160:163]
    v_sub_f32 v11, v11, v233
    v_exp_f32 v11, v11
    v_mfma_f32_16x16x32_bf16 v[160:163], v[32:35], a[116:119], v[160:163]
    global_load_lds_dwordx4 v224, s[72:73] nt
    v_mfma_f32_16x16x32_bf16 a[8:11], v[36:39], a[112:115], a[8:11]
    s_add_u32 s32, s64, 0x60000
    v_sub_f32 v12, v12, v234
    v_exp_f32 v12, v12
    v_mfma_f32_16x16x32_bf16 a[8:11], v[40:43], a[116:119], a[8:11]
    ds_read_b128 a[76:79], v215 offset:16384
    v_cvt_pk_bf16_f32 v95, v10, v11
    v_mfma_f32_16x16x32_bf16 a[8:11], v[68:71], a[120:123], a[8:11]
    s_and_b32 s32, s32, 0x7ffff
    v_sub_f32 v13, v13, v234
    v_exp_f32 v13, v13
    v_mfma_f32_16x16x32_bf16 a[8:11], v[72:75], a[124:127], a[8:11]
    ds_read_b64_tr_b16 a[108:109], v222 offset:45056
    v_mfma_f32_16x16x32_bf16 a[12:15], v[76:79], a[120:123], a[12:15]
    v_sub_f32 v14, v14, v234
    v_exp_f32 v14, v14
    v_mfma_f32_16x16x32_bf16 a[12:15], v[80:83], a[124:127], a[12:15]
    ds_read_b64_tr_b16 a[110:111], v222 offset:47104
    v_cvt_pk_bf16_f32 v102, v12, v13
    v_mfma_f32_16x16x32_bf16 a[12:15], v[44:47], a[112:115], a[12:15]
    s_waitcnt lgkmcnt(2)
    v_sub_f32 v15, v15, v234
    v_exp_f32 v15, v15
    v_mfma_f32_16x16x32_bf16 a[12:15], v[48:51], a[116:119], a[12:15]
    global_load_lds_dwordx4 v225, s[72:73] offset:1024 nt
    v_smfmac_f32_16x16x64_bf16 a[132:135], a[144:147], v[60:67], v236
    v_mfma_f32_16x16x32_bf16 v[4:7], a[64:67], a[148:151], 0
    s_add_u32 s74, s12, s32
    v_sub_f32 v16, v16, v235
    v_exp_f32 v16, v16
    v_mfma_f32_16x16x32_bf16 v[4:7], a[68:71], a[152:155], v[4:7]
    ds_read_b128 a[80:83], v212 offset:20480
    v_cvt_pk_bf16_f32 v103, v14, v15
    v_mfma_f32_16x16x32_bf16 v[4:7], a[72:75], a[156:159], v[4:7]
    s_addc_u32 s75, s13, 0
    v_sub_f32 v17, v17, v235
    v_exp_f32 v17, v17
    v_mfma_f32_16x16x32_bf16 v[4:7], a[76:79], a[160:163], v[4:7]
    ds_read_b64_tr_b16 a[112:113], v223 offset:32768
    v_mfma_f32_16x16x32_bf16 v[8:11], a[72:75], a[172:175], 0
    v_sub_f32 v18, v18, v235
    v_exp_f32 v18, v18
    v_mfma_f32_16x16x32_bf16 v[8:11], a[76:79], a[176:179], v[8:11]
    ds_read_b64_tr_b16 a[114:115], v223 offset:34816
    v_cvt_pk_bf16_f32 v110, v16, v17
    v_mfma_f32_16x16x32_bf16 v[8:11], a[64:67], a[164:167], v[8:11]
    s_waitcnt lgkmcnt(3)
    v_sub_f32 v19, v19, v235
    v_exp_f32 v19, v19
    v_mfma_f32_16x16x32_bf16 v[8:11], a[68:71], a[168:171], v[8:11]
    global_load_lds_dwordx4 v226, s[72:73] offset:2048 nt
    v_mfma_f32_16x16x32_bf16 v[12:15], a[64:67], a[180:183], 0
    v_sub_f32 v4, v4, v232
    v_exp_f32 v4, v4
    v_mfma_f32_16x16x32_bf16 v[12:15], a[68:71], a[184:187], v[12:15]
    ds_read_b128 a[84:87], v213 offset:20480
    v_cvt_pk_bf16_f32 v111, v18, v19
    v_mfma_f32_16x16x32_bf16 v[12:15], a[72:75], a[188:191], v[12:15]
    v_sub_f32 v5, v5, v232
    v_exp_f32 v5, v5
    v_mfma_f32_16x16x32_bf16 v[12:15], a[76:79], a[192:195], v[12:15]
    ds_read_b64_tr_b16 a[116:117], v223 offset:36864
    v_mfma_f32_16x16x32_bf16 v[16:19], a[72:75], a[204:207], 0
    v_sub_f32 v6, v6, v232
    v_exp_f32 v6, v6
    v_mfma_f32_16x16x32_bf16 v[16:19], a[76:79], a[208:211], v[16:19]
    ds_read_b64_tr_b16 a[118:119], v223 offset:38912
    v_cvt_pk_bf16_f32 v88, v4, v5
    v_mfma_f32_16x16x32_bf16 v[16:19], a[64:67], a[196:199], v[16:19]
    v_sub_f32 v7, v7, v232
    v_exp_f32 v7, v7
    v_mfma_f32_16x16x32_bf16 v[16:19], a[68:71], a[200:203], v[16:19]
    global_load_lds_dwordx4 v227, s[72:73] offset:3072 nt
    v_mfma_f32_16x16x32_bf16 v[164:167], v[20:23], a[96:99], v[164:167]
    v_sub_f32 v8, v8, v233
    v_exp_f32 v8, v8
    v_mfma_f32_16x16x32_bf16 v[164:167], v[24:27], a[100:103], v[164:167]
    ds_read_b128 a[88:91], v214 offset:20480
    v_cvt_pk_bf16_f32 v89, v6, v7
    v_mfma_f32_16x16x32_bf16 v[164:167], v[52:55], a[104:107], v[164:167]
    v_sub_f32 v9, v9, v233
    v_exp_f32 v9, v9
    v_mfma_f32_16x16x32_bf16 v[164:167], v[56:59], a[108:111], v[164:167]
    ds_read_b64_tr_b16 a[120:121], v223 offset:40960
    v_mfma_f32_16x16x32_bf16 v[168:171], v[60:63], a[104:107], v[168:171]
    s_add_u32 m0, s31, 0x0
    v_sub_f32 v10, v10, v233
    v_exp_f32 v10, v10
    v_mfma_f32_16x16x32_bf16 v[168:171], v[64:67], a[108:111], v[168:171]
    ds_read_b64_tr_b16 a[122:123], v223 offset:43008
    v_cvt_pk_bf16_f32 v96, v8, v9
    v_mfma_f32_16x16x32_bf16 v[168:171], v[28:31], a[96:99], v[168:171]
    v_sub_f32 v11, v11, v233
    v_exp_f32 v11, v11
    v_mfma_f32_16x16x32_bf16 v[168:171], v[32:35], a[100:103], v[168:171]
    global_load_lds_dwordx4 v228, s[74:75] nt
    v_mfma_f32_16x16x32_bf16 a[16:19], v[36:39], a[96:99], a[16:19]
    ds_read_b128 a[92:95], v215 offset:20480
    v_cvt_pk_bf16_f32 v97, v10, v11
    v_mfma_f32_16x16x32_bf16 a[16:19], v[40:43], a[100:103], a[16:19]
    ds_read_b64_tr_b16 a[124:125], v223 offset:45056
    v_mfma_f32_16x16x32_bf16 a[16:19], v[68:71], a[104:107], a[16:19]
    ds_read_b64_tr_b16 a[126:127], v223 offset:47104
    v_mfma_f32_16x16x32_bf16 a[16:19], v[72:75], a[108:111], a[16:19]
    global_load_lds_dwordx4 v229, s[74:75] offset:1024 nt
    v_mfma_f32_16x16x32_bf16 a[20:23], v[76:79], a[104:107], a[20:23]
    s_add_u32 s32, s66, 0x58000
    v_sub_f32 v12, v12, v234
    v_exp_f32 v12, v12
    v_mfma_f32_16x16x32_bf16 a[20:23], v[80:83], a[108:111], a[20:23]
    s_and_b32 s32, s32, 0x7ffff
    v_sub_f32 v13, v13, v234
    v_exp_f32 v13, v13
    v_mfma_f32_16x16x32_bf16 a[20:23], v[44:47], a[96:99], a[20:23]
    v_sub_f32 v14, v14, v234
    v_exp_f32 v14, v14
    v_mfma_f32_16x16x32_bf16 a[20:23], v[48:51], a[100:103], a[20:23]
    s_waitcnt vmcnt(10) lgkmcnt(0)
    v_sub_f32 v15, v15, v234
    v_exp_f32 v15, v15
    v_smfmac_f32_16x16x64_bf16 a[136:139], a[144:147], v[68:75], v236
    s_barrier
    v_mfma_f32_16x16x32_bf16 v[4:7], a[80:83], a[148:151], 0
    s_add_u32 s72, s14, s32
    v_sub_f32 v16, v16, v235
    v_exp_f32 v16, v16
    v_mfma_f32_16x16x32_bf16 v[4:7], a[84:87], a[152:155], v[4:7]
    ds_read_b128 a[64:67], v212 offset:32768
    v_cvt_pk_bf16_f32 v105, v14, v15
    v_mfma_f32_16x16x32_bf16 v[4:7], a[88:91], a[156:159], v[4:7]
    s_addc_u32 s73, s15, 0
    v_sub_f32 v17, v17, v235
    v_exp_f32 v17, v17
    v_mfma_f32_16x16x32_bf16 v[4:7], a[92:95], a[160:163], v[4:7]
    ds_read_b64_tr_b16 a[96:97], v220
    v_cvt_pk_bf16_f32 v104, v12, v13
    v_mfma_f32_16x16x32_bf16 v[8:11], a[88:91], a[172:175], 0
    v_sub_f32 v18, v18, v235
    v_exp_f32 v18, v18
    v_mfma_f32_16x16x32_bf16 v[8:11], a[92:95], a[176:179], v[8:11]
    ds_read_b64_tr_b16 a[98:99], v220 offset:2048
    v_cvt_pk_bf16_f32 v112, v16, v17
    v_mfma_f32_16x16x32_bf16 v[8:11], a[80:83], a[164:167], v[8:11]
    v_sub_f32 v19, v19, v235
    v_exp_f32 v19, v19
    v_mfma_f32_16x16x32_bf16 v[8:11], a[84:87], a[168:171], v[8:11]
    global_load_lds_dwordx4 v228, s[74:75] offset:2048 nt
    v_mfma_f32_16x16x32_bf16 v[12:15], a[80:83], a[180:183], 0
    v_sub_f32 v4, v4, v232
    v_exp_f32 v4, v4
    v_mfma_f32_16x16x32_bf16 v[12:15], a[84:87], a[184:187], v[12:15]
    ds_read_b128 a[68:71], v213 offset:32768
    v_cvt_pk_bf16_f32 v113, v18, v19
    v_mfma_f32_16x16x32_bf16 v[12:15], a[88:91], a[188:191], v[12:15]
    v_sub_f32 v5, v5, v232
    v_exp_f32 v5, v5
    v_mfma_f32_16x16x32_bf16 v[12:15], a[92:95], a[192:195], v[12:15]
    ds_read_b64_tr_b16 a[100:101], v220 offset:4096
    v_mfma_f32_16x16x32_bf16 v[16:19], a[88:91], a[204:207], 0
    v_sub_f32 v6, v6, v232
    v_exp_f32 v6, v6
    v_mfma_f32_16x16x32_bf16 v[16:19], a[92:95], a[208:211], v[16:19]
    ds_read_b64_tr_b16 a[102:103], v220 offset:6144
    v_cvt_pk_bf16_f32 v90, v4, v5
    v_mfma_f32_16x16x32_bf16 v[16:19], a[80:83], a[196:199], v[16:19]
    v_sub_f32 v7, v7, v232
    v_exp_f32 v7, v7
    v_mfma_f32_16x16x32_bf16 v[16:19], a[84:87], a[200:203], v[16:19]
    global_load_lds_dwordx4 v229, s[74:75] offset:3072 nt
    v_mfma_f32_16x16x32_bf16 v[172:175], v[20:23], a[112:115], v[172:175]
    v_sub_f32 v8, v8, v233
    v_exp_f32 v8, v8
    v_mfma_f32_16x16x32_bf16 v[172:175], v[24:27], a[116:119], v[172:175]
    ds_read_b128 a[72:75], v214 offset:32768
    v_cvt_pk_bf16_f32 v91, v6, v7
    v_mfma_f32_16x16x32_bf16 v[172:175], v[52:55], a[120:123], v[172:175]
    v_sub_f32 v9, v9, v233
    v_exp_f32 v9, v9
    v_mfma_f32_16x16x32_bf16 v[172:175], v[56:59], a[124:127], v[172:175]
    ds_read_b64_tr_b16 a[104:105], v220 offset:8192
    v_mfma_f32_16x16x32_bf16 v[176:179], v[60:63], a[120:123], v[176:179]
    s_add_u32 m0, s33, 0x6000
    v_sub_f32 v10, v10, v233
    v_exp_f32 v10, v10
    v_mfma_f32_16x16x32_bf16 v[176:179], v[64:67], a[124:127], v[176:179]
    ds_read_b64_tr_b16 a[106:107], v220 offset:10240
    v_cvt_pk_bf16_f32 v98, v8, v9
    v_mfma_f32_16x16x32_bf16 v[176:179], v[28:31], a[112:115], v[176:179]
    v_sub_f32 v11, v11, v233
    v_exp_f32 v11, v11
    v_mfma_f32_16x16x32_bf16 v[176:179], v[32:35], a[116:119], v[176:179]
    global_load_lds_dwordx4 v224, s[72:73] nt
    v_mfma_f32_16x16x32_bf16 a[24:27], v[36:39], a[112:115], a[24:27]
    s_add_u32 s32, s65, 0x60000
    v_sub_f32 v12, v12, v234
    v_exp_f32 v12, v12
    v_mfma_f32_16x16x32_bf16 a[24:27], v[40:43], a[116:119], a[24:27]
    ds_read_b128 a[76:79], v215 offset:32768
    v_cvt_pk_bf16_f32 v99, v10, v11
    v_mfma_f32_16x16x32_bf16 a[24:27], v[68:71], a[120:123], a[24:27]
    s_and_b32 s32, s32, 0x7ffff
    v_sub_f32 v13, v13, v234
    v_exp_f32 v13, v13
    v_mfma_f32_16x16x32_bf16 a[24:27], v[72:75], a[124:127], a[24:27]
    ds_read_b64_tr_b16 a[108:109], v220 offset:12288
    v_mfma_f32_16x16x32_bf16 a[28:31], v[76:79], a[120:123], a[28:31]
    v_sub_f32 v14, v14, v234
    v_exp_f32 v14, v14
    v_mfma_f32_16x16x32_bf16 a[28:31], v[80:83], a[124:127], a[28:31]
    ds_read_b64_tr_b16 a[110:111], v220 offset:14336
    v_cvt_pk_bf16_f32 v106, v12, v13
    v_mfma_f32_16x16x32_bf16 a[28:31], v[44:47], a[112:115], a[28:31]
    s_waitcnt lgkmcnt(2)
    v_sub_f32 v15, v15, v234
    v_exp_f32 v15, v15
    v_mfma_f32_16x16x32_bf16 a[28:31], v[48:51], a[116:119], a[28:31]
    global_load_lds_dwordx4 v225, s[72:73] offset:1024 nt
    v_smfmac_f32_16x16x64_bf16 a[140:143], a[144:147], v[76:83], v236
    v_mfma_f32_16x16x32_bf16 v[4:7], a[64:67], a[148:151], 0
    s_add_u32 s74, s12, s32
    v_sub_f32 v16, v16, v235
    v_exp_f32 v16, v16
    v_mfma_f32_16x16x32_bf16 v[4:7], a[68:71], a[152:155], v[4:7]
    ds_read_b128 a[80:83], v212 offset:36864
    v_cvt_pk_bf16_f32 v107, v14, v15
    v_mfma_f32_16x16x32_bf16 v[4:7], a[72:75], a[156:159], v[4:7]
    s_addc_u32 s75, s13, 0
    v_sub_f32 v17, v17, v235
    v_exp_f32 v17, v17
    v_mfma_f32_16x16x32_bf16 v[4:7], a[76:79], a[160:163], v[4:7]
    ds_read_b64_tr_b16 a[112:113], v221
    v_mfma_f32_16x16x32_bf16 v[8:11], a[72:75], a[172:175], 0
    v_sub_f32 v18, v18, v235
    v_exp_f32 v18, v18
    v_mfma_f32_16x16x32_bf16 v[8:11], a[76:79], a[176:179], v[8:11]
    ds_read_b64_tr_b16 a[114:115], v221 offset:2048
    v_cvt_pk_bf16_f32 v114, v16, v17
    v_mfma_f32_16x16x32_bf16 v[8:11], a[64:67], a[164:167], v[8:11]
    s_waitcnt lgkmcnt(3)
    v_sub_f32 v19, v19, v235
    v_exp_f32 v19, v19
    v_mfma_f32_16x16x32_bf16 v[8:11], a[68:71], a[168:171], v[8:11]
    global_load_lds_dwordx4 v226, s[72:73] offset:2048 nt
    v_mfma_f32_16x16x32_bf16 v[12:15], a[64:67], a[180:183], 0
    v_sub_f32 v4, v4, v232
    v_exp_f32 v4, v4
    v_mfma_f32_16x16x32_bf16 v[12:15], a[68:71], a[184:187], v[12:15]
    ds_read_b128 a[84:87], v213 offset:36864
    v_cvt_pk_bf16_f32 v115, v18, v19
    v_mfma_f32_16x16x32_bf16 v[12:15], a[72:75], a[188:191], v[12:15]
    v_sub_f32 v5, v5, v232
    v_exp_f32 v5, v5
    v_mfma_f32_16x16x32_bf16 v[12:15], a[76:79], a[192:195], v[12:15]
    ds_read_b64_tr_b16 a[116:117], v221 offset:4096
    v_mfma_f32_16x16x32_bf16 v[16:19], a[72:75], a[204:207], 0
    v_sub_f32 v6, v6, v232
    v_exp_f32 v6, v6
    v_mfma_f32_16x16x32_bf16 v[16:19], a[76:79], a[208:211], v[16:19]
    ds_read_b64_tr_b16 a[118:119], v221 offset:6144
    v_cvt_pk_bf16_f32 v116, v4, v5
    v_mfma_f32_16x16x32_bf16 v[16:19], a[64:67], a[196:199], v[16:19]
    v_sub_f32 v7, v7, v232
    v_exp_f32 v7, v7
    v_mfma_f32_16x16x32_bf16 v[16:19], a[68:71], a[200:203], v[16:19]
    global_load_lds_dwordx4 v227, s[72:73] offset:3072 nt
    v_mfma_f32_16x16x32_bf16 v[180:183], v[20:23], a[96:99], v[180:183]
    v_sub_f32 v8, v8, v233
    v_exp_f32 v8, v8
    v_mfma_f32_16x16x32_bf16 v[180:183], v[24:27], a[100:103], v[180:183]
    ds_read_b128 a[88:91], v214 offset:36864
    v_cvt_pk_bf16_f32 v117, v6, v7
    v_mfma_f32_16x16x32_bf16 v[180:183], v[52:55], a[104:107], v[180:183]
    v_sub_f32 v9, v9, v233
    v_exp_f32 v9, v9
    v_mfma_f32_16x16x32_bf16 v[180:183], v[56:59], a[108:111], v[180:183]
    ds_read_b64_tr_b16 a[120:121], v221 offset:8192
    v_mfma_f32_16x16x32_bf16 v[184:187], v[60:63], a[104:107], v[184:187]
    s_add_u32 m0, s31, 0x4000
    v_sub_f32 v10, v10, v233
    v_exp_f32 v10, v10
    v_mfma_f32_16x16x32_bf16 v[184:187], v[64:67], a[108:111], v[184:187]
    ds_read_b64_tr_b16 a[122:123], v221 offset:10240
    v_cvt_pk_bf16_f32 v124, v8, v9
    v_mfma_f32_16x16x32_bf16 v[184:187], v[28:31], a[96:99], v[184:187]
    v_sub_f32 v11, v11, v233
    v_exp_f32 v11, v11
    v_mfma_f32_16x16x32_bf16 v[184:187], v[32:35], a[100:103], v[184:187]
    global_load_lds_dwordx4 v228, s[74:75] nt
    v_mfma_f32_16x16x32_bf16 a[32:35], v[36:39], a[96:99], a[32:35]
    ds_read_b128 a[92:95], v215 offset:36864
    v_cvt_pk_bf16_f32 v125, v10, v11
    v_mfma_f32_16x16x32_bf16 a[32:35], v[40:43], a[100:103], a[32:35]
    ds_read_b64_tr_b16 a[124:125], v221 offset:12288
    v_mfma_f32_16x16x32_bf16 a[32:35], v[68:71], a[104:107], a[32:35]
    ds_read_b64_tr_b16 a[126:127], v221 offset:14336
    v_mfma_f32_16x16x32_bf16 a[32:35], v[72:75], a[108:111], a[32:35]
    global_load_lds_dwordx4 v229, s[74:75] offset:1024 nt
    v_mfma_f32_16x16x32_bf16 a[36:39], v[76:79], a[104:107], a[36:39]
    s_add_u32 s32, s67, 0x50000
    v_sub_f32 v12, v12, v234
    v_exp_f32 v12, v12
    v_mfma_f32_16x16x32_bf16 a[36:39], v[80:83], a[108:111], a[36:39]
    s_and_b32 s32, s32, 0x7ffff
    v_sub_f32 v13, v13, v234
    v_exp_f32 v13, v13
    v_mfma_f32_16x16x32_bf16 a[36:39], v[44:47], a[96:99], a[36:39]
    v_sub_f32 v14, v14, v234
    v_exp_f32 v14, v14
    v_mfma_f32_16x16x32_bf16 a[36:39], v[48:51], a[100:103], a[36:39]
    s_waitcnt vmcnt(14) lgkmcnt(0)
    v_sub_f32 v15, v15, v234
    v_exp_f32 v15, v15
    v_smfmac_f32_16x16x64_bf16 a[128:131], a[144:147], v[84:91], v236
    s_barrier
    v_mfma_f32_16x16x32_bf16 v[4:7], a[80:83], a[148:151], 0
    s_add_u32 s72, s14, s32
    v_sub_f32 v16, v16, v235
    v_exp_f32 v16, v16
    v_mfma_f32_16x16x32_bf16 v[4:7], a[84:87], a[152:155], v[4:7]
    ds_read_b128 a[64:67], v212 offset:49152
    v_cvt_pk_bf16_f32 v133, v14, v15
    v_mfma_f32_16x16x32_bf16 v[4:7], a[88:91], a[156:159], v[4:7]
    s_addc_u32 s73, s15, 0
    v_sub_f32 v17, v17, v235
    v_exp_f32 v17, v17
    v_mfma_f32_16x16x32_bf16 v[4:7], a[92:95], a[160:163], v[4:7]
    ds_read_b64_tr_b16 a[96:97], v222
    v_cvt_pk_bf16_f32 v132, v12, v13
    v_mfma_f32_16x16x32_bf16 v[8:11], a[88:91], a[172:175], 0
    v_sub_f32 v18, v18, v235
    v_exp_f32 v18, v18
    v_mfma_f32_16x16x32_bf16 v[8:11], a[92:95], a[176:179], v[8:11]
    ds_read_b64_tr_b16 a[98:99], v222 offset:2048
    v_cvt_pk_bf16_f32 v140, v16, v17
    v_mfma_f32_16x16x32_bf16 v[8:11], a[80:83], a[164:167], v[8:11]
    v_sub_f32 v19, v19, v235
    v_exp_f32 v19, v19
    v_mfma_f32_16x16x32_bf16 v[8:11], a[84:87], a[168:171], v[8:11]
    global_load_lds_dwordx4 v228, s[74:75] offset:2048 nt
    v_mfma_f32_16x16x32_bf16 v[12:15], a[80:83], a[180:183], 0
    v_sub_f32 v4, v4, v232
    v_exp_f32 v4, v4
    v_mfma_f32_16x16x32_bf16 v[12:15], a[84:87], a[184:187], v[12:15]
    ds_read_b128 a[68:71], v213 offset:49152
    v_cvt_pk_bf16_f32 v141, v18, v19
    v_mfma_f32_16x16x32_bf16 v[12:15], a[88:91], a[188:191], v[12:15]
    v_sub_f32 v5, v5, v232
    v_exp_f32 v5, v5
    v_mfma_f32_16x16x32_bf16 v[12:15], a[92:95], a[192:195], v[12:15]
    ds_read_b64_tr_b16 a[100:101], v222 offset:4096
    v_mfma_f32_16x16x32_bf16 v[16:19], a[88:91], a[204:207], 0
    v_sub_f32 v6, v6, v232
    v_exp_f32 v6, v6
    v_mfma_f32_16x16x32_bf16 v[16:19], a[92:95], a[208:211], v[16:19]
    ds_read_b64_tr_b16 a[102:103], v222 offset:6144
    v_cvt_pk_bf16_f32 v118, v4, v5
    v_mfma_f32_16x16x32_bf16 v[16:19], a[80:83], a[196:199], v[16:19]
    v_sub_f32 v7, v7, v232
    v_exp_f32 v7, v7
    v_mfma_f32_16x16x32_bf16 v[16:19], a[84:87], a[200:203], v[16:19]
    global_load_lds_dwordx4 v229, s[74:75] offset:3072 nt
    v_mfma_f32_16x16x32_bf16 v[188:191], v[20:23], a[112:115], v[188:191]
    v_sub_f32 v8, v8, v233
    v_exp_f32 v8, v8
    v_mfma_f32_16x16x32_bf16 v[188:191], v[24:27], a[116:119], v[188:191]
    ds_read_b128 a[72:75], v214 offset:49152
    v_cvt_pk_bf16_f32 v119, v6, v7
    v_mfma_f32_16x16x32_bf16 v[188:191], v[52:55], a[120:123], v[188:191]
    v_sub_f32 v9, v9, v233
    v_exp_f32 v9, v9
    v_mfma_f32_16x16x32_bf16 v[188:191], v[56:59], a[124:127], v[188:191]
    ds_read_b64_tr_b16 a[104:105], v222 offset:8192
    v_mfma_f32_16x16x32_bf16 v[192:195], v[60:63], a[120:123], v[192:195]
    s_add_u32 m0, s33, 0x8000
    v_sub_f32 v10, v10, v233
    v_exp_f32 v10, v10
    v_mfma_f32_16x16x32_bf16 v[192:195], v[64:67], a[124:127], v[192:195]
    ds_read_b64_tr_b16 a[106:107], v222 offset:10240
    v_cvt_pk_bf16_f32 v126, v8, v9
    v_mfma_f32_16x16x32_bf16 v[192:195], v[28:31], a[112:115], v[192:195]
    v_sub_f32 v11, v11, v233
    v_exp_f32 v11, v11
    v_mfma_f32_16x16x32_bf16 v[192:195], v[32:35], a[116:119], v[192:195]
    global_load_lds_dwordx4 v224, s[72:73] nt
    v_mfma_f32_16x16x32_bf16 a[40:43], v[36:39], a[112:115], a[40:43]
    s_add_u32 s32, s64, 0x68000
    v_sub_f32 v12, v12, v234
    v_exp_f32 v12, v12
    v_mfma_f32_16x16x32_bf16 a[40:43], v[40:43], a[116:119], a[40:43]
    ds_read_b128 a[76:79], v215 offset:49152
    v_cvt_pk_bf16_f32 v127, v10, v11
    v_mfma_f32_16x16x32_bf16 a[40:43], v[68:71], a[120:123], a[40:43]
    s_and_b32 s32, s32, 0x7ffff
    v_sub_f32 v13, v13, v234
    v_exp_f32 v13, v13
    v_mfma_f32_16x16x32_bf16 a[40:43], v[72:75], a[124:127], a[40:43]
    ds_read_b64_tr_b16 a[108:109], v222 offset:12288
    v_mfma_f32_16x16x32_bf16 a[44:47], v[76:79], a[120:123], a[44:47]
    v_sub_f32 v14, v14, v234
    v_exp_f32 v14, v14
    v_mfma_f32_16x16x32_bf16 a[44:47], v[80:83], a[124:127], a[44:47]
    ds_read_b64_tr_b16 a[110:111], v222 offset:14336
    v_cvt_pk_bf16_f32 v134, v12, v13
    v_mfma_f32_16x16x32_bf16 a[44:47], v[44:47], a[112:115], a[44:47]
    s_waitcnt lgkmcnt(2)
    v_sub_f32 v15, v15, v234
    v_exp_f32 v15, v15
    v_mfma_f32_16x16x32_bf16 a[44:47], v[48:51], a[116:119], a[44:47]
    global_load_lds_dwordx4 v225, s[72:73] offset:1024 nt
    v_smfmac_f32_16x16x64_bf16 a[132:135], a[144:147], v[92:99], v236
    v_mfma_f32_16x16x32_bf16 v[4:7], a[64:67], a[148:151], 0
    s_add_u32 s74, s12, s32
    v_sub_f32 v16, v16, v235
    v_exp_f32 v16, v16
    v_mfma_f32_16x16x32_bf16 v[4:7], a[68:71], a[152:155], v[4:7]
    ds_read_b128 a[80:83], v212 offset:53248
    v_cvt_pk_bf16_f32 v135, v14, v15
    v_mfma_f32_16x16x32_bf16 v[4:7], a[72:75], a[156:159], v[4:7]
    s_addc_u32 s75, s13, 0
    v_sub_f32 v17, v17, v235
    v_exp_f32 v17, v17
    v_mfma_f32_16x16x32_bf16 v[4:7], a[76:79], a[160:163], v[4:7]
    ds_read_b64_tr_b16 a[112:113], v223
    v_mfma_f32_16x16x32_bf16 v[8:11], a[72:75], a[172:175], 0
    v_sub_f32 v18, v18, v235
    v_exp_f32 v18, v18
    v_mfma_f32_16x16x32_bf16 v[8:11], a[76:79], a[176:179], v[8:11]
    ds_read_b64_tr_b16 a[114:115], v223 offset:2048
    v_cvt_pk_bf16_f32 v142, v16, v17
    v_mfma_f32_16x16x32_bf16 v[8:11], a[64:67], a[164:167], v[8:11]
    s_waitcnt lgkmcnt(3)
    v_sub_f32 v19, v19, v235
    v_exp_f32 v19, v19
    v_mfma_f32_16x16x32_bf16 v[8:11], a[68:71], a[168:171], v[8:11]
    global_load_lds_dwordx4 v226, s[72:73] offset:2048 nt
    v_mfma_f32_16x16x32_bf16 v[12:15], a[64:67], a[180:183], 0
    v_sub_f32 v4, v4, v232
    v_exp_f32 v4, v4
    v_mfma_f32_16x16x32_bf16 v[12:15], a[68:71], a[184:187], v[12:15]
    ds_read_b128 a[84:87], v213 offset:53248
    v_cvt_pk_bf16_f32 v143, v18, v19
    v_mfma_f32_16x16x32_bf16 v[12:15], a[72:75], a[188:191], v[12:15]
    v_sub_f32 v5, v5, v232
    v_exp_f32 v5, v5
    v_mfma_f32_16x16x32_bf16 v[12:15], a[76:79], a[192:195], v[12:15]
    ds_read_b64_tr_b16 a[116:117], v223 offset:4096
    v_mfma_f32_16x16x32_bf16 v[16:19], a[72:75], a[204:207], 0
    v_sub_f32 v6, v6, v232
    v_exp_f32 v6, v6
    v_mfma_f32_16x16x32_bf16 v[16:19], a[76:79], a[208:211], v[16:19]
    ds_read_b64_tr_b16 a[118:119], v223 offset:6144
    v_cvt_pk_bf16_f32 v120, v4, v5
    v_mfma_f32_16x16x32_bf16 v[16:19], a[64:67], a[196:199], v[16:19]
    v_sub_f32 v7, v7, v232
    v_exp_f32 v7, v7
    v_mfma_f32_16x16x32_bf16 v[16:19], a[68:71], a[200:203], v[16:19]
    global_load_lds_dwordx4 v227, s[72:73] offset:3072 nt
    v_mfma_f32_16x16x32_bf16 v[196:199], v[20:23], a[96:99], v[196:199]
    v_sub_f32 v8, v8, v233
    v_exp_f32 v8, v8
    v_mfma_f32_16x16x32_bf16 v[196:199], v[24:27], a[100:103], v[196:199]
    ds_read_b128 a[88:91], v214 offset:53248
    v_cvt_pk_bf16_f32 v121, v6, v7
    v_mfma_f32_16x16x32_bf16 v[196:199], v[52:55], a[104:107], v[196:199]
    v_sub_f32 v9, v9, v233
    v_exp_f32 v9, v9
    v_mfma_f32_16x16x32_bf16 v[196:199], v[56:59], a[108:111], v[196:199]
    ds_read_b64_tr_b16 a[120:121], v223 offset:8192
    v_mfma_f32_16x16x32_bf16 v[200:203], v[60:63], a[104:107], v[200:203]
    s_add_u32 m0, s31, 0x8000
    v_sub_f32 v10, v10, v233
    v_exp_f32 v10, v10
    v_mfma_f32_16x16x32_bf16 v[200:203], v[64:67], a[108:111], v[200:203]
    ds_read_b64_tr_b16 a[122:123], v223 offset:10240
    v_cvt_pk_bf16_f32 v128, v8, v9
    v_mfma_f32_16x16x32_bf16 v[200:203], v[28:31], a[96:99], v[200:203]
    v_sub_f32 v11, v11, v233
    v_exp_f32 v11, v11
    v_mfma_f32_16x16x32_bf16 v[200:203], v[32:35], a[100:103], v[200:203]
    global_load_lds_dwordx4 v228, s[74:75] nt
    v_mfma_f32_16x16x32_bf16 a[48:51], v[36:39], a[96:99], a[48:51]
    ds_read_b128 a[92:95], v215 offset:53248
    v_cvt_pk_bf16_f32 v129, v10, v11
    v_mfma_f32_16x16x32_bf16 a[48:51], v[40:43], a[100:103], a[48:51]
    ds_read_b64_tr_b16 a[124:125], v223 offset:12288
    v_mfma_f32_16x16x32_bf16 a[48:51], v[68:71], a[104:107], a[48:51]
    ds_read_b64_tr_b16 a[126:127], v223 offset:14336
    v_mfma_f32_16x16x32_bf16 a[48:51], v[72:75], a[108:111], a[48:51]
    global_load_lds_dwordx4 v229, s[74:75] offset:1024 nt
    v_mfma_f32_16x16x32_bf16 a[52:55], v[76:79], a[104:107], a[52:55]
    s_add_u32 s32, s67, 0x58000
    v_sub_f32 v12, v12, v234
    v_exp_f32 v12, v12
    v_mfma_f32_16x16x32_bf16 a[52:55], v[80:83], a[108:111], a[52:55]
    s_and_b32 s32, s32, 0x7ffff
    v_sub_f32 v13, v13, v234
    v_exp_f32 v13, v13
    v_mfma_f32_16x16x32_bf16 a[52:55], v[44:47], a[96:99], a[52:55]
    v_sub_f32 v14, v14, v234
    v_exp_f32 v14, v14
    v_mfma_f32_16x16x32_bf16 a[52:55], v[48:51], a[100:103], a[52:55]
    s_waitcnt vmcnt(10) lgkmcnt(0)
    v_sub_f32 v15, v15, v234
    v_exp_f32 v15, v15
    v_smfmac_f32_16x16x64_bf16 a[136:139], a[144:147], v[100:107], v236
    s_barrier
    v_mfma_f32_16x16x32_bf16 v[4:7], a[80:83], a[148:151], 0
    s_add_u32 s72, s14, s32
    v_sub_f32 v16, v16, v235
    v_exp_f32 v16, v16
    v_mfma_f32_16x16x32_bf16 v[4:7], a[84:87], a[152:155], v[4:7]
    ds_read_b128 a[64:67], v212
    v_cvt_pk_bf16_f32 v137, v14, v15
    v_mfma_f32_16x16x32_bf16 v[4:7], a[88:91], a[156:159], v[4:7]
    s_addc_u32 s73, s15, 0
    v_sub_f32 v17, v17, v235
    v_exp_f32 v17, v17
    v_mfma_f32_16x16x32_bf16 v[4:7], a[92:95], a[160:163], v[4:7]
    ds_read_b64_tr_b16 a[96:97], v220 offset:16384
    v_cvt_pk_bf16_f32 v136, v12, v13
    v_mfma_f32_16x16x32_bf16 v[8:11], a[88:91], a[172:175], 0
    v_sub_f32 v18, v18, v235
    v_exp_f32 v18, v18
    v_mfma_f32_16x16x32_bf16 v[8:11], a[92:95], a[176:179], v[8:11]
    ds_read_b64_tr_b16 a[98:99], v220 offset:18432
    v_cvt_pk_bf16_f32 v144, v16, v17
    v_mfma_f32_16x16x32_bf16 v[8:11], a[80:83], a[164:167], v[8:11]
    v_sub_f32 v19, v19, v235
    v_exp_f32 v19, v19
    v_mfma_f32_16x16x32_bf16 v[8:11], a[84:87], a[168:171], v[8:11]
    global_load_lds_dwordx4 v228, s[74:75] offset:2048 nt
    v_mfma_f32_16x16x32_bf16 v[12:15], a[80:83], a[180:183], 0
    v_sub_f32 v4, v4, v232
    v_exp_f32 v4, v4
    v_mfma_f32_16x16x32_bf16 v[12:15], a[84:87], a[184:187], v[12:15]
    ds_read_b128 a[68:71], v213
    v_cvt_pk_bf16_f32 v145, v18, v19
    v_mfma_f32_16x16x32_bf16 v[12:15], a[88:91], a[188:191], v[12:15]
    v_sub_f32 v5, v5, v232
    v_exp_f32 v5, v5
    v_mfma_f32_16x16x32_bf16 v[12:15], a[92:95], a[192:195], v[12:15]
    ds_read_b64_tr_b16 a[100:101], v220 offset:20480
    v_mfma_f32_16x16x32_bf16 v[16:19], a[88:91], a[204:207], 0
    v_sub_f32 v6, v6, v232
    v_exp_f32 v6, v6
    v_mfma_f32_16x16x32_bf16 v[16:19], a[92:95], a[208:211], v[16:19]
    ds_read_b64_tr_b16 a[102:103], v220 offset:22528
    v_cvt_pk_bf16_f32 v122, v4, v5
    v_mfma_f32_16x16x32_bf16 v[16:19], a[80:83], a[196:199], v[16:19]
M_stub7:
    s_cbranch_execz M_back
    v_sub_f32 v7, v7, v232
    v_exp_f32 v7, v7
    v_mfma_f32_16x16x32_bf16 v[16:19], a[84:87], a[200:203], v[16:19]
    global_load_lds_dwordx4 v229, s[74:75] offset:3072 nt
    v_mfma_f32_16x16x32_bf16 v[204:207], v[20:23], a[112:115], v[204:207]
    v_sub_f32 v8, v8, v233
    v_exp_f32 v8, v8
    v_mfma_f32_16x16x32_bf16 v[204:207], v[24:27], a[116:119], v[204:207]
    ds_read_b128 a[72:75], v214
    v_cvt_pk_bf16_f32 v123, v6, v7
    v_mfma_f32_16x16x32_bf16 v[204:207], v[52:55], a[120:123], v[204:207]
    v_sub_f32 v9, v9, v233
    v_exp_f32 v9, v9
    v_mfma_f32_16x16x32_bf16 v[204:207], v[56:59], a[124:127], v[204:207]
    ds_read_b64_tr_b16 a[104:105], v220 offset:24576
    v_mfma_f32_16x16x32_bf16 v[208:211], v[60:63], a[120:123], v[208:211]
    s_add_u32 m0, s33, 0xa000
    v_sub_f32 v10, v10, v233
    v_exp_f32 v10, v10
    v_mfma_f32_16x16x32_bf16 v[208:211], v[64:67], a[124:127], v[208:211]
    ds_read_b64_tr_b16 a[106:107], v220 offset:26624
    v_cvt_pk_bf16_f32 v130, v8, v9
    v_mfma_f32_16x16x32_bf16 v[208:211], v[28:31], a[112:115], v[208:211]
    v_sub_f32 v11, v11, v233
    v_exp_f32 v11, v11
    v_mfma_f32_16x16x32_bf16 v[208:211], v[32:35], a[116:119], v[208:211]
    global_load_lds_dwordx4 v224, s[72:73] nt
    v_mfma_f32_16x16x32_bf16 a[56:59], v[36:39], a[112:115], a[56:59]
    s_add_u32 s32, s65, 0x68000
    v_sub_f32 v12, v12, v234
    v_exp_f32 v12, v12
    v_mfma_f32_16x16x32_bf16 a[56:59], v[40:43], a[116:119], a[56:59]
    ds_read_b128 a[76:79], v215
    v_cvt_pk_bf16_f32 v131, v10, v11
    v_mfma_f32_16x16x32_bf16 a[56:59], v[68:71], a[120:123], a[56:59]
    s_and_b32 s32, s32, 0x7ffff
    v_sub_f32 v13, v13, v234
    v_exp_f32 v13, v13
    v_mfma_f32_16x16x32_bf16 a[56:59], v[72:75], a[124:127], a[56:59]
    ds_read_b64_tr_b16 a[108:109], v220 offset:28672
    v_mfma_f32_16x16x32_bf16 a[60:63], v[76:79], a[120:123], a[60:63]
    v_sub_f32 v14, v14, v234
    v_exp_f32 v14, v14
    v_mfma_f32_16x16x32_bf16 a[60:63], v[80:83], a[124:127], a[60:63]
    ds_read_b64_tr_b16 a[110:111], v220 offset:30720
    v_cvt_pk_bf16_f32 v138, v12, v13
    v_mfma_f32_16x16x32_bf16 a[60:63], v[44:47], a[112:115], a[60:63]
    s_waitcnt lgkmcnt(2)
    v_sub_f32 v15, v15, v234
    v_exp_f32 v15, v15
    v_mfma_f32_16x16x32_bf16 a[60:63], v[48:51], a[116:119], a[60:63]
    global_load_lds_dwordx4 v225, s[72:73] offset:1024 nt
    v_smfmac_f32_16x16x64_bf16 a[140:143], a[144:147], v[108:115], v236
    v_mfma_f32_16x16x32_bf16 v[4:7], a[64:67], a[148:151], 0
    s_add_u32 s74, s12, s32
    v_sub_f32 v16, v16, v235
    v_exp_f32 v16, v16
    v_mfma_f32_16x16x32_bf16 v[4:7], a[68:71], a[152:155], v[4:7]
    ds_read_b128 a[80:83], v212 offset:4096
    v_cvt_pk_bf16_f32 v139, v14, v15
    v_mfma_f32_16x16x32_bf16 v[4:7], a[72:75], a[156:159], v[4:7]
    s_addc_u32 s75, s13, 0
    v_sub_f32 v17, v17, v235
    v_exp_f32 v17, v17
    v_mfma_f32_16x16x32_bf16 v[4:7], a[76:79], a[160:163], v[4:7]
    ds_read_b64_tr_b16 a[112:113], v221 offset:16384
    v_mfma_f32_16x16x32_bf16 v[8:11], a[72:75], a[172:175], 0
    v_sub_f32 v18, v18, v235
    v_exp_f32 v18, v18
    v_mfma_f32_16x16x32_bf16 v[8:11], a[76:79], a[176:179], v[8:11]
    ds_read_b64_tr_b16 a[114:115], v221 offset:18432
    v_cvt_pk_bf16_f32 v146, v16, v17
    v_mfma_f32_16x16x32_bf16 v[8:11], a[64:67], a[164:167], v[8:11]
    s_waitcnt lgkmcnt(3)
    v_sub_f32 v19, v19, v235
    v_exp_f32 v19, v19
    v_mfma_f32_16x16x32_bf16 v[8:11], a[68:71], a[168:171], v[8:11]
    global_load_lds_dwordx4 v226, s[72:73] offset:2048 nt
    v_mfma_f32_16x16x32_bf16 v[12:15], a[64:67], a[180:183], 0
    v_sub_f32 v4, v4, v232
    v_exp_f32 v4, v4
    v_mfma_f32_16x16x32_bf16 v[12:15], a[68:71], a[184:187], v[12:15]
    ds_read_b128 a[84:87], v213 offset:4096
    v_cvt_pk_bf16_f32 v147, v18, v19
    v_mfma_f32_16x16x32_bf16 v[12:15], a[72:75], a[188:191], v[12:15]
    v_sub_f32 v5, v5, v232
    v_exp_f32 v5, v5
    v_mfma_f32_16x16x32_bf16 v[12:15], a[76:79], a[192:195], v[12:15]
    ds_read_b64_tr_b16 a[116:117], v221 offset:20480
    v_mfma_f32_16x16x32_bf16 v[16:19], a[72:75], a[204:207], 0
    v_sub_f32 v6, v6, v232
    v_exp_f32 v6, v6
    v_mfma_f32_16x16x32_bf16 v[16:19], a[76:79], a[208:211], v[16:19]
    ds_read_b64_tr_b16 a[118:119], v221 offset:22528
    v_cvt_pk_bf16_f32 v20, v4, v5
    v_mfma_f32_16x16x32_bf16 v[16:19], a[64:67], a[196:199], v[16:19]
    v_sub_f32 v7, v7, v232
    v_exp_f32 v7, v7
    v_mfma_f32_16x16x32_bf16 v[16:19], a[68:71], a[200:203], v[16:19]
    global_load_lds_dwordx4 v227, s[72:73] offset:3072 nt
    v_mfma_f32_16x16x32_bf16 v[148:151], v[84:87], a[96:99], v[148:151]
    v_sub_f32 v8, v8, v233
    v_exp_f32 v8, v8
    v_mfma_f32_16x16x32_bf16 v[148:151], v[88:91], a[100:103], v[148:151]
    ds_read_b128 a[88:91], v214 offset:4096
    v_cvt_pk_bf16_f32 v21, v6, v7
    v_mfma_f32_16x16x32_bf16 v[148:151], v[116:119], a[104:107], v[148:151]
    v_sub_f32 v9, v9, v233
    v_exp_f32 v9, v9
    v_mfma_f32_16x16x32_bf16 v[148:151], v[120:123], a[108:111], v[148:151]
    ds_read_b64_tr_b16 a[120:121], v221 offset:24576
    v_mfma_f32_16x16x32_bf16 v[152:155], v[124:127], a[104:107], v[152:155]
    s_add_u32 m0, s31, 0xc000
    v_sub_f32 v10, v10, v233
    v_exp_f32 v10, v10
    v_mfma_f32_16x16x32_bf16 v[152:155], v[128:131], a[108:111], v[152:155]
    ds_read_b64_tr_b16 a[122:123], v221 offset:26624
    v_cvt_pk_bf16_f32 v28, v8, v9
    v_mfma_f32_16x16x32_bf16 v[152:155], v[92:95], a[96:99], v[152:155]
    v_sub_f32 v11, v11, v233
    v_exp_f32 v11, v11
    v_mfma_f32_16x16x32_bf16 v[152:155], v[96:99], a[100:103], v[152:155]
    global_load_lds_dwordx4 v228, s[74:75] nt
    v_mfma_f32_16x16x32_bf16 a[0:3], v[100:103], a[96:99], a[0:3]
    ds_read_b128 a[92:95], v215 offset:4096
    v_cvt_pk_bf16_f32 v29, v10, v11
    v_mfma_f32_16x16x32_bf16 a[0:3], v[104:107], a[100:103], a[0:3]
    ds_read_b64_tr_b16 a[124:125], v221 offset:28672
    v_mfma_f32_16x16x32_bf16 a[0:3], v[132:135], a[104:107], a[0:3]
    ds_read_b64_tr_b16 a[126:127], v221 offset:30720
    v_mfma_f32_16x16x32_bf16 a[0:3], v[136:139], a[108:111], a[0:3]
    global_load_lds_dwordx4 v229, s[74:75] offset:1024 nt
    v_mfma_f32_16x16x32_bf16 a[4:7], v[140:143], a[104:107], a[4:7]
    s_add_u32 s32, s66, 0x60000
    v_sub_f32 v12, v12, v234
    v_exp_f32 v12, v12
    v_mfma_f32_16x16x32_bf16 a[4:7], v[144:147], a[108:111], a[4:7]
    s_and_b32 s32, s32, 0x7ffff
    v_sub_f32 v13, v13, v234
    v_exp_f32 v13, v13
    v_mfma_f32_16x16x32_bf16 a[4:7], v[108:111], a[96:99], a[4:7]
    v_sub_f32 v14, v14, v234
    v_exp_f32 v14, v14
    v_mfma_f32_16x16x32_bf16 a[4:7], v[112:115], a[100:103], a[4:7]
    s_waitcnt vmcnt(14) lgkmcnt(0)
    v_sub_f32 v15, v15, v234
    v_exp_f32 v15, v15
    v_smfmac_f32_16x16x64_bf16 a[128:131], a[144:147], v[116:123], v236
    s_barrier
    v_mfma_f32_16x16x32_bf16 v[4:7], a[80:83], a[148:151], 0
    s_add_u32 s72, s14, s32
    v_sub_f32 v16, v16, v235
    v_exp_f32 v16, v16
    v_mfma_f32_16x16x32_bf16 v[4:7], a[84:87], a[152:155], v[4:7]
    ds_read_b128 a[64:67], v212 offset:16384
    v_cvt_pk_bf16_f32 v37, v14, v15
    v_mfma_f32_16x16x32_bf16 v[4:7], a[88:91], a[156:159], v[4:7]
    s_addc_u32 s73, s15, 0
    v_sub_f32 v17, v17, v235
    v_exp_f32 v17, v17
    v_mfma_f32_16x16x32_bf16 v[4:7], a[92:95], a[160:163], v[4:7]
    ds_read_b64_tr_b16 a[96:97], v222 offset:16384
    v_cvt_pk_bf16_f32 v36, v12, v13
    v_mfma_f32_16x16x32_bf16 v[8:11], a[88:91], a[172:175], 0
    v_sub_f32 v18, v18, v235
    v_exp_f32 v18, v18
    v_mfma_f32_16x16x32_bf16 v[8:11], a[92:95], a[176:179], v[8:11]
    ds_read_b64_tr_b16 a[98:99], v222 offset:18432
    v_cvt_pk_bf16_f32 v44, v16, v17
    v_mfma_f32_16x16x32_bf16 v[8:11], a[80:83], a[164:167], v[8:11]
    v_sub_f32 v19, v19, v235
    v_exp_f32 v19, v19
    v_mfma_f32_16x16x32_bf16 v[8:11], a[84:87], a[168:171], v[8:11]
    global_load_lds_dwordx4 v228, s[74:75] offset:2048 nt
    v_mfma_f32_16x16x32_bf16 v[12:15], a[80:83], a[180:183], 0
    v_sub_f32 v4, v4, v232
    v_exp_f32 v4, v4
    v_mfma_f32_16x16x32_bf16 v[12:15], a[84:87], a[184:187], v[12:15]
    ds_read_b128 a[68:71], v213 offset:16384
    v_cvt_pk_bf16_f32 v45, v18, v19
    v_mfma_f32_16x16x32_bf16 v[12:15], a[88:91], a[188:191], v[12:15]
    v_sub_f32 v5, v5, v232
    v_exp_f32 v5, v5
    v_mfma_f32_16x16x32_bf16 v[12:15], a[92:95], a[192:195], v[12:15]
    ds_read_b64_tr_b16 a[100:101], v222 offset:20480
    v_mfma_f32_16x16x32_bf16 v[16:19], a[88:91], a[204:207], 0
    v_sub_f32 v6, v6, v232
    v_exp_f32 v6, v6
    v_mfma_f32_16x16x32_bf16 v[16:19], a[92:95], a[208:211], v[16:19]
    ds_read_b64_tr_b16 a[102:103], v222 offset:22528
    v_cvt_pk_bf16_f32 v22, v4, v5
    v_mfma_f32_16x16x32_bf16 v[16:19], a[80:83], a[196:199], v[16:19]
    v_sub_f32 v7, v7, v232
    v_exp_f32 v7, v7
    v_mfma_f32_16x16x32_bf16 v[16:19], a[84:87], a[200:203], v[16:19]
    global_load_lds_dwordx4 v229, s[74:75] offset:3072 nt
    v_mfma_f32_16x16x32_bf16 v[156:159], v[84:87], a[112:115], v[156:159]
    v_sub_f32 v8, v8, v233
    v_exp_f32 v8, v8
    v_mfma_f32_16x16x32_bf16 v[156:159], v[88:91], a[116:119], v[156:159]
    ds_read_b128 a[72:75], v214 offset:16384
    v_cvt_pk_bf16_f32 v23, v6, v7
    v_mfma_f32_16x16x32_bf16 v[156:159], v[116:119], a[120:123], v[156:159]
    v_sub_f32 v9, v9, v233
    v_exp_f32 v9, v9
    v_mfma_f32_16x16x32_bf16 v[156:159], v[120:123], a[124:127], v[156:159]
    ds_read_b64_tr_b16 a[104:105], v222 offset:24576
    v_mfma_f32_16x16x32_bf16 v[160:163], v[124:127], a[120:123], v[160:163]
    s_add_u32 m0, s33, 0x0
    v_sub_f32 v10, v10, v233
    v_exp_f32 v10, v10
    v_mfma_f32_16x16x32_bf16 v[160:163], v[128:131], a[124:127], v[160:163]
    ds_read_b64_tr_b16 a[106:107], v222 offset:26624
    v_cvt_pk_bf16_f32 v30, v8, v9
    v_mfma_f32_16x16x32_bf16 v[160:163], v[92:95], a[112:115], v[160:163]
    v_sub_f32 v11, v11, v233
    v_exp_f32 v11, v11
    v_mfma_f32_16x16x32_bf16 v[160:163], v[96:99], a[116:119], v[160:163]
    global_load_lds_dwordx4 v224, s[72:73] nt
    v_mfma_f32_16x16x32_bf16 a[8:11], v[100:103], a[112:115], a[8:11]
    s_add_u32 s32, s64, 0x70000
    v_sub_f32 v12, v12, v234
    v_exp_f32 v12, v12
    v_mfma_f32_16x16x32_bf16 a[8:11], v[104:107], a[116:119], a[8:11]
    ds_read_b128 a[76:79], v215 offset:16384
    v_cvt_pk_bf16_f32 v31, v10, v11
    v_mfma_f32_16x16x32_bf16 a[8:11], v[132:135], a[120:123], a[8:11]
    s_and_b32 s32, s32, 0x7ffff
    v_sub_f32 v13, v13, v234
    v_exp_f32 v13, v13
    v_mfma_f32_16x16x32_bf16 a[8:11], v[136:139], a[124:127], a[8:11]
    ds_read_b64_tr_b16 a[108:109], v222 offset:28672
    v_mfma_f32_16x16x32_bf16 a[12:15], v[140:143], a[120:123], a[12:15]
    v_sub_f32 v14, v14, v234
    v_exp_f32 v14, v14
    v_mfma_f32_16x16x32_bf16 a[12:15], v[144:147], a[124:127], a[12:15]
    ds_read_b64_tr_b16 a[110:111], v222 offset:30720
    v_cvt_pk_bf16_f32 v38, v12, v13
    v_mfma_f32_16x16x32_bf16 a[12:15], v[108:111], a[112:115], a[12:15]
    s_waitcnt lgkmcnt(2)
    v_sub_f32 v15, v15, v234
    v_exp_f32 v15, v15
    v_mfma_f32_16x16x32_bf16 a[12:15], v[112:115], a[116:119], a[12:15]
    global_load_lds_dwordx4 v225, s[72:73] offset:1024 nt
    v_smfmac_f32_16x16x64_bf16 a[132:135], a[144:147], v[124:131], v236
    v_mfma_f32_16x16x32_bf16 v[4:7], a[64:67], a[148:151], 0
    s_add_u32 s74, s12, s32
    v_sub_f32 v16, v16, v235
    v_exp_f32 v16, v16
    v_mfma_f32_16x16x32_bf16 v[4:7], a[68:71], a[152:155], v[4:7]
    ds_read_b128 a[80:83], v212 offset:20480
    v_cvt_pk_bf16_f32 v39, v14, v15
    v_mfma_f32_16x16x32_bf16 v[4:7], a[72:75], a[156:159], v[4:7]
    s_addc_u32 s75, s13, 0
    v_sub_f32 v17, v17, v235
    v_exp_f32 v17, v17
    v_mfma_f32_16x16x32_bf16 v[4:7], a[76:79], a[160:163], v[4:7]
    ds_read_b64_tr_b16 a[112:113], v223 offset:16384
    v_mfma_f32_16x16x32_bf16 v[8:11], a[72:75], a[172:175], 0
    v_sub_f32 v18, v18, v235
    v_exp_f32 v18, v18
    v_mfma_f32_16x16x32_bf16 v[8:11], a[76:79], a[176:179], v[8:11]
    ds_read_b64_tr_b16 a[114:115], v223 offset:18432
    v_cvt_pk_bf16_f32 v46, v16, v17
    v_mfma_f32_16x16x32_bf16 v[8:11], a[64:67], a[164:167], v[8:11]
    s_waitcnt lgkmcnt(3)
    v_sub_f32 v19, v19, v235
    v_exp_f32 v19, v19
    v_mfma_f32_16x16x32_bf16 v[8:11], a[68:71], a[168:171], v[8:11]
    global_load_lds_dwordx4 v226, s[72:73] offset:2048 nt
    v_mfma_f32_16x16x32_bf16 v[12:15], a[64:67], a[180:183], 0
    v_sub_f32 v4, v4, v232
    v_exp_f32 v4, v4
    v_mfma_f32_16x16x32_bf16 v[12:15], a[68:71], a[184:187], v[12:15]
    ds_read_b128 a[84:87], v213 offset:20480
    v_cvt_pk_bf16_f32 v47, v18, v19
    v_mfma_f32_16x16x32_bf16 v[12:15], a[72:75], a[188:191], v[12:15]
    v_sub_f32 v5, v5, v232
    v_exp_f32 v5, v5
    v_mfma_f32_16x16x32_bf16 v[12:15], a[76:79], a[192:195], v[12:15]
    ds_read_b64_tr_b16 a[116:117], v223 offset:20480
    v_mfma_f32_16x16x32_bf16 v[16:19], a[72:75], a[204:207], 0
    v_sub_f32 v6, v6, v232
    v_exp_f32 v6, v6
    v_mfma_f32_16x16x32_bf16 v[16:19], a[76:79], a[208:211], v[16:19]
    ds_read_b64_tr_b16 a[118:119], v223 offset:22528
    v_cvt_pk_bf16_f32 v24, v4, v5
    v_mfma_f32_16x16x32_bf16 v[16:19], a[64:67], a[196:199], v[16:19]
    v_sub_f32 v7, v7, v232
    v_exp_f32 v7, v7
    v_mfma_f32_16x16x32_bf16 v[16:19], a[68:71], a[200:203], v[16:19]
    global_load_lds_dwordx4 v227, s[72:73] offset:3072 nt
    v_mfma_f32_16x16x32_bf16 v[164:167], v[84:87], a[96:99], v[164:167]
    v_sub_f32 v8, v8, v233
    v_exp_f32 v8, v8
    v_mfma_f32_16x16x32_bf16 v[164:167], v[88:91], a[100:103], v[164:167]
    ds_read_b128 a[88:91], v214 offset:20480
    v_cvt_pk_bf16_f32 v25, v6, v7
    v_mfma_f32_16x16x32_bf16 v[164:167], v[116:119], a[104:107], v[164:167]
    v_sub_f32 v9, v9, v233
    v_exp_f32 v9, v9
    v_mfma_f32_16x16x32_bf16 v[164:167], v[120:123], a[108:111], v[164:167]
    ds_read_b64_tr_b16 a[120:121], v223 offset:24576
    v_mfma_f32_16x16x32_bf16 v[168:171], v[124:127], a[104:107], v[168:171]
    s_add_u32 m0, s31, 0x0
    v_sub_f32 v10, v10, v233
    v_exp_f32 v10, v10
    v_mfma_f32_16x16x32_bf16 v[168:171], v[128:131], a[108:111], v[168:171]
    ds_read_b64_tr_b16 a[122:123], v223 offset:26624
    v_cvt_pk_bf16_f32 v32, v8, v9
    v_mfma_f32_16x16x32_bf16 v[168:171], v[92:95], a[96:99], v[168:171]
    v_sub_f32 v11, v11, v233
    v_exp_f32 v11, v11
    v_mfma_f32_16x16x32_bf16 v[168:171], v[96:99], a[100:103], v[168:171]
    global_load_lds_dwordx4 v228, s[74:75] nt
    v_mfma_f32_16x16x32_bf16 a[16:19], v[100:103], a[96:99], a[16:19]
    ds_read_b128 a[92:95], v215 offset:20480
    v_cvt_pk_bf16_f32 v33, v10, v11
    v_mfma_f32_16x16x32_bf16 a[16:19], v[104:107], a[100:103], a[16:19]
    ds_read_b64_tr_b16 a[124:125], v223 offset:28672
    v_mfma_f32_16x16x32_bf16 a[16:19], v[132:135], a[104:107], a[16:19]
    ds_read_b64_tr_b16 a[126:127], v223 offset:30720
    v_mfma_f32_16x16x32_bf16 a[16:19], v[136:139], a[108:111], a[16:19]
    global_load_lds_dwordx4 v229, s[74:75] offset:1024 nt
    v_mfma_f32_16x16x32_bf16 a[20:23], v[140:143], a[104:107], a[20:23]
    s_add_u32 s32, s66, 0x68000
    v_sub_f32 v12, v12, v234
    v_exp_f32 v12, v12
    v_mfma_f32_16x16x32_bf16 a[20:23], v[144:147], a[108:111], a[20:23]
    s_and_b32 s32, s32, 0x7ffff
    v_sub_f32 v13, v13, v234
    v_exp_f32 v13, v13
    v_mfma_f32_16x16x32_bf16 a[20:23], v[108:111], a[96:99], a[20:23]
    v_sub_f32 v14, v14, v234
    v_exp_f32 v14, v14
    v_mfma_f32_16x16x32_bf16 a[20:23], v[112:115], a[100:103], a[20:23]
    s_waitcnt vmcnt(10) lgkmcnt(0)
    v_sub_f32 v15, v15, v234
    v_exp_f32 v15, v15
    v_smfmac_f32_16x16x64_bf16 a[136:139], a[144:147], v[132:139], v236
    s_barrier
    v_mfma_f32_16x16x32_bf16 v[4:7], a[80:83], a[148:151], 0
    s_add_u32 s72, s14, s32
    v_sub_f32 v16, v16, v235
    v_exp_f32 v16, v16
    v_mfma_f32_16x16x32_bf16 v[4:7], a[84:87], a[152:155], v[4:7]
    ds_read_b128 a[64:67], v212 offset:32768
    v_cvt_pk_bf16_f32 v41, v14, v15
    v_mfma_f32_16x16x32_bf16 v[4:7], a[88:91], a[156:159], v[4:7]
    s_addc_u32 s73, s15, 0
    v_sub_f32 v17, v17, v235
    v_exp_f32 v17, v17
    v_mfma_f32_16x16x32_bf16 v[4:7], a[92:95], a[160:163], v[4:7]
    ds_read_b64_tr_b16 a[96:97], v220 offset:32768
    v_cvt_pk_bf16_f32 v40, v12, v13
    v_mfma_f32_16x16x32_bf16 v[8:11], a[88:91], a[172:175], 0
    v_sub_f32 v18, v18, v235
    v_exp_f32 v18, v18
    v_mfma_f32_16x16x32_bf16 v[8:11], a[92:95], a[176:179], v[8:11]
    ds_read_b64_tr_b16 a[98:99], v220 offset:34816
    v_cvt_pk_bf16_f32 v48, v16, v17
    v_mfma_f32_16x16x32_bf16 v[8:11], a[80:83], a[164:167], v[8:11]
    v_sub_f32 v19, v19, v235
    v_exp_f32 v19, v19
    v_mfma_f32_16x16x32_bf16 v[8:11], a[84:87], a[168:171], v[8:11]
    global_load_lds_dwordx4 v228, s[74:75] offset:2048 nt
    v_mfma_f32_16x16x32_bf16 v[12:15], a[80:83], a[180:183], 0
    v_sub_f32 v4, v4, v232
    v_exp_f32 v4, v4
    v_mfma_f32_16x16x32_bf16 v[12:15], a[84:87], a[184:187], v[12:15]
    ds_read_b128 a[68:71], v213 offset:32768
    v_cvt_pk_bf16_f32 v49, v18, v19
    v_mfma_f32_16x16x32_bf16 v[12:15], a[88:91], a[188:191], v[12:15]
    v_sub_f32 v5, v5, v232
    v_exp_f32 v5, v5
    v_mfma_f32_16x16x32_bf16 v[12:15], a[92:95], a[192:195], v[12:15]
    ds_read_b64_tr_b16 a[100:101], v220 offset:36864
    v_mfma_f32_16x16x32_bf16 v[16:19], a[88:91], a[204:207], 0
    v_sub_f32 v6, v6, v232
    v_exp_f32 v6, v6
    v_mfma_f32_16x16x32_bf16 v[16:19], a[92:95], a[208:211], v[16:19]
    ds_read_b64_tr_b16 a[102:103], v220 offset:38912
    v_cvt_pk_bf16_f32 v26, v4, v5
    v_mfma_f32_16x16x32_bf16 v[16:19], a[80:83], a[196:199], v[16:19]
    v_sub_f32 v7, v7, v232
    v_exp_f32 v7, v7
    v_mfma_f32_16x16x32_bf16 v[16:19], a[84:87], a[200:203], v[16:19]
    global_load_lds_dwordx4 v229, s[74:75] offset:3072 nt
    v_mfma_f32_16x16x32_bf16 v[172:175], v[84:87], a[112:115], v[172:175]
    v_sub_f32 v8, v8, v233
    v_exp_f32 v8, v8
    v_mfma_f32_16x16x32_bf16 v[172:175], v[88:91], a[116:119], v[172:175]
    ds_read_b128 a[72:75], v214 offset:32768
    v_cvt_pk_bf16_f32 v27, v6, v7
    v_mfma_f32_16x16x32_bf16 v[172:175], v[116:119], a[120:123], v[172:175]
    v_sub_f32 v9, v9, v233
    v_exp_f32 v9, v9
    v_mfma_f32_16x16x32_bf16 v[172:175], v[120:123], a[124:127], v[172:175]
    ds_read_b64_tr_b16 a[104:105], v220 offset:40960
    v_mfma_f32_16x16x32_bf16 v[176:179], v[124:127], a[120:123], v[176:179]
    s_add_u32 m0, s33, 0x2000
    v_sub_f32 v10, v10, v233
    v_exp_f32 v10, v10
    v_mfma_f32_16x16x32_bf16 v[176:179], v[128:131], a[124:127], v[176:179]
    ds_read_b64_tr_b16 a[106:107], v220 offset:43008
    v_cvt_pk_bf16_f32 v34, v8, v9
    v_mfma_f32_16x16x32_bf16 v[176:179], v[92:95], a[112:115], v[176:179]
    v_sub_f32 v11, v11, v233
    v_exp_f32 v11, v11
    v_mfma_f32_16x16x32_bf16 v[176:179], v[96:99], a[116:119], v[176:179]
    global_load_lds_dwordx4 v224, s[72:73] nt
    v_mfma_f32_16x16x32_bf16 a[24:27], v[100:103], a[112:115], a[24:27]
    s_add_u32 s32, s65, 0x70000
    v_sub_f32 v12, v12, v234
    v_exp_f32 v12, v12
    v_mfma_f32_16x16x32_bf16 a[24:27], v[104:107], a[116:119], a[24:27]
    ds_read_b128 a[76:79], v215 offset:32768
    v_cvt_pk_bf16_f32 v35, v10, v11
    v_mfma_f32_16x16x32_bf16 a[24:27], v[132:135], a[120:123], a[24:27]
    s_and_b32 s32, s32, 0x7ffff
    v_sub_f32 v13, v13, v234
    v_exp_f32 v13, v13
    v_mfma_f32_16x16x32_bf16 a[24:27], v[136:139], a[124:127], a[24:27]
    ds_read_b64_tr_b16 a[108:109], v220 offset:45056
    v_mfma_f32_16x16x32_bf16 a[28:31], v[140:143], a[120:123], a[28:31]
    v_sub_f32 v14, v14, v234
    v_exp_f32 v14, v14
    v_mfma_f32_16x16x32_bf16 a[28:31], v[144:147], a[124:127], a[28:31]
    ds_read_b64_tr_b16 a[110:111], v220 offset:47104
    v_cvt_pk_bf16_f32 v42, v12, v13
    v_mfma_f32_16x16x32_bf16 a[28:31], v[108:111], a[112:115], a[28:31]
    s_waitcnt lgkmcnt(2)
    v_sub_f32 v15, v15, v234
    v_exp_f32 v15, v15
    v_mfma_f32_16x16x32_bf16 a[28:31], v[112:115], a[116:119], a[28:31]
    global_load_lds_dwordx4 v225, s[72:73] offset:1024 nt
    v_smfmac_f32_16x16x64_bf16 a[140:143], a[144:147], v[140:147], v236
    v_mfma_f32_16x16x32_bf16 v[4:7], a[64:67], a[148:151], 0
    s_add_u32 s74, s12, s32
    v_sub_f32 v16, v16, v235
    v_exp_f32 v16, v16
    v_mfma_f32_16x16x32_bf16 v[4:7], a[68:71], a[152:155], v[4:7]
    ds_read_b128 a[80:83], v212 offset:36864
    v_cvt_pk_bf16_f32 v43, v14, v15
    v_mfma_f32_16x16x32_bf16 v[4:7], a[72:75], a[156:159], v[4:7]
    s_addc_u32 s75, s13, 0
    v_sub_f32 v17, v17, v235
    v_exp_f32 v17, v17
    v_mfma_f32_16x16x32_bf16 v[4:7], a[76:79], a[160:163], v[4:7]
    ds_read_b64_tr_b16 a[112:113], v221 offset:32768
    v_mfma_f32_16x16x32_bf16 v[8:11], a[72:75], a[172:175], 0
    v_sub_f32 v18, v18, v235
    v_exp_f32 v18, v18
    v_mfma_f32_16x16x32_bf16 v[8:11], a[76:79], a[176:179], v[8:11]
    ds_read_b64_tr_b16 a[114:115], v221 offset:34816
    v_cvt_pk_bf16_f32 v50, v16, v17
    v_mfma_f32_16x16x32_bf16 v[8:11], a[64:67], a[164:167], v[8:11]
    s_waitcnt lgkmcnt(3)
    v_sub_f32 v19, v19, v235
    v_exp_f32 v19, v19
    v_mfma_f32_16x16x32_bf16 v[8:11], a[68:71], a[168:171], v[8:11]
    global_load_lds_dwordx4 v226, s[72:73] offset:2048 nt
    v_mfma_f32_16x16x32_bf16 v[12:15], a[64:67], a[180:183], 0
    v_sub_f32 v4, v4, v232
    v_exp_f32 v4, v4
    v_mfma_f32_16x16x32_bf16 v[12:15], a[68:71], a[184:187], v[12:15]
    ds_read_b128 a[84:87], v213 offset:36864
    v_cvt_pk_bf16_f32 v51, v18, v19
    v_mfma_f32_16x16x32_bf16 v[12:15], a[72:75], a[188:191], v[12:15]
    v_sub_f32 v5, v5, v232
    v_exp_f32 v5, v5
    v_mfma_f32_16x16x32_bf16 v[12:15], a[76:79], a[192:195], v[12:15]
    ds_read_b64_tr_b16 a[116:117], v221 offset:36864
    v_mfma_f32_16x16x32_bf16 v[16:19], a[72:75], a[204:207], 0
    v_sub_f32 v6, v6, v232
    v_exp_f32 v6, v6
    v_mfma_f32_16x16x32_bf16 v[16:19], a[76:79], a[208:211], v[16:19]
    ds_read_b64_tr_b16 a[118:119], v221 offset:38912
    v_cvt_pk_bf16_f32 v52, v4, v5
    v_mfma_f32_16x16x32_bf16 v[16:19], a[64:67], a[196:199], v[16:19]
    v_sub_f32 v7, v7, v232
    v_exp_f32 v7, v7
    v_mfma_f32_16x16x32_bf16 v[16:19], a[68:71], a[200:203], v[16:19]
    global_load_lds_dwordx4 v227, s[72:73] offset:3072 nt
    v_mfma_f32_16x16x32_bf16 v[180:183], v[84:87], a[96:99], v[180:183]
    v_sub_f32 v8, v8, v233
    v_exp_f32 v8, v8
    v_mfma_f32_16x16x32_bf16 v[180:183], v[88:91], a[100:103], v[180:183]
    ds_read_b128 a[88:91], v214 offset:36864
    v_cvt_pk_bf16_f32 v53, v6, v7
    v_mfma_f32_16x16x32_bf16 v[180:183], v[116:119], a[104:107], v[180:183]
    v_sub_f32 v9, v9, v233
    v_exp_f32 v9, v9
    v_mfma_f32_16x16x32_bf16 v[180:183], v[120:123], a[108:111], v[180:183]
    ds_read_b64_tr_b16 a[120:121], v221 offset:40960
    v_mfma_f32_16x16x32_bf16 v[184:187], v[124:127], a[104:107], v[184:187]
    s_add_u32 m0, s31, 0x4000
    v_sub_f32 v10, v10, v233
    v_exp_f32 v10, v10
    v_mfma_f32_16x16x32_bf16 v[184:187], v[128:131], a[108:111], v[184:187]
    ds_read_b64_tr_b16 a[122:123], v221 offset:43008
    v_cvt_pk_bf16_f32 v60, v8, v9
    v_mfma_f32_16x16x32_bf16 v[184:187], v[92:95], a[96:99], v[184:187]
    v_sub_f32 v11, v11, v233
    v_exp_f32 v11, v11
    v_mfma_f32_16x16x32_bf16 v[184:187], v[96:99], a[100:103], v[184:187]
    global_load_lds_dwordx4 v228, s[74:75] nt
    v_mfma_f32_16x16x32_bf16 a[32:35], v[100:103], a[96:99], a[32:35]
    ds_read_b128 a[92:95], v215 offset:36864
    v_cvt_pk_bf16_f32 v61, v10, v11
    v_mfma_f32_16x16x32_bf16 a[32:35], v[104:107], a[100:103], a[32:35]
    ds_read_b64_tr_b16 a[124:125], v221 offset:45056
    v_mfma_f32_16x16x32_bf16 a[32:35], v[132:135], a[104:107], a[32:35]
    ds_read_b64_tr_b16 a[126:127], v221 offset:47104
    v_mfma_f32_16x16x32_bf16 a[32:35], v[136:139], a[108:111], a[32:35]
    global_load_lds_dwordx4 v229, s[74:75] offset:1024 nt
    v_mfma_f32_16x16x32_bf16 a[36:39], v[140:143], a[104:107], a[36:39]
    s_add_u32 s32, s67, 0x60000
    v_sub_f32 v12, v12, v234
    v_exp_f32 v12, v12
    v_mfma_f32_16x16x32_bf16 a[36:39], v[144:147], a[108:111], a[36:39]
    s_and_b32 s32, s32, 0x7ffff
    v_sub_f32 v13, v13, v234
    v_exp_f32 v13, v13
    v_mfma_f32_16x16x32_bf16 a[36:39], v[108:111], a[96:99], a[36:39]
    v_sub_f32 v14, v14, v234
    v_exp_f32 v14, v14
    v_mfma_f32_16x16x32_bf16 a[36:39], v[112:115], a[100:103], a[36:39]
    s_waitcnt vmcnt(14) lgkmcnt(0)
    v_sub_f32 v15, v15, v234
    v_exp_f32 v15, v15
    v_smfmac_f32_16x16x64_bf16 a[128:131], a[144:147], v[20:27], v236
    s_barrier
    v_mfma_f32_16x16x32_bf16 v[4:7], a[80:83], a[148:151], 0
    s_add_u32 s72, s14, s32
    v_sub_f32 v16, v16, v235
    v_exp_f32 v16, v16
    v_mfma_f32_16x16x32_bf16 v[4:7], a[84:87], a[152:155], v[4:7]
    ds_read_b128 a[64:67], v212 offset:49152
    v_cvt_pk_bf16_f32 v69, v14, v15
    v_mfma_f32_16x16x32_bf16 v[4:7], a[88:91], a[156:159], v[4:7]
    s_addc_u32 s73, s15, 0
    v_sub_f32 v17, v17, v235
    v_exp_f32 v17, v17
    v_mfma_f32_16x16x32_bf16 v[4:7], a[92:95], a[160:163], v[4:7]
    ds_read_b64_tr_b16 a[96:97], v222 offset:32768
    v_cvt_pk_bf16_f32 v68, v12, v13
    v_mfma_f32_16x16x32_bf16 v[8:11], a[88:91], a[172:175], 0
    v_sub_f32 v18, v18, v235
    v_exp_f32 v18, v18
    v_mfma_f32_16x16x32_bf16 v[8:11], a[92:95], a[176:179], v[8:11]
    ds_read_b64_tr_b16 a[98:99], v222 offset:34816
    v_cvt_pk_bf16_f32 v76, v16, v17
    v_mfma_f32_16x16x32_bf16 v[8:11], a[80:83], a[164:167], v[8:11]
    v_sub_f32 v19, v19, v235
    v_exp_f32 v19, v19
    v_mfma_f32_16x16x32_bf16 v[8:11], a[84:87], a[168:171], v[8:11]
    global_load_lds_dwordx4 v228, s[74:75] offset:2048 nt
    v_mfma_f32_16x16x32_bf16 v[12:15], a[80:83], a[180:183], 0
    v_sub_f32 v4, v4, v232
    v_exp_f32 v4, v4
    v_mfma_f32_16x16x32_bf16 v[12:15], a[84:87], a[184:187], v[12:15]
    ds_read_b128 a[68:71], v213 offset:49152
    v_cvt_pk_bf16_f32 v77, v18, v19
    v_mfma_f32_16x16x32_bf16 v[12:15], a[88:91], a[188:191], v[12:15]
    v_sub_f32 v5, v5, v232
    v_exp_f32 v5, v5
    v_mfma_f32_16x16x32_bf16 v[12:15], a[92:95], a[192:195], v[12:15]
    ds_read_b64_tr_b16 a[100:101], v222 offset:36864
    v_mfma_f32_16x16x32_bf16 v[16:19], a[88:91], a[204:207], 0
    v_sub_f32 v6, v6, v232
    v_exp_f32 v6, v6
    v_mfma_f32_16x16x32_bf16 v[16:19], a[92:95], a[208:211], v[16:19]
    ds_read_b64_tr_b16 a[102:103], v222 offset:38912
    v_cvt_pk_bf16_f32 v54, v4, v5
    v_mfma_f32_16x16x32_bf16 v[16:19], a[80:83], a[196:199], v[16:19]
    v_sub_f32 v7, v7, v232
    v_exp_f32 v7, v7
    v_mfma_f32_16x16x32_bf16 v[16:19], a[84:87], a[200:203], v[16:19]
    global_load_lds_dwordx4 v229, s[74:75] offset:3072 nt
    v_mfma_f32_16x16x32_bf16 v[188:191], v[84:87], a[112:115], v[188:191]
    v_sub_f32 v8, v8, v233
    v_exp_f32 v8, v8
    v_mfma_f32_16x16x32_bf16 v[188:191], v[88:91], a[116:119], v[188:191]
    ds_read_b128 a[72:75], v214 offset:49152
    v_cvt_pk_bf16_f32 v55, v6, v7
    v_mfma_f32_16x16x32_bf16 v[188:191], v[116:119], a[120:123], v[188:191]
    v_sub_f32 v9, v9, v233
    v_exp_f32 v9, v9
    v_mfma_f32_16x16x32_bf16 v[188:191], v[120:123], a[124:127], v[188:191]
    ds_read_b64_tr_b16 a[104:105], v222 offset:40960
    v_mfma_f32_16x16x32_bf16 v[192:195], v[124:127], a[120:123], v[192:195]
    s_add_u32 m0, s33, 0x4000
    v_sub_f32 v10, v10, v233
    v_exp_f32 v10, v10
    v_mfma_f32_16x16x32_bf16 v[192:195], v[128:131], a[124:127], v[192:195]
    ds_read_b64_tr_b16 a[106:107], v222 offset:43008
    v_cvt_pk_bf16_f32 v62, v8, v9
    v_mfma_f32_16x16x32_bf16 v[192:195], v[92:95], a[112:115], v[192:195]
    v_sub_f32 v11, v11, v233
    v_exp_f32 v11, v11
    v_mfma_f32_16x16x32_bf16 v[192:195], v[96:99], a[116:119], v[192:195]
    global_load_lds_dwordx4 v224, s[72:73] nt
    v_mfma_f32_16x16x32_bf16 a[40:43], v[100:103], a[112:115], a[40:43]
    s_add_u32 s32, s64, 0x78000
    v_sub_f32 v12, v12, v234
    v_exp_f32 v12, v12
    v_mfma_f32_16x16x32_bf16 a[40:43], v[104:107], a[116:119], a[40:43]
    ds_read_b128 a[76:79], v215 offset:49152
    v_cvt_pk_bf16_f32 v63, v10, v11
    v_mfma_f32_16x16x32_bf16 a[40:43], v[132:135], a[120:123], a[40:43]
    s_and_b32 s32, s32, 0x7ffff
    v_sub_f32 v13, v13, v234
    v_exp_f32 v13, v13
    v_mfma_f32_16x16x32_bf16 a[40:43], v[136:139], a[124:127], a[40:43]
    ds_read_b64_tr_b16 a[108:109], v222 offset:45056
    v_mfma_f32_16x16x32_bf16 a[44:47], v[140:143], a[120:123], a[44:47]
    v_sub_f32 v14, v14, v234
    v_exp_f32 v14, v14
    v_mfma_f32_16x16x32_bf16 a[44:47], v[144:147], a[124:127], a[44:47]
    ds_read_b64_tr_b16 a[110:111], v222 offset:47104
    v_cvt_pk_bf16_f32 v70, v12, v13
    v_mfma_f32_16x16x32_bf16 a[44:47], v[108:111], a[112:115], a[44:47]
    s_waitcnt lgkmcnt(2)
    v_sub_f32 v15, v15, v234
    v_exp_f32 v15, v15
    v_mfma_f32_16x16x32_bf16 a[44:47], v[112:115], a[116:119], a[44:47]
    global_load_lds_dwordx4 v225, s[72:73] offset:1024 nt
    v_smfmac_f32_16x16x64_bf16 a[132:135], a[144:147], v[28:35], v236
M_stub8:
    s_cbranch_execz M_back
    v_mfma_f32_16x16x32_bf16 v[4:7], a[64:67], a[148:151], 0
    s_add_u32 s74, s12, s32
    v_sub_f32 v16, v16, v235
    v_exp_f32 v16, v16
    v_mfma_f32_16x16x32_bf16 v[4:7], a[68:71], a[152:155], v[4:7]
    ds_read_b128 a[80:83], v212 offset:53248
    v_cvt_pk_bf16_f32 v71, v14, v15
    v_mfma_f32_16x16x32_bf16 v[4:7], a[72:75], a[156:159], v[4:7]
    s_addc_u32 s75, s13, 0
    v_sub_f32 v17, v17, v235
    v_exp_f32 v17, v17
    v_mfma_f32_16x16x32_bf16 v[4:7], a[76:79], a[160:163], v[4:7]
    ds_read_b64_tr_b16 a[112:113], v223 offset:32768
    v_mfma_f32_16x16x32_bf16 v[8:11], a[72:75], a[172:175], 0
    v_sub_f32 v18, v18, v235
    v_exp_f32 v18, v18
    v_mfma_f32_16x16x32_bf16 v[8:11], a[76:79], a[176:179], v[8:11]
    ds_read_b64_tr_b16 a[114:115], v223 offset:34816
    v_cvt_pk_bf16_f32 v78, v16, v17
    v_mfma_f32_16x16x32_bf16 v[8:11], a[64:67], a[164:167], v[8:11]
    s_waitcnt lgkmcnt(3)
    v_sub_f32 v19, v19, v235
    v_exp_f32 v19, v19
    v_mfma_f32_16x16x32_bf16 v[8:11], a[68:71], a[168:171], v[8:11]
    global_load_lds_dwordx4 v226, s[72:73] offset:2048 nt
    v_mfma_f32_16x16x32_bf16 v[12:15], a[64:67], a[180:183], 0
    v_sub_f32 v4, v4, v232
    v_exp_f32 v4, v4
    v_mfma_f32_16x16x32_bf16 v[12:15], a[68:71], a[184:187], v[12:15]
    ds_read_b128 a[84:87], v213 offset:53248
    v_cvt_pk_bf16_f32 v79, v18, v19
    v_mfma_f32_16x16x32_bf16 v[12:15], a[72:75], a[188:191], v[12:15]
    v_sub_f32 v5, v5, v232
    v_exp_f32 v5, v5
    v_mfma_f32_16x16x32_bf16 v[12:15], a[76:79], a[192:195], v[12:15]
    ds_read_b64_tr_b16 a[116:117], v223 offset:36864
    v_mfma_f32_16x16x32_bf16 v[16:19], a[72:75], a[204:207], 0
    v_sub_f32 v6, v6, v232
    v_exp_f32 v6, v6
    v_mfma_f32_16x16x32_bf16 v[16:19], a[76:79], a[208:211], v[16:19]
    ds_read_b64_tr_b16 a[118:119], v223 offset:38912
    v_cvt_pk_bf16_f32 v56, v4, v5
    v_mfma_f32_16x16x32_bf16 v[16:19], a[64:67], a[196:199], v[16:19]
    v_sub_f32 v7, v7, v232
    v_exp_f32 v7, v7
    v_mfma_f32_16x16x32_bf16 v[16:19], a[68:71], a[200:203], v[16:19]
    global_load_lds_dwordx4 v227, s[72:73] offset:3072 nt
    v_mfma_f32_16x16x32_bf16 v[196:199], v[84:87], a[96:99], v[196:199]
    v_sub_f32 v8, v8, v233
    v_exp_f32 v8, v8
    v_mfma_f32_16x16x32_bf16 v[196:199], v[88:91], a[100:103], v[196:199]
    ds_read_b128 a[88:91], v214 offset:53248
    v_cvt_pk_bf16_f32 v57, v6, v7
    v_mfma_f32_16x16x32_bf16 v[196:199], v[116:119], a[104:107], v[196:199]
    v_sub_f32 v9, v9, v233
    v_exp_f32 v9, v9
    v_mfma_f32_16x16x32_bf16 v[196:199], v[120:123], a[108:111], v[196:199]
    ds_read_b64_tr_b16 a[120:121], v223 offset:40960
    v_mfma_f32_16x16x32_bf16 v[200:203], v[124:127], a[104:107], v[200:203]
    s_add_u32 m0, s31, 0x8000
    v_sub_f32 v10, v10, v233
    v_exp_f32 v10, v10
    v_mfma_f32_16x16x32_bf16 v[200:203], v[128:131], a[108:111], v[200:203]
    ds_read_b64_tr_b16 a[122:123], v223 offset:43008
    v_cvt_pk_bf16_f32 v64, v8, v9
    v_mfma_f32_16x16x32_bf16 v[200:203], v[92:95], a[96:99], v[200:203]
    v_sub_f32 v11, v11, v233
    v_exp_f32 v11, v11
    v_mfma_f32_16x16x32_bf16 v[200:203], v[96:99], a[100:103], v[200:203]
    global_load_lds_dwordx4 v228, s[74:75] nt
    v_mfma_f32_16x16x32_bf16 a[48:51], v[100:103], a[96:99], a[48:51]
    ds_read_b128 a[92:95], v215 offset:53248
    v_cvt_pk_bf16_f32 v65, v10, v11
    v_mfma_f32_16x16x32_bf16 a[48:51], v[104:107], a[100:103], a[48:51]
    ds_read_b64_tr_b16 a[124:125], v223 offset:45056
    v_mfma_f32_16x16x32_bf16 a[48:51], v[132:135], a[104:107], a[48:51]
    ds_read_b64_tr_b16 a[126:127], v223 offset:47104
    v_mfma_f32_16x16x32_bf16 a[48:51], v[136:139], a[108:111], a[48:51]
    global_load_lds_dwordx4 v229, s[74:75] offset:1024 nt
    v_mfma_f32_16x16x32_bf16 a[52:55], v[140:143], a[104:107], a[52:55]
    s_add_u32 s32, s67, 0x68000
    v_sub_f32 v12, v12, v234
    v_exp_f32 v12, v12
    v_mfma_f32_16x16x32_bf16 a[52:55], v[144:147], a[108:111], a[52:55]
    s_and_b32 s32, s32, 0x7ffff
    v_sub_f32 v13, v13, v234
    v_exp_f32 v13, v13
    v_mfma_f32_16x16x32_bf16 a[52:55], v[108:111], a[96:99], a[52:55]
    v_sub_f32 v14, v14, v234
    v_exp_f32 v14, v14
    v_mfma_f32_16x16x32_bf16 a[52:55], v[112:115], a[100:103], a[52:55]
    s_waitcnt vmcnt(10) lgkmcnt(0)
    v_sub_f32 v15, v15, v234
    v_exp_f32 v15, v15
    v_smfmac_f32_16x16x64_bf16 a[136:139], a[144:147], v[36:43], v236
    s_barrier
    v_mfma_f32_16x16x32_bf16 v[4:7], a[80:83], a[148:151], 0
    s_add_u32 s72, s14, s32
    v_sub_f32 v16, v16, v235
    v_exp_f32 v16, v16
    v_mfma_f32_16x16x32_bf16 v[4:7], a[84:87], a[152:155], v[4:7]
    ds_read_b128 a[64:67], v212
    v_cvt_pk_bf16_f32 v73, v14, v15
    v_mfma_f32_16x16x32_bf16 v[4:7], a[88:91], a[156:159], v[4:7]
    s_addc_u32 s73, s15, 0
    v_sub_f32 v17, v17, v235
    v_exp_f32 v17, v17
    v_mfma_f32_16x16x32_bf16 v[4:7], a[92:95], a[160:163], v[4:7]
    ds_read_b64_tr_b16 a[96:97], v220
    v_cvt_pk_bf16_f32 v72, v12, v13
    v_mfma_f32_16x16x32_bf16 v[8:11], a[88:91], a[172:175], 0
    v_sub_f32 v18, v18, v235
    v_exp_f32 v18, v18
    v_mfma_f32_16x16x32_bf16 v[8:11], a[92:95], a[176:179], v[8:11]
    ds_read_b64_tr_b16 a[98:99], v220 offset:2048
    v_cvt_pk_bf16_f32 v80, v16, v17
    v_mfma_f32_16x16x32_bf16 v[8:11], a[80:83], a[164:167], v[8:11]
    v_sub_f32 v19, v19, v235
    v_exp_f32 v19, v19
    v_mfma_f32_16x16x32_bf16 v[8:11], a[84:87], a[168:171], v[8:11]
    global_load_lds_dwordx4 v228, s[74:75] offset:2048 nt
    v_mfma_f32_16x16x32_bf16 v[12:15], a[80:83], a[180:183], 0
    v_sub_f32 v4, v4, v232
    v_exp_f32 v4, v4
    v_mfma_f32_16x16x32_bf16 v[12:15], a[84:87], a[184:187], v[12:15]
    ds_read_b128 a[68:71], v213
    v_cvt_pk_bf16_f32 v81, v18, v19
    v_mfma_f32_16x16x32_bf16 v[12:15], a[88:91], a[188:191], v[12:15]
    v_sub_f32 v5, v5, v232
    v_exp_f32 v5, v5
    v_mfma_f32_16x16x32_bf16 v[12:15], a[92:95], a[192:195], v[12:15]
    ds_read_b64_tr_b16 a[100:101], v220 offset:4096
    v_mfma_f32_16x16x32_bf16 v[16:19], a[88:91], a[204:207], 0
    v_sub_f32 v6, v6, v232
    v_exp_f32 v6, v6
    v_mfma_f32_16x16x32_bf16 v[16:19], a[92:95], a[208:211], v[16:19]
    ds_read_b64_tr_b16 a[102:103], v220 offset:6144
    v_cvt_pk_bf16_f32 v58, v4, v5
    v_mfma_f32_16x16x32_bf16 v[16:19], a[80:83], a[196:199], v[16:19]
    v_sub_f32 v7, v7, v232
    v_exp_f32 v7, v7
    v_mfma_f32_16x16x32_bf16 v[16:19], a[84:87], a[200:203], v[16:19]
    global_load_lds_dwordx4 v229, s[74:75] offset:3072 nt
    v_mfma_f32_16x16x32_bf16 v[204:207], v[84:87], a[112:115], v[204:207]
    v_sub_f32 v8, v8, v233
    v_exp_f32 v8, v8
    v_mfma_f32_16x16x32_bf16 v[204:207], v[88:91], a[116:119], v[204:207]
    ds_read_b128 a[72:75], v214
    v_cvt_pk_bf16_f32 v59, v6, v7
    v_mfma_f32_16x16x32_bf16 v[204:207], v[116:119], a[120:123], v[204:207]
    v_sub_f32 v9, v9, v233
    v_exp_f32 v9, v9
    v_mfma_f32_16x16x32_bf16 v[204:207], v[120:123], a[124:127], v[204:207]
    ds_read_b64_tr_b16 a[104:105], v220 offset:8192
    v_mfma_f32_16x16x32_bf16 v[208:211], v[124:127], a[120:123], v[208:211]
    s_add_u32 m0, s33, 0x6000
    v_sub_f32 v10, v10, v233
    v_exp_f32 v10, v10
    v_mfma_f32_16x16x32_bf16 v[208:211], v[128:131], a[124:127], v[208:211]
    ds_read_b64_tr_b16 a[106:107], v220 offset:10240
    v_cvt_pk_bf16_f32 v66, v8, v9
    v_mfma_f32_16x16x32_bf16 v[208:211], v[92:95], a[112:115], v[208:211]
    v_sub_f32 v11, v11, v233
    v_exp_f32 v11, v11
    v_mfma_f32_16x16x32_bf16 v[208:211], v[96:99], a[116:119], v[208:211]
    global_load_lds_dwordx4 v224, s[72:73] nt
    v_mfma_f32_16x16x32_bf16 a[56:59], v[100:103], a[112:115], a[56:59]
    s_add_u32 s32, s65, 0x78000
    v_sub_f32 v12, v12, v234
    v_exp_f32 v12, v12
    v_mfma_f32_16x16x32_bf16 a[56:59], v[104:107], a[116:119], a[56:59]
    ds_read_b128 a[76:79], v215
    v_cvt_pk_bf16_f32 v67, v10, v11
    v_mfma_f32_16x16x32_bf16 a[56:59], v[132:135], a[120:123], a[56:59]
    s_and_b32 s32, s32, 0x7ffff
    v_sub_f32 v13, v13, v234
    v_exp_f32 v13, v13
    v_mfma_f32_16x16x32_bf16 a[56:59], v[136:139], a[124:127], a[56:59]
    ds_read_b64_tr_b16 a[108:109], v220 offset:12288
    v_mfma_f32_16x16x32_bf16 a[60:63], v[140:143], a[120:123], a[60:63]
    v_sub_f32 v14, v14, v234
    v_exp_f32 v14, v14
    v_mfma_f32_16x16x32_bf16 a[60:63], v[144:147], a[124:127], a[60:63]
    ds_read_b64_tr_b16 a[110:111], v220 offset:14336
    v_cvt_pk_bf16_f32 v74, v12, v13
    v_mfma_f32_16x16x32_bf16 a[60:63], v[108:111], a[112:115], a[60:63]
    s_waitcnt lgkmcnt(2)
    v_sub_f32 v15, v15, v234
    v_exp_f32 v15, v15
    v_mfma_f32_16x16x32_bf16 a[60:63], v[112:115], a[116:119], a[60:63]
    global_load_lds_dwordx4 v225, s[72:73] offset:1024 nt
    v_smfmac_f32_16x16x64_bf16 a[140:143], a[144:147], v[44:51], v236
    v_mfma_f32_16x16x32_bf16 v[4:7], a[64:67], a[148:151], 0
    s_add_u32 s74, s12, s32
    v_sub_f32 v16, v16, v235
    v_exp_f32 v16, v16
    v_mfma_f32_16x16x32_bf16 v[4:7], a[68:71], a[152:155], v[4:7]
    ds_read_b128 a[80:83], v212 offset:4096
    v_cvt_pk_bf16_f32 v75, v14, v15
    v_mfma_f32_16x16x32_bf16 v[4:7], a[72:75], a[156:159], v[4:7]
    s_addc_u32 s75, s13, 0
    v_sub_f32 v17, v17, v235
    v_exp_f32 v17, v17
    v_mfma_f32_16x16x32_bf16 v[4:7], a[76:79], a[160:163], v[4:7]
    ds_read_b64_tr_b16 a[112:113], v221
    v_mfma_f32_16x16x32_bf16 v[8:11], a[72:75], a[172:175], 0
    v_sub_f32 v18, v18, v235
    v_exp_f32 v18, v18
    v_mfma_f32_16x16x32_bf16 v[8:11], a[76:79], a[176:179], v[8:11]
    ds_read_b64_tr_b16 a[114:115], v221 offset:2048
    v_cvt_pk_bf16_f32 v82, v16, v17
    v_mfma_f32_16x16x32_bf16 v[8:11], a[64:67], a[164:167], v[8:11]
    s_waitcnt lgkmcnt(3)
    v_sub_f32 v19, v19, v235
    v_exp_f32 v19, v19
    v_mfma_f32_16x16x32_bf16 v[8:11], a[68:71], a[168:171], v[8:11]
    global_load_lds_dwordx4 v226, s[72:73] offset:2048 nt
    v_mfma_f32_16x16x32_bf16 v[12:15], a[64:67], a[180:183], 0
    v_sub_f32 v4, v4, v232
    v_exp_f32 v4, v4
    v_mfma_f32_16x16x32_bf16 v[12:15], a[68:71], a[184:187], v[12:15]
    ds_read_b128 a[84:87], v213 offset:4096
    v_cvt_pk_bf16_f32 v83, v18, v19
    v_mfma_f32_16x16x32_bf16 v[12:15], a[72:75], a[188:191], v[12:15]
    v_sub_f32 v5, v5, v232
    v_exp_f32 v5, v5
    v_mfma_f32_16x16x32_bf16 v[12:15], a[76:79], a[192:195], v[12:15]
    ds_read_b64_tr_b16 a[116:117], v221 offset:4096
    v_mfma_f32_16x16x32_bf16 v[16:19], a[72:75], a[204:207], 0
    v_sub_f32 v6, v6, v232
    v_exp_f32 v6, v6
    v_mfma_f32_16x16x32_bf16 v[16:19], a[76:79], a[208:211], v[16:19]
    ds_read_b64_tr_b16 a[118:119], v221 offset:6144
    v_cvt_pk_bf16_f32 v84, v4, v5
    v_mfma_f32_16x16x32_bf16 v[16:19], a[64:67], a[196:199], v[16:19]
    v_sub_f32 v7, v7, v232
    v_exp_f32 v7, v7
    v_mfma_f32_16x16x32_bf16 v[16:19], a[68:71], a[200:203], v[16:19]
    global_load_lds_dwordx4 v227, s[72:73] offset:3072 nt
    v_mfma_f32_16x16x32_bf16 v[148:151], v[20:23], a[96:99], v[148:151]
    v_sub_f32 v8, v8, v233
    v_exp_f32 v8, v8
    v_mfma_f32_16x16x32_bf16 v[148:151], v[24:27], a[100:103], v[148:151]
    ds_read_b128 a[88:91], v214 offset:4096
    v_cvt_pk_bf16_f32 v85, v6, v7
    v_mfma_f32_16x16x32_bf16 v[148:151], v[52:55], a[104:107], v[148:151]
    v_sub_f32 v9, v9, v233
    v_exp_f32 v9, v9
    v_mfma_f32_16x16x32_bf16 v[148:151], v[56:59], a[108:111], v[148:151]
    ds_read_b64_tr_b16 a[120:121], v221 offset:8192
    v_mfma_f32_16x16x32_bf16 v[152:155], v[60:63], a[104:107], v[152:155]
    s_add_u32 m0, s31, 0xc000
    v_sub_f32 v10, v10, v233
    v_exp_f32 v10, v10
    v_mfma_f32_16x16x32_bf16 v[152:155], v[64:67], a[108:111], v[152:155]
    ds_read_b64_tr_b16 a[122:123], v221 offset:10240
    v_cvt_pk_bf16_f32 v92, v8, v9
    v_mfma_f32_16x16x32_bf16 v[152:155], v[28:31], a[96:99], v[152:155]
    v_sub_f32 v11, v11, v233
    v_exp_f32 v11, v11
    v_mfma_f32_16x16x32_bf16 v[152:155], v[32:35], a[100:103], v[152:155]
    global_load_lds_dwordx4 v228, s[74:75] nt
    v_mfma_f32_16x16x32_bf16 a[0:3], v[36:39], a[96:99], a[0:3]
    ds_read_b128 a[92:95], v215 offset:4096
    v_cvt_pk_bf16_f32 v93, v10, v11
    v_mfma_f32_16x16x32_bf16 a[0:3], v[40:43], a[100:103], a[0:3]
    ds_read_b64_tr_b16 a[124:125], v221 offset:12288
    v_mfma_f32_16x16x32_bf16 a[0:3], v[68:71], a[104:107], a[0:3]
    ds_read_b64_tr_b16 a[126:127], v221 offset:14336
    v_mfma_f32_16x16x32_bf16 a[0:3], v[72:75], a[108:111], a[0:3]
    global_load_lds_dwordx4 v229, s[74:75] offset:1024 nt
    v_mfma_f32_16x16x32_bf16 a[4:7], v[76:79], a[104:107], a[4:7]
    s_add_u32 s32, s66, 0x70000
    v_sub_f32 v12, v12, v234
    v_exp_f32 v12, v12
    v_mfma_f32_16x16x32_bf16 a[4:7], v[80:83], a[108:111], a[4:7]
    s_and_b32 s32, s32, 0x7ffff
    v_sub_f32 v13, v13, v234
    v_exp_f32 v13, v13
    v_mfma_f32_16x16x32_bf16 a[4:7], v[44:47], a[96:99], a[4:7]
    v_sub_f32 v14, v14, v234
    v_exp_f32 v14, v14
    v_mfma_f32_16x16x32_bf16 a[4:7], v[48:51], a[100:103], a[4:7]
    s_waitcnt vmcnt(14) lgkmcnt(0)
    v_sub_f32 v15, v15, v234
    v_exp_f32 v15, v15
    v_smfmac_f32_16x16x64_bf16 a[128:131], a[144:147], v[52:59], v236
    s_barrier
    v_mfma_f32_16x16x32_bf16 v[4:7], a[80:83], a[148:151], 0
    s_add_u32 s72, s14, s32
    v_sub_f32 v16, v16, v235
    v_exp_f32 v16, v16
    v_mfma_f32_16x16x32_bf16 v[4:7], a[84:87], a[152:155], v[4:7]
    ds_read_b128 a[64:67], v212 offset:16384
    v_cvt_pk_bf16_f32 v101, v14, v15
    v_mfma_f32_16x16x32_bf16 v[4:7], a[88:91], a[156:159], v[4:7]
    s_addc_u32 s73, s15, 0
    v_sub_f32 v17, v17, v235
    v_exp_f32 v17, v17
    v_mfma_f32_16x16x32_bf16 v[4:7], a[92:95], a[160:163], v[4:7]
    ds_read_b64_tr_b16 a[96:97], v222
    v_cvt_pk_bf16_f32 v100, v12, v13
    v_mfma_f32_16x16x32_bf16 v[8:11], a[88:91], a[172:175], 0
    v_sub_f32 v18, v18, v235
    v_exp_f32 v18, v18
    v_mfma_f32_16x16x32_bf16 v[8:11], a[92:95], a[176:179], v[8:11]
    ds_read_b64_tr_b16 a[98:99], v222 offset:2048
    v_cvt_pk_bf16_f32 v108, v16, v17
    v_mfma_f32_16x16x32_bf16 v[8:11], a[80:83], a[164:167], v[8:11]
    v_sub_f32 v19, v19, v235
    v_exp_f32 v19, v19
    v_mfma_f32_16x16x32_bf16 v[8:11], a[84:87], a[168:171], v[8:11]
    global_load_lds_dwordx4 v228, s[74:75] offset:2048 nt
    v_mfma_f32_16x16x32_bf16 v[12:15], a[80:83], a[180:183], 0
    v_sub_f32 v4, v4, v232
    v_exp_f32 v4, v4
    v_mfma_f32_16x16x32_bf16 v[12:15], a[84:87], a[184:187], v[12:15]
    ds_read_b128 a[68:71], v213 offset:16384
    v_cvt_pk_bf16_f32 v109, v18, v19
    v_mfma_f32_16x16x32_bf16 v[12:15], a[88:91], a[188:191], v[12:15]
    v_sub_f32 v5, v5, v232
    v_exp_f32 v5, v5
    v_mfma_f32_16x16x32_bf16 v[12:15], a[92:95], a[192:195], v[12:15]
    ds_read_b64_tr_b16 a[100:101], v222 offset:4096
    v_mfma_f32_16x16x32_bf16 v[16:19], a[88:91], a[204:207], 0
    v_sub_f32 v6, v6, v232
    v_exp_f32 v6, v6
    v_mfma_f32_16x16x32_bf16 v[16:19], a[92:95], a[208:211], v[16:19]
    ds_read_b64_tr_b16 a[102:103], v222 offset:6144
    v_cvt_pk_bf16_f32 v86, v4, v5
    v_mfma_f32_16x16x32_bf16 v[16:19], a[80:83], a[196:199], v[16:19]
    v_sub_f32 v7, v7, v232
    v_exp_f32 v7, v7
    v_mfma_f32_16x16x32_bf16 v[16:19], a[84:87], a[200:203], v[16:19]
    global_load_lds_dwordx4 v229, s[74:75] offset:3072 nt
    v_mfma_f32_16x16x32_bf16 v[156:159], v[20:23], a[112:115], v[156:159]
    v_sub_f32 v8, v8, v233
    v_exp_f32 v8, v8
    v_mfma_f32_16x16x32_bf16 v[156:159], v[24:27], a[116:119], v[156:159]
    ds_read_b128 a[72:75], v214 offset:16384
    v_cvt_pk_bf16_f32 v87, v6, v7
    v_mfma_f32_16x16x32_bf16 v[156:159], v[52:55], a[120:123], v[156:159]
    v_sub_f32 v9, v9, v233
    v_exp_f32 v9, v9
    v_mfma_f32_16x16x32_bf16 v[156:159], v[56:59], a[124:127], v[156:159]
    ds_read_b64_tr_b16 a[104:105], v222 offset:8192
    v_mfma_f32_16x16x32_bf16 v[160:163], v[60:63], a[120:123], v[160:163]
    s_add_u32 m0, s33, 0x8000
    v_sub_f32 v10, v10, v233
    v_exp_f32 v10, v10
    v_mfma_f32_16x16x32_bf16 v[160:163], v[64:67], a[124:127], v[160:163]
    ds_read_b64_tr_b16 a[106:107], v222 offset:10240
    v_cvt_pk_bf16_f32 v94, v8, v9
    v_mfma_f32_16x16x32_bf16 v[160:163], v[28:31], a[112:115], v[160:163]
    v_sub_f32 v11, v11, v233
    v_exp_f32 v11, v11
    v_mfma_f32_16x16x32_bf16 v[160:163], v[32:35], a[116:119], v[160:163]
    global_load_lds_dwordx4 v224, s[72:73] nt
    v_mfma_f32_16x16x32_bf16 a[8:11], v[36:39], a[112:115], a[8:11]
    s_add_u32 s32, s66, 0x78000
    v_sub_f32 v12, v12, v234
    v_exp_f32 v12, v12
    v_mfma_f32_16x16x32_bf16 a[8:11], v[40:43], a[116:119], a[8:11]
    ds_read_b128 a[76:79], v215 offset:16384
    v_cvt_pk_bf16_f32 v95, v10, v11
    v_mfma_f32_16x16x32_bf16 a[8:11], v[68:71], a[120:123], a[8:11]
    s_and_b32 s32, s32, 0x7ffff
    v_sub_f32 v13, v13, v234
    v_exp_f32 v13, v13
    v_mfma_f32_16x16x32_bf16 a[8:11], v[72:75], a[124:127], a[8:11]
    ds_read_b64_tr_b16 a[108:109], v222 offset:12288
    v_mfma_f32_16x16x32_bf16 a[12:15], v[76:79], a[120:123], a[12:15]
    v_sub_f32 v14, v14, v234
    v_exp_f32 v14, v14
    v_mfma_f32_16x16x32_bf16 a[12:15], v[80:83], a[124:127], a[12:15]
    ds_read_b64_tr_b16 a[110:111], v222 offset:14336
    v_cvt_pk_bf16_f32 v102, v12, v13
    v_mfma_f32_16x16x32_bf16 a[12:15], v[44:47], a[112:115], a[12:15]
    s_waitcnt lgkmcnt(2)
    v_sub_f32 v15, v15, v234
    v_exp_f32 v15, v15
    v_mfma_f32_16x16x32_bf16 a[12:15], v[48:51], a[116:119], a[12:15]
    global_load_lds_dwordx4 v225, s[72:73] offset:1024 nt
    v_smfmac_f32_16x16x64_bf16 a[132:135], a[144:147], v[60:67], v236
    v_mfma_f32_16x16x32_bf16 v[4:7], a[64:67], a[148:151], 0
    s_add_u32 s74, s14, s32
    v_sub_f32 v16, v16, v235
    v_exp_f32 v16, v16
    v_mfma_f32_16x16x32_bf16 v[4:7], a[68:71], a[152:155], v[4:7]
    ds_read_b128 a[80:83], v212 offset:20480
    v_cvt_pk_bf16_f32 v103, v14, v15
    v_mfma_f32_16x16x32_bf16 v[4:7], a[72:75], a[156:159], v[4:7]
    s_addc_u32 s75, s15, 0
    v_sub_f32 v17, v17, v235
    v_exp_f32 v17, v17
    v_mfma_f32_16x16x32_bf16 v[4:7], a[76:79], a[160:163], v[4:7]
    ds_read_b64_tr_b16 a[112:113], v223
    v_mfma_f32_16x16x32_bf16 v[8:11], a[72:75], a[172:175], 0
    v_sub_f32 v18, v18, v235
    v_exp_f32 v18, v18
    v_mfma_f32_16x16x32_bf16 v[8:11], a[76:79], a[176:179], v[8:11]
    ds_read_b64_tr_b16 a[114:115], v223 offset:2048
    v_cvt_pk_bf16_f32 v110, v16, v17
    v_mfma_f32_16x16x32_bf16 v[8:11], a[64:67], a[164:167], v[8:11]
    s_waitcnt lgkmcnt(3)
    v_sub_f32 v19, v19, v235
    v_exp_f32 v19, v19
    v_mfma_f32_16x16x32_bf16 v[8:11], a[68:71], a[168:171], v[8:11]
    global_load_lds_dwordx4 v226, s[72:73] offset:2048 nt
    v_mfma_f32_16x16x32_bf16 v[12:15], a[64:67], a[180:183], 0
    v_sub_f32 v4, v4, v232
    v_exp_f32 v4, v4
    v_mfma_f32_16x16x32_bf16 v[12:15], a[68:71], a[184:187], v[12:15]
    ds_read_b128 a[84:87], v213 offset:20480
    v_cvt_pk_bf16_f32 v111, v18, v19
    v_mfma_f32_16x16x32_bf16 v[12:15], a[72:75], a[188:191], v[12:15]
    v_sub_f32 v5, v5, v232
    v_exp_f32 v5, v5
    v_mfma_f32_16x16x32_bf16 v[12:15], a[76:79], a[192:195], v[12:15]
    ds_read_b64_tr_b16 a[116:117], v223 offset:4096
    v_mfma_f32_16x16x32_bf16 v[16:19], a[72:75], a[204:207], 0
    v_sub_f32 v6, v6, v232
    v_exp_f32 v6, v6
    v_mfma_f32_16x16x32_bf16 v[16:19], a[76:79], a[208:211], v[16:19]
    ds_read_b64_tr_b16 a[118:119], v223 offset:6144
    v_cvt_pk_bf16_f32 v88, v4, v5
    v_mfma_f32_16x16x32_bf16 v[16:19], a[64:67], a[196:199], v[16:19]
    v_sub_f32 v7, v7, v232
    v_exp_f32 v7, v7
    v_mfma_f32_16x16x32_bf16 v[16:19], a[68:71], a[200:203], v[16:19]
    global_load_lds_dwordx4 v227, s[72:73] offset:3072 nt
    v_mfma_f32_16x16x32_bf16 v[164:167], v[20:23], a[96:99], v[164:167]
    v_sub_f32 v8, v8, v233
    v_exp_f32 v8, v8
    v_mfma_f32_16x16x32_bf16 v[164:167], v[24:27], a[100:103], v[164:167]
    ds_read_b128 a[88:91], v214 offset:20480
    v_cvt_pk_bf16_f32 v89, v6, v7
    v_mfma_f32_16x16x32_bf16 v[164:167], v[52:55], a[104:107], v[164:167]
    v_sub_f32 v9, v9, v233
    v_exp_f32 v9, v9
    v_mfma_f32_16x16x32_bf16 v[164:167], v[56:59], a[108:111], v[164:167]
    ds_read_b64_tr_b16 a[120:121], v223 offset:8192
    v_mfma_f32_16x16x32_bf16 v[168:171], v[60:63], a[104:107], v[168:171]
    s_add_u32 m0, s33, 0xa000
    v_sub_f32 v10, v10, v233
    v_exp_f32 v10, v10
    v_mfma_f32_16x16x32_bf16 v[168:171], v[64:67], a[108:111], v[168:171]
    ds_read_b64_tr_b16 a[122:123], v223 offset:10240
    v_cvt_pk_bf16_f32 v96, v8, v9
    v_mfma_f32_16x16x32_bf16 v[168:171], v[28:31], a[96:99], v[168:171]
    v_sub_f32 v11, v11, v233
    v_exp_f32 v11, v11
    v_mfma_f32_16x16x32_bf16 v[168:171], v[32:35], a[100:103], v[168:171]
    global_load_lds_dwordx4 v224, s[74:75] nt
    v_mfma_f32_16x16x32_bf16 a[16:19], v[36:39], a[96:99], a[16:19]
    ds_read_b128 a[92:95], v215 offset:20480
    v_cvt_pk_bf16_f32 v97, v10, v11
    v_mfma_f32_16x16x32_bf16 a[16:19], v[40:43], a[100:103], a[16:19]
    ds_read_b64_tr_b16 a[124:125], v223 offset:12288
    v_mfma_f32_16x16x32_bf16 a[16:19], v[68:71], a[104:107], a[16:19]
    ds_read_b64_tr_b16 a[126:127], v223 offset:14336
    v_mfma_f32_16x16x32_bf16 a[16:19], v[72:75], a[108:111], a[16:19]
    global_load_lds_dwordx4 v225, s[74:75] offset:1024 nt
    v_mfma_f32_16x16x32_bf16 a[20:23], v[76:79], a[104:107], a[20:23]
    s_add_u32 s32, s67, 0x70000
    v_sub_f32 v12, v12, v234
    v_exp_f32 v12, v12
    v_mfma_f32_16x16x32_bf16 a[20:23], v[80:83], a[108:111], a[20:23]
    s_and_b32 s32, s32, 0x7ffff
    v_sub_f32 v13, v13, v234
    v_exp_f32 v13, v13
    v_mfma_f32_16x16x32_bf16 a[20:23], v[44:47], a[96:99], a[20:23]
    v_sub_f32 v14, v14, v234
    v_exp_f32 v14, v14
    v_mfma_f32_16x16x32_bf16 a[20:23], v[48:51], a[100:103], a[20:23]
    s_waitcnt vmcnt(10) lgkmcnt(0)
    v_sub_f32 v15, v15, v234
    v_exp_f32 v15, v15
    v_smfmac_f32_16x16x64_bf16 a[136:139], a[144:147], v[68:75], v236
    s_barrier
    v_mfma_f32_16x16x32_bf16 v[4:7], a[80:83], a[148:151], 0
    s_add_u32 s72, s14, s32
    v_sub_f32 v16, v16, v235
    v_exp_f32 v16, v16
    v_mfma_f32_16x16x32_bf16 v[4:7], a[84:87], a[152:155], v[4:7]
    ds_read_b128 a[64:67], v212 offset:32768
    v_cvt_pk_bf16_f32 v105, v14, v15
    v_mfma_f32_16x16x32_bf16 v[4:7], a[88:91], a[156:159], v[4:7]
    s_addc_u32 s73, s15, 0
    v_sub_f32 v17, v17, v235
    v_exp_f32 v17, v17
    v_mfma_f32_16x16x32_bf16 v[4:7], a[92:95], a[160:163], v[4:7]
    ds_read_b64_tr_b16 a[96:97], v220 offset:16384
    v_cvt_pk_bf16_f32 v104, v12, v13
    v_mfma_f32_16x16x32_bf16 v[8:11], a[88:91], a[172:175], 0
    v_sub_f32 v18, v18, v235
    v_exp_f32 v18, v18
    v_mfma_f32_16x16x32_bf16 v[8:11], a[92:95], a[176:179], v[8:11]
    ds_read_b64_tr_b16 a[98:99], v220 offset:18432
    v_cvt_pk_bf16_f32 v112, v16, v17
    v_mfma_f32_16x16x32_bf16 v[8:11], a[80:83], a[164:167], v[8:11]
    v_sub_f32 v19, v19, v235
    v_exp_f32 v19, v19
    v_mfma_f32_16x16x32_bf16 v[8:11], a[84:87], a[168:171], v[8:11]
    global_load_lds_dwordx4 v226, s[74:75] offset:2048 nt
    v_mfma_f32_16x16x32_bf16 v[12:15], a[80:83], a[180:183], 0
    v_sub_f32 v4, v4, v232
    v_exp_f32 v4, v4
    v_mfma_f32_16x16x32_bf16 v[12:15], a[84:87], a[184:187], v[12:15]
    ds_read_b128 a[68:71], v213 offset:32768
    v_cvt_pk_bf16_f32 v113, v18, v19
    v_mfma_f32_16x16x32_bf16 v[12:15], a[88:91], a[188:191], v[12:15]
    v_sub_f32 v5, v5, v232
    v_exp_f32 v5, v5
    v_mfma_f32_16x16x32_bf16 v[12:15], a[92:95], a[192:195], v[12:15]
    ds_read_b64_tr_b16 a[100:101], v220 offset:20480
    v_mfma_f32_16x16x32_bf16 v[16:19], a[88:91], a[204:207], 0
    v_sub_f32 v6, v6, v232
    v_exp_f32 v6, v6
    v_mfma_f32_16x16x32_bf16 v[16:19], a[92:95], a[208:211], v[16:19]
    ds_read_b64_tr_b16 a[102:103], v220 offset:22528
    v_cvt_pk_bf16_f32 v90, v4, v5
    v_mfma_f32_16x16x32_bf16 v[16:19], a[80:83], a[196:199], v[16:19]
    v_sub_f32 v7, v7, v232
    v_exp_f32 v7, v7
    v_mfma_f32_16x16x32_bf16 v[16:19], a[84:87], a[200:203], v[16:19]
    global_load_lds_dwordx4 v227, s[74:75] offset:3072 nt
    v_mfma_f32_16x16x32_bf16 v[172:175], v[20:23], a[112:115], v[172:175]
    v_sub_f32 v8, v8, v233
    v_exp_f32 v8, v8
    v_mfma_f32_16x16x32_bf16 v[172:175], v[24:27], a[116:119], v[172:175]
    ds_read_b128 a[72:75], v214 offset:32768
    v_cvt_pk_bf16_f32 v91, v6, v7
    v_mfma_f32_16x16x32_bf16 v[172:175], v[52:55], a[120:123], v[172:175]
    v_sub_f32 v9, v9, v233
    v_exp_f32 v9, v9
    v_mfma_f32_16x16x32_bf16 v[172:175], v[56:59], a[124:127], v[172:175]
    ds_read_b64_tr_b16 a[104:105], v220 offset:24576
    v_mfma_f32_16x16x32_bf16 v[176:179], v[60:63], a[120:123], v[176:179]
    s_add_u32 m0, s33, 0x0
    v_sub_f32 v10, v10, v233
    v_exp_f32 v10, v10
    v_mfma_f32_16x16x32_bf16 v[176:179], v[64:67], a[124:127], v[176:179]
    ds_read_b64_tr_b16 a[106:107], v220 offset:26624
    v_cvt_pk_bf16_f32 v98, v8, v9
    v_mfma_f32_16x16x32_bf16 v[176:179], v[28:31], a[112:115], v[176:179]
    v_sub_f32 v11, v11, v233
    v_exp_f32 v11, v11
    v_mfma_f32_16x16x32_bf16 v[176:179], v[32:35], a[116:119], v[176:179]
    global_load_lds_dwordx4 v224, s[72:73] nt
    v_mfma_f32_16x16x32_bf16 a[24:27], v[36:39], a[112:115], a[24:27]
    s_add_u32 s32, s67, 0x78000
    v_sub_f32 v12, v12, v234
    v_exp_f32 v12, v12
    v_mfma_f32_16x16x32_bf16 a[24:27], v[40:43], a[116:119], a[24:27]
    ds_read_b128 a[76:79], v215 offset:32768
    v_cvt_pk_bf16_f32 v99, v10, v11
    v_mfma_f32_16x16x32_bf16 a[24:27], v[68:71], a[120:123], a[24:27]
    s_and_b32 s32, s32, 0x7ffff
    v_sub_f32 v13, v13, v234
    v_exp_f32 v13, v13
    v_mfma_f32_16x16x32_bf16 a[24:27], v[72:75], a[124:127], a[24:27]
    ds_read_b64_tr_b16 a[108:109], v220 offset:28672
    v_mfma_f32_16x16x32_bf16 a[28:31], v[76:79], a[120:123], a[28:31]
    v_sub_f32 v14, v14, v234
    v_exp_f32 v14, v14
    v_mfma_f32_16x16x32_bf16 a[28:31], v[80:83], a[124:127], a[28:31]
    ds_read_b64_tr_b16 a[110:111], v220 offset:30720
    v_cvt_pk_bf16_f32 v106, v12, v13
    v_mfma_f32_16x16x32_bf16 a[28:31], v[44:47], a[112:115], a[28:31]
    s_waitcnt lgkmcnt(2)
    v_sub_f32 v15, v15, v234
    v_exp_f32 v15, v15
    v_mfma_f32_16x16x32_bf16 a[28:31], v[48:51], a[116:119], a[28:31]
    global_load_lds_dwordx4 v225, s[72:73] offset:1024 nt
    v_smfmac_f32_16x16x64_bf16 a[140:143], a[144:147], v[76:83], v236
    v_mfma_f32_16x16x32_bf16 v[4:7], a[64:67], a[180:183], 0
    s_add_u32 s74, s14, s32
    v_sub_f32 v16, v16, v235
    v_exp_f32 v16, v16
    v_mfma_f32_16x16x32_bf16 v[4:7], a[68:71], a[184:187], v[4:7]
    ds_read_b128 a[80:83], v212 offset:36864
    v_cvt_pk_bf16_f32 v107, v14, v15
    v_mfma_f32_16x16x32_bf16 v[4:7], a[72:75], a[188:191], v[4:7]
    s_addc_u32 s75, s15, 0
    v_sub_f32 v17, v17, v235
    v_exp_f32 v17, v17
    v_mfma_f32_16x16x32_bf16 v[4:7], a[76:79], a[192:195], v[4:7]
    ds_read_b64_tr_b16 a[112:113], v221 offset:16384
    v_mfma_f32_16x16x32_bf16 v[8:11], a[72:75], a[204:207], 0
    v_sub_f32 v18, v18, v235
    v_exp_f32 v18, v18
    v_mfma_f32_16x16x32_bf16 v[8:11], a[76:79], a[208:211], v[8:11]
    ds_read_b64_tr_b16 a[114:115], v221 offset:18432
    v_cvt_pk_bf16_f32 v114, v16, v17
    v_mfma_f32_16x16x32_bf16 v[8:11], a[64:67], a[196:199], v[8:11]
    s_waitcnt lgkmcnt(3)
    v_sub_f32 v19, v19, v235
    v_exp_f32 v19, v19
    v_mfma_f32_16x16x32_bf16 v[8:11], a[68:71], a[200:203], v[8:11]
    global_load_lds_dwordx4 v226, s[72:73] offset:2048 nt
    v_mfma_f32_16x16x32_bf16 v[12:15], a[64:67], a[148:151], 0
    v_sub_f32 v4, v4, v234
    v_exp_f32 v4, v4
    v_mfma_f32_16x16x32_bf16 v[12:15], a[68:71], a[152:155], v[12:15]
    ds_read_b128 a[84:87], v213 offset:36864
    v_cvt_pk_bf16_f32 v115, v18, v19
    v_mfma_f32_16x16x32_bf16 v[12:15], a[72:75], a[156:159], v[12:15]
    v_sub_f32 v5, v5, v234
    v_exp_f32 v5, v5
    v_mfma_f32_16x16x32_bf16 v[12:15], a[76:79], a[160:163], v[12:15]
    ds_read_b64_tr_b16 a[116:117], v221 offset:20480
    v_mfma_f32_16x16x32_bf16 v[16:19], a[72:75], a[172:175], 0
    v_sub_f32 v6, v6, v234
    v_exp_f32 v6, v6
    v_mfma_f32_16x16x32_bf16 v[16:19], a[76:79], a[176:179], v[16:19]
    ds_read_b64_tr_b16 a[118:119], v221 offset:22528
    v_cvt_pk_bf16_f32 v132, v4, v5
    v_mfma_f32_16x16x32_bf16 v[16:19], a[64:67], a[164:167], v[16:19]
    v_sub_f32 v7, v7, v234
    v_exp_f32 v7, v7
    v_mfma_f32_16x16x32_bf16 v[16:19], a[68:71], a[168:171], v[16:19]
    global_load_lds_dwordx4 v227, s[72:73] offset:3072 nt
    v_mfma_f32_16x16x32_bf16 v[180:183], v[20:23], a[96:99], v[180:183]
    v_sub_f32 v8, v8, v235
    v_exp_f32 v8, v8
    v_mfma_f32_16x16x32_bf16 v[180:183], v[24:27], a[100:103], v[180:183]
    ds_read_b128 a[88:91], v214 offset:36864
    v_cvt_pk_bf16_f32 v133, v6, v7
    v_mfma_f32_16x16x32_bf16 v[180:183], v[52:55], a[104:107], v[180:183]
M_stub9:
    s_cbranch_execz M_back
    v_sub_f32 v9, v9, v235
    v_exp_f32 v9, v9
    v_mfma_f32_16x16x32_bf16 v[180:183], v[56:59], a[108:111], v[180:183]
    ds_read_b64_tr_b16 a[120:121], v221 offset:24576
    v_mfma_f32_16x16x32_bf16 v[184:187], v[60:63], a[104:107], v[184:187]
    s_add_u32 m0, s33, 0x2000
    v_sub_f32 v10, v10, v235
    v_exp_f32 v10, v10
    v_mfma_f32_16x16x32_bf16 v[184:187], v[64:67], a[108:111], v[184:187]
    ds_read_b64_tr_b16 a[122:123], v221 offset:26624
    v_cvt_pk_bf16_f32 v140, v8, v9
    v_mfma_f32_16x16x32_bf16 v[184:187], v[28:31], a[96:99], v[184:187]
    v_sub_f32 v11, v11, v235
    v_exp_f32 v11, v11
    v_mfma_f32_16x16x32_bf16 v[184:187], v[32:35], a[100:103], v[184:187]
    global_load_lds_dwordx4 v224, s[74:75] nt
    v_mfma_f32_16x16x32_bf16 a[32:35], v[36:39], a[96:99], a[32:35]
    ds_read_b128 a[92:95], v215 offset:36864
    v_cvt_pk_bf16_f32 v141, v10, v11
    v_mfma_f32_16x16x32_bf16 a[32:35], v[40:43], a[100:103], a[32:35]
    ds_read_b64_tr_b16 a[124:125], v221 offset:28672
    v_mfma_f32_16x16x32_bf16 a[32:35], v[68:71], a[104:107], a[32:35]
    ds_read_b64_tr_b16 a[126:127], v221 offset:30720
    v_mfma_f32_16x16x32_bf16 a[32:35], v[72:75], a[108:111], a[32:35]
    global_load_lds_dwordx4 v225, s[74:75] offset:1024 nt
    v_mfma_f32_16x16x32_bf16 a[36:39], v[76:79], a[104:107], a[36:39]
    s_lshl_b32 s36, s30, 13
    v_sub_f32 v12, v12, v232
    v_exp_f32 v12, v12
    v_mfma_f32_16x16x32_bf16 a[36:39], v[80:83], a[108:111], a[36:39]
    s_add_u32 s36, s36, s68
    v_sub_f32 v13, v13, v232
    v_exp_f32 v13, v13
    v_mfma_f32_16x16x32_bf16 a[36:39], v[44:47], a[96:99], a[36:39]
    v_sub_f32 v14, v14, v232
    v_exp_f32 v14, v14
    v_mfma_f32_16x16x32_bf16 a[36:39], v[48:51], a[100:103], a[36:39]
    s_waitcnt vmcnt(14) lgkmcnt(0)
    v_sub_f32 v15, v15, v232
    v_exp_f32 v15, v15
    v_smfmac_f32_16x16x64_bf16 a[128:131], a[144:147], v[84:91], v236
    s_barrier
    v_mfma_f32_16x16x32_bf16 v[4:7], a[80:83], a[180:183], 0
    s_add_u32 s36, s36, s45
    v_sub_f32 v16, v16, v233
    v_exp_f32 v16, v16
    v_mfma_f32_16x16x32_bf16 v[4:7], a[84:87], a[184:187], v[4:7]
    ds_read_b128 a[64:67], v212 offset:49152
    v_cvt_pk_bf16_f32 v117, v14, v15
    v_mfma_f32_16x16x32_bf16 v[4:7], a[88:91], a[188:191], v[4:7]
    s_xor_b32 s37, s36, 0x80
    v_sub_f32 v17, v17, v233
    v_exp_f32 v17, v17
    v_mfma_f32_16x16x32_bf16 v[4:7], a[92:95], a[192:195], v[4:7]
    ds_read_b64_tr_b16 a[96:97], v222 offset:16384
    v_cvt_pk_bf16_f32 v116, v12, v13
    v_mfma_f32_16x16x32_bf16 v[8:11], a[88:91], a[204:207], 0
    v_sub_f32 v18, v18, v233
    v_exp_f32 v18, v18
    v_mfma_f32_16x16x32_bf16 v[8:11], a[92:95], a[208:211], v[8:11]
    ds_read_b64_tr_b16 a[98:99], v222 offset:18432
    v_cvt_pk_bf16_f32 v124, v16, v17
    v_mfma_f32_16x16x32_bf16 v[8:11], a[80:83], a[196:199], v[8:11]
    v_sub_f32 v19, v19, v233
    v_exp_f32 v19, v19
    v_mfma_f32_16x16x32_bf16 v[8:11], a[84:87], a[200:203], v[8:11]
    global_load_lds_dwordx4 v226, s[74:75] offset:2048 nt
    v_mfma_f32_16x16x32_bf16 v[12:15], a[80:83], a[148:151], 0
    s_add_u32 s38, s36, 4096
    v_sub_f32 v4, v4, v234
    v_exp_f32 v4, v4
    v_mfma_f32_16x16x32_bf16 v[12:15], a[84:87], a[152:155], v[12:15]
    ds_read_b128 a[68:71], v213 offset:49152
    v_cvt_pk_bf16_f32 v125, v18, v19
    v_mfma_f32_16x16x32_bf16 v[12:15], a[88:91], a[156:159], v[12:15]
    s_xor_b32 s39, s38, 0x80
    v_sub_f32 v5, v5, v234
    v_exp_f32 v5, v5
    v_mfma_f32_16x16x32_bf16 v[12:15], a[92:95], a[160:163], v[12:15]
    ds_read_b64_tr_b16 a[100:101], v222 offset:20480
    v_mfma_f32_16x16x32_bf16 v[16:19], a[88:91], a[172:175], 0
    v_sub_f32 v6, v6, v234
    v_exp_f32 v6, v6
    v_mfma_f32_16x16x32_bf16 v[16:19], a[92:95], a[176:179], v[16:19]
    ds_read_b64_tr_b16 a[102:103], v222 offset:22528
    v_cvt_pk_bf16_f32 v134, v4, v5
    v_mfma_f32_16x16x32_bf16 v[16:19], a[80:83], a[164:167], v[16:19]
    v_sub_f32 v7, v7, v234
    v_exp_f32 v7, v7
    v_mfma_f32_16x16x32_bf16 v[16:19], a[84:87], a[168:171], v[16:19]
    global_load_lds_dwordx4 v227, s[74:75] offset:3072 nt
    v_mfma_f32_16x16x32_bf16 v[188:191], v[20:23], a[112:115], v[188:191]
    s_add_u32 s20, s10, s36
    v_sub_f32 v8, v8, v235
    v_exp_f32 v8, v8
    v_mfma_f32_16x16x32_bf16 v[188:191], v[24:27], a[116:119], v[188:191]
    ds_read_b128 a[72:75], v214 offset:49152
    v_cvt_pk_bf16_f32 v135, v6, v7
    v_mfma_f32_16x16x32_bf16 v[188:191], v[52:55], a[120:123], v[188:191]
    s_addc_u32 s21, s11, 0
    v_sub_f32 v9, v9, v235
    v_exp_f32 v9, v9
    v_mfma_f32_16x16x32_bf16 v[188:191], v[56:59], a[124:127], v[188:191]
    ds_read_b64_tr_b16 a[104:105], v222 offset:24576
    v_mfma_f32_16x16x32_bf16 v[192:195], v[60:63], a[120:123], v[192:195]
    v_sub_f32 v10, v10, v235
    v_exp_f32 v10, v10
    v_mfma_f32_16x16x32_bf16 v[192:195], v[64:67], a[124:127], v[192:195]
    ds_read_b64_tr_b16 a[106:107], v222 offset:26624
    v_cvt_pk_bf16_f32 v142, v8, v9
    v_mfma_f32_16x16x32_bf16 v[192:195], v[28:31], a[112:115], v[192:195]
    v_sub_f32 v11, v11, v235
    v_exp_f32 v11, v11
    v_mfma_f32_16x16x32_bf16 v[192:195], v[32:35], a[116:119], v[192:195]
    v_mfma_f32_16x16x32_bf16 a[40:43], v[36:39], a[112:115], a[40:43]
    s_add_u32 s22, s10, s37
    v_sub_f32 v12, v12, v232
    v_exp_f32 v12, v12
    v_mfma_f32_16x16x32_bf16 a[40:43], v[40:43], a[116:119], a[40:43]
    ds_read_b128 a[76:79], v215 offset:49152
    v_cvt_pk_bf16_f32 v143, v10, v11
    v_mfma_f32_16x16x32_bf16 a[40:43], v[68:71], a[120:123], a[40:43]
    s_addc_u32 s23, s11, 0
    v_sub_f32 v13, v13, v232
    v_exp_f32 v13, v13
    v_mfma_f32_16x16x32_bf16 a[40:43], v[72:75], a[124:127], a[40:43]
    ds_read_b64_tr_b16 a[108:109], v222 offset:28672
    v_mfma_f32_16x16x32_bf16 a[44:47], v[76:79], a[120:123], a[44:47]
    v_sub_f32 v14, v14, v232
    v_exp_f32 v14, v14
    v_mfma_f32_16x16x32_bf16 a[44:47], v[80:83], a[124:127], a[44:47]
    ds_read_b64_tr_b16 a[110:111], v222 offset:30720
    v_cvt_pk_bf16_f32 v118, v12, v13
    v_mfma_f32_16x16x32_bf16 a[44:47], v[44:47], a[112:115], a[44:47]
    s_waitcnt lgkmcnt(2)
    v_sub_f32 v15, v15, v232
    v_exp_f32 v15, v15
    v_mfma_f32_16x16x32_bf16 a[44:47], v[48:51], a[116:119], a[44:47]
    v_smfmac_f32_16x16x64_bf16 a[132:135], a[144:147], v[92:99], v236
    v_mfma_f32_16x16x32_bf16 v[4:7], a[64:67], a[180:183], 0
    s_add_u32 s24, s10, s38
    v_sub_f32 v16, v16, v233
    v_exp_f32 v16, v16
    v_mfma_f32_16x16x32_bf16 v[4:7], a[68:71], a[184:187], v[4:7]
    ds_read_b128 a[80:83], v212 offset:53248
    v_cvt_pk_bf16_f32 v119, v14, v15
    v_mfma_f32_16x16x32_bf16 v[4:7], a[72:75], a[188:191], v[4:7]
    s_addc_u32 s25, s11, 0
    v_sub_f32 v17, v17, v233
    v_exp_f32 v17, v17
    v_mfma_f32_16x16x32_bf16 v[4:7], a[76:79], a[192:195], v[4:7]
    ds_read_b64_tr_b16 a[112:113], v223 offset:16384
    v_mfma_f32_16x16x32_bf16 v[8:11], a[72:75], a[204:207], 0
    v_sub_f32 v18, v18, v233
    v_exp_f32 v18, v18
    v_mfma_f32_16x16x32_bf16 v[8:11], a[76:79], a[208:211], v[8:11]
    ds_read_b64_tr_b16 a[114:115], v223 offset:18432
    v_cvt_pk_bf16_f32 v126, v16, v17
    v_mfma_f32_16x16x32_bf16 v[8:11], a[64:67], a[196:199], v[8:11]
    s_waitcnt lgkmcnt(3)
    v_sub_f32 v19, v19, v233
    v_exp_f32 v19, v19
    v_mfma_f32_16x16x32_bf16 v[8:11], a[68:71], a[200:203], v[8:11]
    v_mfma_f32_16x16x32_bf16 v[12:15], a[64:67], a[148:151], 0
    s_add_u32 s26, s10, s39
    v_sub_f32 v4, v4, v234
    v_exp_f32 v4, v4
    v_mfma_f32_16x16x32_bf16 v[12:15], a[68:71], a[152:155], v[12:15]
    ds_read_b128 a[84:87], v213 offset:53248
    v_cvt_pk_bf16_f32 v127, v18, v19
    v_mfma_f32_16x16x32_bf16 v[12:15], a[72:75], a[156:159], v[12:15]
    s_addc_u32 s27, s11, 0
    v_sub_f32 v5, v5, v234
    v_exp_f32 v5, v5
    v_mfma_f32_16x16x32_bf16 v[12:15], a[76:79], a[160:163], v[12:15]
    ds_read_b64_tr_b16 a[116:117], v223 offset:20480
    v_mfma_f32_16x16x32_bf16 v[16:19], a[72:75], a[172:175], 0
    v_sub_f32 v6, v6, v234
    v_exp_f32 v6, v6
    v_mfma_f32_16x16x32_bf16 v[16:19], a[76:79], a[176:179], v[16:19]
    ds_read_b64_tr_b16 a[118:119], v223 offset:22528
    v_cvt_pk_bf16_f32 v136, v4, v5
    v_mfma_f32_16x16x32_bf16 v[16:19], a[64:67], a[164:167], v[16:19]
    v_sub_f32 v7, v7, v234
    v_exp_f32 v7, v7
    v_mfma_f32_16x16x32_bf16 v[16:19], a[68:71], a[168:171], v[16:19]
    v_mfma_f32_16x16x32_bf16 v[196:199], v[20:23], a[96:99], v[196:199]
    v_sub_f32 v8, v8, v235
    v_exp_f32 v8, v8
    v_mfma_f32_16x16x32_bf16 v[196:199], v[24:27], a[100:103], v[196:199]
    ds_read_b128 a[88:91], v214 offset:53248
    v_cvt_pk_bf16_f32 v137, v6, v7
    v_mfma_f32_16x16x32_bf16 v[196:199], v[52:55], a[104:107], v[196:199]
    v_sub_f32 v9, v9, v235
    v_exp_f32 v9, v9
    v_mfma_f32_16x16x32_bf16 v[196:199], v[56:59], a[108:111], v[196:199]
    ds_read_b64_tr_b16 a[120:121], v223 offset:24576
    v_mfma_f32_16x16x32_bf16 v[200:203], v[60:63], a[104:107], v[200:203]
    v_sub_f32 v10, v10, v235
    v_exp_f32 v10, v10
    v_mfma_f32_16x16x32_bf16 v[200:203], v[64:67], a[108:111], v[200:203]
    ds_read_b64_tr_b16 a[122:123], v223 offset:26624
    v_cvt_pk_bf16_f32 v144, v8, v9
    v_mfma_f32_16x16x32_bf16 v[200:203], v[28:31], a[96:99], v[200:203]
    v_sub_f32 v11, v11, v235
    v_exp_f32 v11, v11
    v_mfma_f32_16x16x32_bf16 v[200:203], v[32:35], a[100:103], v[200:203]
    v_mfma_f32_16x16x32_bf16 a[48:51], v[36:39], a[96:99], a[48:51]
    ds_read_b128 a[92:95], v215 offset:53248
    v_cvt_pk_bf16_f32 v145, v10, v11
    v_mfma_f32_16x16x32_bf16 a[48:51], v[40:43], a[100:103], a[48:51]
    ds_read_b64_tr_b16 a[124:125], v223 offset:28672
    v_mfma_f32_16x16x32_bf16 a[48:51], v[68:71], a[104:107], a[48:51]
    ds_read_b64_tr_b16 a[126:127], v223 offset:30720
    v_mfma_f32_16x16x32_bf16 a[48:51], v[72:75], a[108:111], a[48:51]
    v_mfma_f32_16x16x32_bf16 a[52:55], v[76:79], a[104:107], a[52:55]
    v_sub_f32 v12, v12, v232
    v_exp_f32 v12, v12
    v_mfma_f32_16x16x32_bf16 a[52:55], v[80:83], a[108:111], a[52:55]
    v_sub_f32 v13, v13, v232
    v_exp_f32 v13, v13
    v_mfma_f32_16x16x32_bf16 a[52:55], v[44:47], a[96:99], a[52:55]
    v_sub_f32 v14, v14, v232
    v_exp_f32 v14, v14
    v_mfma_f32_16x16x32_bf16 a[52:55], v[48:51], a[100:103], a[52:55]
    s_waitcnt vmcnt(8) lgkmcnt(0)
    v_sub_f32 v15, v15, v232
    v_exp_f32 v15, v15
    v_smfmac_f32_16x16x64_bf16 a[136:139], a[144:147], v[100:107], v236
    s_barrier
    v_mfma_f32_16x16x32_bf16 v[4:7], a[80:83], a[180:183], 0
    v_sub_f32 v16, v16, v233
    v_exp_f32 v16, v16
    v_mfma_f32_16x16x32_bf16 v[4:7], a[84:87], a[184:187], v[4:7]
    ds_read_b64_tr_b16 a[212:213], v221 offset:32768
    v_cvt_pk_bf16_f32 v121, v14, v15
    v_mfma_f32_16x16x32_bf16 v[4:7], a[88:91], a[188:191], v[4:7]
    v_sub_f32 v17, v17, v233
    v_exp_f32 v17, v17
    v_mfma_f32_16x16x32_bf16 v[4:7], a[92:95], a[192:195], v[4:7]
    ds_read_b64_tr_b16 a[96:97], v220 offset:32768
    v_cvt_pk_bf16_f32 v120, v12, v13
    v_mfma_f32_16x16x32_bf16 v[8:11], a[88:91], a[204:207], 0
    v_sub_f32 v18, v18, v233
    v_exp_f32 v18, v18
    v_mfma_f32_16x16x32_bf16 v[8:11], a[92:95], a[208:211], v[8:11]
    ds_read_b64_tr_b16 a[98:99], v220 offset:34816
    v_cvt_pk_bf16_f32 v128, v16, v17
    v_mfma_f32_16x16x32_bf16 v[8:11], a[80:83], a[196:199], v[8:11]
    v_sub_f32 v19, v19, v233
    v_exp_f32 v19, v19
    v_mfma_f32_16x16x32_bf16 v[8:11], a[84:87], a[200:203], v[8:11]
    ds_read_b64_tr_b16 a[214:215], v221 offset:34816
    v_mfma_f32_16x16x32_bf16 v[12:15], a[80:83], a[148:151], 0
    v_sub_f32 v4, v4, v234
    v_exp_f32 v4, v4
    v_mfma_f32_16x16x32_bf16 v[12:15], a[84:87], a[152:155], v[12:15]
    ds_read_b64_tr_b16 a[216:217], v221 offset:36864
    v_cvt_pk_bf16_f32 v129, v18, v19
    v_mfma_f32_16x16x32_bf16 v[12:15], a[88:91], a[156:159], v[12:15]
    v_sub_f32 v5, v5, v234
    v_exp_f32 v5, v5
    v_mfma_f32_16x16x32_bf16 v[12:15], a[92:95], a[160:163], v[12:15]
    ds_read_b64_tr_b16 a[100:101], v220 offset:36864
    v_mfma_f32_16x16x32_bf16 v[16:19], a[88:91], a[172:175], 0
    v_sub_f32 v6, v6, v234
    v_exp_f32 v6, v6
    v_mfma_f32_16x16x32_bf16 v[16:19], a[92:95], a[176:179], v[16:19]
    ds_read_b64_tr_b16 a[102:103], v220 offset:38912
    v_cvt_pk_bf16_f32 v138, v4, v5
    v_mfma_f32_16x16x32_bf16 v[16:19], a[80:83], a[164:167], v[16:19]
    v_sub_f32 v7, v7, v234
    v_exp_f32 v7, v7
    v_mfma_f32_16x16x32_bf16 v[16:19], a[84:87], a[168:171], v[16:19]
    ds_read_b64_tr_b16 a[218:219], v221 offset:38912
    v_mfma_f32_16x16x32_bf16 v[204:207], v[20:23], a[112:115], v[204:207]
    v_sub_f32 v8, v8, v235
    v_exp_f32 v8, v8
    v_mfma_f32_16x16x32_bf16 v[204:207], v[24:27], a[116:119], v[204:207]
    ds_read_b64_tr_b16 a[220:221], v221 offset:40960
    v_cvt_pk_bf16_f32 v139, v6, v7
    v_mfma_f32_16x16x32_bf16 v[204:207], v[52:55], a[120:123], v[204:207]
    v_sub_f32 v9, v9, v235
    v_exp_f32 v9, v9
    v_mfma_f32_16x16x32_bf16 v[204:207], v[56:59], a[124:127], v[204:207]
    ds_read_b64_tr_b16 a[104:105], v220 offset:40960
    v_mfma_f32_16x16x32_bf16 v[208:211], v[60:63], a[120:123], v[208:211]
    v_sub_f32 v10, v10, v235
    v_exp_f32 v10, v10
    v_mfma_f32_16x16x32_bf16 v[208:211], v[64:67], a[124:127], v[208:211]
    ds_read_b64_tr_b16 a[106:107], v220 offset:43008
    v_cvt_pk_bf16_f32 v146, v8, v9
    v_mfma_f32_16x16x32_bf16 v[208:211], v[28:31], a[112:115], v[208:211]
    v_sub_f32 v11, v11, v235
    v_exp_f32 v11, v11
    v_mfma_f32_16x16x32_bf16 v[208:211], v[32:35], a[116:119], v[208:211]
    ds_read_b64_tr_b16 a[222:223], v221 offset:43008
    v_mfma_f32_16x16x32_bf16 a[56:59], v[36:39], a[112:115], a[56:59]
    v_sub_f32 v12, v12, v232
    v_exp_f32 v12, v12
    v_mfma_f32_16x16x32_bf16 a[56:59], v[40:43], a[116:119], a[56:59]
    ds_read_b64_tr_b16 a[224:225], v221 offset:45056
    v_cvt_pk_bf16_f32 v147, v10, v11
    v_mfma_f32_16x16x32_bf16 a[56:59], v[68:71], a[120:123], a[56:59]
    v_sub_f32 v13, v13, v232
    v_exp_f32 v13, v13
    v_mfma_f32_16x16x32_bf16 a[56:59], v[72:75], a[124:127], a[56:59]
    ds_read_b64_tr_b16 a[108:109], v220 offset:45056
    v_mfma_f32_16x16x32_bf16 a[60:63], v[76:79], a[120:123], a[60:63]
    v_sub_f32 v14, v14, v232
    v_exp_f32 v14, v14
    v_mfma_f32_16x16x32_bf16 a[60:63], v[80:83], a[124:127], a[60:63]
    ds_read_b64_tr_b16 a[110:111], v220 offset:47104
    v_cvt_pk_bf16_f32 v122, v12, v13
    v_mfma_f32_16x16x32_bf16 a[60:63], v[44:47], a[112:115], a[60:63]
    v_sub_f32 v15, v15, v232
    v_exp_f32 v15, v15
    v_mfma_f32_16x16x32_bf16 a[60:63], v[48:51], a[116:119], a[60:63]
    v_smfmac_f32_16x16x64_bf16 a[140:143], a[144:147], v[108:115], v236
    ds_read_b64_tr_b16 a[226:227], v221 offset:47104
    s_waitcnt lgkmcnt(13)
    v_mfma_f32_16x16x32_bf16 a[0:3], v[100:103], a[96:99], a[0:3]
    ds_read_b64_tr_b16 a[228:229], v222 offset:32768
    s_waitcnt lgkmcnt(10)
    v_cvt_pk_bf16_f32 v123, v14, v15
    v_mfma_f32_16x16x32_bf16 a[0:3], v[104:107], a[100:103], a[0:3]
    ds_read_b64_tr_b16 a[230:231], v222 offset:34816
    s_waitcnt lgkmcnt(7)
    v_mfma_f32_16x16x32_bf16 a[0:3], v[132:135], a[104:107], a[0:3]
    ds_read_b64_tr_b16 a[232:233], v222 offset:36864
    s_waitcnt lgkmcnt(4)
    v_mfma_f32_16x16x32_bf16 a[0:3], v[136:139], a[108:111], a[0:3]
    ds_read_b64_tr_b16 a[234:235], v222 offset:38912
    v_mfma_f32_16x16x32_bf16 a[8:11], v[132:135], a[220:223], a[8:11]
    ds_read_b64_tr_b16 a[236:237], v222 offset:40960
    ds_read_b64_tr_b16 a[238:239], v222 offset:43008
    s_waitcnt lgkmcnt(6)
    v_mfma_f32_16x16x32_bf16 a[8:11], v[136:139], a[224:227], a[8:11]
    ds_read_b64_tr_b16 a[240:241], v222 offset:45056
    ds_read_b64_tr_b16 a[242:243], v222 offset:47104
    v_mfma_f32_16x16x32_bf16 a[8:11], v[100:103], a[212:215], a[8:11]
    ds_read_b64_tr_b16 a[72:73], v223 offset:40960
    ds_read_b64_tr_b16 a[74:75], v223 offset:43008
    v_mfma_f32_16x16x32_bf16 a[8:11], v[104:107], a[216:219], a[8:11]
    ds_read_b64_tr_b16 a[76:77], v223 offset:45056
    ds_read_b64_tr_b16 a[78:79], v223 offset:47104
    v_smfmac_f32_16x16x64_bf16 a[136:139], a[144:147], v[132:139], v236
    ds_read_b64_tr_b16 a[64:65], v223 offset:32768
    ds_read_b64_tr_b16 a[66:67], v223 offset:34816
    v_smfmac_f32_16x16x64_bf16 a[140:143], a[144:147], v[140:147], v236
    ds_read_b64_tr_b16 a[68:69], v223 offset:36864
    ds_read_b64_tr_b16 a[70:71], v223 offset:38912
    s_waitcnt lgkmcnt(10)
    v_mfma_f32_16x16x32_bf16 a[16:19], v[100:103], a[228:231], a[16:19]
    ds_write_b128 v239, a[0:3]
    v_sub_f32 v16, v16, v233
    v_exp_f32 v16, v16
    v_mfma_f32_16x16x32_bf16 a[16:19], v[104:107], a[232:235], a[16:19]
    v_accvgpr_read_b32 v248, a136
    v_accvgpr_read_b32 v250, a137
    v_add_f32 v248, v248, v250
    v_mfma_f32_16x16x32_bf16 a[16:19], v[132:135], a[236:239], a[16:19]
    ds_write_b128 v239, a[8:11] offset:8192
    s_waitcnt lgkmcnt(4)
    v_accvgpr_read_b32 v249, a140
    v_accvgpr_read_b32 v250, a141
    v_mfma_f32_16x16x32_bf16 a[16:19], v[136:139], a[240:243], a[16:19]
    v_add_f32 v249, v249, v250
    v_mfma_f32_16x16x32_bf16 a[24:27], v[132:135], a[72:75], a[24:27]
    v_sub_f32 v17, v17, v233
    v_exp_f32 v17, v17
    v_mfma_f32_16x16x32_bf16 a[24:27], v[136:139], a[76:79], a[24:27]
    ds_write_b64 v240, v[248:249]
    v_sub_f32 v18, v18, v233
    v_exp_f32 v18, v18
    v_mfma_f32_16x16x32_bf16 a[24:27], v[100:103], a[64:67], a[24:27]
    s_waitcnt lgkmcnt(2)
    v_sub_f32 v19, v19, v233
    v_exp_f32 v19, v19
    v_mfma_f32_16x16x32_bf16 a[24:27], v[104:107], a[68:71], a[24:27]
    v_cvt_pk_bf16_f32 v130, v16, v17
    v_cvt_pk_bf16_f32 v131, v18, v19
    v_mfma_f32_16x16x32_bf16 a[4:7], v[108:111], a[96:99], a[4:7]
    ds_write_b128 v239, a[16:19] offset:16384
    v_mfma_f32_16x16x32_bf16 a[4:7], v[112:115], a[100:103], a[4:7]
    v_mfma_f32_16x16x32_bf16 a[4:7], v[140:143], a[104:107], a[4:7]
    v_mfma_f32_16x16x32_bf16 a[4:7], v[144:147], a[108:111], a[4:7]
    v_mfma_f32_16x16x32_bf16 a[12:15], v[140:143], a[220:223], a[12:15]
    ds_write_b128 v239, a[24:27] offset:24576
    v_mfma_f32_16x16x32_bf16 a[12:15], v[144:147], a[224:227], a[12:15]
    v_mfma_f32_16x16x32_bf16 a[12:15], v[108:111], a[212:215], a[12:15]
    v_mfma_f32_16x16x32_bf16 a[12:15], v[112:115], a[216:219], a[12:15]
    v_smfmac_f32_16x16x64_bf16 a[128:131], a[144:147], v[116:123], v236
    s_waitcnt vmcnt(0) lgkmcnt(0)
    v_smfmac_f32_16x16x64_bf16 a[132:135], a[144:147], v[124:131], v236
    s_barrier
    ds_read_b64 v[250:251], v241
    v_mfma_f32_16x16x32_bf16 a[20:23], v[108:111], a[228:231], a[20:23]
    ds_read_b128 v[20:23], v238
    ds_read_b128 v[24:27], v238 offset:8192
    v_mfma_f32_16x16x32_bf16 a[20:23], v[112:115], a[232:235], a[20:23]
    ds_write_b128 v239, a[4:7] offset:1024
    s_waitcnt lgkmcnt(3)
    v_accvgpr_read_b32 v252, a128
    v_accvgpr_read_b32 v254, a129
    v_add_f32 v252, v252, v254
    v_add_f32 v252, v252, v250
    v_rcp_f32 v254, v252
    v_mfma_f32_16x16x32_bf16 a[20:23], v[140:143], a[236:239], a[20:23]
    ds_write_b128 v239, a[12:15] offset:9216
    s_waitcnt lgkmcnt(3)
    v_add_f32 v148, v20, v148
    v_mfma_f32_16x16x32_bf16 a[20:23], v[144:147], a[240:243], a[20:23]
    ds_read_b128 v[28:31], v238 offset:16384
    v_add_f32 v149, v21, v149
    v_mfma_f32_16x16x4_f32 v[212:215], v254, v237, 0
    ds_read_b128 v[32:35], v238 offset:24576
    ds_read_b64_tr_b16 a[112:113], v220
    ds_read_b64_tr_b16 a[114:115], v220 offset:2048
    ds_read_b64_tr_b16 a[116:117], v220 offset:4096
    ds_read_b64_tr_b16 a[118:119], v220 offset:6144
    v_add_f32 v150, v22, v150
    v_add_f32 v151, v23, v151
    v_mfma_f32_16x16x32_bf16 a[28:31], v[108:111], a[64:67], a[28:31]
    ds_write_b128 v239, a[20:23] offset:17408
    s_waitcnt lgkmcnt(9)
    v_add_f32 v156, v24, v156
    v_add_f32 v157, v25, v157
    v_mfma_f32_16x16x32_bf16 a[28:31], v[112:115], a[68:71], a[28:31]
    ds_read_b64_tr_b16 a[120:121], v220 offset:8192
    ds_read_b64_tr_b16 a[122:123], v220 offset:10240
    v_add_f32 v158, v26, v158
    v_mfma_f32_16x16x32_bf16 a[28:31], v[140:143], a[72:75], a[28:31]
    ds_read_b64_tr_b16 a[124:125], v220 offset:12288
    v_add_f32 v159, v27, v159
    v_mfma_f32_16x16x32_bf16 a[28:31], v[144:147], a[76:79], a[28:31]
    ds_read_b64_tr_b16 a[126:127], v220 offset:14336
    v_accvgpr_read_b32 v253, a132
    v_mfma_f32_16x16x32_bf16 v[148:151], v[84:87], a[96:99], v[148:151]
    ds_read_b64_tr_b16 a[88:89], v221 offset:8192
    ds_read_b64_tr_b16 a[90:91], v221 offset:10240
    v_accvgpr_read_b32 v255, a133
    v_mfma_f32_16x16x32_bf16 v[148:151], v[88:91], a[100:103], v[148:151]
    ds_read_b64_tr_b16 a[92:93], v221 offset:12288
    v_add_f32 v253, v253, v255
    v_mfma_f32_16x16x32_bf16 v[148:151], v[116:119], a[104:107], v[148:151]
    ds_write_b128 v239, a[28:31] offset:25600
    v_add_f32 v253, v253, v251
    v_mfma_f32_16x16x32_bf16 v[148:151], v[120:123], a[108:111], v[148:151]
    ds_read_b64_tr_b16 a[94:95], v221 offset:14336
    v_rcp_f32 v255, v253
    v_mfma_f32_16x16x32_bf16 v[156:159], v[116:119], a[220:223], v[156:159]
    ds_read_b64_tr_b16 a[80:81], v221
    s_waitcnt lgkmcnt(5)
    v_add_f32 v164, v28, v164
    v_mfma_f32_16x16x32_bf16 v[156:159], v[120:123], a[224:227], v[156:159]
    ds_read_b64_tr_b16 a[82:83], v221 offset:2048
    v_add_f32 v165, v29, v165
    v_mfma_f32_16x16x32_bf16 v[156:159], v[84:87], a[212:215], v[156:159]
    ds_read_b64_tr_b16 a[84:85], v221 offset:4096
    ds_read_b64_tr_b16 a[86:87], v221 offset:6144
    v_add_f32 v166, v30, v166
    v_add_f32 v167, v31, v167
    v_mfma_f32_16x16x32_bf16 v[156:159], v[88:91], a[216:219], v[156:159]
    ds_read_b64_tr_b16 a[0:1], v222
    v_add_f32 v172, v32, v172
    s_waitcnt lgkmcnt(6)
    v_mfma_f32_16x16x4_f32 v[216:219], v255, v237, 0
    s_barrier
    ds_read_b64_tr_b16 a[2:3], v222 offset:2048
    ds_read_b64_tr_b16 a[4:5], v222 offset:4096
    ds_read_b64_tr_b16 a[6:7], v222 offset:6144
    ds_read_b64_tr_b16 a[8:9], v222 offset:8192
    v_add_f32 v173, v33, v173
    v_mfma_f32_16x16x32_bf16 v[164:167], v[84:87], a[228:231], v[164:167]
    ds_read_b64_tr_b16 a[10:11], v222 offset:10240
    v_add_f32 v174, v34, v174
    v_mfma_f32_16x16x32_bf16 v[164:167], v[88:91], a[232:235], v[164:167]
    ds_read_b64_tr_b16 a[12:13], v222 offset:12288
    v_add_f32 v175, v35, v175
    v_mfma_f32_16x16x32_bf16 v[164:167], v[116:119], a[236:239], v[164:167]
    ds_read_b64_tr_b16 a[14:15], v222 offset:14336
    v_mul_f32 v148, v148, v212
    v_mfma_f32_16x16x32_bf16 v[164:167], v[120:123], a[240:243], v[164:167]
    ds_read_b64_tr_b16 a[24:25], v223 offset:8192
    ds_read_b64_tr_b16 a[26:27], v223 offset:10240
    v_mul_f32 v149, v149, v213
    v_mfma_f32_16x16x32_bf16 v[172:175], v[116:119], a[72:75], v[172:175]
    ds_read_b64_tr_b16 a[28:29], v223 offset:12288
    v_mul_f32 v150, v150, v214
    v_mfma_f32_16x16x32_bf16 v[172:175], v[120:123], a[76:79], v[172:175]
    ds_read_b64_tr_b16 a[30:31], v223 offset:14336
    v_mul_f32 v151, v151, v215
    v_mfma_f32_16x16x32_bf16 v[172:175], v[84:87], a[64:67], v[172:175]
    ds_read_b64_tr_b16 a[16:17], v223
    ds_read_b64_tr_b16 a[18:19], v223 offset:2048
    v_mul_f32 v156, v156, v212
    v_mfma_f32_16x16x32_bf16 v[172:175], v[88:91], a[68:71], v[172:175]
    ds_read_b128 v[52:55], v238 offset:1024
    v_mul_f32 v157, v157, v213
    v_mfma_f32_16x16x32_bf16 a[32:35], v[100:103], a[112:115], a[32:35]
    ds_read_b64_tr_b16 a[20:21], v223 offset:4096
    v_mul_f32 v158, v158, v214
    v_mfma_f32_16x16x32_bf16 a[32:35], v[104:107], a[116:119], a[32:35]
    ds_read_b64_tr_b16 a[22:23], v223 offset:6144
    ds_read_b128 v[56:59], v238 offset:9216
    v_mul_f32 v159, v159, v215
    v_mfma_f32_16x16x32_bf16 a[32:35], v[132:135], a[120:123], a[32:35]
    ds_read_b128 v[60:63], v238 offset:17408
    v_mul_f32 v164, v164, v212
    v_mfma_f32_16x16x32_bf16 a[32:35], v[136:139], a[124:127], a[32:35]
    ds_read_b128 v[64:67], v238 offset:25600
    v_mul_f32 v165, v165, v213
    v_mfma_f32_16x16x32_bf16 a[40:43], v[132:135], a[88:91], a[40:43]
    s_waitcnt lgkmcnt(6)
    v_mul_f32 v166, v166, v214
    v_mul_f32 v167, v167, v215
    v_mul_f32 v172, v172, v212
    v_mfma_f32_16x16x32_bf16 a[40:43], v[136:139], a[92:95], a[40:43]
    v_mul_f32 v173, v173, v213
    v_mul_f32 v174, v174, v214
    v_mfma_f32_16x16x32_bf16 a[40:43], v[100:103], a[80:83], a[40:43]
    ds_write_b128 v239, a[32:35] offset:32768
    v_mul_f32 v175, v175, v215
    v_mfma_f32_16x16x32_bf16 a[40:43], v[104:107], a[84:87], a[40:43]
    v_cvt_pk_bf16_f32 v4, v148, v156
    v_cvt_pk_bf16_f32 v6, v149, v157
    v_cvt_pk_bf16_f32 v8, v150, v158
    v_mfma_f32_16x16x32_bf16 a[48:51], v[100:103], a[0:3], a[48:51]
    v_cvt_pk_bf16_f32 v10, v151, v159
    v_cvt_pk_bf16_f32 v5, v164, v172
    v_mfma_f32_16x16x32_bf16 a[48:51], v[104:107], a[4:7], a[48:51]
    ds_write_b64 v243, v[4:5]
    v_cvt_pk_bf16_f32 v7, v165, v173
    v_mfma_f32_16x16x32_bf16 a[48:51], v[132:135], a[8:11], a[48:51]
    s_waitcnt lgkmcnt(2)
    v_cvt_pk_bf16_f32 v9, v166, v174
    v_cvt_pk_bf16_f32 v11, v167, v175
    v_add_f32 v152, v52, v152
    v_mfma_f32_16x16x32_bf16 a[48:51], v[136:139], a[12:15], a[48:51]
    ds_write_b64 v243, v[6:7] offset:128
    v_add_f32 v153, v53, v153
    v_mfma_f32_16x16x32_bf16 a[56:59], v[132:135], a[24:27], a[56:59]
    v_add_f32 v154, v54, v154
    v_add_f32 v155, v55, v155
    v_mfma_f32_16x16x32_bf16 a[56:59], v[136:139], a[28:31], a[56:59]
    ds_write_b64 v244, v[8:9] offset:256
    v_add_f32 v160, v56, v160
    v_mfma_f32_16x16x32_bf16 a[56:59], v[100:103], a[16:19], a[56:59]
    v_add_f32 v161, v57, v161
    v_add_f32 v162, v58, v162
    v_add_f32 v163, v59, v163
    v_mfma_f32_16x16x32_bf16 a[56:59], v[104:107], a[20:23], a[56:59]
    ds_write_b64 v244, v[10:11] offset:384
    v_add_f32 v168, v60, v168
    v_mfma_f32_16x16x32_bf16 v[152:155], v[92:95], a[96:99], v[152:155]
    ds_read_b64_tr_b16 v[4:5], v245
    v_add_f32 v169, v61, v169
    v_mfma_f32_16x16x32_bf16 v[152:155], v[96:99], a[100:103], v[152:155]
    ds_read_b64_tr_b16 v[6:7], v246
    ds_read_b64_tr_b16 v[8:9], v245 offset:1024
    v_add_f32 v170, v62, v170
    v_mfma_f32_16x16x32_bf16 v[152:155], v[124:127], a[104:107], v[152:155]
    ds_read_b64_tr_b16 v[10:11], v246 offset:1024
    v_add_f32 v171, v63, v171
    v_mfma_f32_16x16x32_bf16 v[152:155], v[128:131], a[108:111], v[152:155]
    ds_write_b128 v239, a[40:43] offset:40960
    v_add_f32 v176, v64, v176
    v_mfma_f32_16x16x32_bf16 v[160:163], v[124:127], a[220:223], v[160:163]
    s_waitcnt lgkmcnt(3)
    v_add_f32 v177, v65, v177
    v_add_f32 v178, v66, v178
    v_add_f32 v179, v67, v179
    v_mfma_f32_16x16x32_bf16 v[160:163], v[128:131], a[224:227], v[160:163]
    global_store_dwordx4 v242, v[4:7], s[20:21] sc0 sc1
    ds_write_b128 v239, a[48:51] offset:49152
    v_mfma_f32_16x16x32_bf16 v[160:163], v[92:95], a[212:215], v[160:163]
    v_mul_f32 v152, v152, v216
    v_mul_f32 v153, v153, v217
    v_mfma_f32_16x16x32_bf16 v[160:163], v[96:99], a[216:219], v[160:163]
    v_mul_f32 v154, v154, v218
    v_mul_f32 v155, v155, v219
    ds_write_b128 v239, a[56:59] offset:57344
    s_waitcnt lgkmcnt(0)
    v_mfma_f32_16x16x32_bf16 v[168:171], v[92:95], a[228:231], v[168:171]
    s_barrier
    global_store_dwordx4 v242, v[8:11], s[20:21] offset:2048 sc0 sc1
    v_mfma_f32_16x16x32_bf16 v[168:171], v[96:99], a[232:235], v[168:171]
    ds_read_b128 v[36:39], v238 offset:32768
    ds_read_b128 v[40:43], v238 offset:40960
    v_mul_f32 v160, v160, v216
    v_mfma_f32_16x16x32_bf16 v[168:171], v[124:127], a[236:239], v[168:171]
    ds_read_b128 v[44:47], v238 offset:49152
    ds_read_b128 v[48:51], v238 offset:57344
    v_mul_f32 v161, v161, v217
    v_mfma_f32_16x16x32_bf16 v[168:171], v[128:131], a[240:243], v[168:171]
    v_mul_f32 v162, v162, v218
    v_mul_f32 v163, v163, v219
    v_mfma_f32_16x16x32_bf16 v[176:179], v[124:127], a[72:75], v[176:179]
    v_cvt_pk_bf16_f32 v12, v152, v160
    v_cvt_pk_bf16_f32 v14, v153, v161
    v_mfma_f32_16x16x32_bf16 v[176:179], v[128:131], a[76:79], v[176:179]
    v_cvt_pk_bf16_f32 v16, v154, v162
    v_cvt_pk_bf16_f32 v18, v155, v163
    v_mfma_f32_16x16x32_bf16 v[176:179], v[92:95], a[64:67], v[176:179]
    v_mul_f32 v168, v168, v216
    v_mul_f32 v169, v169, v217
    v_mul_f32 v170, v170, v218
    v_mfma_f32_16x16x32_bf16 v[176:179], v[96:99], a[68:71], v[176:179]
    s_waitcnt lgkmcnt(2)
    v_mul_f32 v171, v171, v219
    v_add_f32 v180, v36, v180
    v_mfma_f32_16x16x32_bf16 a[36:39], v[108:111], a[112:115], a[36:39]
    v_add_f32 v181, v37, v181
    v_add_f32 v182, v38, v182
    v_mfma_f32_16x16x32_bf16 a[36:39], v[112:115], a[116:119], a[36:39]
    v_add_f32 v183, v39, v183
    v_add_f32 v188, v40, v188
    v_mul_f32 v176, v176, v216
    v_mfma_f32_16x16x32_bf16 a[36:39], v[140:143], a[120:123], a[36:39]
    v_mul_f32 v177, v177, v217
    v_mul_f32 v178, v178, v218
    v_mfma_f32_16x16x32_bf16 a[36:39], v[144:147], a[124:127], a[36:39]
    v_mul_f32 v179, v179, v219
    v_cvt_pk_bf16_f32 v13, v168, v176
    v_mfma_f32_16x16x32_bf16 a[44:47], v[140:143], a[88:91], a[44:47]
    ds_write_b64 v243, v[12:13] offset:2048
    v_cvt_pk_bf16_f32 v15, v169, v177
    v_cvt_pk_bf16_f32 v17, v170, v178
    v_mfma_f32_16x16x32_bf16 a[44:47], v[144:147], a[92:95], a[44:47]
    ds_write_b64 v243, v[14:15] offset:2176
    v_cvt_pk_bf16_f32 v19, v171, v179
    v_mfma_f32_16x16x32_bf16 a[44:47], v[108:111], a[80:83], a[44:47]
M_stub10:
    s_cbranch_execz M_back
    v_add_f32 v189, v41, v189
    v_add_f32 v190, v42, v190
    v_mfma_f32_16x16x32_bf16 a[44:47], v[112:115], a[84:87], a[44:47]
    ds_write_b64 v244, v[16:17] offset:2304
    v_add_f32 v191, v43, v191
    v_mfma_f32_16x16x32_bf16 a[52:55], v[108:111], a[0:3], a[52:55]
    s_waitcnt lgkmcnt(3)
    v_add_f32 v196, v44, v196
    v_add_f32 v197, v45, v197
    v_add_f32 v198, v46, v198
    v_mfma_f32_16x16x32_bf16 a[52:55], v[112:115], a[4:7], a[52:55]
    ds_write_b64 v244, v[18:19] offset:2432
    v_add_f32 v199, v47, v199
    v_mfma_f32_16x16x32_bf16 a[52:55], v[140:143], a[8:11], a[52:55]
    ds_read_b64_tr_b16 v[12:13], v245 offset:2048
    v_add_f32 v204, v48, v204
    v_mfma_f32_16x16x32_bf16 a[52:55], v[144:147], a[12:15], a[52:55]
    ds_read_b64_tr_b16 v[14:15], v246 offset:2048
    ds_read_b64_tr_b16 v[16:17], v245 offset:3072
    v_add_f32 v205, v49, v205
    v_mfma_f32_16x16x32_bf16 a[60:63], v[140:143], a[24:27], a[60:63]
    ds_read_b64_tr_b16 v[18:19], v246 offset:3072
    v_add_f32 v206, v50, v206
    v_mfma_f32_16x16x32_bf16 a[60:63], v[144:147], a[28:31], a[60:63]
    ds_write_b128 v239, a[36:39] offset:33792
    v_add_f32 v207, v51, v207
    v_mfma_f32_16x16x32_bf16 a[60:63], v[108:111], a[16:19], a[60:63]
    s_waitcnt lgkmcnt(3)
    v_mfma_f32_16x16x32_bf16 a[60:63], v[112:115], a[20:23], a[60:63]
    global_store_dwordx4 v242, v[12:15], s[24:25] sc0 sc1
    ds_write_b128 v239, a[44:47] offset:41984
    v_mfma_f32_16x16x32_bf16 v[180:183], v[84:87], a[112:115], v[180:183]
    v_mfma_f32_16x16x32_bf16 v[180:183], v[88:91], a[116:119], v[180:183]
    s_waitcnt lgkmcnt(2)
    v_mfma_f32_16x16x32_bf16 v[180:183], v[116:119], a[120:123], v[180:183]
    global_store_dwordx4 v242, v[16:19], s[24:25] offset:2048 sc0 sc1
    ds_write_b128 v239, a[52:55] offset:50176
    v_mfma_f32_16x16x32_bf16 v[180:183], v[120:123], a[124:127], v[180:183]
    v_mfma_f32_16x16x32_bf16 v[188:191], v[116:119], a[88:91], v[188:191]
    v_mfma_f32_16x16x32_bf16 v[188:191], v[120:123], a[92:95], v[188:191]
    ds_write_b128 v239, a[60:63] offset:58368
    v_mfma_f32_16x16x32_bf16 v[188:191], v[84:87], a[80:83], v[188:191]
    v_mfma_f32_16x16x32_bf16 v[188:191], v[88:91], a[84:87], v[188:191]
    s_waitcnt lgkmcnt(0)
    v_mfma_f32_16x16x32_bf16 v[196:199], v[84:87], a[0:3], v[196:199]
    s_barrier
    ds_read_b128 v[68:71], v238 offset:33792
    v_mul_f32 v180, v180, v212
    v_mfma_f32_16x16x32_bf16 v[196:199], v[88:91], a[4:7], v[196:199]
    ds_read_b128 v[72:75], v238 offset:41984
    ds_read_b128 v[76:79], v238 offset:50176
    v_mul_f32 v181, v181, v213
    v_mfma_f32_16x16x32_bf16 v[196:199], v[116:119], a[8:11], v[196:199]
    ds_read_b128 v[80:83], v238 offset:58368
    v_mul_f32 v182, v182, v214
    v_mul_f32 v183, v183, v215
    v_mfma_f32_16x16x32_bf16 v[196:199], v[120:123], a[12:15], v[196:199]
    v_mul_f32 v188, v188, v212
    v_mul_f32 v189, v189, v213
    v_mul_f32 v190, v190, v214
    v_mfma_f32_16x16x32_bf16 v[204:207], v[116:119], a[24:27], v[204:207]
    s_waitcnt lgkmcnt(3)
    v_add_f32 v184, v68, v184
    v_add_f32 v185, v69, v185
    v_add_f32 v186, v70, v186
    v_mfma_f32_16x16x32_bf16 v[204:207], v[120:123], a[28:31], v[204:207]
    v_add_f32 v187, v71, v187
    v_mul_f32 v191, v191, v215
    v_mul_f32 v196, v196, v212
    v_mfma_f32_16x16x32_bf16 v[204:207], v[84:87], a[16:19], v[204:207]
    v_mul_f32 v197, v197, v213
    v_mul_f32 v198, v198, v214
    v_mul_f32 v199, v199, v215
    v_mfma_f32_16x16x32_bf16 v[204:207], v[88:91], a[20:23], v[204:207]
    v_cvt_pk_bf16_f32 v4, v180, v188
    v_cvt_pk_bf16_f32 v6, v181, v189
    v_cvt_pk_bf16_f32 v8, v182, v190
    v_mfma_f32_16x16x32_bf16 v[184:187], v[92:95], a[112:115], v[184:187]
    s_waitcnt lgkmcnt(0)
    v_cvt_pk_bf16_f32 v10, v183, v191
    v_add_f32 v192, v72, v192
    v_add_f32 v193, v73, v193
    v_mfma_f32_16x16x32_bf16 v[184:187], v[96:99], a[116:119], v[184:187]
    v_mul_f32 v204, v204, v212
    v_mul_f32 v205, v205, v213
    v_mul_f32 v206, v206, v214
    v_mfma_f32_16x16x32_bf16 v[184:187], v[124:127], a[120:123], v[184:187]
    v_mul_f32 v207, v207, v215
    v_cvt_pk_bf16_f32 v5, v196, v204
    v_cvt_pk_bf16_f32 v7, v197, v205
    v_mfma_f32_16x16x32_bf16 v[184:187], v[128:131], a[124:127], v[184:187]
    ds_write_b64 v243, v[4:5]
    v_cvt_pk_bf16_f32 v9, v198, v206
    v_cvt_pk_bf16_f32 v11, v199, v207
    v_add_f32 v194, v74, v194
    v_add_f32 v195, v75, v195
    s_nop 1
    v_mfma_f32_16x16x32_bf16 v[192:195], v[124:127], a[88:91], v[192:195]
    ds_write_b64 v243, v[6:7] offset:128
    v_add_f32 v200, v76, v200
    v_add_f32 v201, v77, v201
    v_mfma_f32_16x16x32_bf16 v[192:195], v[128:131], a[92:95], v[192:195]
    ds_write_b64 v244, v[8:9] offset:256
    v_add_f32 v202, v78, v202
    v_add_f32 v203, v79, v203
    v_mfma_f32_16x16x32_bf16 v[192:195], v[92:95], a[80:83], v[192:195]
    ds_write_b64 v244, v[10:11] offset:384
    ds_read_b64_tr_b16 v[4:5], v245
    v_add_f32 v208, v80, v208
    v_mfma_f32_16x16x32_bf16 v[192:195], v[96:99], a[84:87], v[192:195]
    ds_read_b64_tr_b16 v[6:7], v246
    ds_read_b64_tr_b16 v[8:9], v245 offset:1024
    v_add_f32 v209, v81, v209
    v_mfma_f32_16x16x32_bf16 v[200:203], v[92:95], a[0:3], v[200:203]
    ds_read_b64_tr_b16 v[10:11], v246 offset:1024
    v_add_f32 v210, v82, v210
    v_add_f32 v211, v83, v211
    v_mfma_f32_16x16x32_bf16 v[200:203], v[96:99], a[4:7], v[200:203]
    v_mul_f32 v184, v184, v216
    v_mul_f32 v185, v185, v217
    v_mul_f32 v186, v186, v218
    v_mfma_f32_16x16x32_bf16 v[200:203], v[124:127], a[8:11], v[200:203]
    v_mul_f32 v187, v187, v219
    v_mul_f32 v192, v192, v216
    v_mul_f32 v193, v193, v217
    v_mfma_f32_16x16x32_bf16 v[200:203], v[128:131], a[12:15], v[200:203]
    s_waitcnt lgkmcnt(2)
    v_mul_f32 v194, v194, v218
    v_mul_f32 v195, v195, v219
    v_cvt_pk_bf16_f32 v12, v184, v192
    v_mfma_f32_16x16x32_bf16 v[208:211], v[124:127], a[24:27], v[208:211]
    global_store_dwordx4 v242, v[4:7], s[22:23] sc0 sc1
    v_cvt_pk_bf16_f32 v14, v185, v193
    v_cvt_pk_bf16_f32 v16, v186, v194
    v_mfma_f32_16x16x32_bf16 v[208:211], v[128:131], a[28:31], v[208:211]
    v_mul_f32 v200, v200, v216
    v_mul_f32 v201, v201, v217
    v_mul_f32 v202, v202, v218
    v_mfma_f32_16x16x32_bf16 v[208:211], v[92:95], a[16:19], v[208:211]
    v_mul_f32 v203, v203, v219
    v_cvt_pk_bf16_f32 v18, v187, v195
    v_mfma_f32_16x16x32_bf16 v[208:211], v[96:99], a[20:23], v[208:211]
    s_waitcnt lgkmcnt(0)
    global_store_dwordx4 v242, v[8:11], s[22:23] offset:2048 sc0 sc1
    s_nop 5
    v_pk_mul_f32 v[208:209], v[208:209], v[216:217]
    v_pk_mul_f32 v[210:211], v[210:211], v[218:219]
    v_cvt_pk_bf16_f32 v13, v200, v208
    ds_write_b64 v243, v[12:13] offset:2048
    v_cvt_pk_bf16_f32 v15, v201, v209
    ds_write_b64 v243, v[14:15] offset:2176
    v_cvt_pk_bf16_f32 v17, v202, v210
    v_cvt_pk_bf16_f32 v19, v203, v211
    ds_write_b64 v244, v[16:17] offset:2304
    ds_write_b64 v244, v[18:19] offset:2432
    ds_read_b64_tr_b16 v[12:13], v245 offset:2048
    ds_read_b64_tr_b16 v[14:15], v246 offset:2048
    ds_read_b64_tr_b16 v[16:17], v245 offset:3072
    ds_read_b64_tr_b16 v[18:19], v246 offset:3072
    s_waitcnt lgkmcnt(2)
    global_store_dwordx4 v242, v[12:15], s[26:27] sc0 sc1
    s_waitcnt lgkmcnt(0)
    global_store_dwordx4 v242, v[16:19], s[26:27] offset:2048 sc0 sc1
M_done:
M_exit:
    s_endpgm
.section .rodata,"a"
.p2align 6
.amdhsa_kernel standalone__gqa_softmax__near_ridge_kernel
  .amdhsa_next_free_vgpr 504
  .amdhsa_next_free_sgpr 100
  .amdhsa_accum_offset 256
  .amdhsa_group_segment_fixed_size 0
  .amdhsa_kernarg_size 48
  .amdhsa_user_sgpr_count 2
  .amdhsa_user_sgpr_kernarg_segment_ptr 1
  .amdhsa_system_sgpr_workgroup_id_x 1
.end_amdhsa_kernel
```
